```python
import torch

def _softmax(x, axis=-1):
    return torch.softmax(x, dim=axis)
def _gelu(x):
    return torch.nn.functional.gelu(x, approximate="tanh")
def _silu(x):
    return torch.nn.functional.silu(x)
def _sigmoid(x):
    return torch.sigmoid(x)
def _layernorm(x, axis=-1, eps=1e-5):
    m = x.mean(dim=axis, keepdim=True)
    v = x.var(dim=axis, keepdim=True, unbiased=False)
    return (x - m) / torch.sqrt(v + eps)
def _scatter_add(tgt, idx, src, axis=0):
    return tgt.clone().index_add_(axis, idx, src)
def _segment_sum(src, seg, n):
    out = torch.zeros((n,) + src.shape[1:], dtype=src.dtype)
    return out.index_add_(0, seg, src)
def _pad(x, pw):
    flat = tuple(v for pair in reversed(pw) for v in pair)
    return torch.nn.functional.pad(x, flat)

kernel_name = 'parallel_sum__ssm_conv_s4d__dense_activation_relu__prompt'

def setup_inputs():

    _w = (lambda a: (lambda t: t.to(torch.bfloat16) if t.is_floating_point() else t)(torch.as_tensor(a)))
    def _A_setup():
        Bsz, L, D, N = 1, 2048, 576, 128
        return {
            "u": _w((lambda *s: torch.randn(*s, dtype=torch.bfloat16) * 0.05)(Bsz, L, D)),
            "log_A_real": _w((lambda *s: torch.randn(*s, dtype=torch.bfloat16) * 3.2)(D, N) * 0.5),
            "A_imag": _w((lambda *s: torch.randn(*s, dtype=torch.bfloat16) * 0.2)(D, N) * 3.14),
            "C_real": _w((lambda *s: torch.randn(*s, dtype=torch.bfloat16) * 3.2)(D, N) / N ** 0.5),
            "C_imag": _w((lambda *s: torch.randn(*s, dtype=torch.bfloat16) * 3.2)(D, N) / N ** 0.5),
            "log_dt": _w((lambda *s: torch.randn(*s, dtype=torch.bfloat16) * 0.2)(D) * 0.5 - 4.0),
            "D_skip": _w((lambda *s: torch.randn(*s, dtype=torch.bfloat16) * 0.4)(D)),
        }
    _A_in = _A_setup()

    def _B_setup():
        B, S, D, Dff = 1, 2048, 576, 4608
        return {
            "x": _w((lambda *s: torch.randn(*s, dtype=torch.bfloat16) * 0.05)(B, S, D)),
            "w1": _w((lambda *s: torch.randn(*s, dtype=torch.bfloat16) * 0.05)(D, Dff)),
            "w2": _w((lambda *s: torch.randn(*s, dtype=torch.bfloat16) * 0.05)(Dff, D)),
        }
    _B_in = _B_setup()

    return {
        "A_u": _A_in["u"],
        "A_log_A_real": _A_in["log_A_real"],
        "A_A_imag": _A_in["A_imag"],
        "A_C_real": _A_in["C_real"],
        "A_C_imag": _A_in["C_imag"],
        "A_log_dt": _A_in["log_dt"],
        "A_D_skip": _A_in["D_skip"],
        "B_x": _B_in["x"],
        "B_w1": _B_in["w1"],
        "B_w2": _B_in["w2"],
    }

def reference(A_u, A_log_A_real, A_A_imag, A_C_real, A_C_imag, A_log_dt, A_D_skip, B_x, B_w1, B_w2):
    def _A_ref(u, log_A_real, A_imag, C_real, C_imag, log_dt, D_skip):
        L = u.shape[1]
        dt = torch.exp(log_dt)
        A = -torch.exp(log_A_real) + 1j * A_imag
        C = (C_real + 1j * C_imag) * dt[:, None]
        pos = (lambda x, dt: x.to(dt))(torch.arange(L), log_dt.dtype)
        P = torch.exp((A * dt[:, None])[:, :, None] * pos[None, None, :])
        K = 2.0 * torch.einsum("dn,dnl->dl", C, P).real
        L2 = 2 * L
        u_t = (lambda x, *d: x.permute(*d))(u, 0, 2, 1)
        Kf = (lambda x, *a, **k: torch.fft.rfft(x.float(), *a, **k))(K, L2)
        Uf = (lambda x, *a, **k: torch.fft.rfft(x.float(), *a, **k))(u_t, L2)
        y = (lambda x, *a, **k: torch.fft.irfft(x, *a, **k).to(torch.bfloat16))(Uf * Kf[None, :, :], L2)[:, :, :L]
        y = (lambda x, *d: x.permute(*d))(y, 0, 2, 1)
        return y + u * D_skip[None, None, :]

    def _B_ref(x, w1, w2):
        h = torch.einsum("bsd,df->bsf", x, w1)
        zero = torch.zeros_like(h)
        h = torch.maximum(h, zero)
        return torch.einsum("bsf,fd->bsd", h, w2)

    x = A_u
    xn = _layernorm(x, axis=-1)
    return x + _A_ref(xn, A_log_A_real, A_A_imag, A_C_real, A_C_imag, A_log_dt, A_D_skip) + _B_ref(xn, B_w1, B_w2)
```

```asm
; @launch grid=(256,1,1) block=(256,1,1) lds=163840
.amdgcn_target "amdgcn-amd-amdhsa--gfx950"
.text
.globl parallel_sum__ssm_conv_s4d__dense_activation_relu__prompt_kernel
.p2align 8
.type parallel_sum__ssm_conv_s4d__dense_activation_relu__prompt_kernel,@function
parallel_sum__ssm_conv_s4d__dense_activation_relu__prompt_kernel:
L_start:
    s_cmp_ge_u32 s2, 256
    s_cbranch_scc1 L_end
    s_load_dwordx2 s[4:5], s[0:1], 0
    s_load_dwordx2 s[8:9], s[0:1], 64
    s_load_dwordx2 s[12:13], s[0:1], 72
    s_load_dwordx2 s[16:17], s[0:1], 96
    s_load_dwordx2 s[20:21], s[0:1], 80
    s_load_dwordx2 s[24:25], s[0:1], 88
    s_getpc_b64 s[56:57]
L_pc:
    v_lshrrev_b32 v2, 6, v0
    s_lshr_b32 s3, s2, 3
    v_lshl_add_u32 v3, s3, 2, v2
    v_and_b32 v1, 7, v0
    v_lshl_add_u32 v3, v3, 3, v1
    v_lshlrev_b32 v3, 7, v3
    v_min_u32 v3, L_end-L_pc, v3
    global_load_dword v63, v3, s[56:57]
    v_readfirstlane_b32 s28, v2
    v_and_b32 v1, 63, v0
    s_mov_b32 s7, 0x20000
    s_mov_b32 s11, 0x20000
    s_cmp_ge_u32 s3, 24
    s_cbranch_scc1 L_aux
    s_mul_i32 s32, s3, 21846
    s_lshr_b32 s32, s32, 16
    s_and_b32 s29, s2, 4
    s_lshl_b32 s29, s29, 1
    s_add_u32 s29, s29, s32
    s_lshl_b32 s35, s29, 2
    s_add_u32 s35, s35, s28
    s_mul_i32 s35, s35, 36864
    v_lshrrev_b32 v2, 3, v1
    v_mul_u32_u24 v2, 1152, v2
    v_add_u32 v2, s35, v2
    v_lshrrev_b32 v3, 4, v1
    v_xor_b32 v3, v3, v1
    v_and_b32 v3, 7, v3
    v_lshl_add_u32 v4, v3, 4, v2
    v_xor_b32 v3, 4, v3
    v_lshl_add_u32 v5, v3, 4, v2
    v_add_u32 v16, 4096, v4
    v_add_u32 v17, 12288, v5
    v_add_u32 v18, 20480, v4
    v_add_u32 v19, 28672, v5
    s_and_b32 s34, s28, 1
    s_mul_i32 s36, s28, 40960
    s_lshl_b32 s33, s34, 7
    s_add_u32 s36, s36, s33
    s_mov_b32 s6, 2363392
    s_mov_b32 s38, 0
    s_add_u32 m0, s36, 24576
    s_waitcnt lgkmcnt(0)
    s_sub_u32 s4, s4, 4096
    s_subb_u32 s5, s5, 0
    buffer_load_dwordx4 v16, s[4:7], s38 offen offset:0 lds
    buffer_load_dwordx4 v17, s[4:7], s38 offen offset:1024 lds
    buffer_load_dwordx4 v18, s[4:7], s38 offen offset:2048 lds
    buffer_load_dwordx4 v19, s[4:7], s38 offen offset:3072 lds
    s_mul_i32 s33, s32, 3
    s_sub_u32 s30, s3, s33
    s_and_b32 s31, s2, 3
    s_mul_i32 s33, s31, 3
    s_add_u32 s39, s33, s30
    s_mul_i32 s33, s39, 768
    s_mul_i32 s32, s28, 73728
    s_add_u32 s33, s33, s32
    s_add_u32 s33, s33, 4096
    s_lshl_b32 s34, s34, 2
    s_mov_b32 s10, 5312512
    s_mov_b32 s37, 0
    s_sub_u32 s8, s8, 4096
    s_subb_u32 s9, s9, 0
    s_mov_b32 m0, s36
    v_add_u32 v2, 0, v1
    v_mul_u32_u24 v3, 2731, v2
    v_lshrrev_b32 v3, 16, v3
    v_mul_u32_u24 v4, 24, v3
    v_sub_u32 v4, v2, v4
    v_and_or_b32 v5, v3, 2, s34
    v_xor_b32 v4, v4, v5
    v_mul_u32_u24 v3, 9216, v3
    v_lshl_add_u32 v4, v4, 4, v3
    v_add_u32 v4, s33, v4
    v_subrev_u32 v10, 0, v4
    buffer_load_dwordx4 v10, s[8:11], s37 offen offset:0 lds
    v_add_u32 v13, 291840, v4
    v_add_u32 v2, 64, v1
    v_mul_u32_u24 v3, 2731, v2
    v_lshrrev_b32 v3, 16, v3
    v_mul_u32_u24 v4, 24, v3
    v_sub_u32 v4, v2, v4
    v_and_or_b32 v5, v3, 2, s34
    v_xor_b32 v4, v4, v5
    v_mul_u32_u24 v3, 9216, v3
    v_lshl_add_u32 v4, v4, 4, v3
    v_add_u32 v4, s33, v4
    v_subrev_u32 v11, 1024, v4
    buffer_load_dwordx4 v11, s[8:11], s37 offen offset:1024 lds
    v_add_u32 v14, 294912, v4
    v_add_u32 v2, 128, v1
    v_mul_u32_u24 v3, 2731, v2
    v_lshrrev_b32 v3, 16, v3
    v_mul_u32_u24 v4, 24, v3
    v_sub_u32 v4, v2, v4
    v_and_or_b32 v5, v3, 2, s34
    v_xor_b32 v4, v4, v5
    v_mul_u32_u24 v3, 9216, v3
    v_lshl_add_u32 v4, v4, 4, v3
    v_add_u32 v4, s33, v4
    v_subrev_u32 v12, 2048, v4
    buffer_load_dwordx4 v12, s[8:11], s37 offen offset:2048 lds
    v_add_u32 v15, 293888, v4
    buffer_load_dwordx4 v13, s[8:11], s37 offen offset:3072 lds
    s_add_u32 m0, s36, 4096
    s_mov_b64 s[0:1], s[56:57]
    buffer_load_dwordx4 v14, s[8:11], s37 offen offset:0 lds
    buffer_load_dwordx4 v15, s[8:11], s37 offen offset:1024 lds
    s_mov_b32 s15, 0x20000
    s_mov_b32 s19, 0x20000
    s_mov_b32 s23, 0x20000
    s_mov_b32 s27, 0x20000
    s_mov_b32 s18, 0x10000000
    s_mov_b32 s22, 2359296
    s_mov_b32 s26, 256
    s_cmp_eq_u32 s28, 0
    s_cselect_b64 s[100:101], -1, 0
    s_mov_b32 s14, 5312512
    s_sub_u32 s12, s12, 4096
    s_subb_u32 s13, s13, 0
    v_lshrrev_b32 v4, 4, v1
    v_bfe_u32 v5, v1, 2, 2
    v_and_b32 v6, 3, v1
    v_lshlrev_b32 v6, 3, v6
    v_mov_b32 v7, 40960
    v_mad_u32_u24 v6, v4, v7, v6
    v_and_b32 v7, 1, v4
    v_lshl_add_u32 v6, v7, 7, v6
    v_lshrrev_b32 v8, 1, v5
    v_lshl_or_b32 v8, v7, 1, v8
    v_mul_u32_u24 v9, 384, v5
    v_add_u32 v9, v9, v6
    v_xor_b32 v2, 0, v8
    v_lshl_add_u32 v20, v2, 5, v9
    v_xor_b32 v2, 1, v8
    v_lshl_add_u32 v21, v2, 5, v9
    v_xor_b32 v2, 2, v8
    v_lshl_add_u32 v22, v2, 5, v9
    v_xor_b32 v2, 3, v8
    v_lshl_add_u32 v23, v2, 5, v9
    v_and_b32 v2, 15, v1
    v_lshrrev_b32 v8, 1, v2
    v_xor_b32 v8, v8, v4
    v_lshlrev_b32 v2, 7, v2
    s_add_u32 s32, s36, 24576
    v_add_u32 v2, s32, v2
    v_lshl_add_u32 v24, v8, 4, v2
    v_xor_b32 v8, 4, v8
    v_lshl_add_u32 v25, v8, 4, v2
    v_lshlrev_b32 v38, 4, v1
    s_add_u32 s32, s36, 36864
    v_lshl_add_u32 v39, v4, 4, s32
    v_subrev_u32 v2, 4, v1
    v_min_u32 v2, 5, v2
    s_lshl_b32 s32, s39, 7
    s_add_u32 s32, s32, 55296
    v_lshl_add_u32 v2, v2, 2, s32
    s_lshl_b32 s32, s29, 7
    s_add_u32 s32, s32, 53248
    v_lshl_add_u32 v3, v1, 2, s32
    v_cmp_gt_u32 vcc, 4, v1
    s_nop 1
    v_cndmask_b32 v2, v2, v3, vcc
    v_mov_b32 v3, 2147483632
    v_cmp_gt_u32 vcc, 64, v0
    s_nop 1
    v_cndmask_b32 v7, v3, v2, vcc
    buffer_load_dword v6, v7, s[16:19], 0 offen sc1
    s_mul_i32 s33, s31, 1327104
    s_lshl_b32 s46, s29, 2
    s_add_u32 s46, s46, s31
    s_mul_i32 s34, s46, 3
    s_mov_b32 s48, s30
    s_mul_i32 s40, s48, 442368
    s_add_u32 s40, s40, s33
    s_add_u32 s49, s34, s48
    s_lshl_b32 s49, s49, 2
    s_add_u32 s49, s49, s28
    s_mul_i32 s49, s49, 24576
    s_add_u32 s43, s49, 4784128
    s_add_u32 s48, s48, 1
    s_cmp_eq_u32 s48, 3
    s_cselect_b32 s48, 0, s48
    s_mul_i32 s41, s48, 442368
    s_add_u32 s41, s41, s33
    s_add_u32 s49, s34, s48
    s_lshl_b32 s49, s49, 2
    s_add_u32 s49, s49, s28
    s_mul_i32 s49, s49, 24576
    s_add_u32 s44, s49, 4784128
    s_add_u32 s48, s48, 1
    s_cmp_eq_u32 s48, 3
    s_cselect_b32 s48, 0, s48
    s_mul_i32 s42, s48, 442368
    s_add_u32 s42, s42, s33
    s_add_u32 s49, s34, s48
    s_lshl_b32 s49, s49, 2
    s_add_u32 s49, s49, s28
    s_mul_i32 s49, s49, 24576
    s_add_u32 s45, s49, 4784128
    s_lshl_b32 s46, s46, 7
    s_mul_i32 s47, s29, 3
    s_add_u32 s47, s47, s30
    s_mul_i32 s50, s47, 196608
    s_add_u32 s50, s50, 23658496
    s_lshl_b32 s47, s47, 7
    s_add_u32 s47, s47, 8192
    s_mov_b32 s58, 0xffff0000
    s_mul_i32 s33, s30, 384
    s_mul_i32 s34, s28, 4608
    s_add_u32 s33, s33, s34
    s_add_u32 s33, s33, 4096
    s_and_b32 s34, s28, 1
    s_lshl_b32 s34, s34, 2
    v_add_u32 v2, 0, v1
    v_mul_u32_u24 v3, 2731, v2
    v_lshrrev_b32 v3, 16, v3
    v_mul_u32_u24 v5, 24, v3
    v_sub_u32 v5, v2, v5
    v_and_or_b32 v4, v3, 2, s34
    v_xor_b32 v5, v5, v4
    v_lshrrev_b32 v4, 2, v3
    v_and_b32 v3, 3, v3
    v_lshl_add_u32 v3, v4, 4, v3
    v_mul_u32_u24 v3, 1152, v3
    v_lshl_add_u32 v5, v5, 4, v3
    v_add_u32 v5, s33, v5
    v_subrev_u32 v26, 0, v5
    v_add_u32 v29, 33792, v5
    v_add_u32 v2, 64, v1
    v_mul_u32_u24 v3, 2731, v2
    v_lshrrev_b32 v3, 16, v3
    v_mul_u32_u24 v5, 24, v3
    v_sub_u32 v5, v2, v5
    v_and_or_b32 v4, v3, 2, s34
    v_xor_b32 v5, v5, v4
    v_lshrrev_b32 v4, 2, v3
    v_and_b32 v3, 3, v3
    v_lshl_add_u32 v3, v4, 4, v3
    v_mul_u32_u24 v3, 1152, v3
    v_lshl_add_u32 v5, v5, 4, v3
    v_add_u32 v5, s33, v5
    v_subrev_u32 v27, 1024, v5
    v_add_u32 v30, 36864, v5
    v_add_u32 v2, 128, v1
    v_mul_u32_u24 v3, 2731, v2
    v_lshrrev_b32 v3, 16, v3
    v_mul_u32_u24 v5, 24, v3
    v_sub_u32 v5, v2, v5
    v_and_or_b32 v4, v3, 2, s34
    v_xor_b32 v5, v5, v4
    v_lshrrev_b32 v4, 2, v3
    v_and_b32 v3, 3, v3
    v_lshl_add_u32 v3, v4, 4, v3
    v_mul_u32_u24 v3, 1152, v3
    v_lshl_add_u32 v5, v5, 4, v3
    v_add_u32 v5, s33, v5
    v_subrev_u32 v28, 2048, v5
    v_add_u32 v31, 35840, v5
    v_min_u32 v2, 53, v1
    v_mul_u32_u24 v3, 171, v2
    v_lshrrev_b32 v3, 9, v3
    v_mul_u32_u24 v4, 3, v3
    v_sub_u32 v2, v2, v4
    v_mul_u32_u24 v3, 1152, v3
    v_lshl_add_u32 v56, v2, 7, v3
    s_lshl_b32 s56, s29, 2
    s_add_u32 s56, s56, s28
    s_mul_i32 s56, s56, 18
    s_mul_i32 s57, s31, 1152
    s_add_u32 s56, s56, s57
    s_mul_i32 s56, s56, 1152
    s_mul_i32 s57, s30, 384
    s_add_u32 s56, s56, s57
    s_add_u32 s56, s56, 4096
    s_add_u32 s37, s37, 589824
    s_add_u32 m0, s36, 6144
    s_nop 0
    buffer_load_dwordx4 v10, s[8:11], s37 offen offset:0 lds
    buffer_load_dwordx4 v11, s[8:11], s37 offen offset:1024 lds
    buffer_load_dwordx4 v12, s[8:11], s37 offen offset:2048 lds
    buffer_load_dwordx4 v13, s[8:11], s37 offen offset:3072 lds
    s_add_u32 m0, s36, 10240
    s_nop 0
    buffer_load_dwordx4 v14, s[8:11], s37 offen offset:0 lds
    buffer_load_dwordx4 v15, s[8:11], s37 offen offset:1024 lds
    s_add_u32 s38, s38, 128
    s_add_u32 m0, s36, 28672
    s_nop 0
    buffer_load_dwordx4 v16, s[4:7], s38 offen offset:0 lds
    buffer_load_dwordx4 v17, s[4:7], s38 offen offset:1024 lds
    buffer_load_dwordx4 v18, s[4:7], s38 offen offset:2048 lds
    buffer_load_dwordx4 v19, s[4:7], s38 offen offset:3072 lds
    s_waitcnt vmcnt(11)
    s_barrier
    ds_read_b128 a[36:39], v24 offset:0
    ds_read_b128 a[40:43], v24 offset:2048
    ds_read_b128 a[44:47], v25 offset:0
    ds_read_b128 a[48:51], v25 offset:2048
    ds_read_b64_tr_b16 a[0:1], v20 offset:0
    ds_read_b64_tr_b16 a[2:3], v20 offset:1536
    ds_read_b64_tr_b16 a[4:5], v21 offset:0
    ds_read_b64_tr_b16 a[6:7], v21 offset:1536
    ds_read_b64_tr_b16 a[8:9], v22 offset:0
    ds_read_b64_tr_b16 a[10:11], v22 offset:1536
    ds_read_b64_tr_b16 a[12:13], v23 offset:0
    ds_read_b64_tr_b16 a[14:15], v23 offset:1536
    ds_read_b64_tr_b16 a[16:17], v20 offset:128
    ds_read_b64_tr_b16 a[18:19], v20 offset:1664
    ds_read_b64_tr_b16 a[20:21], v21 offset:128
    ds_read_b64_tr_b16 a[22:23], v21 offset:1664
    s_waitcnt lgkmcnt(4)
L_stage0:
    v_mfma_f32_16x16x32_bf16 v[64:67], a[0:3], a[36:39], 0
    ds_read_b64_tr_b16 a[24:25], v22 offset:128
    s_add_u32 s37, s37, 589824
    v_mfma_f32_16x16x32_bf16 v[72:75], a[0:3], a[40:43], 0
    ds_read_b64_tr_b16 a[26:27], v22 offset:1664
    s_add_u32 m0, s36, 12288
    v_mfma_f32_16x16x32_bf16 v[76:79], a[4:7], a[40:43], 0
    ds_read_b64_tr_b16 a[0:1], v23 offset:128
    buffer_load_dwordx4 v10, s[8:11], s37 offen offset:0 lds
    v_mfma_f32_16x16x32_bf16 v[68:71], a[4:7], a[36:39], 0
    ds_read_b64_tr_b16 a[2:3], v23 offset:1664
    v_mfma_f32_16x16x32_bf16 v[80:83], a[8:11], a[36:39], 0
    ds_read_b64_tr_b16 a[4:5], v20 offset:256
    v_mfma_f32_16x16x32_bf16 v[88:91], a[8:11], a[40:43], 0
    ds_read_b64_tr_b16 a[6:7], v20 offset:1792
    v_mfma_f32_16x16x32_bf16 v[92:95], a[12:15], a[40:43], 0
    ds_read_b64_tr_b16 a[8:9], v21 offset:256
    buffer_load_dwordx4 v11, s[8:11], s37 offen offset:1024 lds
    v_mfma_f32_16x16x32_bf16 v[84:87], a[12:15], a[36:39], 0
    ds_read_b64_tr_b16 a[10:11], v21 offset:1792
    s_waitcnt lgkmcnt(4)
    v_mfma_f32_16x16x32_bf16 v[96:99], a[16:19], a[36:39], 0
    ds_read_b64_tr_b16 a[12:13], v22 offset:256
    v_mfma_f32_16x16x32_bf16 v[104:107], a[16:19], a[40:43], 0
    ds_read_b64_tr_b16 a[14:15], v22 offset:1792
    v_mfma_f32_16x16x32_bf16 v[108:111], a[20:23], a[40:43], 0
    ds_read_b64_tr_b16 a[16:17], v23 offset:256
    buffer_load_dwordx4 v12, s[8:11], s37 offen offset:2048 lds
    v_mfma_f32_16x16x32_bf16 v[100:103], a[20:23], a[36:39], 0
    ds_read_b64_tr_b16 a[18:19], v23 offset:1792
    v_mfma_f32_16x16x32_bf16 v[112:115], a[24:27], a[36:39], 0
    ds_read_b64_tr_b16 a[20:21], v20 offset:3072
    v_mfma_f32_16x16x32_bf16 v[120:123], a[24:27], a[40:43], 0
    ds_read_b64_tr_b16 a[22:23], v20 offset:4608
    v_mfma_f32_16x16x32_bf16 v[124:127], a[0:3], a[40:43], 0
    ds_read_b64_tr_b16 a[24:25], v21 offset:3072
    buffer_load_dwordx4 v13, s[8:11], s37 offen offset:3072 lds
    v_mfma_f32_16x16x32_bf16 v[116:119], a[0:3], a[36:39], 0
    ds_read_b64_tr_b16 a[26:27], v21 offset:4608
    s_waitcnt lgkmcnt(4)
    v_mfma_f32_16x16x32_bf16 v[128:131], a[4:7], a[36:39], 0
    ds_read_b64_tr_b16 a[0:1], v22 offset:3072
    s_add_u32 m0, s36, 16384
    v_mfma_f32_16x16x32_bf16 v[136:139], a[4:7], a[40:43], 0
    ds_read_b64_tr_b16 a[2:3], v22 offset:4608
    v_mfma_f32_16x16x32_bf16 v[140:143], a[8:11], a[40:43], 0
    ds_read_b64_tr_b16 a[4:5], v23 offset:3072
    buffer_load_dwordx4 v14, s[8:11], s37 offen offset:0 lds
    v_mfma_f32_16x16x32_bf16 v[132:135], a[8:11], a[36:39], 0
    ds_read_b64_tr_b16 a[6:7], v23 offset:4608
    v_mfma_f32_16x16x32_bf16 v[144:147], a[12:15], a[36:39], 0
    ds_read_b64_tr_b16 a[8:9], v20 offset:3200
    v_mfma_f32_16x16x32_bf16 v[152:155], a[12:15], a[40:43], 0
    ds_read_b64_tr_b16 a[10:11], v20 offset:4736
    v_mfma_f32_16x16x32_bf16 v[156:159], a[16:19], a[40:43], 0
    ds_read_b64_tr_b16 a[12:13], v21 offset:3200
    buffer_load_dwordx4 v15, s[8:11], s37 offen offset:1024 lds
    v_mfma_f32_16x16x32_bf16 v[148:151], a[16:19], a[36:39], 0
    ds_read_b64_tr_b16 a[14:15], v21 offset:4736
    s_waitcnt lgkmcnt(4)
    v_mfma_f32_16x16x32_bf16 v[64:67], a[20:23], a[44:47], v[64:67]
    ds_read_b64_tr_b16 a[16:17], v22 offset:3200
    s_add_u32 s38, s38, 128
    v_mfma_f32_16x16x32_bf16 v[72:75], a[20:23], a[48:51], v[72:75]
    ds_read_b64_tr_b16 a[18:19], v22 offset:4736
    s_add_u32 m0, s36, 32768
    v_mfma_f32_16x16x32_bf16 v[76:79], a[24:27], a[48:51], v[76:79]
    ds_read_b64_tr_b16 a[20:21], v23 offset:3200
    v_mfma_f32_16x16x32_bf16 v[68:71], a[24:27], a[44:47], v[68:71]
    ds_read_b64_tr_b16 a[22:23], v23 offset:4736
    buffer_load_dwordx4 v16, s[4:7], s38 offen offset:0 lds
    v_mfma_f32_16x16x32_bf16 v[80:83], a[0:3], a[44:47], v[80:83]
    ds_read_b64_tr_b16 a[24:25], v20 offset:3328
    v_mfma_f32_16x16x32_bf16 v[88:91], a[0:3], a[48:51], v[88:91]
    ds_read_b64_tr_b16 a[26:27], v20 offset:4864
    v_mfma_f32_16x16x32_bf16 v[92:95], a[4:7], a[48:51], v[92:95]
    ds_read_b64_tr_b16 a[0:1], v21 offset:3328
    v_mfma_f32_16x16x32_bf16 v[84:87], a[4:7], a[44:47], v[84:87]
    ds_read_b64_tr_b16 a[2:3], v21 offset:4864
    s_waitcnt vmcnt(7) lgkmcnt(4)
    v_mfma_f32_16x16x32_bf16 v[96:99], a[8:11], a[44:47], v[96:99]
    ds_read_b64_tr_b16 a[4:5], v22 offset:3328
    buffer_load_dwordx4 v17, s[4:7], s38 offen offset:1024 lds
    v_mfma_f32_16x16x32_bf16 v[104:107], a[8:11], a[48:51], v[104:107]
    ds_read_b64_tr_b16 a[6:7], v22 offset:4864
    v_mfma_f32_16x16x32_bf16 v[108:111], a[12:15], a[48:51], v[108:111]
    ds_read_b64_tr_b16 a[8:9], v23 offset:3328
    v_mfma_f32_16x16x32_bf16 v[100:103], a[12:15], a[44:47], v[100:103]
    ds_read_b64_tr_b16 a[10:11], v23 offset:4864
    s_barrier
    v_mfma_f32_16x16x32_bf16 v[112:115], a[16:19], a[44:47], v[112:115]
    ds_read_b64_tr_b16 a[12:13], v20 offset:6144
    ds_read_b128 a[52:55], v24 offset:4096
    v_mfma_f32_16x16x32_bf16 v[120:123], a[16:19], a[48:51], v[120:123]
    ds_read_b64_tr_b16 a[14:15], v20 offset:7680
    ds_read_b128 a[56:59], v24 offset:6144
    v_mfma_f32_16x16x32_bf16 v[124:127], a[20:23], a[48:51], v[124:127]
    ds_read_b64_tr_b16 a[16:17], v21 offset:6144
    ds_read_b128 a[60:63], v25 offset:4096
    v_mfma_f32_16x16x32_bf16 v[116:119], a[20:23], a[44:47], v[116:119]
    ds_read_b64_tr_b16 a[18:19], v21 offset:7680
    s_waitcnt lgkmcnt(7)
    v_mfma_f32_16x16x32_bf16 v[128:131], a[24:27], a[44:47], v[128:131]
    ds_read_b64_tr_b16 a[20:21], v22 offset:6144
    ds_read_b128 a[64:67], v25 offset:6144
    v_mfma_f32_16x16x32_bf16 v[136:139], a[24:27], a[48:51], v[136:139]
    ds_read_b64_tr_b16 a[22:23], v22 offset:7680
    buffer_load_dwordx4 v18, s[4:7], s38 offen offset:2048 lds
    v_mfma_f32_16x16x32_bf16 v[140:143], a[0:3], a[48:51], v[140:143]
    ds_read_b64_tr_b16 a[24:25], v23 offset:6144
    v_mfma_f32_16x16x32_bf16 v[132:135], a[0:3], a[44:47], v[132:135]
    ds_read_b64_tr_b16 a[26:27], v23 offset:7680
    v_mfma_f32_16x16x32_bf16 v[144:147], a[4:7], a[44:47], v[144:147]
    ds_read_b64_tr_b16 a[0:1], v20 offset:6272
    v_mfma_f32_16x16x32_bf16 v[152:155], a[4:7], a[48:51], v[152:155]
    ds_read_b64_tr_b16 a[2:3], v20 offset:7808
    buffer_load_dwordx4 v19, s[4:7], s38 offen offset:3072 lds
    v_mfma_f32_16x16x32_bf16 v[156:159], a[8:11], a[48:51], v[156:159]
    ds_read_b64_tr_b16 a[4:5], v21 offset:6272
    v_mfma_f32_16x16x32_bf16 v[148:151], a[8:11], a[44:47], v[148:151]
    ds_read_b64_tr_b16 a[6:7], v21 offset:7808
    s_waitcnt lgkmcnt(4)
L_stage1:
    v_mfma_f32_16x16x32_bf16 v[64:67], a[12:15], a[52:55], v[64:67]
    ds_read_b64_tr_b16 a[8:9], v22 offset:6272
    s_add_u32 s37, s37, 589824
    v_mfma_f32_16x16x32_bf16 v[72:75], a[12:15], a[56:59], v[72:75]
    ds_read_b64_tr_b16 a[10:11], v22 offset:7808
    s_add_u32 m0, s36, 18432
    v_mfma_f32_16x16x32_bf16 v[76:79], a[16:19], a[56:59], v[76:79]
    ds_read_b64_tr_b16 a[12:13], v23 offset:6272
    buffer_load_dwordx4 v10, s[8:11], s37 offen offset:0 lds
    v_mfma_f32_16x16x32_bf16 v[68:71], a[16:19], a[52:55], v[68:71]
    ds_read_b64_tr_b16 a[14:15], v23 offset:7808
    v_mfma_f32_16x16x32_bf16 v[80:83], a[20:23], a[52:55], v[80:83]
    ds_read_b64_tr_b16 a[16:17], v20 offset:6400
    v_mfma_f32_16x16x32_bf16 v[88:91], a[20:23], a[56:59], v[88:91]
    ds_read_b64_tr_b16 a[18:19], v20 offset:7936
    v_mfma_f32_16x16x32_bf16 v[92:95], a[24:27], a[56:59], v[92:95]
    ds_read_b64_tr_b16 a[20:21], v21 offset:6400
    buffer_load_dwordx4 v11, s[8:11], s37 offen offset:1024 lds
    v_mfma_f32_16x16x32_bf16 v[84:87], a[24:27], a[52:55], v[84:87]
    ds_read_b64_tr_b16 a[22:23], v21 offset:7936
    s_waitcnt lgkmcnt(4)
    v_mfma_f32_16x16x32_bf16 v[96:99], a[0:3], a[52:55], v[96:99]
    ds_read_b64_tr_b16 a[24:25], v22 offset:6400
    v_mfma_f32_16x16x32_bf16 v[104:107], a[0:3], a[56:59], v[104:107]
    ds_read_b64_tr_b16 a[26:27], v22 offset:7936
    v_mfma_f32_16x16x32_bf16 v[108:111], a[4:7], a[56:59], v[108:111]
    ds_read_b64_tr_b16 a[0:1], v23 offset:6400
    buffer_load_dwordx4 v12, s[8:11], s37 offen offset:2048 lds
    v_mfma_f32_16x16x32_bf16 v[100:103], a[4:7], a[52:55], v[100:103]
    ds_read_b64_tr_b16 a[2:3], v23 offset:7936
    v_mfma_f32_16x16x32_bf16 v[112:115], a[8:11], a[52:55], v[112:115]
    ds_read_b64_tr_b16 a[4:5], v20 offset:9216
    v_mfma_f32_16x16x32_bf16 v[120:123], a[8:11], a[56:59], v[120:123]
    ds_read_b64_tr_b16 a[6:7], v20 offset:10752
    v_mfma_f32_16x16x32_bf16 v[124:127], a[12:15], a[56:59], v[124:127]
    ds_read_b64_tr_b16 a[8:9], v21 offset:9216
    buffer_load_dwordx4 v13, s[8:11], s37 offen offset:3072 lds
    v_mfma_f32_16x16x32_bf16 v[116:119], a[12:15], a[52:55], v[116:119]
    ds_read_b64_tr_b16 a[10:11], v21 offset:10752
    s_waitcnt lgkmcnt(4)
    v_mfma_f32_16x16x32_bf16 v[128:131], a[16:19], a[52:55], v[128:131]
    ds_read_b64_tr_b16 a[12:13], v22 offset:9216
    s_add_u32 m0, s36, 22528
    v_mfma_f32_16x16x32_bf16 v[136:139], a[16:19], a[56:59], v[136:139]
    ds_read_b64_tr_b16 a[14:15], v22 offset:10752
    v_mfma_f32_16x16x32_bf16 v[140:143], a[20:23], a[56:59], v[140:143]
    ds_read_b64_tr_b16 a[16:17], v23 offset:9216
    buffer_load_dwordx4 v14, s[8:11], s37 offen offset:0 lds
    v_mfma_f32_16x16x32_bf16 v[132:135], a[20:23], a[52:55], v[132:135]
    ds_read_b64_tr_b16 a[18:19], v23 offset:10752
    v_mfma_f32_16x16x32_bf16 v[144:147], a[24:27], a[52:55], v[144:147]
    ds_read_b64_tr_b16 a[20:21], v20 offset:9344
    v_mfma_f32_16x16x32_bf16 v[152:155], a[24:27], a[56:59], v[152:155]
    ds_read_b64_tr_b16 a[22:23], v20 offset:10880
    v_mfma_f32_16x16x32_bf16 v[156:159], a[0:3], a[56:59], v[156:159]
    ds_read_b64_tr_b16 a[24:25], v21 offset:9344
    buffer_load_dwordx4 v15, s[8:11], s37 offen offset:1024 lds
    v_mfma_f32_16x16x32_bf16 v[148:151], a[0:3], a[52:55], v[148:151]
    ds_read_b64_tr_b16 a[26:27], v21 offset:10880
    s_waitcnt lgkmcnt(4)
    v_mfma_f32_16x16x32_bf16 v[64:67], a[4:7], a[60:63], v[64:67]
    ds_read_b64_tr_b16 a[0:1], v22 offset:9344
    s_add_u32 s38, s38, 128
    v_mfma_f32_16x16x32_bf16 v[72:75], a[4:7], a[64:67], v[72:75]
    ds_read_b64_tr_b16 a[2:3], v22 offset:10880
    s_add_u32 m0, s36, 24576
    v_mfma_f32_16x16x32_bf16 v[76:79], a[8:11], a[64:67], v[76:79]
    ds_read_b64_tr_b16 a[4:5], v23 offset:9344
    v_mfma_f32_16x16x32_bf16 v[68:71], a[8:11], a[60:63], v[68:71]
    ds_read_b64_tr_b16 a[6:7], v23 offset:10880
    buffer_load_dwordx4 v16, s[4:7], s38 offen offset:0 lds
    v_mfma_f32_16x16x32_bf16 v[80:83], a[12:15], a[60:63], v[80:83]
    ds_read_b64_tr_b16 a[8:9], v20 offset:9472
    v_mfma_f32_16x16x32_bf16 v[88:91], a[12:15], a[64:67], v[88:91]
    ds_read_b64_tr_b16 a[10:11], v20 offset:11008
    v_mfma_f32_16x16x32_bf16 v[92:95], a[16:19], a[64:67], v[92:95]
    ds_read_b64_tr_b16 a[12:13], v21 offset:9472
    v_mfma_f32_16x16x32_bf16 v[84:87], a[16:19], a[60:63], v[84:87]
    ds_read_b64_tr_b16 a[14:15], v21 offset:11008
    s_waitcnt vmcnt(7) lgkmcnt(4)
    v_mfma_f32_16x16x32_bf16 v[96:99], a[20:23], a[60:63], v[96:99]
    ds_read_b64_tr_b16 a[16:17], v22 offset:9472
    buffer_load_dwordx4 v17, s[4:7], s38 offen offset:1024 lds
    v_mfma_f32_16x16x32_bf16 v[104:107], a[20:23], a[64:67], v[104:107]
    ds_read_b64_tr_b16 a[18:19], v22 offset:11008
    v_mfma_f32_16x16x32_bf16 v[108:111], a[24:27], a[64:67], v[108:111]
    ds_read_b64_tr_b16 a[20:21], v23 offset:9472
    v_mfma_f32_16x16x32_bf16 v[100:103], a[24:27], a[60:63], v[100:103]
    ds_read_b64_tr_b16 a[22:23], v23 offset:11008
    s_barrier
    v_mfma_f32_16x16x32_bf16 v[112:115], a[0:3], a[60:63], v[112:115]
    ds_read_b64_tr_b16 a[24:25], v20 offset:12288
    ds_read_b128 a[68:71], v24 offset:8192
    v_mfma_f32_16x16x32_bf16 v[120:123], a[0:3], a[64:67], v[120:123]
    ds_read_b64_tr_b16 a[26:27], v20 offset:13824
    ds_read_b128 a[72:75], v24 offset:10240
    v_mfma_f32_16x16x32_bf16 v[124:127], a[4:7], a[64:67], v[124:127]
    ds_read_b64_tr_b16 a[0:1], v21 offset:12288
    ds_read_b128 a[76:79], v25 offset:8192
    v_mfma_f32_16x16x32_bf16 v[116:119], a[4:7], a[60:63], v[116:119]
    ds_read_b64_tr_b16 a[2:3], v21 offset:13824
    s_waitcnt lgkmcnt(7)
    v_mfma_f32_16x16x32_bf16 v[128:131], a[8:11], a[60:63], v[128:131]
    ds_read_b64_tr_b16 a[4:5], v22 offset:12288
    ds_read_b128 a[80:83], v25 offset:10240
    v_mfma_f32_16x16x32_bf16 v[136:139], a[8:11], a[64:67], v[136:139]
    ds_read_b64_tr_b16 a[6:7], v22 offset:13824
    buffer_load_dwordx4 v18, s[4:7], s38 offen offset:2048 lds
    v_mfma_f32_16x16x32_bf16 v[140:143], a[12:15], a[64:67], v[140:143]
    ds_read_b64_tr_b16 a[8:9], v23 offset:12288
    v_mfma_f32_16x16x32_bf16 v[132:135], a[12:15], a[60:63], v[132:135]
    ds_read_b64_tr_b16 a[10:11], v23 offset:13824
    v_mfma_f32_16x16x32_bf16 v[144:147], a[16:19], a[60:63], v[144:147]
    ds_read_b64_tr_b16 a[12:13], v20 offset:12416
    v_mfma_f32_16x16x32_bf16 v[152:155], a[16:19], a[64:67], v[152:155]
    ds_read_b64_tr_b16 a[14:15], v20 offset:13952
    buffer_load_dwordx4 v19, s[4:7], s38 offen offset:3072 lds
    v_mfma_f32_16x16x32_bf16 v[156:159], a[20:23], a[64:67], v[156:159]
    ds_read_b64_tr_b16 a[16:17], v21 offset:12416
    v_mfma_f32_16x16x32_bf16 v[148:151], a[20:23], a[60:63], v[148:151]
    ds_read_b64_tr_b16 a[18:19], v21 offset:13952
    s_waitcnt lgkmcnt(4)
L_stage2:
    v_mfma_f32_16x16x32_bf16 v[64:67], a[24:27], a[68:71], v[64:67]
    ds_read_b64_tr_b16 a[20:21], v22 offset:12416
    s_add_u32 s37, s37, 589824
    v_mfma_f32_16x16x32_bf16 v[72:75], a[24:27], a[72:75], v[72:75]
    ds_read_b64_tr_b16 a[22:23], v22 offset:13952
    s_add_u32 m0, s36, 0
    v_mfma_f32_16x16x32_bf16 v[76:79], a[0:3], a[72:75], v[76:79]
    ds_read_b64_tr_b16 a[24:25], v23 offset:12416
    buffer_load_dwordx4 v10, s[8:11], s37 offen offset:0 lds
    v_mfma_f32_16x16x32_bf16 v[68:71], a[0:3], a[68:71], v[68:71]
    ds_read_b64_tr_b16 a[26:27], v23 offset:13952
    buffer_load_dwordx4 v11, s[8:11], s37 offen offset:1024 lds
    v_mfma_f32_16x16x32_bf16 v[80:83], a[4:7], a[68:71], v[80:83]
    ds_read_b64_tr_b16 a[0:1], v20 offset:12544
    buffer_load_dwordx4 v12, s[8:11], s37 offen offset:2048 lds
    v_mfma_f32_16x16x32_bf16 v[88:91], a[4:7], a[72:75], v[88:91]
    ds_read_b64_tr_b16 a[2:3], v20 offset:14080
    v_mfma_f32_16x16x32_bf16 v[92:95], a[8:11], a[72:75], v[92:95]
    ds_read_b64_tr_b16 a[4:5], v21 offset:12544
    buffer_load_dwordx4 v13, s[8:11], s37 offen offset:3072 lds
    v_mfma_f32_16x16x32_bf16 v[84:87], a[8:11], a[68:71], v[84:87]
    ds_read_b64_tr_b16 a[6:7], v21 offset:14080
    s_waitcnt lgkmcnt(4)
    v_mfma_f32_16x16x32_bf16 v[96:99], a[12:15], a[68:71], v[96:99]
    ds_read_b64_tr_b16 a[8:9], v22 offset:12544
    s_add_u32 m0, s36, 4096
    v_mfma_f32_16x16x32_bf16 v[104:107], a[12:15], a[72:75], v[104:107]
    ds_read_b64_tr_b16 a[10:11], v22 offset:14080
    buffer_load_dwordx4 v14, s[8:11], s37 offen offset:0 lds
    v_mfma_f32_16x16x32_bf16 v[108:111], a[16:19], a[72:75], v[108:111]
    ds_read_b64_tr_b16 a[12:13], v23 offset:12544
    v_mfma_f32_16x16x32_bf16 v[100:103], a[16:19], a[68:71], v[100:103]
    ds_read_b64_tr_b16 a[14:15], v23 offset:14080
    buffer_load_dwordx4 v15, s[8:11], s37 offen offset:1024 lds
    v_mfma_f32_16x16x32_bf16 v[112:115], a[20:23], a[68:71], v[112:115]
    ds_read_b64_tr_b16 a[16:17], v20 offset:15360
    s_add_u32 s38, s38, 128
    v_mfma_f32_16x16x32_bf16 v[120:123], a[20:23], a[72:75], v[120:123]
    ds_read_b64_tr_b16 a[18:19], v20 offset:16896
    s_add_u32 m0, s36, 28672
    v_mfma_f32_16x16x32_bf16 v[124:127], a[24:27], a[72:75], v[124:127]
    ds_read_b64_tr_b16 a[20:21], v21 offset:15360
    buffer_load_dwordx4 v16, s[4:7], s38 offen offset:0 lds
    v_mfma_f32_16x16x32_bf16 v[116:119], a[24:27], a[68:71], v[116:119]
    ds_read_b64_tr_b16 a[22:23], v21 offset:16896
    s_waitcnt lgkmcnt(4)
    v_mfma_f32_16x16x32_bf16 v[128:131], a[0:3], a[68:71], v[128:131]
    ds_read_b64_tr_b16 a[24:25], v22 offset:15360
    buffer_load_dwordx4 v17, s[4:7], s38 offen offset:1024 lds
    v_mfma_f32_16x16x32_bf16 v[136:139], a[0:3], a[72:75], v[136:139]
    ds_read_b64_tr_b16 a[26:27], v22 offset:16896
    buffer_load_dwordx4 v18, s[4:7], s38 offen offset:2048 lds
    v_mfma_f32_16x16x32_bf16 v[140:143], a[4:7], a[72:75], v[140:143]
    ds_read_b64_tr_b16 a[0:1], v23 offset:15360
    v_mfma_f32_16x16x32_bf16 v[132:135], a[4:7], a[68:71], v[132:135]
    ds_read_b64_tr_b16 a[2:3], v23 offset:16896
    buffer_load_dwordx4 v19, s[4:7], s38 offen offset:3072 lds
    v_mfma_f32_16x16x32_bf16 v[144:147], a[8:11], a[68:71], v[144:147]
    ds_read_b64_tr_b16 a[4:5], v20 offset:15488
    s_add_u32 s37, s37, 589824
    v_mfma_f32_16x16x32_bf16 v[152:155], a[8:11], a[72:75], v[152:155]
    ds_read_b64_tr_b16 a[6:7], v20 offset:17024
    s_add_u32 m0, s36, 6144
    v_mfma_f32_16x16x32_bf16 v[156:159], a[12:15], a[72:75], v[156:159]
    ds_read_b64_tr_b16 a[8:9], v21 offset:15488
    buffer_load_dwordx4 v10, s[8:11], s37 offen offset:0 lds
    v_mfma_f32_16x16x32_bf16 v[148:151], a[12:15], a[68:71], v[148:151]
    ds_read_b64_tr_b16 a[10:11], v21 offset:17024
    s_waitcnt lgkmcnt(4)
    v_mfma_f32_16x16x32_bf16 v[64:67], a[16:19], a[76:79], v[64:67]
    ds_read_b64_tr_b16 a[12:13], v22 offset:15488
    buffer_load_dwordx4 v11, s[8:11], s37 offen offset:1024 lds
    v_mfma_f32_16x16x32_bf16 v[72:75], a[16:19], a[80:83], v[72:75]
    ds_read_b64_tr_b16 a[14:15], v22 offset:17024
    v_mfma_f32_16x16x32_bf16 v[76:79], a[20:23], a[80:83], v[76:79]
    ds_read_b64_tr_b16 a[16:17], v23 offset:15488
    buffer_load_dwordx4 v12, s[8:11], s37 offen offset:2048 lds
    v_mfma_f32_16x16x32_bf16 v[68:71], a[20:23], a[76:79], v[68:71]
    ds_read_b64_tr_b16 a[18:19], v23 offset:17024
    buffer_load_dwordx4 v13, s[8:11], s37 offen offset:3072 lds
    v_mfma_f32_16x16x32_bf16 v[80:83], a[24:27], a[76:79], v[80:83]
    ds_read_b64_tr_b16 a[20:21], v20 offset:15616
    s_add_u32 m0, s36, 10240
    v_mfma_f32_16x16x32_bf16 v[88:91], a[24:27], a[80:83], v[88:91]
    ds_read_b64_tr_b16 a[22:23], v20 offset:17152
    buffer_load_dwordx4 v14, s[8:11], s37 offen offset:0 lds
    v_mfma_f32_16x16x32_bf16 v[92:95], a[0:3], a[80:83], v[92:95]
    ds_read_b64_tr_b16 a[24:25], v21 offset:15616
    v_mfma_f32_16x16x32_bf16 v[84:87], a[0:3], a[76:79], v[84:87]
    ds_read_b64_tr_b16 a[26:27], v21 offset:17152
    s_waitcnt vmcnt(15) lgkmcnt(4)
    v_mfma_f32_16x16x32_bf16 v[96:99], a[4:7], a[76:79], v[96:99]
    ds_read_b64_tr_b16 a[0:1], v22 offset:15616
    buffer_load_dwordx4 v15, s[8:11], s37 offen offset:1024 lds
    v_mfma_f32_16x16x32_bf16 v[104:107], a[4:7], a[80:83], v[104:107]
    ds_read_b64_tr_b16 a[2:3], v22 offset:17152
    s_add_u32 s38, s38, 128
    v_mfma_f32_16x16x32_bf16 v[108:111], a[8:11], a[80:83], v[108:111]
    ds_read_b64_tr_b16 a[4:5], v23 offset:15616
    s_add_u32 m0, s36, 32768
    v_mfma_f32_16x16x32_bf16 v[100:103], a[8:11], a[76:79], v[100:103]
    ds_read_b64_tr_b16 a[6:7], v23 offset:17152
    s_barrier
    v_mfma_f32_16x16x32_bf16 v[112:115], a[12:15], a[76:79], v[112:115]
    ds_read_b64_tr_b16 a[8:9], v20 offset:18432
    ds_read_b128 a[84:87], v24 offset:0
    v_mfma_f32_16x16x32_bf16 v[120:123], a[12:15], a[80:83], v[120:123]
    ds_read_b64_tr_b16 a[10:11], v20 offset:19968
    ds_read_b128 a[88:91], v24 offset:2048
    buffer_load_dwordx4 v16, s[4:7], s38 offen offset:0 lds
    v_mfma_f32_16x16x32_bf16 v[124:127], a[16:19], a[80:83], v[124:127]
    ds_read_b64_tr_b16 a[12:13], v21 offset:18432
    ds_read_b128 a[92:95], v25 offset:0
    v_mfma_f32_16x16x32_bf16 v[116:119], a[16:19], a[76:79], v[116:119]
    ds_read_b64_tr_b16 a[14:15], v21 offset:19968
    s_waitcnt lgkmcnt(7)
    v_mfma_f32_16x16x32_bf16 v[128:131], a[20:23], a[76:79], v[128:131]
    ds_read_b64_tr_b16 a[16:17], v22 offset:18432
    ds_read_b128 a[96:99], v25 offset:2048
    v_mfma_f32_16x16x32_bf16 v[136:139], a[20:23], a[80:83], v[136:139]
    ds_read_b64_tr_b16 a[18:19], v22 offset:19968
    buffer_load_dwordx4 v17, s[4:7], s38 offen offset:1024 lds
    v_mfma_f32_16x16x32_bf16 v[140:143], a[24:27], a[80:83], v[140:143]
    ds_read_b64_tr_b16 a[20:21], v23 offset:18432
    v_mfma_f32_16x16x32_bf16 v[132:135], a[24:27], a[76:79], v[132:135]
    ds_read_b64_tr_b16 a[22:23], v23 offset:19968
    v_mfma_f32_16x16x32_bf16 v[144:147], a[0:3], a[76:79], v[144:147]
    ds_read_b64_tr_b16 a[24:25], v20 offset:18560
    buffer_load_dwordx4 v18, s[4:7], s38 offen offset:2048 lds
    v_mfma_f32_16x16x32_bf16 v[152:155], a[0:3], a[80:83], v[152:155]
    ds_read_b64_tr_b16 a[26:27], v20 offset:20096
    v_mfma_f32_16x16x32_bf16 v[156:159], a[4:7], a[80:83], v[156:159]
    ds_read_b64_tr_b16 a[0:1], v21 offset:18560
    buffer_load_dwordx4 v19, s[4:7], s38 offen offset:3072 lds
    v_mfma_f32_16x16x32_bf16 v[148:151], a[4:7], a[76:79], v[148:151]
    ds_read_b64_tr_b16 a[2:3], v21 offset:20096
    s_waitcnt lgkmcnt(4)
L_stage3:
    v_mfma_f32_16x16x32_bf16 v[64:67], a[8:11], a[84:87], v[64:67]
    ds_read_b64_tr_b16 a[4:5], v22 offset:18560
    s_add_u32 s37, s37, 589824
    v_mfma_f32_16x16x32_bf16 v[72:75], a[8:11], a[88:91], v[72:75]
    ds_read_b64_tr_b16 a[6:7], v22 offset:20096
    s_add_u32 m0, s36, 12288
    v_mfma_f32_16x16x32_bf16 v[76:79], a[12:15], a[88:91], v[76:79]
    ds_read_b64_tr_b16 a[8:9], v23 offset:18560
    buffer_load_dwordx4 v10, s[8:11], s37 offen offset:0 lds
    v_mfma_f32_16x16x32_bf16 v[68:71], a[12:15], a[84:87], v[68:71]
    ds_read_b64_tr_b16 a[10:11], v23 offset:20096
    v_mfma_f32_16x16x32_bf16 v[80:83], a[16:19], a[84:87], v[80:83]
    ds_read_b64_tr_b16 a[12:13], v20 offset:18688
    v_mfma_f32_16x16x32_bf16 v[88:91], a[16:19], a[88:91], v[88:91]
    ds_read_b64_tr_b16 a[14:15], v20 offset:20224
    v_mfma_f32_16x16x32_bf16 v[92:95], a[20:23], a[88:91], v[92:95]
    ds_read_b64_tr_b16 a[16:17], v21 offset:18688
    buffer_load_dwordx4 v11, s[8:11], s37 offen offset:1024 lds
    v_mfma_f32_16x16x32_bf16 v[84:87], a[20:23], a[84:87], v[84:87]
    ds_read_b64_tr_b16 a[18:19], v21 offset:20224
    s_waitcnt lgkmcnt(4)
    v_mfma_f32_16x16x32_bf16 v[96:99], a[24:27], a[84:87], v[96:99]
    ds_read_b64_tr_b16 a[20:21], v22 offset:18688
    v_mfma_f32_16x16x32_bf16 v[104:107], a[24:27], a[88:91], v[104:107]
    ds_read_b64_tr_b16 a[22:23], v22 offset:20224
    v_mfma_f32_16x16x32_bf16 v[108:111], a[0:3], a[88:91], v[108:111]
    ds_read_b64_tr_b16 a[24:25], v23 offset:18688
    buffer_load_dwordx4 v12, s[8:11], s37 offen offset:2048 lds
    v_mfma_f32_16x16x32_bf16 v[100:103], a[0:3], a[84:87], v[100:103]
    ds_read_b64_tr_b16 a[26:27], v23 offset:20224
    v_mfma_f32_16x16x32_bf16 v[112:115], a[4:7], a[84:87], v[112:115]
    ds_read_b64_tr_b16 a[0:1], v20 offset:21504
    v_mfma_f32_16x16x32_bf16 v[120:123], a[4:7], a[88:91], v[120:123]
    ds_read_b64_tr_b16 a[2:3], v20 offset:23040
    v_mfma_f32_16x16x32_bf16 v[124:127], a[8:11], a[88:91], v[124:127]
    ds_read_b64_tr_b16 a[4:5], v21 offset:21504
    buffer_load_dwordx4 v13, s[8:11], s37 offen offset:3072 lds
    v_mfma_f32_16x16x32_bf16 v[116:119], a[8:11], a[84:87], v[116:119]
    ds_read_b64_tr_b16 a[6:7], v21 offset:23040
    s_waitcnt lgkmcnt(4)
    v_mfma_f32_16x16x32_bf16 v[128:131], a[12:15], a[84:87], v[128:131]
    ds_read_b64_tr_b16 a[8:9], v22 offset:21504
    s_add_u32 m0, s36, 16384
    v_mfma_f32_16x16x32_bf16 v[136:139], a[12:15], a[88:91], v[136:139]
    ds_read_b64_tr_b16 a[10:11], v22 offset:23040
    v_mfma_f32_16x16x32_bf16 v[140:143], a[16:19], a[88:91], v[140:143]
    ds_read_b64_tr_b16 a[12:13], v23 offset:21504
    buffer_load_dwordx4 v14, s[8:11], s37 offen offset:0 lds
    v_mfma_f32_16x16x32_bf16 v[132:135], a[16:19], a[84:87], v[132:135]
    ds_read_b64_tr_b16 a[14:15], v23 offset:23040
    v_mfma_f32_16x16x32_bf16 v[144:147], a[20:23], a[84:87], v[144:147]
    ds_read_b64_tr_b16 a[16:17], v20 offset:21632
    v_mfma_f32_16x16x32_bf16 v[152:155], a[20:23], a[88:91], v[152:155]
    ds_read_b64_tr_b16 a[18:19], v20 offset:23168
    v_mfma_f32_16x16x32_bf16 v[156:159], a[24:27], a[88:91], v[156:159]
    ds_read_b64_tr_b16 a[20:21], v21 offset:21632
    buffer_load_dwordx4 v15, s[8:11], s37 offen offset:1024 lds
    v_mfma_f32_16x16x32_bf16 v[148:151], a[24:27], a[84:87], v[148:151]
    ds_read_b64_tr_b16 a[22:23], v21 offset:23168
    s_waitcnt lgkmcnt(4)
    v_mfma_f32_16x16x32_bf16 v[64:67], a[0:3], a[92:95], v[64:67]
    ds_read_b64_tr_b16 a[24:25], v22 offset:21632
    s_add_u32 s38, s38, 128
    v_mfma_f32_16x16x32_bf16 v[72:75], a[0:3], a[96:99], v[72:75]
    ds_read_b64_tr_b16 a[26:27], v22 offset:23168
    s_add_u32 m0, s36, 24576
    v_mfma_f32_16x16x32_bf16 v[76:79], a[4:7], a[96:99], v[76:79]
    ds_read_b64_tr_b16 a[0:1], v23 offset:21632
    v_mfma_f32_16x16x32_bf16 v[68:71], a[4:7], a[92:95], v[68:71]
    ds_read_b64_tr_b16 a[2:3], v23 offset:23168
    buffer_load_dwordx4 v16, s[4:7], s38 offen offset:0 lds
    v_mfma_f32_16x16x32_bf16 v[80:83], a[8:11], a[92:95], v[80:83]
    ds_read_b64_tr_b16 a[4:5], v20 offset:21760
    v_mfma_f32_16x16x32_bf16 v[88:91], a[8:11], a[96:99], v[88:91]
    ds_read_b64_tr_b16 a[6:7], v20 offset:23296
    v_mfma_f32_16x16x32_bf16 v[92:95], a[12:15], a[96:99], v[92:95]
    ds_read_b64_tr_b16 a[8:9], v21 offset:21760
    v_mfma_f32_16x16x32_bf16 v[84:87], a[12:15], a[92:95], v[84:87]
    ds_read_b64_tr_b16 a[10:11], v21 offset:23296
    s_waitcnt vmcnt(17) lgkmcnt(4)
    v_mfma_f32_16x16x32_bf16 v[96:99], a[16:19], a[92:95], v[96:99]
    ds_read_b64_tr_b16 a[12:13], v22 offset:21760
    buffer_load_dwordx4 v17, s[4:7], s38 offen offset:1024 lds
    v_mfma_f32_16x16x32_bf16 v[104:107], a[16:19], a[96:99], v[104:107]
    ds_read_b64_tr_b16 a[14:15], v22 offset:23296
    v_mfma_f32_16x16x32_bf16 v[108:111], a[20:23], a[96:99], v[108:111]
    ds_read_b64_tr_b16 a[16:17], v23 offset:21760
    v_mfma_f32_16x16x32_bf16 v[100:103], a[20:23], a[92:95], v[100:103]
    ds_read_b64_tr_b16 a[18:19], v23 offset:23296
    s_barrier
    v_mfma_f32_16x16x32_bf16 v[112:115], a[24:27], a[92:95], v[112:115]
    ds_read_b64_tr_b16 a[20:21], v20 offset:0
    ds_read_b128 a[100:103], v24 offset:4096
    v_mfma_f32_16x16x32_bf16 v[120:123], a[24:27], a[96:99], v[120:123]
    ds_read_b64_tr_b16 a[22:23], v20 offset:1536
    ds_read_b128 a[104:107], v24 offset:6144
    v_mfma_f32_16x16x32_bf16 v[124:127], a[0:3], a[96:99], v[124:127]
    ds_read_b64_tr_b16 a[24:25], v21 offset:0
    ds_read_b128 a[108:111], v25 offset:4096
    v_mfma_f32_16x16x32_bf16 v[116:119], a[0:3], a[92:95], v[116:119]
    ds_read_b64_tr_b16 a[26:27], v21 offset:1536
    s_waitcnt lgkmcnt(7)
    v_mfma_f32_16x16x32_bf16 v[128:131], a[4:7], a[92:95], v[128:131]
    ds_read_b64_tr_b16 a[0:1], v22 offset:0
    ds_read_b128 a[112:115], v25 offset:6144
    v_mfma_f32_16x16x32_bf16 v[136:139], a[4:7], a[96:99], v[136:139]
    ds_read_b64_tr_b16 a[2:3], v22 offset:1536
    buffer_load_dwordx4 v18, s[4:7], s38 offen offset:2048 lds
    v_mfma_f32_16x16x32_bf16 v[140:143], a[8:11], a[96:99], v[140:143]
    ds_read_b64_tr_b16 a[4:5], v23 offset:0
    v_mfma_f32_16x16x32_bf16 v[132:135], a[8:11], a[92:95], v[132:135]
    ds_read_b64_tr_b16 a[6:7], v23 offset:1536
    v_mfma_f32_16x16x32_bf16 v[144:147], a[12:15], a[92:95], v[144:147]
    ds_read_b64_tr_b16 a[8:9], v20 offset:128
    v_mfma_f32_16x16x32_bf16 v[152:155], a[12:15], a[96:99], v[152:155]
    ds_read_b64_tr_b16 a[10:11], v20 offset:1664
    buffer_load_dwordx4 v19, s[4:7], s38 offen offset:3072 lds
    v_mfma_f32_16x16x32_bf16 v[156:159], a[16:19], a[96:99], v[156:159]
    ds_read_b64_tr_b16 a[12:13], v21 offset:128
    v_mfma_f32_16x16x32_bf16 v[148:151], a[16:19], a[92:95], v[148:151]
    ds_read_b64_tr_b16 a[14:15], v21 offset:1664
    s_waitcnt lgkmcnt(4)
L_stage4:
    v_mfma_f32_16x16x32_bf16 v[64:67], a[20:23], a[100:103], v[64:67]
    ds_read_b64_tr_b16 a[16:17], v22 offset:128
    s_add_u32 s37, s37, 589824
    v_mfma_f32_16x16x32_bf16 v[72:75], a[20:23], a[104:107], v[72:75]
    ds_read_b64_tr_b16 a[18:19], v22 offset:1664
    s_add_u32 m0, s36, 18432
    v_mfma_f32_16x16x32_bf16 v[76:79], a[24:27], a[104:107], v[76:79]
    ds_read_b64_tr_b16 a[20:21], v23 offset:128
    buffer_load_dwordx4 v10, s[8:11], s37 offen offset:0 lds
    v_mfma_f32_16x16x32_bf16 v[68:71], a[24:27], a[100:103], v[68:71]
    ds_read_b64_tr_b16 a[22:23], v23 offset:1664
    v_mfma_f32_16x16x32_bf16 v[80:83], a[0:3], a[100:103], v[80:83]
    ds_read_b64_tr_b16 a[24:25], v20 offset:256
    v_mfma_f32_16x16x32_bf16 v[88:91], a[0:3], a[104:107], v[88:91]
    ds_read_b64_tr_b16 a[26:27], v20 offset:1792
    v_mfma_f32_16x16x32_bf16 v[92:95], a[4:7], a[104:107], v[92:95]
    ds_read_b64_tr_b16 a[0:1], v21 offset:256
    buffer_load_dwordx4 v11, s[8:11], s37 offen offset:1024 lds
    v_mfma_f32_16x16x32_bf16 v[84:87], a[4:7], a[100:103], v[84:87]
    ds_read_b64_tr_b16 a[2:3], v21 offset:1792
    s_waitcnt lgkmcnt(4)
    v_mfma_f32_16x16x32_bf16 v[96:99], a[8:11], a[100:103], v[96:99]
    ds_read_b64_tr_b16 a[4:5], v22 offset:256
    v_mfma_f32_16x16x32_bf16 v[104:107], a[8:11], a[104:107], v[104:107]
    ds_read_b64_tr_b16 a[6:7], v22 offset:1792
    v_mfma_f32_16x16x32_bf16 v[108:111], a[12:15], a[104:107], v[108:111]
    ds_read_b64_tr_b16 a[8:9], v23 offset:256
    buffer_load_dwordx4 v12, s[8:11], s37 offen offset:2048 lds
    v_mfma_f32_16x16x32_bf16 v[100:103], a[12:15], a[100:103], v[100:103]
    ds_read_b64_tr_b16 a[10:11], v23 offset:1792
    v_mfma_f32_16x16x32_bf16 v[112:115], a[16:19], a[100:103], v[112:115]
    ds_read_b64_tr_b16 a[12:13], v20 offset:3072
    v_mfma_f32_16x16x32_bf16 v[120:123], a[16:19], a[104:107], v[120:123]
    ds_read_b64_tr_b16 a[14:15], v20 offset:4608
    v_mfma_f32_16x16x32_bf16 v[124:127], a[20:23], a[104:107], v[124:127]
    ds_read_b64_tr_b16 a[16:17], v21 offset:3072
    buffer_load_dwordx4 v13, s[8:11], s37 offen offset:3072 lds
    v_mfma_f32_16x16x32_bf16 v[116:119], a[20:23], a[100:103], v[116:119]
    ds_read_b64_tr_b16 a[18:19], v21 offset:4608
    s_waitcnt lgkmcnt(4)
    v_mfma_f32_16x16x32_bf16 v[128:131], a[24:27], a[100:103], v[128:131]
    ds_read_b64_tr_b16 a[20:21], v22 offset:3072
    s_add_u32 m0, s36, 22528
    v_mfma_f32_16x16x32_bf16 v[136:139], a[24:27], a[104:107], v[136:139]
    ds_read_b64_tr_b16 a[22:23], v22 offset:4608
    v_mfma_f32_16x16x32_bf16 v[140:143], a[0:3], a[104:107], v[140:143]
    ds_read_b64_tr_b16 a[24:25], v23 offset:3072
    buffer_load_dwordx4 v14, s[8:11], s37 offen offset:0 lds
    v_mfma_f32_16x16x32_bf16 v[132:135], a[0:3], a[100:103], v[132:135]
    ds_read_b64_tr_b16 a[26:27], v23 offset:4608
    v_mfma_f32_16x16x32_bf16 v[144:147], a[4:7], a[100:103], v[144:147]
    ds_read_b64_tr_b16 a[0:1], v20 offset:3200
    v_mfma_f32_16x16x32_bf16 v[152:155], a[4:7], a[104:107], v[152:155]
    ds_read_b64_tr_b16 a[2:3], v20 offset:4736
    v_mfma_f32_16x16x32_bf16 v[156:159], a[8:11], a[104:107], v[156:159]
    ds_read_b64_tr_b16 a[4:5], v21 offset:3200
    buffer_load_dwordx4 v15, s[8:11], s37 offen offset:1024 lds
    v_mfma_f32_16x16x32_bf16 v[148:151], a[8:11], a[100:103], v[148:151]
    ds_read_b64_tr_b16 a[6:7], v21 offset:4736
    s_waitcnt lgkmcnt(4)
    v_mfma_f32_16x16x32_bf16 v[64:67], a[12:15], a[108:111], v[64:67]
    ds_read_b64_tr_b16 a[8:9], v22 offset:3200
    s_add_u32 s38, s38, 128
    v_mfma_f32_16x16x32_bf16 v[72:75], a[12:15], a[112:115], v[72:75]
    ds_read_b64_tr_b16 a[10:11], v22 offset:4736
    s_add_u32 m0, s36, 28672
    v_mfma_f32_16x16x32_bf16 v[76:79], a[16:19], a[112:115], v[76:79]
    ds_read_b64_tr_b16 a[12:13], v23 offset:3200
    v_mfma_f32_16x16x32_bf16 v[68:71], a[16:19], a[108:111], v[68:71]
    ds_read_b64_tr_b16 a[14:15], v23 offset:4736
    buffer_load_dwordx4 v16, s[4:7], s38 offen offset:0 lds
    v_mfma_f32_16x16x32_bf16 v[80:83], a[20:23], a[108:111], v[80:83]
    ds_read_b64_tr_b16 a[16:17], v20 offset:3328
    v_mfma_f32_16x16x32_bf16 v[88:91], a[20:23], a[112:115], v[88:91]
    ds_read_b64_tr_b16 a[18:19], v20 offset:4864
    v_mfma_f32_16x16x32_bf16 v[92:95], a[24:27], a[112:115], v[92:95]
    ds_read_b64_tr_b16 a[20:21], v21 offset:3328
    v_mfma_f32_16x16x32_bf16 v[84:87], a[24:27], a[108:111], v[84:87]
    ds_read_b64_tr_b16 a[22:23], v21 offset:4864
    s_waitcnt vmcnt(17) lgkmcnt(4)
    v_mfma_f32_16x16x32_bf16 v[96:99], a[0:3], a[108:111], v[96:99]
    ds_read_b64_tr_b16 a[24:25], v22 offset:3328
    buffer_load_dwordx4 v17, s[4:7], s38 offen offset:1024 lds
    v_mfma_f32_16x16x32_bf16 v[104:107], a[0:3], a[112:115], v[104:107]
    ds_read_b64_tr_b16 a[26:27], v22 offset:4864
    v_mfma_f32_16x16x32_bf16 v[108:111], a[4:7], a[112:115], v[108:111]
    ds_read_b64_tr_b16 a[0:1], v23 offset:3328
    v_mfma_f32_16x16x32_bf16 v[100:103], a[4:7], a[108:111], v[100:103]
    ds_read_b64_tr_b16 a[2:3], v23 offset:4864
    s_barrier
    v_mfma_f32_16x16x32_bf16 v[112:115], a[8:11], a[108:111], v[112:115]
    ds_read_b64_tr_b16 a[4:5], v20 offset:6144
    ds_read_b128 a[116:119], v24 offset:8192
    v_mfma_f32_16x16x32_bf16 v[120:123], a[8:11], a[112:115], v[120:123]
    ds_read_b64_tr_b16 a[6:7], v20 offset:7680
    ds_read_b128 a[120:123], v24 offset:10240
    v_mfma_f32_16x16x32_bf16 v[124:127], a[12:15], a[112:115], v[124:127]
    ds_read_b64_tr_b16 a[8:9], v21 offset:6144
    ds_read_b128 a[124:127], v25 offset:8192
    v_mfma_f32_16x16x32_bf16 v[116:119], a[12:15], a[108:111], v[116:119]
    ds_read_b64_tr_b16 a[10:11], v21 offset:7680
    s_waitcnt lgkmcnt(7)
    v_mfma_f32_16x16x32_bf16 v[128:131], a[16:19], a[108:111], v[128:131]
    ds_read_b64_tr_b16 a[12:13], v22 offset:6144
    ds_read_b128 a[128:131], v25 offset:10240
    v_mfma_f32_16x16x32_bf16 v[136:139], a[16:19], a[112:115], v[136:139]
    ds_read_b64_tr_b16 a[14:15], v22 offset:7680
    buffer_load_dwordx4 v18, s[4:7], s38 offen offset:2048 lds
    v_mfma_f32_16x16x32_bf16 v[140:143], a[20:23], a[112:115], v[140:143]
    ds_read_b64_tr_b16 a[16:17], v23 offset:6144
    v_mfma_f32_16x16x32_bf16 v[132:135], a[20:23], a[108:111], v[132:135]
    ds_read_b64_tr_b16 a[18:19], v23 offset:7680
    v_mfma_f32_16x16x32_bf16 v[144:147], a[24:27], a[108:111], v[144:147]
    ds_read_b64_tr_b16 a[20:21], v20 offset:6272
    v_mfma_f32_16x16x32_bf16 v[152:155], a[24:27], a[112:115], v[152:155]
    ds_read_b64_tr_b16 a[22:23], v20 offset:7808
    buffer_load_dwordx4 v19, s[4:7], s38 offen offset:3072 lds
    v_mfma_f32_16x16x32_bf16 v[156:159], a[0:3], a[112:115], v[156:159]
    ds_read_b64_tr_b16 a[24:25], v21 offset:6272
    v_mfma_f32_16x16x32_bf16 v[148:151], a[0:3], a[108:111], v[148:151]
    ds_read_b64_tr_b16 a[26:27], v21 offset:7808
    s_waitcnt lgkmcnt(4)
L_stage5:
    v_mfma_f32_16x16x32_bf16 v[64:67], a[4:7], a[116:119], v[64:67]
    ds_read_b64_tr_b16 a[0:1], v22 offset:6272
    buffer_load_dword v57, v56, s[12:15], s56 offen
    v_mfma_f32_16x16x32_bf16 v[72:75], a[4:7], a[120:123], v[72:75]
    ds_read_b64_tr_b16 a[2:3], v22 offset:7808
    v_mfma_f32_16x16x32_bf16 v[76:79], a[8:11], a[120:123], v[76:79]
    ds_read_b64_tr_b16 a[4:5], v23 offset:6272
    v_mfma_f32_16x16x32_bf16 v[68:71], a[8:11], a[116:119], v[68:71]
    ds_read_b64_tr_b16 a[6:7], v23 offset:7808
    v_mfma_f32_16x16x32_bf16 v[80:83], a[12:15], a[116:119], v[80:83]
    ds_read_b64_tr_b16 a[8:9], v20 offset:6400
    v_mfma_f32_16x16x32_bf16 v[88:91], a[12:15], a[120:123], v[88:91]
    ds_read_b64_tr_b16 a[10:11], v20 offset:7936
    v_mfma_f32_16x16x32_bf16 v[92:95], a[16:19], a[120:123], v[92:95]
    ds_read_b64_tr_b16 a[12:13], v21 offset:6400
    v_mfma_f32_16x16x32_bf16 v[84:87], a[16:19], a[116:119], v[84:87]
    ds_read_b64_tr_b16 a[14:15], v21 offset:7936
    s_waitcnt lgkmcnt(4)
    v_mfma_f32_16x16x32_bf16 v[96:99], a[20:23], a[116:119], v[96:99]
    ds_read_b64_tr_b16 a[16:17], v22 offset:6400
    v_mfma_f32_16x16x32_bf16 v[104:107], a[20:23], a[120:123], v[104:107]
    ds_read_b64_tr_b16 a[18:19], v22 offset:7936
    v_mfma_f32_16x16x32_bf16 v[108:111], a[24:27], a[120:123], v[108:111]
    ds_read_b64_tr_b16 a[20:21], v23 offset:6400
    v_mfma_f32_16x16x32_bf16 v[100:103], a[24:27], a[116:119], v[100:103]
    ds_read_b64_tr_b16 a[22:23], v23 offset:7936
    v_mfma_f32_16x16x32_bf16 v[112:115], a[0:3], a[116:119], v[112:115]
    ds_read_b64_tr_b16 a[24:25], v20 offset:9216
    v_mfma_f32_16x16x32_bf16 v[120:123], a[0:3], a[120:123], v[120:123]
    ds_read_b64_tr_b16 a[26:27], v20 offset:10752
    v_mfma_f32_16x16x32_bf16 v[124:127], a[4:7], a[120:123], v[124:127]
    ds_read_b64_tr_b16 a[0:1], v21 offset:9216
    v_mfma_f32_16x16x32_bf16 v[116:119], a[4:7], a[116:119], v[116:119]
    ds_read_b64_tr_b16 a[2:3], v21 offset:10752
    s_waitcnt lgkmcnt(4)
    v_mfma_f32_16x16x32_bf16 v[128:131], a[8:11], a[116:119], v[128:131]
    ds_read_b64_tr_b16 a[4:5], v22 offset:9216
    v_mfma_f32_16x16x32_bf16 v[136:139], a[8:11], a[120:123], v[136:139]
    ds_read_b64_tr_b16 a[6:7], v22 offset:10752
    v_mfma_f32_16x16x32_bf16 v[140:143], a[12:15], a[120:123], v[140:143]
    ds_read_b64_tr_b16 a[8:9], v23 offset:9216
    v_mfma_f32_16x16x32_bf16 v[132:135], a[12:15], a[116:119], v[132:135]
    ds_read_b64_tr_b16 a[10:11], v23 offset:10752
    v_mfma_f32_16x16x32_bf16 v[144:147], a[16:19], a[116:119], v[144:147]
    ds_read_b64_tr_b16 a[12:13], v20 offset:9344
    v_mfma_f32_16x16x32_bf16 v[152:155], a[16:19], a[120:123], v[152:155]
    ds_read_b64_tr_b16 a[14:15], v20 offset:10880
    v_mfma_f32_16x16x32_bf16 v[156:159], a[20:23], a[120:123], v[156:159]
    ds_read_b64_tr_b16 a[16:17], v21 offset:9344
    v_mfma_f32_16x16x32_bf16 v[148:151], a[20:23], a[116:119], v[148:151]
    ds_read_b64_tr_b16 a[18:19], v21 offset:10880
    s_waitcnt lgkmcnt(4)
    v_mfma_f32_16x16x32_bf16 v[64:67], a[24:27], a[124:127], v[64:67]
    ds_read_b64_tr_b16 a[20:21], v22 offset:9344
    v_mfma_f32_16x16x32_bf16 v[72:75], a[24:27], a[128:131], v[72:75]
    ds_read_b64_tr_b16 a[22:23], v22 offset:10880
    v_mfma_f32_16x16x32_bf16 v[76:79], a[0:3], a[128:131], v[76:79]
    ds_read_b64_tr_b16 a[24:25], v23 offset:9344
    v_mfma_f32_16x16x32_bf16 v[68:71], a[0:3], a[124:127], v[68:71]
    ds_read_b64_tr_b16 a[26:27], v23 offset:10880
    v_mfma_f32_16x16x32_bf16 v[80:83], a[4:7], a[124:127], v[80:83]
    ds_read_b64_tr_b16 a[0:1], v20 offset:9472
    v_mfma_f32_16x16x32_bf16 v[88:91], a[4:7], a[128:131], v[88:91]
    ds_read_b64_tr_b16 a[2:3], v20 offset:11008
    v_mfma_f32_16x16x32_bf16 v[92:95], a[8:11], a[128:131], v[92:95]
    ds_read_b64_tr_b16 a[4:5], v21 offset:9472
    v_mfma_f32_16x16x32_bf16 v[84:87], a[8:11], a[124:127], v[84:87]
    ds_read_b64_tr_b16 a[6:7], v21 offset:11008
    s_waitcnt vmcnt(11) lgkmcnt(4)
    v_mfma_f32_16x16x32_bf16 v[96:99], a[12:15], a[124:127], v[96:99]
    ds_read_b64_tr_b16 a[8:9], v22 offset:9472
    v_mfma_f32_16x16x32_bf16 v[104:107], a[12:15], a[128:131], v[104:107]
    ds_read_b64_tr_b16 a[10:11], v22 offset:11008
    v_mfma_f32_16x16x32_bf16 v[108:111], a[16:19], a[128:131], v[108:111]
    ds_read_b64_tr_b16 a[12:13], v23 offset:9472
    v_mfma_f32_16x16x32_bf16 v[100:103], a[16:19], a[124:127], v[100:103]
    ds_read_b64_tr_b16 a[14:15], v23 offset:11008
    s_barrier
    v_mfma_f32_16x16x32_bf16 v[112:115], a[20:23], a[124:127], v[112:115]
    ds_read_b64_tr_b16 a[16:17], v20 offset:12288
    ds_read_b128 a[132:135], v24 offset:0
    v_mfma_f32_16x16x32_bf16 v[120:123], a[20:23], a[128:131], v[120:123]
    ds_read_b64_tr_b16 a[18:19], v20 offset:13824
    ds_read_b128 a[136:139], v24 offset:2048
    v_mfma_f32_16x16x32_bf16 v[124:127], a[24:27], a[128:131], v[124:127]
    ds_read_b64_tr_b16 a[20:21], v21 offset:12288
    ds_read_b128 a[140:143], v25 offset:0
    v_mfma_f32_16x16x32_bf16 v[116:119], a[24:27], a[124:127], v[116:119]
    ds_read_b64_tr_b16 a[22:23], v21 offset:13824
    s_waitcnt lgkmcnt(7)
    v_mfma_f32_16x16x32_bf16 v[128:131], a[0:3], a[124:127], v[128:131]
    ds_read_b64_tr_b16 a[24:25], v22 offset:12288
    ds_read_b128 a[144:147], v25 offset:2048
    v_mfma_f32_16x16x32_bf16 v[136:139], a[0:3], a[128:131], v[136:139]
    ds_read_b64_tr_b16 a[26:27], v22 offset:13824
    v_mfma_f32_16x16x32_bf16 v[140:143], a[4:7], a[128:131], v[140:143]
    ds_read_b64_tr_b16 a[0:1], v23 offset:12288
    v_mfma_f32_16x16x32_bf16 v[132:135], a[4:7], a[124:127], v[132:135]
    ds_read_b64_tr_b16 a[2:3], v23 offset:13824
    v_mfma_f32_16x16x32_bf16 v[144:147], a[8:11], a[124:127], v[144:147]
    ds_read_b64_tr_b16 a[4:5], v20 offset:12416
    v_mfma_f32_16x16x32_bf16 v[152:155], a[8:11], a[128:131], v[152:155]
    ds_read_b64_tr_b16 a[6:7], v20 offset:13952
    v_mfma_f32_16x16x32_bf16 v[156:159], a[12:15], a[128:131], v[156:159]
    ds_read_b64_tr_b16 a[8:9], v21 offset:12416
    v_mfma_f32_16x16x32_bf16 v[148:151], a[12:15], a[124:127], v[148:151]
    ds_read_b64_tr_b16 a[10:11], v21 offset:13952
    s_waitcnt lgkmcnt(4)
L_stage6:
    v_mfma_f32_16x16x32_bf16 v[64:67], a[16:19], a[132:135], v[64:67]
    ds_read_b64_tr_b16 a[12:13], v22 offset:12416
    v_mfma_f32_16x16x32_bf16 v[72:75], a[16:19], a[136:139], v[72:75]
    ds_read_b64_tr_b16 a[14:15], v22 offset:13952
    v_mfma_f32_16x16x32_bf16 v[76:79], a[20:23], a[136:139], v[76:79]
    ds_read_b64_tr_b16 a[16:17], v23 offset:12416
    v_mfma_f32_16x16x32_bf16 v[68:71], a[20:23], a[132:135], v[68:71]
    ds_read_b64_tr_b16 a[18:19], v23 offset:13952
    v_mfma_f32_16x16x32_bf16 v[80:83], a[24:27], a[132:135], v[80:83]
    ds_read_b64_tr_b16 a[20:21], v20 offset:12544
    v_mfma_f32_16x16x32_bf16 v[88:91], a[24:27], a[136:139], v[88:91]
    ds_read_b64_tr_b16 a[22:23], v20 offset:14080
    v_mfma_f32_16x16x32_bf16 v[92:95], a[0:3], a[136:139], v[92:95]
    ds_read_b64_tr_b16 a[24:25], v21 offset:12544
    v_mfma_f32_16x16x32_bf16 v[84:87], a[0:3], a[132:135], v[84:87]
    ds_read_b64_tr_b16 a[26:27], v21 offset:14080
    s_waitcnt lgkmcnt(4)
    v_mfma_f32_16x16x32_bf16 v[96:99], a[4:7], a[132:135], v[96:99]
    ds_read_b64_tr_b16 a[0:1], v22 offset:12544
    v_mfma_f32_16x16x32_bf16 v[104:107], a[4:7], a[136:139], v[104:107]
    ds_read_b64_tr_b16 a[2:3], v22 offset:14080
    v_mfma_f32_16x16x32_bf16 v[108:111], a[8:11], a[136:139], v[108:111]
    ds_read_b64_tr_b16 a[4:5], v23 offset:12544
    v_mfma_f32_16x16x32_bf16 v[100:103], a[8:11], a[132:135], v[100:103]
    ds_read_b64_tr_b16 a[6:7], v23 offset:14080
    v_mfma_f32_16x16x32_bf16 v[112:115], a[12:15], a[132:135], v[112:115]
    ds_read_b64_tr_b16 a[8:9], v20 offset:15360
    v_mfma_f32_16x16x32_bf16 v[120:123], a[12:15], a[136:139], v[120:123]
    ds_read_b64_tr_b16 a[10:11], v20 offset:16896
    v_mfma_f32_16x16x32_bf16 v[124:127], a[16:19], a[136:139], v[124:127]
    ds_read_b64_tr_b16 a[12:13], v21 offset:15360
    v_mfma_f32_16x16x32_bf16 v[116:119], a[16:19], a[132:135], v[116:119]
    ds_read_b64_tr_b16 a[14:15], v21 offset:16896
    s_waitcnt lgkmcnt(4)
    v_mfma_f32_16x16x32_bf16 v[128:131], a[20:23], a[132:135], v[128:131]
    ds_read_b64_tr_b16 a[16:17], v22 offset:15360
    s_add_u32 s37, s37, 589824
    s_add_u32 m0, s36, 0
    v_mfma_f32_16x16x32_bf16 v[136:139], a[20:23], a[136:139], v[136:139]
    ds_read_b64_tr_b16 a[18:19], v22 offset:16896
    buffer_load_dwordx4 v10, s[8:11], s37 offen offset:0 lds
    v_mfma_f32_16x16x32_bf16 v[140:143], a[24:27], a[136:139], v[140:143]
    ds_read_b64_tr_b16 a[20:21], v23 offset:15360
    buffer_load_dwordx4 v11, s[8:11], s37 offen offset:1024 lds
    v_mfma_f32_16x16x32_bf16 v[132:135], a[24:27], a[132:135], v[132:135]
    ds_read_b64_tr_b16 a[22:23], v23 offset:16896
    buffer_load_dwordx4 v12, s[8:11], s37 offen offset:2048 lds
    v_mfma_f32_16x16x32_bf16 v[144:147], a[0:3], a[132:135], v[144:147]
    ds_read_b64_tr_b16 a[24:25], v20 offset:15488
    buffer_load_dwordx4 v13, s[8:11], s37 offen offset:3072 lds
    v_mfma_f32_16x16x32_bf16 v[152:155], a[0:3], a[136:139], v[152:155]
    ds_read_b64_tr_b16 a[26:27], v20 offset:17024
    s_add_u32 m0, s36, 4096
    v_mfma_f32_16x16x32_bf16 v[156:159], a[4:7], a[136:139], v[156:159]
    ds_read_b64_tr_b16 a[0:1], v21 offset:15488
    buffer_load_dwordx4 v14, s[8:11], s37 offen offset:0 lds
    v_mfma_f32_16x16x32_bf16 v[148:151], a[4:7], a[132:135], v[148:151]
    ds_read_b64_tr_b16 a[2:3], v21 offset:17024
    s_waitcnt lgkmcnt(4)
    v_mfma_f32_16x16x32_bf16 v[64:67], a[8:11], a[140:143], v[64:67]
    ds_read_b64_tr_b16 a[4:5], v22 offset:15488
    buffer_load_dwordx4 v15, s[8:11], s37 offen offset:1024 lds
    v_mfma_f32_16x16x32_bf16 v[72:75], a[8:11], a[144:147], v[72:75]
    ds_read_b64_tr_b16 a[6:7], v22 offset:17024
    s_add_u32 s38, s38, 128
    v_mfma_f32_16x16x32_bf16 v[76:79], a[12:15], a[144:147], v[76:79]
    ds_read_b64_tr_b16 a[8:9], v23 offset:15488
    s_add_u32 m0, s36, 32768
    v_mfma_f32_16x16x32_bf16 v[68:71], a[12:15], a[140:143], v[68:71]
    ds_read_b64_tr_b16 a[10:11], v23 offset:17024
    buffer_load_dwordx4 v16, s[4:7], s38 offen offset:0 lds
    v_mfma_f32_16x16x32_bf16 v[80:83], a[16:19], a[140:143], v[80:83]
    ds_read_b64_tr_b16 a[12:13], v20 offset:15616
    buffer_load_dwordx4 v17, s[4:7], s38 offen offset:1024 lds
    v_mfma_f32_16x16x32_bf16 v[88:91], a[16:19], a[144:147], v[88:91]
    ds_read_b64_tr_b16 a[14:15], v20 offset:17152
    buffer_load_dwordx4 v18, s[4:7], s38 offen offset:2048 lds
    v_mfma_f32_16x16x32_bf16 v[92:95], a[20:23], a[144:147], v[92:95]
    ds_read_b64_tr_b16 a[16:17], v21 offset:15616
    buffer_load_dwordx4 v19, s[4:7], s38 offen offset:3072 lds
    v_mfma_f32_16x16x32_bf16 v[84:87], a[20:23], a[140:143], v[84:87]
    ds_read_b64_tr_b16 a[18:19], v21 offset:17152
    s_waitcnt vmcnt(11) lgkmcnt(4)
    v_mfma_f32_16x16x32_bf16 v[96:99], a[24:27], a[140:143], v[96:99]
    ds_read_b64_tr_b16 a[20:21], v22 offset:15616
    s_movk_i32 s37, 384
    v_mfma_f32_16x16x32_bf16 v[104:107], a[24:27], a[144:147], v[104:107]
    ds_read_b64_tr_b16 a[22:23], v22 offset:17152
    s_add_u32 m0, s36, 6144
    v_mfma_f32_16x16x32_bf16 v[108:111], a[0:3], a[144:147], v[108:111]
    ds_read_b64_tr_b16 a[24:25], v23 offset:15616
    buffer_load_dwordx4 v10, s[8:11], s37 offen offset:0 lds
    v_mfma_f32_16x16x32_bf16 v[100:103], a[0:3], a[140:143], v[100:103]
    ds_read_b64_tr_b16 a[26:27], v23 offset:17152
    s_barrier
    v_mfma_f32_16x16x32_bf16 v[112:115], a[4:7], a[140:143], v[112:115]
    ds_read_b64_tr_b16 a[0:1], v20 offset:18432
    ds_read_b128 a[148:151], v24 offset:4096
    v_mfma_f32_16x16x32_bf16 v[120:123], a[4:7], a[144:147], v[120:123]
    ds_read_b64_tr_b16 a[2:3], v20 offset:19968
    ds_read_b128 a[152:155], v24 offset:6144
    v_mfma_f32_16x16x32_bf16 v[124:127], a[8:11], a[144:147], v[124:127]
    ds_read_b64_tr_b16 a[4:5], v21 offset:18432
    ds_read_b128 a[156:159], v25 offset:4096
    buffer_load_dwordx4 v11, s[8:11], s37 offen offset:1024 lds
    v_mfma_f32_16x16x32_bf16 v[116:119], a[8:11], a[140:143], v[116:119]
    ds_read_b64_tr_b16 a[6:7], v21 offset:19968
    s_waitcnt lgkmcnt(7)
    v_mfma_f32_16x16x32_bf16 v[128:131], a[12:15], a[140:143], v[128:131]
    ds_read_b64_tr_b16 a[8:9], v22 offset:18432
    ds_read_b128 a[160:163], v25 offset:6144
    v_mfma_f32_16x16x32_bf16 v[136:139], a[12:15], a[144:147], v[136:139]
    ds_read_b64_tr_b16 a[10:11], v22 offset:19968
    buffer_load_dwordx4 v12, s[8:11], s37 offen offset:2048 lds
    v_mfma_f32_16x16x32_bf16 v[140:143], a[16:19], a[144:147], v[140:143]
    ds_read_b64_tr_b16 a[12:13], v23 offset:18432
    v_mfma_f32_16x16x32_bf16 v[132:135], a[16:19], a[140:143], v[132:135]
    ds_read_b64_tr_b16 a[14:15], v23 offset:19968
    buffer_load_dwordx4 v13, s[8:11], s37 offen offset:3072 lds
    v_mfma_f32_16x16x32_bf16 v[144:147], a[20:23], a[140:143], v[144:147]
    ds_read_b64_tr_b16 a[16:17], v20 offset:18560
    s_add_u32 m0, s36, 10240
    v_mfma_f32_16x16x32_bf16 v[152:155], a[20:23], a[144:147], v[152:155]
    ds_read_b64_tr_b16 a[18:19], v20 offset:20096
    buffer_load_dwordx4 v14, s[8:11], s37 offen offset:0 lds
    v_mfma_f32_16x16x32_bf16 v[156:159], a[24:27], a[144:147], v[156:159]
    ds_read_b64_tr_b16 a[20:21], v21 offset:18560
    buffer_load_dwordx4 v15, s[8:11], s37 offen offset:1024 lds
    v_mfma_f32_16x16x32_bf16 v[148:151], a[24:27], a[140:143], v[148:151]
    ds_read_b64_tr_b16 a[22:23], v21 offset:20096
    s_waitcnt lgkmcnt(4)
L_stage7:
    v_mfma_f32_16x16x32_bf16 v[64:67], a[0:3], a[148:151], v[64:67]
    ds_read_b64_tr_b16 a[24:25], v22 offset:18560
    v_mfma_f32_16x16x32_bf16 v[72:75], a[0:3], a[152:155], v[72:75]
    ds_read_b64_tr_b16 a[26:27], v22 offset:20096
    s_add_u32 s37, s37, 589824
    v_mfma_f32_16x16x32_bf16 v[76:79], a[4:7], a[152:155], v[76:79]
    ds_read_b64_tr_b16 a[0:1], v23 offset:18560
    s_add_u32 m0, s36, 12288
    v_mfma_f32_16x16x32_bf16 v[68:71], a[4:7], a[148:151], v[68:71]
    ds_read_b64_tr_b16 a[2:3], v23 offset:20096
    buffer_load_dwordx4 v10, s[8:11], s37 offen offset:0 lds
    v_mfma_f32_16x16x32_bf16 v[80:83], a[8:11], a[148:151], v[80:83]
    ds_read_b64_tr_b16 a[4:5], v20 offset:18688
    v_mfma_f32_16x16x32_bf16 v[88:91], a[8:11], a[152:155], v[88:91]
    ds_read_b64_tr_b16 a[6:7], v20 offset:20224
    v_mfma_f32_16x16x32_bf16 v[92:95], a[12:15], a[152:155], v[92:95]
    ds_read_b64_tr_b16 a[8:9], v21 offset:18688
    v_mfma_f32_16x16x32_bf16 v[84:87], a[12:15], a[148:151], v[84:87]
    ds_read_b64_tr_b16 a[10:11], v21 offset:20224
    s_waitcnt lgkmcnt(4)
    v_mfma_f32_16x16x32_bf16 v[96:99], a[16:19], a[148:151], v[96:99]
    ds_read_b64_tr_b16 a[12:13], v22 offset:18688
    v_mfma_f32_16x16x32_bf16 v[104:107], a[16:19], a[152:155], v[104:107]
    ds_read_b64_tr_b16 a[14:15], v22 offset:20224
    v_mfma_f32_16x16x32_bf16 v[108:111], a[20:23], a[152:155], v[108:111]
    ds_read_b64_tr_b16 a[16:17], v23 offset:18688
    buffer_load_dwordx4 v11, s[8:11], s37 offen offset:1024 lds
    v_mfma_f32_16x16x32_bf16 v[100:103], a[20:23], a[148:151], v[100:103]
    ds_read_b64_tr_b16 a[18:19], v23 offset:20224
    v_and_b32 v32, 1, v1
    v_mfma_f32_16x16x32_bf16 v[112:115], a[24:27], a[148:151], v[112:115]
    ds_read_b64_tr_b16 a[20:21], v20 offset:21504
    v_lshl_add_u32 v32, s3, 1, v32
    v_mfma_f32_16x16x32_bf16 v[120:123], a[24:27], a[152:155], v[120:123]
    ds_read_b64_tr_b16 a[22:23], v20 offset:23040
    v_lshlrev_b32 v32, 7, v32
    v_mfma_f32_16x16x32_bf16 v[124:127], a[0:3], a[152:155], v[124:127]
    ds_read_b64_tr_b16 a[24:25], v21 offset:21504
    v_add_u32 v32, L_stage11-L_pc, v32
    v_mfma_f32_16x16x32_bf16 v[116:119], a[0:3], a[148:151], v[116:119]
    ds_read_b64_tr_b16 a[26:27], v21 offset:23040
    s_waitcnt lgkmcnt(4)
    v_mfma_f32_16x16x32_bf16 v[128:131], a[4:7], a[148:151], v[128:131]
    ds_read_b64_tr_b16 a[0:1], v22 offset:21504
    global_load_dword v33, v32, s[0:1]
    v_mfma_f32_16x16x32_bf16 v[136:139], a[4:7], a[152:155], v[136:139]
    ds_read_b64_tr_b16 a[2:3], v22 offset:23040
    v_mfma_f32_16x16x32_bf16 v[140:143], a[8:11], a[152:155], v[140:143]
    ds_read_b64_tr_b16 a[4:5], v23 offset:21504
    v_mfma_f32_16x16x32_bf16 v[132:135], a[8:11], a[148:151], v[132:135]
    ds_read_b64_tr_b16 a[6:7], v23 offset:23040
    v_mfma_f32_16x16x32_bf16 v[144:147], a[12:15], a[148:151], v[144:147]
    ds_read_b64_tr_b16 a[8:9], v20 offset:21632
    buffer_load_dwordx4 v12, s[8:11], s37 offen offset:2048 lds
    v_mfma_f32_16x16x32_bf16 v[152:155], a[12:15], a[152:155], v[152:155]
    ds_read_b64_tr_b16 a[10:11], v20 offset:23168
    v_mfma_f32_16x16x32_bf16 v[156:159], a[16:19], a[152:155], v[156:159]
    ds_read_b64_tr_b16 a[12:13], v21 offset:21632
    v_mfma_f32_16x16x32_bf16 v[148:151], a[16:19], a[148:151], v[148:151]
    ds_read_b64_tr_b16 a[14:15], v21 offset:23168
    s_waitcnt lgkmcnt(4)
    v_mfma_f32_16x16x32_bf16 v[64:67], a[20:23], a[156:159], v[64:67]
    ds_read_b64_tr_b16 a[16:17], v22 offset:21632
    v_mfma_f32_16x16x32_bf16 v[72:75], a[20:23], a[160:163], v[72:75]
    ds_read_b64_tr_b16 a[18:19], v22 offset:23168
    buffer_load_dwordx4 v13, s[8:11], s37 offen offset:3072 lds
    v_mfma_f32_16x16x32_bf16 v[76:79], a[24:27], a[160:163], v[76:79]
    ds_read_b64_tr_b16 a[20:21], v23 offset:21632
    v_mfma_f32_16x16x32_bf16 v[68:71], a[24:27], a[156:159], v[68:71]
    ds_read_b64_tr_b16 a[22:23], v23 offset:23168
    s_add_u32 m0, s36, 16384
    v_mfma_f32_16x16x32_bf16 v[80:83], a[0:3], a[156:159], v[80:83]
    ds_read_b64_tr_b16 a[24:25], v20 offset:21760
    v_mfma_f32_16x16x32_bf16 v[88:91], a[0:3], a[160:163], v[88:91]
    ds_read_b64_tr_b16 a[26:27], v20 offset:23296
    v_mfma_f32_16x16x32_bf16 v[92:95], a[4:7], a[160:163], v[92:95]
    ds_read_b64_tr_b16 a[0:1], v21 offset:21760
    buffer_load_dwordx4 v14, s[8:11], s37 offen offset:0 lds
    v_mfma_f32_16x16x32_bf16 v[84:87], a[4:7], a[156:159], v[84:87]
    ds_read_b64_tr_b16 a[2:3], v21 offset:23296
    s_waitcnt vmcnt(12) lgkmcnt(4)
    v_mfma_f32_16x16x32_bf16 v[96:99], a[8:11], a[156:159], v[96:99]
    ds_read_b64_tr_b16 a[4:5], v22 offset:21760
    v_mfma_f32_16x16x32_bf16 v[104:107], a[8:11], a[160:163], v[104:107]
    ds_read_b64_tr_b16 a[6:7], v22 offset:23296
    v_mfma_f32_16x16x32_bf16 v[108:111], a[12:15], a[160:163], v[108:111]
    ds_read_b64_tr_b16 a[8:9], v23 offset:21760
    v_mfma_f32_16x16x32_bf16 v[100:103], a[12:15], a[156:159], v[100:103]
    ds_read_b64_tr_b16 a[10:11], v23 offset:23296
    s_barrier
    v_mfma_f32_16x16x32_bf16 v[112:115], a[16:19], a[156:159], v[112:115]
    ds_read_b64_tr_b16 a[12:13], v20 offset:0
    ds_read_b128 a[164:167], v24 offset:8192
    v_mfma_f32_16x16x32_bf16 v[120:123], a[16:19], a[160:163], v[120:123]
    ds_read_b64_tr_b16 a[14:15], v20 offset:1536
    ds_read_b128 a[168:171], v24 offset:10240
    v_mfma_f32_16x16x32_bf16 v[124:127], a[20:23], a[160:163], v[124:127]
    ds_read_b64_tr_b16 a[16:17], v21 offset:0
    ds_read_b128 a[172:175], v25 offset:8192
    v_mfma_f32_16x16x32_bf16 v[116:119], a[20:23], a[156:159], v[116:119]
    ds_read_b64_tr_b16 a[18:19], v21 offset:1536
    s_waitcnt lgkmcnt(7)
    v_mfma_f32_16x16x32_bf16 v[128:131], a[24:27], a[156:159], v[128:131]
    ds_read_b64_tr_b16 a[20:21], v22 offset:0
    ds_read_b128 a[176:179], v25 offset:10240
    v_mfma_f32_16x16x32_bf16 v[136:139], a[24:27], a[160:163], v[136:139]
    ds_read_b64_tr_b16 a[22:23], v22 offset:1536
    buffer_load_dwordx4 v15, s[8:11], s37 offen offset:1024 lds
    v_mfma_f32_16x16x32_bf16 v[140:143], a[0:3], a[160:163], v[140:143]
    ds_read_b64_tr_b16 a[24:25], v23 offset:0
    v_mfma_f32_16x16x32_bf16 v[132:135], a[0:3], a[156:159], v[132:135]
    ds_read_b64_tr_b16 a[26:27], v23 offset:1536
    v_mfma_f32_16x16x32_bf16 v[144:147], a[4:7], a[156:159], v[144:147]
    ds_read_b64_tr_b16 a[0:1], v20 offset:128
    v_lshlrev_b32 v62, 2, v1
    v_mfma_f32_16x16x32_bf16 v[152:155], a[4:7], a[160:163], v[152:155]
    ds_read_b64_tr_b16 a[2:3], v20 offset:1664
    buffer_load_dword v63, v7, s[16:19], 0 offen sc1
    v_mfma_f32_16x16x32_bf16 v[156:159], a[8:11], a[160:163], v[156:159]
    ds_read_b64_tr_b16 a[4:5], v21 offset:128
    v_and_b32 v61, 15, v1
    v_mfma_f32_16x16x32_bf16 v[148:151], a[8:11], a[156:159], v[148:151]
    ds_read_b64_tr_b16 a[6:7], v21 offset:1664
    s_waitcnt lgkmcnt(4)
L_stage8:
    v_mfma_f32_16x16x32_bf16 v[64:67], a[12:15], a[164:167], v[64:67]
    ds_read_b64_tr_b16 a[8:9], v22 offset:128
    v_lshlrev_b32 v61, 3, v61
    v_mfma_f32_16x16x32_bf16 v[72:75], a[12:15], a[168:171], v[72:75]
    ds_read_b64_tr_b16 a[10:11], v22 offset:1664
    s_add_u32 s37, s37, 589824
    v_mfma_f32_16x16x32_bf16 v[76:79], a[16:19], a[168:171], v[76:79]
    ds_read_b64_tr_b16 a[12:13], v23 offset:128
    s_add_u32 m0, s36, 18432
    v_mfma_f32_16x16x32_bf16 v[68:71], a[16:19], a[164:167], v[68:71]
    ds_read_b64_tr_b16 a[14:15], v23 offset:1664
    buffer_load_dwordx4 v10, s[8:11], s37 offen offset:0 lds
    v_mfma_f32_16x16x32_bf16 v[80:83], a[20:23], a[164:167], v[80:83]
    ds_read_b64_tr_b16 a[16:17], v20 offset:256
    s_lshl_b32 s51, s29, 2
    v_mfma_f32_16x16x32_bf16 v[88:91], a[20:23], a[168:171], v[88:91]
    ds_read_b64_tr_b16 a[18:19], v20 offset:1792
    s_add_u32 s51, s51, s28
    v_mfma_f32_16x16x32_bf16 v[92:95], a[24:27], a[168:171], v[92:95]
    ds_read_b64_tr_b16 a[20:21], v21 offset:256
    s_lshl_b32 s51, s51, 8
    v_mfma_f32_16x16x32_bf16 v[84:87], a[24:27], a[164:167], v[84:87]
    ds_read_b64_tr_b16 a[22:23], v21 offset:1792
    s_waitcnt lgkmcnt(4)
    v_mfma_f32_16x16x32_bf16 v[96:99], a[0:3], a[164:167], v[96:99]
    ds_read_b64_tr_b16 a[24:25], v22 offset:256
    s_add_u32 s51, s51, 16384
    v_mfma_f32_16x16x32_bf16 v[104:107], a[0:3], a[168:171], v[104:107]
    ds_read_b64_tr_b16 a[26:27], v22 offset:1792
    v_mfma_f32_16x16x32_bf16 v[108:111], a[4:7], a[168:171], v[108:111]
    ds_read_b64_tr_b16 a[0:1], v23 offset:256
    v_mfma_f32_16x16x32_bf16 v[100:103], a[4:7], a[164:167], v[100:103]
    ds_read_b64_tr_b16 a[2:3], v23 offset:1792
    buffer_load_dwordx4 v11, s[8:11], s37 offen offset:1024 lds
    v_mfma_f32_16x16x32_bf16 v[112:115], a[8:11], a[164:167], v[112:115]
    ds_read_b64_tr_b16 a[4:5], v20 offset:3072
    v_mfma_f32_16x16x32_bf16 v[120:123], a[8:11], a[168:171], v[120:123]
    ds_read_b64_tr_b16 a[6:7], v20 offset:4608
    v_mfma_f32_16x16x32_bf16 v[124:127], a[12:15], a[168:171], v[124:127]
    ds_read_b64_tr_b16 a[8:9], v21 offset:3072
    v_mfma_f32_16x16x32_bf16 v[116:119], a[12:15], a[164:167], v[116:119]
    ds_read_b64_tr_b16 a[10:11], v21 offset:4608
    s_waitcnt lgkmcnt(4)
    v_mfma_f32_16x16x32_bf16 v[128:131], a[16:19], a[164:167], v[128:131]
    ds_read_b64_tr_b16 a[12:13], v22 offset:3072
    v_mfma_f32_16x16x32_bf16 v[136:139], a[16:19], a[168:171], v[136:139]
    ds_read_b64_tr_b16 a[14:15], v22 offset:4608
    v_mfma_f32_16x16x32_bf16 v[140:143], a[20:23], a[168:171], v[140:143]
    ds_read_b64_tr_b16 a[16:17], v23 offset:3072
    v_mfma_f32_16x16x32_bf16 v[132:135], a[20:23], a[164:167], v[132:135]
    ds_read_b64_tr_b16 a[18:19], v23 offset:4608
    buffer_load_dwordx4 v12, s[8:11], s37 offen offset:2048 lds
    v_mfma_f32_16x16x32_bf16 v[144:147], a[24:27], a[164:167], v[144:147]
    ds_read_b64_tr_b16 a[20:21], v20 offset:3200
    v_mfma_f32_16x16x32_bf16 v[152:155], a[24:27], a[168:171], v[152:155]
    ds_read_b64_tr_b16 a[22:23], v20 offset:4736
    v_mfma_f32_16x16x32_bf16 v[156:159], a[0:3], a[168:171], v[156:159]
    ds_read_b64_tr_b16 a[24:25], v21 offset:3200
    v_mfma_f32_16x16x32_bf16 v[148:151], a[0:3], a[164:167], v[148:151]
    ds_read_b64_tr_b16 a[26:27], v21 offset:4736
    s_waitcnt lgkmcnt(4)
    v_mfma_f32_16x16x32_bf16 v[64:67], a[4:7], a[172:175], v[64:67]
    ds_read_b64_tr_b16 a[0:1], v22 offset:3200
    v_mfma_f32_16x16x32_bf16 v[72:75], a[4:7], a[176:179], v[72:75]
    ds_read_b64_tr_b16 a[2:3], v22 offset:4736
    v_mfma_f32_16x16x32_bf16 v[76:79], a[8:11], a[176:179], v[76:79]
    ds_read_b64_tr_b16 a[4:5], v23 offset:3200
    buffer_load_dwordx4 v13, s[8:11], s37 offen offset:3072 lds
    v_mfma_f32_16x16x32_bf16 v[68:71], a[8:11], a[172:175], v[68:71]
    ds_read_b64_tr_b16 a[6:7], v23 offset:4736
    v_mfma_f32_16x16x32_bf16 v[80:83], a[12:15], a[172:175], v[80:83]
    ds_read_b64_tr_b16 a[8:9], v20 offset:3328
    s_add_u32 m0, s36, 22528
    v_mfma_f32_16x16x32_bf16 v[88:91], a[12:15], a[176:179], v[88:91]
    ds_read_b64_tr_b16 a[10:11], v20 offset:4864
    v_mfma_f32_16x16x32_bf16 v[92:95], a[16:19], a[176:179], v[92:95]
    ds_read_b64_tr_b16 a[12:13], v21 offset:3328
    v_mfma_f32_16x16x32_bf16 v[84:87], a[16:19], a[172:175], v[84:87]
    ds_read_b64_tr_b16 a[14:15], v21 offset:4864
    s_waitcnt vmcnt(12) lgkmcnt(4)
    buffer_load_dwordx4 v14, s[8:11], s37 offen offset:0 lds
    v_mfma_f32_16x16x32_bf16 v[96:99], a[20:23], a[172:175], v[96:99]
    ds_read_b64_tr_b16 a[16:17], v22 offset:3328
    s_waitcnt vmcnt(5)
    v_cmp_eq_u32 vcc, v6, v63
    s_nop 0
    s_and_b64 vcc, vcc, 0x7f
    s_and_b64 vcc, vcc, s[100:101]
    s_cbranch_vccnz L_pa_slow
L_pa_ok:
    v_mfma_f32_16x16x32_bf16 v[104:107], a[20:23], a[176:179], v[104:107]
    ds_read_b64_tr_b16 a[18:19], v22 offset:4864
    v_mfma_f32_16x16x32_bf16 v[108:111], a[24:27], a[176:179], v[108:111]
    ds_read_b64_tr_b16 a[20:21], v23 offset:3328
    v_mfma_f32_16x16x32_bf16 v[100:103], a[24:27], a[172:175], v[100:103]
    ds_read_b64_tr_b16 a[22:23], v23 offset:4864
    s_barrier
    v_mfma_f32_16x16x32_bf16 v[112:115], a[0:3], a[172:175], v[112:115]
    ds_read_b64_tr_b16 a[24:25], v20 offset:6144
    buffer_load_dwordx2 v[40:41], v61, s[16:19], s51 offen sc1
    v_mfma_f32_16x16x32_bf16 v[120:123], a[0:3], a[176:179], v[120:123]
    ds_read_b64_tr_b16 a[26:27], v20 offset:7680
    buffer_load_dwordx2 v[42:43], v61, s[16:19], s51 offen offset:128 sc1
    v_mfma_f32_16x16x32_bf16 v[124:127], a[4:7], a[176:179], v[124:127]
    ds_read_b64_tr_b16 a[0:1], v21 offset:6144
    v_mfma_f32_16x16x32_bf16 v[116:119], a[4:7], a[172:175], v[116:119]
    ds_read_b64_tr_b16 a[2:3], v21 offset:7680
    s_waitcnt lgkmcnt(4)
    v_mfma_f32_16x16x32_bf16 v[128:131], a[8:11], a[172:175], v[128:131]
    ds_read_b64_tr_b16 a[4:5], v22 offset:6144
    v_mfma_f32_16x16x32_bf16 v[136:139], a[8:11], a[176:179], v[136:139]
    ds_read_b64_tr_b16 a[6:7], v22 offset:7680
    v_mfma_f32_16x16x32_bf16 v[140:143], a[12:15], a[176:179], v[140:143]
    ds_read_b64_tr_b16 a[8:9], v23 offset:6144
    v_mfma_f32_16x16x32_bf16 v[132:135], a[12:15], a[172:175], v[132:135]
    ds_read_b64_tr_b16 a[10:11], v23 offset:7680
    buffer_load_dwordx4 v15, s[8:11], s37 offen offset:1024 lds
    v_mfma_f32_16x16x32_bf16 v[144:147], a[16:19], a[172:175], v[144:147]
    ds_read_b64_tr_b16 a[12:13], v20 offset:6272
    v_mfma_f32_16x16x32_bf16 v[152:155], a[16:19], a[176:179], v[152:155]
    ds_read_b64_tr_b16 a[14:15], v20 offset:7808
    v_mfma_f32_16x16x32_bf16 v[156:159], a[20:23], a[176:179], v[156:159]
    ds_read_b64_tr_b16 a[16:17], v21 offset:6272
    v_mfma_f32_16x16x32_bf16 v[148:151], a[20:23], a[172:175], v[148:151]
    ds_read_b64_tr_b16 a[18:19], v21 offset:7808
    s_waitcnt lgkmcnt(4)
L_stage9:
    v_mfma_f32_16x16x32_bf16 v[160:163], a[24:27], a[36:39], 0
    ds_read_b64_tr_b16 a[20:21], v22 offset:6272
    s_mul_i32 s32, s39, 1536
    v_mfma_f32_16x16x32_bf16 v[168:171], a[24:27], a[40:43], 0
    ds_read_b64_tr_b16 a[22:23], v22 offset:7808
    s_add_u32 s32, s32, 32768
    v_mfma_f32_16x16x32_bf16 v[172:175], a[0:3], a[40:43], 0
    ds_read_b64_tr_b16 a[24:25], v23 offset:6272
    s_add_u32 m0, s36, 36864
    v_mfma_f32_16x16x32_bf16 v[164:167], a[0:3], a[36:39], 0
    ds_read_b64_tr_b16 a[26:27], v23 offset:7808
    s_nop 0
    v_mfma_f32_16x16x32_bf16 v[176:179], a[4:7], a[36:39], 0
    ds_read_b64_tr_b16 a[0:1], v20 offset:6400
    buffer_load_dwordx4 v38, s[16:19], s32 offen offset:0 sc1 lds
    v_mfma_f32_16x16x32_bf16 v[184:187], a[4:7], a[40:43], 0
    ds_read_b64_tr_b16 a[2:3], v20 offset:7936
    s_add_u32 s37, s37, 589824
    v_mfma_f32_16x16x32_bf16 v[188:191], a[8:11], a[40:43], 0
    ds_read_b64_tr_b16 a[4:5], v21 offset:6400
    s_add_u32 m0, s36, 24576
    v_mfma_f32_16x16x32_bf16 v[180:183], a[8:11], a[36:39], 0
    ds_read_b64_tr_b16 a[6:7], v21 offset:7936
    s_waitcnt lgkmcnt(4)
    v_mfma_f32_16x16x32_bf16 v[192:195], a[12:15], a[36:39], 0
    ds_read_b64_tr_b16 a[8:9], v22 offset:6400
    buffer_load_dwordx4 v10, s[8:11], s37 offen offset:0 lds
    v_mfma_f32_16x16x32_bf16 v[200:203], a[12:15], a[40:43], 0
    ds_read_b64_tr_b16 a[10:11], v22 offset:7936
    buffer_load_dwordx4 v11, s[8:11], s37 offen offset:1024 lds
    v_mfma_f32_16x16x32_bf16 v[204:207], a[16:19], a[40:43], 0
    ds_read_b64_tr_b16 a[12:13], v23 offset:6400
    v_lshrrev_b32 v4, 4, v1
    v_mfma_f32_16x16x32_bf16 v[196:199], a[16:19], a[36:39], 0
    ds_read_b64_tr_b16 a[14:15], v23 offset:7936
    v_bfe_u32 v5, v1, 2, 2
    v_mfma_f32_16x16x32_bf16 v[208:211], a[20:23], a[36:39], 0
    ds_read_b64_tr_b16 a[16:17], v20 offset:9216
    buffer_load_dwordx4 v12, s[8:11], s37 offen offset:2048 lds
    v_mfma_f32_16x16x32_bf16 v[216:219], a[20:23], a[40:43], 0
    ds_read_b64_tr_b16 a[18:19], v20 offset:10752
    v_and_b32 v4, 1, v4
    v_mfma_f32_16x16x32_bf16 v[220:223], a[24:27], a[40:43], 0
    ds_read_b64_tr_b16 a[20:21], v21 offset:9216
    v_lshrrev_b32 v8, 1, v5
    v_mfma_f32_16x16x32_bf16 v[212:215], a[24:27], a[36:39], 0
    ds_read_b64_tr_b16 a[22:23], v21 offset:10752
    s_waitcnt lgkmcnt(4)
    v_mfma_f32_16x16x32_bf16 v[224:227], a[0:3], a[36:39], 0
    ds_read_b64_tr_b16 a[24:25], v22 offset:9216
    buffer_load_dwordx4 v13, s[8:11], s37 offen offset:3072 lds
    v_mfma_f32_16x16x32_bf16 v[232:235], a[0:3], a[40:43], 0
    ds_read_b64_tr_b16 a[26:27], v22 offset:10752
    v_lshl_or_b32 v8, v4, 1, v8
    v_mfma_f32_16x16x32_bf16 v[236:239], a[4:7], a[40:43], 0
    ds_read_b64_tr_b16 a[0:1], v23 offset:9216
    s_add_u32 m0, s36, 28672
    v_mfma_f32_16x16x32_bf16 v[228:231], a[4:7], a[36:39], 0
    ds_read_b64_tr_b16 a[2:3], v23 offset:10752
    buffer_load_dwordx4 v14, s[8:11], s37 offen offset:0 lds
    v_mfma_f32_16x16x32_bf16 v[240:243], a[8:11], a[36:39], 0
    ds_read_b64_tr_b16 a[4:5], v20 offset:9344
    v_lshlrev_b32 v9, 5, v8
    v_mfma_f32_16x16x32_bf16 v[248:251], a[8:11], a[40:43], 0
    ds_read_b64_tr_b16 a[6:7], v20 offset:10880
    v_sub_u32 v9, v20, v9
    v_mfma_f32_16x16x32_bf16 v[252:255], a[12:15], a[40:43], 0
    ds_read_b64_tr_b16 a[8:9], v21 offset:9344
    buffer_load_dwordx4 v15, s[8:11], s37 offen offset:1024 lds
    v_mfma_f32_16x16x32_bf16 v[244:247], a[12:15], a[36:39], 0
    ds_read_b64_tr_b16 a[10:11], v21 offset:10880
    s_waitcnt lgkmcnt(4)
    v_mfma_f32_16x16x32_bf16 v[160:163], a[16:19], a[44:47], v[160:163]
    ds_read_b64_tr_b16 a[12:13], v22 offset:9344
    s_add_u32 s37, s37, 589824
    v_mfma_f32_16x16x32_bf16 v[168:171], a[16:19], a[48:51], v[168:171]
    ds_read_b64_tr_b16 a[14:15], v22 offset:10880
    s_add_u32 m0, s36, 30720
    v_mfma_f32_16x16x32_bf16 v[172:175], a[20:23], a[48:51], v[172:175]
    ds_read_b64_tr_b16 a[16:17], v23 offset:9344
    buffer_load_dwordx4 v10, s[8:11], s37 offen offset:0 lds
    v_mfma_f32_16x16x32_bf16 v[164:167], a[20:23], a[44:47], v[164:167]
    ds_read_b64_tr_b16 a[18:19], v23 offset:10880
    s_xor_b32 s33, s31, 0
    v_mfma_f32_16x16x32_bf16 v[176:179], a[24:27], a[44:47], v[176:179]
    ds_read_b64_tr_b16 a[20:21], v20 offset:9472
    s_mul_i32 s33, s33, 3
    v_mfma_f32_16x16x32_bf16 v[184:187], a[24:27], a[48:51], v[184:187]
    ds_read_b64_tr_b16 a[22:23], v20 offset:11008
    buffer_load_dwordx4 v11, s[8:11], s37 offen offset:1024 lds
    v_mfma_f32_16x16x32_bf16 v[188:191], a[0:3], a[48:51], v[188:191]
    ds_read_b64_tr_b16 a[24:25], v21 offset:9472
    v_xor_b32 v2, s33, v8
    v_mfma_f32_16x16x32_bf16 v[180:183], a[0:3], a[44:47], v[180:183]
    ds_read_b64_tr_b16 a[26:27], v21 offset:11008
    s_waitcnt lgkmcnt(4)
    v_mfma_f32_16x16x32_bf16 v[192:195], a[4:7], a[44:47], v[192:195]
    ds_read_b64_tr_b16 a[0:1], v22 offset:9472
    v_lshl_add_u32 v32, v2, 5, v9
    v_mfma_f32_16x16x32_bf16 v[200:203], a[4:7], a[48:51], v[200:203]
    ds_read_b64_tr_b16 a[2:3], v22 offset:11008
    buffer_load_dwordx4 v12, s[8:11], s37 offen offset:2048 lds
    v_mfma_f32_16x16x32_bf16 v[204:207], a[8:11], a[48:51], v[204:207]
    ds_read_b64_tr_b16 a[4:5], v23 offset:9472
    s_add_u32 s33, s33, 1
    v_mfma_f32_16x16x32_bf16 v[196:199], a[8:11], a[44:47], v[196:199]
    ds_read_b64_tr_b16 a[6:7], v23 offset:11008
    s_barrier
    v_mfma_f32_16x16x32_bf16 v[208:211], a[12:15], a[44:47], v[208:211]
    ds_read_b64_tr_b16 a[8:9], v20 offset:12288
    v_xor_b32 v2, s33, v8
    v_mfma_f32_16x16x32_bf16 v[216:219], a[12:15], a[48:51], v[216:219]
    ds_read_b64_tr_b16 a[10:11], v20 offset:13824
    v_lshl_add_u32 v33, v2, 5, v9
    v_mfma_f32_16x16x32_bf16 v[220:223], a[16:19], a[48:51], v[220:223]
    ds_read_b64_tr_b16 a[12:13], v21 offset:12288
    buffer_load_dwordx4 v13, s[8:11], s37 offen offset:3072 lds
    v_mfma_f32_16x16x32_bf16 v[212:215], a[16:19], a[44:47], v[212:215]
    ds_read_b64_tr_b16 a[14:15], v21 offset:13824
    s_waitcnt lgkmcnt(4)
    v_mfma_f32_16x16x32_bf16 v[224:227], a[20:23], a[44:47], v[224:227]
    ds_read_b64_tr_b16 a[16:17], v22 offset:12288
    s_add_u32 s33, s33, 1
    v_mfma_f32_16x16x32_bf16 v[232:235], a[20:23], a[48:51], v[232:235]
    ds_read_b64_tr_b16 a[18:19], v22 offset:13824
    s_add_u32 m0, s36, 34816
    v_mfma_f32_16x16x32_bf16 v[236:239], a[24:27], a[48:51], v[236:239]
    ds_read_b64_tr_b16 a[20:21], v23 offset:12288
    buffer_load_dwordx4 v14, s[8:11], s37 offen offset:0 lds
    v_mfma_f32_16x16x32_bf16 v[228:231], a[24:27], a[44:47], v[228:231]
    ds_read_b64_tr_b16 a[22:23], v23 offset:13824
    v_xor_b32 v2, s33, v8
    v_mfma_f32_16x16x32_bf16 v[240:243], a[0:3], a[44:47], v[240:243]
    ds_read_b64_tr_b16 a[24:25], v20 offset:12416
    v_mfma_f32_16x16x32_bf16 v[248:251], a[0:3], a[48:51], v[248:251]
    ds_read_b64_tr_b16 a[26:27], v20 offset:13952
    buffer_load_dwordx4 v15, s[8:11], s37 offen offset:1024 lds
    v_mfma_f32_16x16x32_bf16 v[252:255], a[4:7], a[48:51], v[252:255]
    ds_read_b64_tr_b16 a[0:1], v21 offset:12416
    v_lshl_add_u32 v34, v2, 5, v9
    v_mfma_f32_16x16x32_bf16 v[244:247], a[4:7], a[44:47], v[244:247]
    ds_read_b64_tr_b16 a[2:3], v21 offset:13952
    s_waitcnt lgkmcnt(4)
L_stage10:
    v_mfma_f32_16x16x32_bf16 v[160:163], a[8:11], a[52:55], v[160:163]
    ds_read_b64_tr_b16 a[4:5], v22 offset:12416
    s_xor_b32 s33, s31, 1
    v_mfma_f32_16x16x32_bf16 v[168:171], a[8:11], a[56:59], v[168:171]
    ds_read_b64_tr_b16 a[6:7], v22 offset:13952
    s_add_u32 s37, s37, 589824
    v_mfma_f32_16x16x32_bf16 v[172:175], a[12:15], a[56:59], v[172:175]
    ds_read_b64_tr_b16 a[8:9], v23 offset:12416
    s_add_u32 m0, s36, 0
    v_mfma_f32_16x16x32_bf16 v[164:167], a[12:15], a[52:55], v[164:167]
    ds_read_b64_tr_b16 a[10:11], v23 offset:13952
    buffer_load_dwordx4 v10, s[8:11], s37 offen offset:0 lds
    v_mfma_f32_16x16x32_bf16 v[176:179], a[16:19], a[52:55], v[176:179]
    ds_read_b64_tr_b16 a[12:13], v20 offset:12544
    s_mul_i32 s33, s33, 3
    v_mfma_f32_16x16x32_bf16 v[184:187], a[16:19], a[56:59], v[184:187]
    ds_read_b64_tr_b16 a[14:15], v20 offset:14080
    v_xor_b32 v2, s33, v8
    v_mfma_f32_16x16x32_bf16 v[188:191], a[20:23], a[56:59], v[188:191]
    ds_read_b64_tr_b16 a[16:17], v21 offset:12544
    v_lshl_add_u32 v35, v2, 5, v9
    v_mfma_f32_16x16x32_bf16 v[180:183], a[20:23], a[52:55], v[180:183]
    ds_read_b64_tr_b16 a[18:19], v21 offset:14080
    s_waitcnt lgkmcnt(4)
    v_mfma_f32_16x16x32_bf16 v[192:195], a[24:27], a[52:55], v[192:195]
    ds_read_b64_tr_b16 a[20:21], v22 offset:12544
    s_add_u32 s33, s33, 1
    v_mfma_f32_16x16x32_bf16 v[200:203], a[24:27], a[56:59], v[200:203]
    ds_read_b64_tr_b16 a[22:23], v22 offset:14080
    v_xor_b32 v2, s33, v8
    v_mfma_f32_16x16x32_bf16 v[204:207], a[0:3], a[56:59], v[204:207]
    ds_read_b64_tr_b16 a[24:25], v23 offset:12544
    v_lshl_add_u32 v36, v2, 5, v9
    v_mfma_f32_16x16x32_bf16 v[196:199], a[0:3], a[52:55], v[196:199]
    ds_read_b64_tr_b16 a[26:27], v23 offset:14080
    buffer_load_dwordx4 v11, s[8:11], s37 offen offset:1024 lds
    v_mfma_f32_16x16x32_bf16 v[208:211], a[4:7], a[52:55], v[208:211]
    ds_read_b64_tr_b16 a[0:1], v20 offset:15360
    s_add_u32 s33, s33, 1
    v_mfma_f32_16x16x32_bf16 v[216:219], a[4:7], a[56:59], v[216:219]
    ds_read_b64_tr_b16 a[2:3], v20 offset:16896
    v_xor_b32 v2, s33, v8
    v_mfma_f32_16x16x32_bf16 v[220:223], a[8:11], a[56:59], v[220:223]
    ds_read_b64_tr_b16 a[4:5], v21 offset:15360
    v_lshl_add_u32 v37, v2, 5, v9
    v_mfma_f32_16x16x32_bf16 v[212:215], a[8:11], a[52:55], v[212:215]
    ds_read_b64_tr_b16 a[6:7], v21 offset:16896
    s_waitcnt lgkmcnt(4)
    v_mfma_f32_16x16x32_bf16 v[224:227], a[12:15], a[52:55], v[224:227]
    ds_read_b64_tr_b16 a[8:9], v22 offset:15360
    s_xor_b32 s33, s31, 2
    v_mfma_f32_16x16x32_bf16 v[232:235], a[12:15], a[56:59], v[232:235]
    ds_read_b64_tr_b16 a[10:11], v22 offset:16896
    s_mul_i32 s33, s33, 3
    v_mfma_f32_16x16x32_bf16 v[236:239], a[16:19], a[56:59], v[236:239]
    ds_read_b64_tr_b16 a[12:13], v23 offset:15360
    v_xor_b32 v2, s33, v8
    v_mfma_f32_16x16x32_bf16 v[228:231], a[16:19], a[52:55], v[228:231]
    ds_read_b64_tr_b16 a[14:15], v23 offset:16896
    buffer_load_dwordx4 v12, s[8:11], s37 offen offset:2048 lds
    v_mfma_f32_16x16x32_bf16 v[240:243], a[20:23], a[52:55], v[240:243]
    ds_read_b64_tr_b16 a[16:17], v20 offset:15488
    v_lshl_add_u32 v16, v2, 5, v9
    v_mfma_f32_16x16x32_bf16 v[248:251], a[20:23], a[56:59], v[248:251]
    ds_read_b64_tr_b16 a[18:19], v20 offset:17024
    s_add_u32 s33, s33, 1
    v_mfma_f32_16x16x32_bf16 v[252:255], a[24:27], a[56:59], v[252:255]
    ds_read_b64_tr_b16 a[20:21], v21 offset:15488
    v_mfma_f32_16x16x32_bf16 v[244:247], a[24:27], a[52:55], v[244:247]
    ds_read_b64_tr_b16 a[22:23], v21 offset:17024
    s_waitcnt lgkmcnt(4)
    v_mfma_f32_16x16x32_bf16 v[160:163], a[0:3], a[60:63], v[160:163]
    ds_read_b64_tr_b16 a[24:25], v22 offset:15488
    v_xor_b32 v2, s33, v8
    v_mfma_f32_16x16x32_bf16 v[168:171], a[0:3], a[64:67], v[168:171]
    ds_read_b64_tr_b16 a[26:27], v22 offset:17024
    v_lshl_add_u32 v17, v2, 5, v9
    v_mfma_f32_16x16x32_bf16 v[172:175], a[4:7], a[64:67], v[172:175]
    ds_read_b64_tr_b16 a[0:1], v23 offset:15488
    buffer_load_dwordx4 v13, s[8:11], s37 offen offset:3072 lds
    v_mfma_f32_16x16x32_bf16 v[164:167], a[4:7], a[60:63], v[164:167]
    ds_read_b64_tr_b16 a[2:3], v23 offset:17024
    s_add_u32 s33, s33, 1
    v_mfma_f32_16x16x32_bf16 v[176:179], a[8:11], a[60:63], v[176:179]
    ds_read_b64_tr_b16 a[4:5], v20 offset:15616
    v_xor_b32 v2, s33, v8
    v_mfma_f32_16x16x32_bf16 v[184:187], a[8:11], a[64:67], v[184:187]
    ds_read_b64_tr_b16 a[6:7], v20 offset:17152
    v_lshl_add_u32 v18, v2, 5, v9
    v_mfma_f32_16x16x32_bf16 v[188:191], a[12:15], a[64:67], v[188:191]
    ds_read_b64_tr_b16 a[8:9], v21 offset:15616
    s_xor_b32 s33, s31, 3
    v_mfma_f32_16x16x32_bf16 v[180:183], a[12:15], a[60:63], v[180:183]
    ds_read_b64_tr_b16 a[10:11], v21 offset:17152
    s_waitcnt vmcnt(17) lgkmcnt(4)
    v_mfma_f32_16x16x32_bf16 v[192:195], a[16:19], a[60:63], v[192:195]
    ds_read_b64_tr_b16 a[12:13], v22 offset:15616
    s_mul_i32 s33, s33, 3
    v_mfma_f32_16x16x32_bf16 v[200:203], a[16:19], a[64:67], v[200:203]
    ds_read_b64_tr_b16 a[14:15], v22 offset:17152
    s_add_u32 m0, s36, 4096
    v_mfma_f32_16x16x32_bf16 v[204:207], a[20:23], a[64:67], v[204:207]
    ds_read_b64_tr_b16 a[16:17], v23 offset:15616
    buffer_load_dwordx4 v14, s[8:11], s37 offen offset:0 lds
    v_mfma_f32_16x16x32_bf16 v[196:199], a[20:23], a[60:63], v[196:199]
    ds_read_b64_tr_b16 a[18:19], v23 offset:17152
    s_barrier
    v_mfma_f32_16x16x32_bf16 v[208:211], a[24:27], a[60:63], v[208:211]
    ds_read_b64_tr_b16 a[20:21], v20 offset:18432
    v_xor_b32 v2, s33, v8
    v_mfma_f32_16x16x32_bf16 v[216:219], a[24:27], a[64:67], v[216:219]
    ds_read_b64_tr_b16 a[22:23], v20 offset:19968
    v_lshl_add_u32 v19, v2, 5, v9
    v_mfma_f32_16x16x32_bf16 v[220:223], a[0:3], a[64:67], v[220:223]
    ds_read_b64_tr_b16 a[24:25], v21 offset:18432
    s_add_u32 s33, s33, 1
    v_mfma_f32_16x16x32_bf16 v[212:215], a[0:3], a[60:63], v[212:215]
    ds_read_b64_tr_b16 a[26:27], v21 offset:19968
    s_waitcnt lgkmcnt(4)
    v_mfma_f32_16x16x32_bf16 v[224:227], a[4:7], a[60:63], v[224:227]
    ds_read_b64_tr_b16 a[0:1], v22 offset:18432
    v_xor_b32 v2, s33, v8
    v_mfma_f32_16x16x32_bf16 v[232:235], a[4:7], a[64:67], v[232:235]
    ds_read_b64_tr_b16 a[2:3], v22 offset:19968
    v_lshl_add_u32 v24, v2, 5, v9
    v_mfma_f32_16x16x32_bf16 v[236:239], a[8:11], a[64:67], v[236:239]
    ds_read_b64_tr_b16 a[4:5], v23 offset:18432
    s_add_u32 s33, s33, 1
    v_mfma_f32_16x16x32_bf16 v[228:231], a[8:11], a[60:63], v[228:231]
    ds_read_b64_tr_b16 a[6:7], v23 offset:19968
    buffer_load_dwordx4 v15, s[8:11], s37 offen offset:1024 lds
    v_mfma_f32_16x16x32_bf16 v[240:243], a[12:15], a[60:63], v[240:243]
    ds_read_b64_tr_b16 a[8:9], v20 offset:18560
    v_xor_b32 v2, s33, v8
    v_mfma_f32_16x16x32_bf16 v[248:251], a[12:15], a[64:67], v[248:251]
    ds_read_b64_tr_b16 a[10:11], v20 offset:20096
    v_lshl_add_u32 v25, v2, 5, v9
    v_mfma_f32_16x16x32_bf16 v[252:255], a[16:19], a[64:67], v[252:255]
    ds_read_b64_tr_b16 a[12:13], v21 offset:18560
    v_mfma_f32_16x16x32_bf16 v[244:247], a[16:19], a[60:63], v[244:247]
    ds_read_b64_tr_b16 a[14:15], v21 offset:20096
    s_waitcnt lgkmcnt(4)
L_stage11:
    v_mfma_f32_16x16x32_bf16 v[160:163], a[20:23], a[68:71], v[160:163]
    ds_read_b64_tr_b16 a[16:17], v22 offset:18560
    v_mfma_f32_16x16x32_bf16 v[168:171], a[20:23], a[72:75], v[168:171]
    ds_read_b64_tr_b16 a[18:19], v22 offset:20096
    s_add_u32 s37, s37, 589824
    v_mfma_f32_16x16x32_bf16 v[172:175], a[24:27], a[72:75], v[172:175]
    ds_read_b64_tr_b16 a[20:21], v23 offset:18560
    s_add_u32 m0, s36, 6144
    v_mfma_f32_16x16x32_bf16 v[164:167], a[24:27], a[68:71], v[164:167]
    ds_read_b64_tr_b16 a[22:23], v23 offset:20096
    buffer_load_dwordx4 v10, s[8:11], s37 offen offset:0 lds
    v_mfma_f32_16x16x32_bf16 v[176:179], a[0:3], a[68:71], v[176:179]
    ds_read_b64_tr_b16 a[24:25], v20 offset:18688
    s_waitcnt vmcnt(19)
    v_xor_b32 v40, 0x80000000, v40
    v_xor_b32 v42, 0x80000000, v42
    v_mfma_f32_16x16x32_bf16 v[184:187], a[0:3], a[72:75], v[184:187]
    ds_read_b64_tr_b16 a[26:27], v20 offset:20224
    ds_read_b128 v[44:47], v39 offset:0
    ds_read_b128 v[48:51], v39 offset:64
    v_mfma_f32_16x16x32_bf16 v[188:191], a[4:7], a[72:75], v[188:191]
    ds_read_b64_tr_b16 a[0:1], v21 offset:18688
    s_add_u32 s52, s43, 0
    ds_read_b128 v[52:55], v39 offset:128
    v_mfma_f32_16x16x32_bf16 v[180:183], a[4:7], a[68:71], v[180:183]
    ds_read_b64_tr_b16 a[2:3], v21 offset:20224
    s_waitcnt lgkmcnt(7)
    ds_read_b128 v[56:59], v39 offset:192
    v_mfma_f32_16x16x32_bf16 v[192:195], a[8:11], a[68:71], v[192:195]
    ds_read_b64_tr_b16 a[4:5], v22 offset:18688
    s_waitcnt lgkmcnt(5)
    v_fmac_f32 v64, v40, v44
    v_mfma_f32_16x16x32_bf16 v[200:203], a[8:11], a[72:75], v[200:203]
    ds_read_b64_tr_b16 a[6:7], v22 offset:20224
    v_fmac_f32 v65, v40, v45
    v_fmac_f32 v66, v40, v46
    v_mfma_f32_16x16x32_bf16 v[204:207], a[12:15], a[72:75], v[204:207]
    ds_read_b64_tr_b16 a[8:9], v23 offset:18688
    v_fmac_f32 v67, v40, v47
    v_fmac_f32 v68, v40, v48
    v_mfma_f32_16x16x32_bf16 v[196:199], a[12:15], a[68:71], v[196:199]
    ds_read_b64_tr_b16 a[10:11], v23 offset:20224
    buffer_load_dwordx4 v11, s[8:11], s37 offen offset:1024 lds
    v_fmac_f32 v69, v40, v49
    v_mfma_f32_16x16x32_bf16 v[208:211], a[16:19], a[68:71], v[208:211]
    ds_read_b64_tr_b16 a[12:13], v20 offset:21504
    v_fmac_f32 v70, v40, v50
    v_fmac_f32 v71, v40, v51
    v_mfma_f32_16x16x32_bf16 v[216:219], a[16:19], a[72:75], v[216:219]
    ds_read_b64_tr_b16 a[14:15], v20 offset:23040
    v_cvt_pk_bf16_f32 v64, v64, v65
    v_cvt_pk_bf16_f32 v65, v66, v67
    v_mfma_f32_16x16x32_bf16 v[220:223], a[20:23], a[72:75], v[220:223]
    ds_read_b64_tr_b16 a[16:17], v21 offset:21504
    v_cvt_pk_bf16_f32 v66, v68, v69
    v_cvt_pk_bf16_f32 v67, v70, v71
    v_mfma_f32_16x16x32_bf16 v[212:215], a[20:23], a[68:71], v[212:215]
    ds_read_b64_tr_b16 a[18:19], v21 offset:23040
    s_waitcnt lgkmcnt(4)
    v_pk_max_i16 v64, v64, 0
    v_mfma_f32_16x16x32_bf16 v[224:227], a[24:27], a[68:71], v[224:227]
    ds_read_b64_tr_b16 a[20:21], v22 offset:21504
    v_pk_max_i16 v65, v65, 0
    v_pk_max_i16 v66, v66, 0
    v_pk_max_i16 v67, v67, 0
    v_mfma_f32_16x16x32_bf16 v[232:235], a[24:27], a[72:75], v[232:235]
    ds_read_b64_tr_b16 a[22:23], v22 offset:23040
    buffer_store_dwordx4 v[64:67], v38, s[16:19], s52 offen offset:0 sc1
    v_mfma_f32_16x16x32_bf16 v[236:239], a[0:3], a[72:75], v[236:239]
    ds_read_b64_tr_b16 a[24:25], v23 offset:21504
    v_fmac_f32 v72, v42, v44
    v_fmac_f32 v73, v42, v45
    v_mfma_f32_16x16x32_bf16 v[228:231], a[0:3], a[68:71], v[228:231]
    ds_read_b64_tr_b16 a[26:27], v23 offset:23040
    buffer_load_dwordx4 v12, s[8:11], s37 offen offset:2048 lds
    v_fmac_f32 v74, v42, v46
    v_mfma_f32_16x16x32_bf16 v[240:243], a[4:7], a[68:71], v[240:243]
    ds_read_b64_tr_b16 a[0:1], v20 offset:21632
    v_fmac_f32 v75, v42, v47
    v_fmac_f32 v76, v42, v48
    v_mfma_f32_16x16x32_bf16 v[248:251], a[4:7], a[72:75], v[248:251]
    ds_read_b64_tr_b16 a[2:3], v20 offset:23168
    v_fmac_f32 v77, v42, v49
    v_fmac_f32 v78, v42, v50
    v_mfma_f32_16x16x32_bf16 v[252:255], a[8:11], a[72:75], v[252:255]
    ds_read_b64_tr_b16 a[4:5], v21 offset:21632
    v_fmac_f32 v79, v42, v51
    v_cvt_pk_bf16_f32 v68, v72, v73
    v_mfma_f32_16x16x32_bf16 v[244:247], a[8:11], a[68:71], v[244:247]
    ds_read_b64_tr_b16 a[6:7], v21 offset:23168
    s_waitcnt lgkmcnt(4)
    v_cvt_pk_bf16_f32 v69, v74, v75
    v_mfma_f32_16x16x32_bf16 v[160:163], a[12:15], a[76:79], v[160:163]
    ds_read_b64_tr_b16 a[8:9], v22 offset:21632
    v_cvt_pk_bf16_f32 v70, v76, v77
    v_cvt_pk_bf16_f32 v71, v78, v79
    v_mfma_f32_16x16x32_bf16 v[168:171], a[12:15], a[80:83], v[168:171]
    ds_read_b64_tr_b16 a[10:11], v22 offset:23168
    v_pk_max_i16 v68, v68, 0
    v_pk_max_i16 v69, v69, 0
    v_mfma_f32_16x16x32_bf16 v[172:175], a[16:19], a[80:83], v[172:175]
    ds_read_b64_tr_b16 a[12:13], v23 offset:21632
    buffer_load_dwordx4 v13, s[8:11], s37 offen offset:3072 lds
    v_pk_max_i16 v70, v70, 0
    v_mfma_f32_16x16x32_bf16 v[164:167], a[16:19], a[76:79], v[164:167]
    ds_read_b64_tr_b16 a[14:15], v23 offset:23168
    v_pk_max_i16 v71, v71, 0
    v_mfma_f32_16x16x32_bf16 v[176:179], a[20:23], a[76:79], v[176:179]
    ds_read_b64_tr_b16 a[16:17], v20 offset:21760
    buffer_store_dwordx4 v[68:71], v38, s[16:19], s52 offen offset:1024 sc1
    v_mfma_f32_16x16x32_bf16 v[184:187], a[20:23], a[80:83], v[184:187]
    ds_read_b64_tr_b16 a[18:19], v20 offset:23296
    ds_read_b128 v[44:47], v39 offset:256
    ds_read_b128 v[48:51], v39 offset:320
    v_mfma_f32_16x16x32_bf16 v[188:191], a[24:27], a[80:83], v[188:191]
    ds_read_b64_tr_b16 a[20:21], v21 offset:21760
    v_fmac_f32 v80, v40, v52
    v_fmac_f32 v81, v40, v53
    v_mfma_f32_16x16x32_bf16 v[180:183], a[24:27], a[76:79], v[180:183]
    ds_read_b64_tr_b16 a[22:23], v21 offset:23296
    s_waitcnt vmcnt(18) lgkmcnt(6)
    v_fmac_f32 v82, v40, v54
    v_mfma_f32_16x16x32_bf16 v[192:195], a[0:3], a[76:79], v[192:195]
    ds_read_b64_tr_b16 a[24:25], v22 offset:21760
    v_fmac_f32 v83, v40, v55
    v_fmac_f32 v84, v40, v56
    v_mfma_f32_16x16x32_bf16 v[200:203], a[0:3], a[80:83], v[200:203]
    ds_read_b64_tr_b16 a[26:27], v22 offset:23296
    s_add_u32 m0, s36, 10240
    v_fmac_f32 v85, v40, v57
    v_mfma_f32_16x16x32_bf16 v[204:207], a[4:7], a[80:83], v[204:207]
    ds_read_b64_tr_b16 a[0:1], v23 offset:21760
    buffer_load_dwordx4 v14, s[8:11], s37 offen offset:0 lds
    v_fmac_f32 v86, v40, v58
    v_mfma_f32_16x16x32_bf16 v[196:199], a[4:7], a[76:79], v[196:199]
    ds_read_b64_tr_b16 a[2:3], v23 offset:23296
    s_barrier
    v_fmac_f32 v87, v40, v59
    v_mfma_f32_16x16x32_bf16 v[208:211], a[8:11], a[76:79], v[208:211]
    ds_read_b64_tr_b16 a[4:5], v20 offset:24576
    v_cvt_pk_bf16_f32 v72, v80, v81
    v_cvt_pk_bf16_f32 v73, v82, v83
    v_mfma_f32_16x16x32_bf16 v[216:219], a[8:11], a[80:83], v[216:219]
    ds_read_b64_tr_b16 a[6:7], v20 offset:26112
    v_cvt_pk_bf16_f32 v74, v84, v85
    v_cvt_pk_bf16_f32 v75, v86, v87
    v_mfma_f32_16x16x32_bf16 v[220:223], a[12:15], a[80:83], v[220:223]
    ds_read_b64_tr_b16 a[8:9], v21 offset:24576
    v_pk_max_i16 v72, v72, 0
    v_pk_max_i16 v73, v73, 0
    v_mfma_f32_16x16x32_bf16 v[212:215], a[12:15], a[76:79], v[212:215]
    ds_read_b64_tr_b16 a[10:11], v21 offset:26112
    s_waitcnt lgkmcnt(4)
    v_pk_max_i16 v74, v74, 0
    v_mfma_f32_16x16x32_bf16 v[224:227], a[16:19], a[76:79], v[224:227]
    ds_read_b64_tr_b16 a[12:13], v22 offset:24576
    v_pk_max_i16 v75, v75, 0
    v_mfma_f32_16x16x32_bf16 v[232:235], a[16:19], a[80:83], v[232:235]
    ds_read_b64_tr_b16 a[14:15], v22 offset:26112
    buffer_store_dwordx4 v[72:75], v38, s[16:19], s52 offen offset:2048 sc1
    v_fmac_f32 v88, v42, v52
    v_mfma_f32_16x16x32_bf16 v[236:239], a[20:23], a[80:83], v[236:239]
    ds_read_b64_tr_b16 a[16:17], v23 offset:24576
    v_fmac_f32 v89, v42, v53
    v_fmac_f32 v90, v42, v54
    v_fmac_f32 v91, v42, v55
    v_mfma_f32_16x16x32_bf16 v[228:231], a[20:23], a[76:79], v[228:231]
    ds_read_b64_tr_b16 a[18:19], v23 offset:26112
    buffer_load_dwordx4 v15, s[8:11], s37 offen offset:1024 lds
    v_fmac_f32 v92, v42, v56
    v_mfma_f32_16x16x32_bf16 v[240:243], a[24:27], a[76:79], v[240:243]
    ds_read_b64_tr_b16 a[20:21], v20 offset:24704
    v_fmac_f32 v93, v42, v57
    v_fmac_f32 v94, v42, v58
    v_mfma_f32_16x16x32_bf16 v[248:251], a[24:27], a[80:83], v[248:251]
    ds_read_b64_tr_b16 a[22:23], v20 offset:26240
    v_fmac_f32 v95, v42, v59
    v_cvt_pk_bf16_f32 v76, v88, v89
    v_mfma_f32_16x16x32_bf16 v[252:255], a[0:3], a[80:83], v[252:255]
    ds_read_b64_tr_b16 a[24:25], v21 offset:24704
    v_cvt_pk_bf16_f32 v77, v90, v91
    v_cvt_pk_bf16_f32 v78, v92, v93
    v_mfma_f32_16x16x32_bf16 v[244:247], a[0:3], a[76:79], v[244:247]
    ds_read_b64_tr_b16 a[26:27], v21 offset:26240
    s_waitcnt lgkmcnt(4)
    v_cvt_pk_bf16_f32 v79, v94, v95
L_stage12:
    v_mfma_f32_16x16x32_bf16 v[160:163], a[4:7], a[84:87], v[160:163]
    ds_read_b64_tr_b16 a[0:1], v22 offset:24704
    v_pk_max_i16 v76, v76, 0
    v_pk_max_i16 v77, v77, 0
    v_mfma_f32_16x16x32_bf16 v[168:171], a[4:7], a[88:91], v[168:171]
    ds_read_b64_tr_b16 a[2:3], v22 offset:26240
    s_add_u32 s37, s37, 589824
    v_pk_max_i16 v78, v78, 0
    v_mfma_f32_16x16x32_bf16 v[172:175], a[8:11], a[88:91], v[172:175]
    ds_read_b64_tr_b16 a[4:5], v23 offset:24704
    s_add_u32 m0, s36, 12288
    v_pk_max_i16 v79, v79, 0
    v_mfma_f32_16x16x32_bf16 v[164:167], a[8:11], a[84:87], v[164:167]
    ds_read_b64_tr_b16 a[6:7], v23 offset:26240
    buffer_load_dwordx4 v10, s[8:11], s37 offen offset:0 lds
    v_mfma_f32_16x16x32_bf16 v[176:179], a[12:15], a[84:87], v[176:179]
    ds_read_b64_tr_b16 a[8:9], v20 offset:24832
    buffer_store_dwordx4 v[76:79], v38, s[16:19], s52 offen offset:3072 sc1
    v_mfma_f32_16x16x32_bf16 v[184:187], a[12:15], a[88:91], v[184:187]
    ds_read_b64_tr_b16 a[10:11], v20 offset:26368
    s_add_u32 s52, s52, 4096
    ds_read_b128 v[52:55], v39 offset:384
    v_mfma_f32_16x16x32_bf16 v[188:191], a[16:19], a[88:91], v[188:191]
    ds_read_b64_tr_b16 a[12:13], v21 offset:24832
    ds_read_b128 v[56:59], v39 offset:448
    v_fmac_f32 v96, v40, v44
    v_mfma_f32_16x16x32_bf16 v[180:183], a[16:19], a[84:87], v[180:183]
    ds_read_b64_tr_b16 a[14:15], v21 offset:26368
    s_waitcnt lgkmcnt(6)
    v_fmac_f32 v97, v40, v45
    v_mfma_f32_16x16x32_bf16 v[192:195], a[20:23], a[84:87], v[192:195]
    ds_read_b64_tr_b16 a[16:17], v22 offset:24832
    v_fmac_f32 v98, v40, v46
    v_fmac_f32 v99, v40, v47
    v_mfma_f32_16x16x32_bf16 v[200:203], a[20:23], a[88:91], v[200:203]
    ds_read_b64_tr_b16 a[18:19], v22 offset:26368
    v_fmac_f32 v100, v40, v48
    v_fmac_f32 v101, v40, v49
    v_mfma_f32_16x16x32_bf16 v[204:207], a[24:27], a[88:91], v[204:207]
    ds_read_b64_tr_b16 a[20:21], v23 offset:24832
    v_fmac_f32 v102, v40, v50
    v_fmac_f32 v103, v40, v51
    v_and_b32 v8, 1, v1
    v_mfma_f32_16x16x32_bf16 v[196:199], a[24:27], a[84:87], v[196:199]
    ds_read_b64_tr_b16 a[22:23], v23 offset:26368
    buffer_load_dwordx4 v11, s[8:11], s37 offen offset:1024 lds
    v_cvt_pk_bf16_f32 v80, v96, v97
    v_mfma_f32_16x16x32_bf16 v[208:211], a[0:3], a[84:87], v[208:211]
    ds_read_b64_tr_b16 a[24:25], v20 offset:27648
    v_cvt_pk_bf16_f32 v81, v98, v99
    v_cvt_pk_bf16_f32 v82, v100, v101
    v_mfma_f32_16x16x32_bf16 v[216:219], a[0:3], a[88:91], v[216:219]
    ds_read_b64_tr_b16 a[26:27], v20 offset:29184
    v_cvt_pk_bf16_f32 v83, v102, v103
    v_pk_max_i16 v80, v80, 0
    v_mfma_f32_16x16x32_bf16 v[220:223], a[4:7], a[88:91], v[220:223]
    ds_read_b64_tr_b16 a[0:1], v21 offset:27648
    v_pk_max_i16 v81, v81, 0
    v_pk_max_i16 v82, v82, 0
    v_lshl_add_u32 v8, s3, 1, v8
    v_mfma_f32_16x16x32_bf16 v[212:215], a[4:7], a[84:87], v[212:215]
    ds_read_b64_tr_b16 a[2:3], v21 offset:29184
    s_waitcnt lgkmcnt(4)
    v_pk_max_i16 v83, v83, 0
    v_mfma_f32_16x16x32_bf16 v[224:227], a[8:11], a[84:87], v[224:227]
    ds_read_b64_tr_b16 a[4:5], v22 offset:27648
    buffer_store_dwordx4 v[80:83], v38, s[16:19], s52 offen offset:0 sc1
    v_mfma_f32_16x16x32_bf16 v[232:235], a[8:11], a[88:91], v[232:235]
    ds_read_b64_tr_b16 a[6:7], v22 offset:29184
    v_fmac_f32 v104, v42, v44
    v_fmac_f32 v105, v42, v45
    v_mfma_f32_16x16x32_bf16 v[236:239], a[12:15], a[88:91], v[236:239]
    ds_read_b64_tr_b16 a[8:9], v23 offset:27648
    v_fmac_f32 v106, v42, v46
    v_fmac_f32 v107, v42, v47
    v_lshlrev_b32 v8, 7, v8
    v_mfma_f32_16x16x32_bf16 v[228:231], a[12:15], a[84:87], v[228:231]
    ds_read_b64_tr_b16 a[10:11], v23 offset:29184
    buffer_load_dwordx4 v12, s[8:11], s37 offen offset:2048 lds
    v_fmac_f32 v108, v42, v48
    v_fmac_f32 v109, v42, v49
    v_mfma_f32_16x16x32_bf16 v[240:243], a[16:19], a[84:87], v[240:243]
    ds_read_b64_tr_b16 a[12:13], v20 offset:27776
    v_fmac_f32 v110, v42, v50
    v_fmac_f32 v111, v42, v51
    v_mfma_f32_16x16x32_bf16 v[248:251], a[16:19], a[88:91], v[248:251]
    ds_read_b64_tr_b16 a[14:15], v20 offset:29312
    v_cvt_pk_bf16_f32 v84, v104, v105
    v_cvt_pk_bf16_f32 v85, v106, v107
    v_mfma_f32_16x16x32_bf16 v[252:255], a[20:23], a[88:91], v[252:255]
    ds_read_b64_tr_b16 a[16:17], v21 offset:27776
    v_cvt_pk_bf16_f32 v86, v108, v109
    v_cvt_pk_bf16_f32 v87, v110, v111
    v_add_u32 v8, L_stage16-L_pc, v8
    v_mfma_f32_16x16x32_bf16 v[244:247], a[20:23], a[84:87], v[244:247]
    ds_read_b64_tr_b16 a[18:19], v21 offset:29312
    s_waitcnt lgkmcnt(4)
    v_pk_max_i16 v84, v84, 0
    v_mfma_f32_16x16x32_bf16 v[160:163], a[24:27], a[92:95], v[160:163]
    ds_read_b64_tr_b16 a[20:21], v22 offset:27776
    v_pk_max_i16 v85, v85, 0
    v_pk_max_i16 v86, v86, 0
    v_mfma_f32_16x16x32_bf16 v[168:171], a[24:27], a[96:99], v[168:171]
    ds_read_b64_tr_b16 a[22:23], v22 offset:29312
    v_pk_max_i16 v87, v87, 0
    v_mfma_f32_16x16x32_bf16 v[172:175], a[0:3], a[96:99], v[172:175]
    ds_read_b64_tr_b16 a[24:25], v23 offset:27776
    buffer_load_dwordx4 v13, s[8:11], s37 offen offset:3072 lds
    buffer_store_dwordx4 v[84:87], v38, s[16:19], s52 offen offset:1024 sc1
    global_load_dword v9, v8, s[0:1]
    v_mfma_f32_16x16x32_bf16 v[164:167], a[0:3], a[92:95], v[164:167]
    ds_read_b64_tr_b16 a[26:27], v23 offset:29312
    ds_read_b128 v[44:47], v39 offset:512
    v_mfma_f32_16x16x32_bf16 v[176:179], a[4:7], a[92:95], v[176:179]
    ds_read_b64_tr_b16 a[0:1], v20 offset:27904
    ds_read_b128 v[48:51], v39 offset:576
    v_mfma_f32_16x16x32_bf16 v[184:187], a[4:7], a[96:99], v[184:187]
    ds_read_b64_tr_b16 a[2:3], v20 offset:29440
    v_fmac_f32 v112, v40, v52
    v_fmac_f32 v113, v40, v53
    v_mfma_f32_16x16x32_bf16 v[188:191], a[8:11], a[96:99], v[188:191]
    ds_read_b64_tr_b16 a[4:5], v21 offset:27904
    v_fmac_f32 v114, v40, v54
    v_fmac_f32 v115, v40, v55
    v_mfma_f32_16x16x32_bf16 v[180:183], a[8:11], a[92:95], v[180:183]
    ds_read_b64_tr_b16 a[6:7], v21 offset:29440
    s_waitcnt vmcnt(23) lgkmcnt(6)
    v_fmac_f32 v116, v40, v56
    v_mfma_f32_16x16x32_bf16 v[192:195], a[12:15], a[92:95], v[192:195]
    ds_read_b64_tr_b16 a[8:9], v22 offset:27904
    v_fmac_f32 v117, v40, v57
    v_fmac_f32 v118, v40, v58
    v_fmac_f32 v119, v40, v59
    v_mfma_f32_16x16x32_bf16 v[200:203], a[12:15], a[96:99], v[200:203]
    ds_read_b64_tr_b16 a[10:11], v22 offset:29440
    s_add_u32 m0, s36, 16384
    v_cvt_pk_bf16_f32 v88, v112, v113
    v_mfma_f32_16x16x32_bf16 v[204:207], a[16:19], a[96:99], v[204:207]
    ds_read_b64_tr_b16 a[12:13], v23 offset:27904
    buffer_load_dwordx4 v14, s[8:11], s37 offen offset:0 lds
    v_cvt_pk_bf16_f32 v89, v114, v115
    v_mfma_f32_16x16x32_bf16 v[196:199], a[16:19], a[92:95], v[196:199]
    ds_read_b64_tr_b16 a[14:15], v23 offset:29440
    s_barrier
    v_cvt_pk_bf16_f32 v90, v116, v117
    v_mfma_f32_16x16x32_bf16 v[208:211], a[20:23], a[92:95], v[208:211]
    ds_read_b64_tr_b16 a[16:17], v20 offset:30720
    v_cvt_pk_bf16_f32 v91, v118, v119
    v_pk_max_i16 v88, v88, 0
    v_mfma_f32_16x16x32_bf16 v[216:219], a[20:23], a[96:99], v[216:219]
    ds_read_b64_tr_b16 a[18:19], v20 offset:32256
    v_pk_max_i16 v89, v89, 0
    v_pk_max_i16 v90, v90, 0
    v_mfma_f32_16x16x32_bf16 v[220:223], a[24:27], a[96:99], v[220:223]
    ds_read_b64_tr_b16 a[20:21], v21 offset:30720
    v_pk_max_i16 v91, v91, 0
    v_mfma_f32_16x16x32_bf16 v[212:215], a[24:27], a[92:95], v[212:215]
    ds_read_b64_tr_b16 a[22:23], v21 offset:32256
    s_waitcnt lgkmcnt(4)
    buffer_store_dwordx4 v[88:91], v38, s[16:19], s52 offen offset:2048 sc1
    v_mfma_f32_16x16x32_bf16 v[224:227], a[0:3], a[92:95], v[224:227]
    ds_read_b64_tr_b16 a[24:25], v22 offset:30720
    v_fmac_f32 v120, v42, v52
    v_fmac_f32 v121, v42, v53
    v_mfma_f32_16x16x32_bf16 v[232:235], a[0:3], a[96:99], v[232:235]
    ds_read_b64_tr_b16 a[26:27], v22 offset:32256
    v_fmac_f32 v122, v42, v54
    v_fmac_f32 v123, v42, v55
    v_mfma_f32_16x16x32_bf16 v[236:239], a[4:7], a[96:99], v[236:239]
    ds_read_b64_tr_b16 a[0:1], v23 offset:30720
    v_fmac_f32 v124, v42, v56
    v_fmac_f32 v125, v42, v57
    v_mfma_f32_16x16x32_bf16 v[228:231], a[4:7], a[92:95], v[228:231]
    ds_read_b64_tr_b16 a[2:3], v23 offset:32256
    buffer_load_dwordx4 v15, s[8:11], s37 offen offset:1024 lds
    v_fmac_f32 v126, v42, v58
    v_mfma_f32_16x16x32_bf16 v[240:243], a[8:11], a[92:95], v[240:243]
    ds_read_b64_tr_b16 a[4:5], v20 offset:30848
    v_fmac_f32 v127, v42, v59
    v_cvt_pk_bf16_f32 v92, v120, v121
    v_mfma_f32_16x16x32_bf16 v[248:251], a[8:11], a[96:99], v[248:251]
    ds_read_b64_tr_b16 a[6:7], v20 offset:32384
    v_cvt_pk_bf16_f32 v93, v122, v123
    v_cvt_pk_bf16_f32 v94, v124, v125
    v_cvt_pk_bf16_f32 v95, v126, v127
    v_mfma_f32_16x16x32_bf16 v[252:255], a[12:15], a[96:99], v[252:255]
    ds_read_b64_tr_b16 a[8:9], v21 offset:30848
    v_pk_max_i16 v92, v92, 0
    v_pk_max_i16 v93, v93, 0
    v_mfma_f32_16x16x32_bf16 v[244:247], a[12:15], a[92:95], v[244:247]
    ds_read_b64_tr_b16 a[10:11], v21 offset:32384
    s_waitcnt lgkmcnt(4)
    v_pk_max_i16 v94, v94, 0
L_stage13:
    v_mfma_f32_16x16x32_bf16 v[160:163], a[16:19], a[100:103], v[160:163]
    ds_read_b64_tr_b16 a[12:13], v22 offset:30848
    v_pk_max_i16 v95, v95, 0
    v_mfma_f32_16x16x32_bf16 v[168:171], a[16:19], a[104:107], v[168:171]
    ds_read_b64_tr_b16 a[14:15], v22 offset:32384
    s_add_u32 s37, s37, 589824
    buffer_store_dwordx4 v[92:95], v38, s[16:19], s52 offen offset:3072 sc1
    v_mfma_f32_16x16x32_bf16 v[172:175], a[20:23], a[104:107], v[172:175]
    ds_read_b64_tr_b16 a[16:17], v23 offset:30848
    s_add_u32 m0, s36, 18432
    v_mfma_f32_16x16x32_bf16 v[164:167], a[20:23], a[100:103], v[164:167]
    ds_read_b64_tr_b16 a[18:19], v23 offset:32384
    buffer_load_dwordx4 v10, s[8:11], s37 offen offset:0 lds
    s_add_u32 s52, s52, 4096
    v_mfma_f32_16x16x32_bf16 v[176:179], a[24:27], a[100:103], v[176:179]
    ds_read_b64_tr_b16 a[20:21], v20 offset:30976
    ds_read_b128 v[52:55], v39 offset:640
    ds_read_b128 v[56:59], v39 offset:704
    v_mfma_f32_16x16x32_bf16 v[184:187], a[24:27], a[104:107], v[184:187]
    ds_read_b64_tr_b16 a[22:23], v20 offset:32512
    v_fmac_f32 v128, v40, v44
    v_mfma_f32_16x16x32_bf16 v[188:191], a[0:3], a[104:107], v[188:191]
    ds_read_b64_tr_b16 a[24:25], v21 offset:30976
    v_fmac_f32 v129, v40, v45
    v_fmac_f32 v130, v40, v46
    v_mfma_f32_16x16x32_bf16 v[180:183], a[0:3], a[100:103], v[180:183]
    ds_read_b64_tr_b16 a[26:27], v21 offset:32512
    s_waitcnt lgkmcnt(6)
    v_fmac_f32 v131, v40, v47
    v_mfma_f32_16x16x32_bf16 v[192:195], a[4:7], a[100:103], v[192:195]
    ds_read_b64_tr_b16 a[0:1], v22 offset:30976
    v_fmac_f32 v132, v40, v48
    v_fmac_f32 v133, v40, v49
    v_mfma_f32_16x16x32_bf16 v[200:203], a[4:7], a[104:107], v[200:203]
    ds_read_b64_tr_b16 a[2:3], v22 offset:32512
    v_fmac_f32 v134, v40, v50
    v_fmac_f32 v135, v40, v51
    v_cvt_pk_bf16_f32 v96, v128, v129
    v_mfma_f32_16x16x32_bf16 v[204:207], a[8:11], a[104:107], v[204:207]
    ds_read_b64_tr_b16 a[4:5], v23 offset:30976
    v_cvt_pk_bf16_f32 v97, v130, v131
    v_cvt_pk_bf16_f32 v98, v132, v133
    v_mfma_f32_16x16x32_bf16 v[196:199], a[8:11], a[100:103], v[196:199]
    ds_read_b64_tr_b16 a[6:7], v23 offset:32512
    buffer_load_dwordx4 v11, s[8:11], s37 offen offset:1024 lds
    v_cvt_pk_bf16_f32 v99, v134, v135
    v_mfma_f32_16x16x32_bf16 v[208:211], a[12:15], a[100:103], v[208:211]
    ds_read_b64_tr_b16 a[8:9], v20 offset:33792
    v_pk_max_i16 v96, v96, 0
    v_pk_max_i16 v97, v97, 0
    v_mfma_f32_16x16x32_bf16 v[216:219], a[12:15], a[104:107], v[216:219]
    ds_read_b64_tr_b16 a[10:11], v20 offset:35328
    v_pk_max_i16 v98, v98, 0
    v_pk_max_i16 v99, v99, 0
    v_mfma_f32_16x16x32_bf16 v[220:223], a[16:19], a[104:107], v[220:223]
    ds_read_b64_tr_b16 a[12:13], v21 offset:33792
    buffer_store_dwordx4 v[96:99], v38, s[16:19], s52 offen offset:0 sc1
    v_mfma_f32_16x16x32_bf16 v[212:215], a[16:19], a[100:103], v[212:215]
    ds_read_b64_tr_b16 a[14:15], v21 offset:35328
    s_waitcnt lgkmcnt(4)
    v_fmac_f32 v136, v42, v44
    v_mfma_f32_16x16x32_bf16 v[224:227], a[20:23], a[100:103], v[224:227]
    ds_read_b64_tr_b16 a[16:17], v22 offset:33792
    v_fmac_f32 v137, v42, v45
    v_fmac_f32 v138, v42, v46
    v_mfma_f32_16x16x32_bf16 v[232:235], a[20:23], a[104:107], v[232:235]
    ds_read_b64_tr_b16 a[18:19], v22 offset:35328
    v_fmac_f32 v139, v42, v47
    v_fmac_f32 v140, v42, v48
    v_mfma_f32_16x16x32_bf16 v[236:239], a[24:27], a[104:107], v[236:239]
    ds_read_b64_tr_b16 a[20:21], v23 offset:33792
    v_fmac_f32 v141, v42, v49
    v_fmac_f32 v142, v42, v50
    v_mfma_f32_16x16x32_bf16 v[228:231], a[24:27], a[100:103], v[228:231]
    ds_read_b64_tr_b16 a[22:23], v23 offset:35328
    buffer_load_dwordx4 v12, s[8:11], s37 offen offset:2048 lds
    v_fmac_f32 v143, v42, v51
    v_mfma_f32_16x16x32_bf16 v[240:243], a[0:3], a[100:103], v[240:243]
    ds_read_b64_tr_b16 a[24:25], v20 offset:33920
    v_cvt_pk_bf16_f32 v100, v136, v137
    v_cvt_pk_bf16_f32 v101, v138, v139
    v_mfma_f32_16x16x32_bf16 v[248:251], a[0:3], a[104:107], v[248:251]
    ds_read_b64_tr_b16 a[26:27], v20 offset:35456
    v_cvt_pk_bf16_f32 v102, v140, v141
    v_cvt_pk_bf16_f32 v103, v142, v143
    v_mfma_f32_16x16x32_bf16 v[252:255], a[4:7], a[104:107], v[252:255]
    ds_read_b64_tr_b16 a[0:1], v21 offset:33920
    v_pk_max_i16 v100, v100, 0
    v_pk_max_i16 v101, v101, 0
    v_pk_max_i16 v102, v102, 0
    v_mfma_f32_16x16x32_bf16 v[244:247], a[4:7], a[100:103], v[244:247]
    ds_read_b64_tr_b16 a[2:3], v21 offset:35456
    s_waitcnt lgkmcnt(4)
    v_pk_max_i16 v103, v103, 0
    v_mfma_f32_16x16x32_bf16 v[160:163], a[8:11], a[108:111], v[160:163]
    ds_read_b64_tr_b16 a[4:5], v22 offset:33920
    buffer_store_dwordx4 v[100:103], v38, s[16:19], s52 offen offset:1024 sc1
    v_mfma_f32_16x16x32_bf16 v[168:171], a[8:11], a[112:115], v[168:171]
    ds_read_b64_tr_b16 a[6:7], v22 offset:35456
    v_mfma_f32_16x16x32_bf16 v[172:175], a[12:15], a[112:115], v[172:175]
    ds_read_b64_tr_b16 a[8:9], v23 offset:33920
    buffer_load_dwordx4 v13, s[8:11], s37 offen offset:3072 lds
    v_fmac_f32 v144, v40, v52
    v_mfma_f32_16x16x32_bf16 v[164:167], a[12:15], a[108:111], v[164:167]
    ds_read_b64_tr_b16 a[10:11], v23 offset:35456
    v_fmac_f32 v145, v40, v53
    v_fmac_f32 v146, v40, v54
    v_mfma_f32_16x16x32_bf16 v[176:179], a[16:19], a[108:111], v[176:179]
    ds_read_b64_tr_b16 a[12:13], v20 offset:34048
    v_fmac_f32 v147, v40, v55
    v_fmac_f32 v148, v40, v56
    v_mfma_f32_16x16x32_bf16 v[184:187], a[16:19], a[112:115], v[184:187]
    ds_read_b64_tr_b16 a[14:15], v20 offset:35584
    v_fmac_f32 v149, v40, v57
    v_fmac_f32 v150, v40, v58
    v_mfma_f32_16x16x32_bf16 v[188:191], a[20:23], a[112:115], v[188:191]
    ds_read_b64_tr_b16 a[16:17], v21 offset:34048
    v_fmac_f32 v151, v40, v59
    v_cvt_pk_bf16_f32 v104, v144, v145
    v_mfma_f32_16x16x32_bf16 v[180:183], a[20:23], a[108:111], v[180:183]
    ds_read_b64_tr_b16 a[18:19], v21 offset:35584
    s_waitcnt vmcnt(27) lgkmcnt(4)
    v_cvt_pk_bf16_f32 v105, v146, v147
    v_mfma_f32_16x16x32_bf16 v[192:195], a[24:27], a[108:111], v[192:195]
    ds_read_b64_tr_b16 a[20:21], v22 offset:34048
    v_cvt_pk_bf16_f32 v106, v148, v149
    v_cvt_pk_bf16_f32 v107, v150, v151
    v_mfma_f32_16x16x32_bf16 v[200:203], a[24:27], a[112:115], v[200:203]
    ds_read_b64_tr_b16 a[22:23], v22 offset:35584
    s_add_u32 m0, s36, 22528
    v_pk_max_i16 v104, v104, 0
    v_mfma_f32_16x16x32_bf16 v[204:207], a[0:3], a[112:115], v[204:207]
    ds_read_b64_tr_b16 a[24:25], v23 offset:34048
    buffer_load_dwordx4 v14, s[8:11], s37 offen offset:0 lds
    v_pk_max_i16 v105, v105, 0
    v_mfma_f32_16x16x32_bf16 v[196:199], a[0:3], a[108:111], v[196:199]
    ds_read_b64_tr_b16 a[26:27], v23 offset:35584
    s_barrier
    v_pk_max_i16 v106, v106, 0
    v_pk_max_i16 v107, v107, 0
    v_mfma_f32_16x16x32_bf16 v[208:211], a[4:7], a[108:111], v[208:211]
    ds_read_b64_tr_b16 a[0:1], v20 offset:0
    buffer_store_dwordx4 v[104:107], v38, s[16:19], s52 offen offset:2048 sc1
    v_mfma_f32_16x16x32_bf16 v[216:219], a[4:7], a[112:115], v[216:219]
    ds_read_b64_tr_b16 a[2:3], v20 offset:1536
    v_fmac_f32 v152, v42, v52
    v_fmac_f32 v153, v42, v53
    v_mfma_f32_16x16x32_bf16 v[220:223], a[8:11], a[112:115], v[220:223]
    ds_read_b64_tr_b16 a[4:5], v21 offset:0
    v_fmac_f32 v154, v42, v54
    v_fmac_f32 v155, v42, v55
    v_mfma_f32_16x16x32_bf16 v[212:215], a[8:11], a[108:111], v[212:215]
    ds_read_b64_tr_b16 a[6:7], v21 offset:1536
    s_waitcnt lgkmcnt(4)
    v_fmac_f32 v156, v42, v56
    v_mfma_f32_16x16x32_bf16 v[224:227], a[12:15], a[108:111], v[224:227]
    ds_read_b64_tr_b16 a[8:9], v22 offset:0
    v_fmac_f32 v157, v42, v57
    v_fmac_f32 v158, v42, v58
    v_mfma_f32_16x16x32_bf16 v[232:235], a[12:15], a[112:115], v[232:235]
    ds_read_b64_tr_b16 a[10:11], v22 offset:1536
    v_fmac_f32 v159, v42, v59
    v_cvt_pk_bf16_f32 v108, v152, v153
    v_mfma_f32_16x16x32_bf16 v[236:239], a[16:19], a[112:115], v[236:239]
    ds_read_b64_tr_b16 a[12:13], v23 offset:0
    v_cvt_pk_bf16_f32 v109, v154, v155
    v_cvt_pk_bf16_f32 v110, v156, v157
    v_mfma_f32_16x16x32_bf16 v[228:231], a[16:19], a[108:111], v[228:231]
    ds_read_b64_tr_b16 a[14:15], v23 offset:1536
    buffer_load_dwordx4 v15, s[8:11], s37 offen offset:1024 lds
    v_cvt_pk_bf16_f32 v111, v158, v159
    v_mfma_f32_16x16x32_bf16 v[240:243], a[20:23], a[108:111], v[240:243]
    ds_read_b64_tr_b16 a[16:17], v20 offset:128
    v_pk_max_i16 v108, v108, 0
    v_pk_max_i16 v109, v109, 0
    v_mfma_f32_16x16x32_bf16 v[248:251], a[20:23], a[112:115], v[248:251]
    ds_read_b64_tr_b16 a[18:19], v20 offset:1664
    v_pk_max_i16 v110, v110, 0
    v_pk_max_i16 v111, v111, 0
    v_mfma_f32_16x16x32_bf16 v[252:255], a[24:27], a[112:115], v[252:255]
    ds_read_b64_tr_b16 a[20:21], v21 offset:128
    buffer_store_dwordx4 v[108:111], v38, s[16:19], s52 offen offset:3072 sc1
    v_mfma_f32_16x16x32_bf16 v[244:247], a[24:27], a[108:111], v[244:247]
    ds_read_b64_tr_b16 a[22:23], v21 offset:1664
    s_waitcnt lgkmcnt(4)
L_stage14:
    v_mfma_f32_16x16x32_bf16 v[160:163], a[0:3], a[116:119], v[160:163]
    ds_read_b64_tr_b16 a[24:25], v22 offset:128
    buffer_load_dword v3, v7, s[16:19], 0 offen sc1
    v_mfma_f32_16x16x32_bf16 v[168:171], a[0:3], a[120:123], v[168:171]
    ds_read_b64_tr_b16 a[26:27], v22 offset:1664
    s_add_u32 s37, s40, 0
    v_mfma_f32_16x16x32_bf16 v[172:175], a[4:7], a[120:123], v[172:175]
    ds_read_b64_tr_b16 a[0:1], v23 offset:128
    v_mfma_f32_16x16x32_bf16 v[164:167], a[4:7], a[116:119], v[164:167]
    ds_read_b64_tr_b16 a[2:3], v23 offset:1664
    s_add_u32 m0, s36, 24576
    v_mfma_f32_16x16x32_bf16 v[176:179], a[8:11], a[116:119], v[176:179]
    ds_read_b64_tr_b16 a[4:5], v20 offset:256
    v_mfma_f32_16x16x32_bf16 v[184:187], a[8:11], a[120:123], v[184:187]
    ds_read_b64_tr_b16 a[6:7], v20 offset:1792
    buffer_load_dwordx4 v26, s[12:15], s37 offen offset:0 lds
    v_mfma_f32_16x16x32_bf16 v[188:191], a[12:15], a[120:123], v[188:191]
    ds_read_b64_tr_b16 a[8:9], v21 offset:256
    v_mfma_f32_16x16x32_bf16 v[180:183], a[12:15], a[116:119], v[180:183]
    ds_read_b64_tr_b16 a[10:11], v21 offset:1792
    s_waitcnt lgkmcnt(4)
    v_mfma_f32_16x16x32_bf16 v[192:195], a[16:19], a[116:119], v[192:195]
    ds_read_b64_tr_b16 a[12:13], v22 offset:256
    v_mfma_f32_16x16x32_bf16 v[200:203], a[16:19], a[120:123], v[200:203]
    ds_read_b64_tr_b16 a[14:15], v22 offset:1792
    v_mfma_f32_16x16x32_bf16 v[204:207], a[20:23], a[120:123], v[204:207]
    ds_read_b64_tr_b16 a[16:17], v23 offset:256
    v_mfma_f32_16x16x32_bf16 v[196:199], a[20:23], a[116:119], v[196:199]
    ds_read_b64_tr_b16 a[18:19], v23 offset:1792
    buffer_load_dwordx4 v27, s[12:15], s37 offen offset:1024 lds
    v_mfma_f32_16x16x32_bf16 v[208:211], a[24:27], a[116:119], v[208:211]
    ds_read_b64_tr_b16 a[20:21], v20 offset:3072
    v_mfma_f32_16x16x32_bf16 v[216:219], a[24:27], a[120:123], v[216:219]
    ds_read_b64_tr_b16 a[22:23], v20 offset:4608
    v_mfma_f32_16x16x32_bf16 v[220:223], a[0:3], a[120:123], v[220:223]
    ds_read_b64_tr_b16 a[24:25], v21 offset:3072
    v_mfma_f32_16x16x32_bf16 v[212:215], a[0:3], a[116:119], v[212:215]
    ds_read_b64_tr_b16 a[26:27], v21 offset:4608
    s_waitcnt lgkmcnt(4)
    v_mfma_f32_16x16x32_bf16 v[224:227], a[4:7], a[116:119], v[224:227]
    ds_read_b64_tr_b16 a[0:1], v22 offset:3072
    v_mfma_f32_16x16x32_bf16 v[232:235], a[4:7], a[120:123], v[232:235]
    ds_read_b64_tr_b16 a[2:3], v22 offset:4608
    v_mfma_f32_16x16x32_bf16 v[236:239], a[8:11], a[120:123], v[236:239]
    ds_read_b64_tr_b16 a[4:5], v23 offset:3072
    v_mfma_f32_16x16x32_bf16 v[228:231], a[8:11], a[116:119], v[228:231]
    ds_read_b64_tr_b16 a[6:7], v23 offset:4608
    buffer_load_dwordx4 v28, s[12:15], s37 offen offset:2048 lds
    v_mfma_f32_16x16x32_bf16 v[240:243], a[12:15], a[116:119], v[240:243]
    ds_read_b64_tr_b16 a[8:9], v20 offset:3200
    v_mfma_f32_16x16x32_bf16 v[248:251], a[12:15], a[120:123], v[248:251]
    ds_read_b64_tr_b16 a[10:11], v20 offset:4736
    v_mfma_f32_16x16x32_bf16 v[252:255], a[16:19], a[120:123], v[252:255]
    ds_read_b64_tr_b16 a[12:13], v21 offset:3200
    v_mfma_f32_16x16x32_bf16 v[244:247], a[16:19], a[116:119], v[244:247]
    ds_read_b64_tr_b16 a[14:15], v21 offset:4736
    s_waitcnt lgkmcnt(4)
    v_mfma_f32_16x16x32_bf16 v[160:163], a[20:23], a[124:127], v[160:163]
    ds_read_b64_tr_b16 a[16:17], v22 offset:3200
    v_mfma_f32_16x16x32_bf16 v[168:171], a[20:23], a[128:131], v[168:171]
    ds_read_b64_tr_b16 a[18:19], v22 offset:4736
    v_mfma_f32_16x16x32_bf16 v[172:175], a[24:27], a[128:131], v[172:175]
    ds_read_b64_tr_b16 a[20:21], v23 offset:3200
    buffer_load_dwordx4 v29, s[12:15], s37 offen offset:3072 lds
    v_mfma_f32_16x16x32_bf16 v[164:167], a[24:27], a[124:127], v[164:167]
    ds_read_b64_tr_b16 a[22:23], v23 offset:4736
    v_mfma_f32_16x16x32_bf16 v[176:179], a[0:3], a[124:127], v[176:179]
    ds_read_b64_tr_b16 a[24:25], v20 offset:3328
    v_mfma_f32_16x16x32_bf16 v[184:187], a[0:3], a[128:131], v[184:187]
    ds_read_b64_tr_b16 a[26:27], v20 offset:4864
    v_mfma_f32_16x16x32_bf16 v[188:191], a[4:7], a[128:131], v[188:191]
    ds_read_b64_tr_b16 a[0:1], v21 offset:3328
    s_add_u32 m0, s36, 28672
    v_mfma_f32_16x16x32_bf16 v[180:183], a[4:7], a[124:127], v[180:183]
    ds_read_b64_tr_b16 a[2:3], v21 offset:4864
    s_waitcnt vmcnt(27) lgkmcnt(4)
    v_mfma_f32_16x16x32_bf16 v[192:195], a[8:11], a[124:127], v[192:195]
    ds_read_b64_tr_b16 a[4:5], v22 offset:3328
    v_mfma_f32_16x16x32_bf16 v[200:203], a[8:11], a[128:131], v[200:203]
    ds_read_b64_tr_b16 a[6:7], v22 offset:4864
    v_mfma_f32_16x16x32_bf16 v[204:207], a[12:15], a[128:131], v[204:207]
    ds_read_b64_tr_b16 a[8:9], v23 offset:3328
    buffer_load_dwordx4 v30, s[12:15], s37 offen offset:0 lds
    v_mfma_f32_16x16x32_bf16 v[196:199], a[12:15], a[124:127], v[196:199]
    ds_read_b64_tr_b16 a[10:11], v23 offset:4864
    s_barrier
    v_mfma_f32_16x16x32_bf16 v[208:211], a[16:19], a[124:127], v[208:211]
    ds_read_b64_tr_b16 a[12:13], v20 offset:6144
    s_lshl_b32 s51, s30, 2
    v_mfma_f32_16x16x32_bf16 v[216:219], a[16:19], a[128:131], v[216:219]
    ds_read_b64_tr_b16 a[14:15], v20 offset:7680
    s_add_u32 s51, s51, s28
    v_mfma_f32_16x16x32_bf16 v[220:223], a[20:23], a[128:131], v[220:223]
    ds_read_b64_tr_b16 a[16:17], v21 offset:6144
    s_lshl_b32 s51, s51, 2
    v_mfma_f32_16x16x32_bf16 v[212:215], a[20:23], a[124:127], v[212:215]
    ds_read_b64_tr_b16 a[18:19], v21 offset:7680
    s_waitcnt lgkmcnt(4)
    v_mfma_f32_16x16x32_bf16 v[224:227], a[24:27], a[124:127], v[224:227]
    ds_read_b64_tr_b16 a[20:21], v22 offset:6144
    s_add_u32 s51, s51, s46
    v_mfma_f32_16x16x32_bf16 v[232:235], a[24:27], a[128:131], v[232:235]
    ds_read_b64_tr_b16 a[22:23], v22 offset:7680
    v_mov_b32 v60, 0
    v_mfma_f32_16x16x32_bf16 v[236:239], a[0:3], a[128:131], v[236:239]
    ds_read_b64_tr_b16 a[24:25], v23 offset:6144
    v_min_u32 v62, 2, v1
    v_mfma_f32_16x16x32_bf16 v[228:231], a[0:3], a[124:127], v[228:231]
    ds_read_b64_tr_b16 a[26:27], v23 offset:7680
    buffer_load_dwordx4 v31, s[12:15], s37 offen offset:1024 lds
    v_mfma_f32_16x16x32_bf16 v[240:243], a[4:7], a[124:127], v[240:243]
    ds_read_b64_tr_b16 a[0:1], v20 offset:6272
    v_lshlrev_b32 v62, 4, v62
    v_mfma_f32_16x16x32_bf16 v[248:251], a[4:7], a[128:131], v[248:251]
    ds_read_b64_tr_b16 a[2:3], v20 offset:7808
    s_lshl_b32 s54, s28, 2
    v_mfma_f32_16x16x32_bf16 v[252:255], a[8:11], a[128:131], v[252:255]
    ds_read_b64_tr_b16 a[4:5], v21 offset:6272
    s_add_u32 s54, s54, s46
    v_mfma_f32_16x16x32_bf16 v[244:247], a[8:11], a[124:127], v[244:247]
    ds_read_b64_tr_b16 a[6:7], v21 offset:7808
    s_waitcnt lgkmcnt(4)
L_stage15:
    v_mfma_f32_16x16x32_bf16 v[160:163], a[12:15], a[132:135], v[160:163]
    ds_read_b64_tr_b16 a[8:9], v22 offset:6272
    v_mov_b32 v61, 1
    v_mfma_f32_16x16x32_bf16 v[168:171], a[12:15], a[136:139], v[168:171]
    ds_read_b64_tr_b16 a[10:11], v22 offset:7808
    s_add_u32 s37, s40, 73728
    v_mfma_f32_16x16x32_bf16 v[172:175], a[16:19], a[136:139], v[172:175]
    ds_read_b64_tr_b16 a[12:13], v23 offset:6272
    s_add_u32 m0, s36, 30720
    v_mfma_f32_16x16x32_bf16 v[164:167], a[16:19], a[132:135], v[164:167]
    ds_read_b64_tr_b16 a[14:15], v23 offset:7808
    buffer_load_dwordx4 v26, s[12:15], s37 offen offset:0 lds
    v_mfma_f32_16x16x32_bf16 v[176:179], a[20:23], a[132:135], v[176:179]
    ds_read_b64_tr_b16 a[16:17], v20 offset:6400
    s_waitcnt vmcnt(8)
    v_mfma_f32_16x16x32_bf16 v[184:187], a[20:23], a[136:139], v[184:187]
    ds_read_b64_tr_b16 a[18:19], v20 offset:7936
    buffer_store_dword v61, v60, s[16:19], s51 offen sc1
    v_mfma_f32_16x16x32_bf16 v[188:191], a[24:27], a[136:139], v[188:191]
    ds_read_b64_tr_b16 a[20:21], v21 offset:6400
    v_mfma_f32_16x16x32_bf16 v[180:183], a[24:27], a[132:135], v[180:183]
    ds_read_b64_tr_b16 a[22:23], v21 offset:7936
    s_waitcnt lgkmcnt(4)
    v_mfma_f32_16x16x32_bf16 v[192:195], a[0:3], a[132:135], v[192:195]
    ds_read_b64_tr_b16 a[24:25], v22 offset:6400
    v_mfma_f32_16x16x32_bf16 v[200:203], a[0:3], a[136:139], v[200:203]
    ds_read_b64_tr_b16 a[26:27], v22 offset:7936
    v_mfma_f32_16x16x32_bf16 v[204:207], a[4:7], a[136:139], v[204:207]
    ds_read_b64_tr_b16 a[0:1], v23 offset:6400
    v_mfma_f32_16x16x32_bf16 v[196:199], a[4:7], a[132:135], v[196:199]
    ds_read_b64_tr_b16 a[2:3], v23 offset:7936
    buffer_load_dwordx4 v27, s[12:15], s37 offen offset:1024 lds
    v_mfma_f32_16x16x32_bf16 v[208:211], a[8:11], a[132:135], v[208:211]
    ds_read_b64_tr_b16 a[4:5], v20 offset:9216
    v_mfma_f32_16x16x32_bf16 v[216:219], a[8:11], a[136:139], v[216:219]
    ds_read_b64_tr_b16 a[6:7], v20 offset:10752
    v_mfma_f32_16x16x32_bf16 v[220:223], a[12:15], a[136:139], v[220:223]
    ds_read_b64_tr_b16 a[8:9], v21 offset:9216
    v_mfma_f32_16x16x32_bf16 v[212:215], a[12:15], a[132:135], v[212:215]
    ds_read_b64_tr_b16 a[10:11], v21 offset:10752
    s_waitcnt lgkmcnt(4)
    v_mfma_f32_16x16x32_bf16 v[224:227], a[16:19], a[132:135], v[224:227]
    ds_read_b64_tr_b16 a[12:13], v22 offset:9216
    v_mfma_f32_16x16x32_bf16 v[232:235], a[16:19], a[136:139], v[232:235]
    ds_read_b64_tr_b16 a[14:15], v22 offset:10752
    v_mfma_f32_16x16x32_bf16 v[236:239], a[20:23], a[136:139], v[236:239]
    ds_read_b64_tr_b16 a[16:17], v23 offset:9216
    v_mfma_f32_16x16x32_bf16 v[228:231], a[20:23], a[132:135], v[228:231]
    ds_read_b64_tr_b16 a[18:19], v23 offset:10752
    buffer_load_dwordx4 v28, s[12:15], s37 offen offset:2048 lds
    v_mfma_f32_16x16x32_bf16 v[240:243], a[24:27], a[132:135], v[240:243]
    ds_read_b64_tr_b16 a[20:21], v20 offset:9344
    v_mfma_f32_16x16x32_bf16 v[248:251], a[24:27], a[136:139], v[248:251]
    ds_read_b64_tr_b16 a[22:23], v20 offset:10880
    v_mfma_f32_16x16x32_bf16 v[252:255], a[0:3], a[136:139], v[252:255]
    ds_read_b64_tr_b16 a[24:25], v21 offset:9344
    v_mfma_f32_16x16x32_bf16 v[244:247], a[0:3], a[132:135], v[244:247]
    ds_read_b64_tr_b16 a[26:27], v21 offset:10880
    s_waitcnt lgkmcnt(4)
    v_mfma_f32_16x16x32_bf16 v[160:163], a[4:7], a[140:143], v[160:163]
    ds_read_b64_tr_b16 a[0:1], v22 offset:9344
    v_mfma_f32_16x16x32_bf16 v[168:171], a[4:7], a[144:147], v[168:171]
    ds_read_b64_tr_b16 a[2:3], v22 offset:10880
    v_mfma_f32_16x16x32_bf16 v[172:175], a[8:11], a[144:147], v[172:175]
    ds_read_b64_tr_b16 a[4:5], v23 offset:9344
    buffer_load_dwordx4 v29, s[12:15], s37 offen offset:3072 lds
    v_mfma_f32_16x16x32_bf16 v[164:167], a[8:11], a[140:143], v[164:167]
    ds_read_b64_tr_b16 a[6:7], v23 offset:10880
    v_mfma_f32_16x16x32_bf16 v[176:179], a[12:15], a[140:143], v[176:179]
    ds_read_b64_tr_b16 a[8:9], v20 offset:9472
    v_mfma_f32_16x16x32_bf16 v[184:187], a[12:15], a[144:147], v[184:187]
    ds_read_b64_tr_b16 a[10:11], v20 offset:11008
    v_mfma_f32_16x16x32_bf16 v[188:191], a[16:19], a[144:147], v[188:191]
    ds_read_b64_tr_b16 a[12:13], v21 offset:9472
    s_add_u32 m0, s36, 34816
    v_mfma_f32_16x16x32_bf16 v[180:183], a[16:19], a[140:143], v[180:183]
    ds_read_b64_tr_b16 a[14:15], v21 offset:11008
    s_waitcnt lgkmcnt(4)
    v_mfma_f32_16x16x32_bf16 v[192:195], a[20:23], a[140:143], v[192:195]
    ds_read_b64_tr_b16 a[16:17], v22 offset:9472
    s_waitcnt vmcnt(11)
    v_cmp_eq_u32 vcc, v6, v3
    s_nop 0
    s_and_b64 vcc, vcc, 0x380
    s_and_b64 vcc, vcc, s[100:101]
    s_cbranch_vccnz L_pb_slow
L_pb_ok:
    v_mfma_f32_16x16x32_bf16 v[200:203], a[20:23], a[144:147], v[200:203]
    ds_read_b64_tr_b16 a[18:19], v22 offset:11008
    v_mfma_f32_16x16x32_bf16 v[204:207], a[24:27], a[144:147], v[204:207]
    ds_read_b64_tr_b16 a[20:21], v23 offset:9472
    buffer_load_dwordx4 v30, s[12:15], s37 offen offset:0 lds
    v_mfma_f32_16x16x32_bf16 v[196:199], a[24:27], a[140:143], v[196:199]
    ds_read_b64_tr_b16 a[22:23], v23 offset:11008
    s_barrier
    v_mfma_f32_16x16x32_bf16 v[208:211], a[0:3], a[140:143], v[208:211]
    ds_read_b64_tr_b16 a[24:25], v20 offset:12288
    v_mfma_f32_16x16x32_bf16 v[216:219], a[0:3], a[144:147], v[216:219]
    ds_read_b64_tr_b16 a[26:27], v20 offset:13824
    v_mfma_f32_16x16x32_bf16 v[220:223], a[4:7], a[144:147], v[220:223]
    ds_read_b64_tr_b16 a[0:1], v21 offset:12288
    v_mfma_f32_16x16x32_bf16 v[212:215], a[4:7], a[140:143], v[212:215]
    ds_read_b64_tr_b16 a[2:3], v21 offset:13824
    s_waitcnt lgkmcnt(4)
    v_mfma_f32_16x16x32_bf16 v[224:227], a[8:11], a[140:143], v[224:227]
    ds_read_b64_tr_b16 a[4:5], v22 offset:12288
    v_mfma_f32_16x16x32_bf16 v[232:235], a[8:11], a[144:147], v[232:235]
    ds_read_b64_tr_b16 a[6:7], v22 offset:13824
    v_mfma_f32_16x16x32_bf16 v[236:239], a[12:15], a[144:147], v[236:239]
    ds_read_b64_tr_b16 a[8:9], v23 offset:12288
    v_mfma_f32_16x16x32_bf16 v[228:231], a[12:15], a[140:143], v[228:231]
    ds_read_b64_tr_b16 a[10:11], v23 offset:13824
    buffer_load_dwordx4 v31, s[12:15], s37 offen offset:1024 lds
    v_mfma_f32_16x16x32_bf16 v[240:243], a[16:19], a[140:143], v[240:243]
    ds_read_b64_tr_b16 a[12:13], v20 offset:12416
    v_mfma_f32_16x16x32_bf16 v[248:251], a[16:19], a[144:147], v[248:251]
    ds_read_b64_tr_b16 a[14:15], v20 offset:13952
    v_mfma_f32_16x16x32_bf16 v[252:255], a[20:23], a[144:147], v[252:255]
    ds_read_b64_tr_b16 a[16:17], v21 offset:12416
    v_mfma_f32_16x16x32_bf16 v[244:247], a[20:23], a[140:143], v[244:247]
    ds_read_b64_tr_b16 a[18:19], v21 offset:13952
    s_waitcnt lgkmcnt(4)
L_stage16:
    v_mfma_f32_16x16x32_bf16 v[160:163], a[24:27], a[148:151], v[160:163]
    ds_read_b64_tr_b16 a[20:21], v22 offset:12416
    s_mul_i32 s32, s39, 1536
    v_add_u32 v2, 0, v1
    v_mfma_f32_16x16x32_bf16 v[168:171], a[24:27], a[152:155], v[168:171]
    ds_read_b64_tr_b16 a[22:23], v22 offset:13952
    s_add_u32 s32, s32, 32768
    v_mfma_f32_16x16x32_bf16 v[172:175], a[0:3], a[152:155], v[172:175]
    ds_read_b64_tr_b16 a[24:25], v23 offset:12416
    s_add_u32 m0, s36, 36864
    v_mfma_f32_16x16x32_bf16 v[164:167], a[0:3], a[148:151], v[164:167]
    ds_read_b64_tr_b16 a[26:27], v23 offset:13952
    s_nop 0
    v_mfma_f32_16x16x32_bf16 v[176:179], a[4:7], a[148:151], v[176:179]
    ds_read_b64_tr_b16 a[0:1], v20 offset:12544
    buffer_load_dwordx4 v38, s[16:19], s32 offen offset:768 sc1 lds
    v_mfma_f32_16x16x32_bf16 v[184:187], a[4:7], a[152:155], v[184:187]
    ds_read_b64_tr_b16 a[2:3], v20 offset:14080
    buffer_load_dword v63, v62, s[16:19], s54 offen sc1
    v_mfma_f32_16x16x32_bf16 v[188:191], a[8:11], a[152:155], v[188:191]
    ds_read_b64_tr_b16 a[4:5], v21 offset:12544
    s_add_u32 s37, s40, 147456
    v_mfma_f32_16x16x32_bf16 v[180:183], a[8:11], a[148:151], v[180:183]
    ds_read_b64_tr_b16 a[6:7], v21 offset:14080
    s_waitcnt lgkmcnt(4)
    v_mfma_f32_16x16x32_bf16 v[192:195], a[12:15], a[148:151], v[192:195]
    ds_read_b64_tr_b16 a[8:9], v22 offset:12544
    s_add_u32 m0, s36, 0
    v_mfma_f32_16x16x32_bf16 v[200:203], a[12:15], a[152:155], v[200:203]
    ds_read_b64_tr_b16 a[10:11], v22 offset:14080
    buffer_load_dwordx4 v26, s[12:15], s37 offen offset:0 lds
    v_mfma_f32_16x16x32_bf16 v[204:207], a[16:19], a[152:155], v[204:207]
    ds_read_b64_tr_b16 a[12:13], v23 offset:12544
    v_mul_u32_u24 v3, 10923, v2
    v_mfma_f32_16x16x32_bf16 v[196:199], a[16:19], a[148:151], v[196:199]
    ds_read_b64_tr_b16 a[14:15], v23 offset:14080
    v_lshrrev_b32 v3, 16, v3
    v_mfma_f32_16x16x32_bf16 v[208:211], a[20:23], a[148:151], v[208:211]
    ds_read_b64_tr_b16 a[16:17], v20 offset:15360
    v_mul_u32_u24 v5, 6, v3
    v_mfma_f32_16x16x32_bf16 v[216:219], a[20:23], a[152:155], v[216:219]
    ds_read_b64_tr_b16 a[18:19], v20 offset:16896
    v_sub_u32 v5, v2, v5
    v_mfma_f32_16x16x32_bf16 v[220:223], a[24:27], a[152:155], v[220:223]
    ds_read_b64_tr_b16 a[20:21], v21 offset:15360
    v_mul_u32_u24 v3, 1152, v3
    v_mfma_f32_16x16x32_bf16 v[212:215], a[24:27], a[148:151], v[212:215]
    ds_read_b64_tr_b16 a[22:23], v21 offset:16896
    s_waitcnt lgkmcnt(4)
    v_mfma_f32_16x16x32_bf16 v[224:227], a[0:3], a[148:151], v[224:227]
    ds_read_b64_tr_b16 a[24:25], v22 offset:15360
    buffer_load_dwordx4 v27, s[12:15], s37 offen offset:1024 lds
    v_mfma_f32_16x16x32_bf16 v[232:235], a[0:3], a[152:155], v[232:235]
    ds_read_b64_tr_b16 a[26:27], v22 offset:16896
    v_lshl_add_u32 v5, v5, 4, v3
    v_mfma_f32_16x16x32_bf16 v[236:239], a[4:7], a[152:155], v[236:239]
    ds_read_b64_tr_b16 a[0:1], v23 offset:15360
    v_subrev_u32 v10, 0, v5
    v_mfma_f32_16x16x32_bf16 v[228:231], a[4:7], a[148:151], v[228:231]
    ds_read_b64_tr_b16 a[2:3], v23 offset:16896
    v_add_u32 v2, 64, v1
    v_mul_u32_u24 v3, 10923, v2
    v_mfma_f32_16x16x32_bf16 v[240:243], a[8:11], a[148:151], v[240:243]
    ds_read_b64_tr_b16 a[4:5], v20 offset:15488
    v_lshrrev_b32 v3, 16, v3
    v_mfma_f32_16x16x32_bf16 v[248:251], a[8:11], a[152:155], v[248:251]
    ds_read_b64_tr_b16 a[6:7], v20 offset:17024
    v_mul_u32_u24 v5, 6, v3
    v_mfma_f32_16x16x32_bf16 v[252:255], a[12:15], a[152:155], v[252:255]
    ds_read_b64_tr_b16 a[8:9], v21 offset:15488
    buffer_load_dwordx4 v28, s[12:15], s37 offen offset:2048 lds
    v_mfma_f32_16x16x32_bf16 v[244:247], a[12:15], a[148:151], v[244:247]
    ds_read_b64_tr_b16 a[10:11], v21 offset:17024
    s_waitcnt lgkmcnt(4)
    v_mfma_f32_16x16x32_bf16 v[160:163], a[16:19], a[156:159], v[160:163]
    ds_read_b64_tr_b16 a[12:13], v22 offset:15488
    v_sub_u32 v5, v2, v5
    v_mfma_f32_16x16x32_bf16 v[168:171], a[16:19], a[160:163], v[168:171]
    ds_read_b64_tr_b16 a[14:15], v22 offset:17024
    v_mul_u32_u24 v3, 1152, v3
    v_mfma_f32_16x16x32_bf16 v[172:175], a[20:23], a[160:163], v[172:175]
    ds_read_b64_tr_b16 a[16:17], v23 offset:15488
    v_lshl_add_u32 v5, v5, 4, v3
    v_mfma_f32_16x16x32_bf16 v[164:167], a[20:23], a[156:159], v[164:167]
    ds_read_b64_tr_b16 a[18:19], v23 offset:17024
    v_subrev_u32 v11, 1024, v5
    v_mfma_f32_16x16x32_bf16 v[176:179], a[24:27], a[156:159], v[176:179]
    ds_read_b64_tr_b16 a[20:21], v20 offset:15616
    v_add_u32 v2, 128, v1
    v_mfma_f32_16x16x32_bf16 v[184:187], a[24:27], a[160:163], v[184:187]
    ds_read_b64_tr_b16 a[22:23], v20 offset:17152
    buffer_load_dwordx4 v29, s[12:15], s37 offen offset:3072 lds
    v_mfma_f32_16x16x32_bf16 v[188:191], a[0:3], a[160:163], v[188:191]
    ds_read_b64_tr_b16 a[24:25], v21 offset:15616
    v_mul_u32_u24 v3, 10923, v2
    v_mfma_f32_16x16x32_bf16 v[180:183], a[0:3], a[156:159], v[180:183]
    ds_read_b64_tr_b16 a[26:27], v21 offset:17152
    s_waitcnt lgkmcnt(4)
    v_mfma_f32_16x16x32_bf16 v[192:195], a[4:7], a[156:159], v[192:195]
    ds_read_b64_tr_b16 a[0:1], v22 offset:15616
    v_lshrrev_b32 v3, 16, v3
    v_mfma_f32_16x16x32_bf16 v[200:203], a[4:7], a[160:163], v[200:203]
    ds_read_b64_tr_b16 a[2:3], v22 offset:17152
    v_mul_u32_u24 v5, 6, v3
    v_mfma_f32_16x16x32_bf16 v[204:207], a[8:11], a[160:163], v[204:207]
    ds_read_b64_tr_b16 a[4:5], v23 offset:15616
    v_sub_u32 v5, v2, v5
    v_mfma_f32_16x16x32_bf16 v[196:199], a[8:11], a[156:159], v[196:199]
    ds_read_b64_tr_b16 a[6:7], v23 offset:17152
    s_barrier
    v_mfma_f32_16x16x32_bf16 v[208:211], a[12:15], a[156:159], v[208:211]
    ds_read_b64_tr_b16 a[8:9], v20 offset:18432
    s_add_u32 m0, s36, 4096
    v_mfma_f32_16x16x32_bf16 v[216:219], a[12:15], a[160:163], v[216:219]
    ds_read_b64_tr_b16 a[10:11], v20 offset:19968
    buffer_load_dwordx4 v30, s[12:15], s37 offen offset:0 lds
    v_mfma_f32_16x16x32_bf16 v[220:223], a[16:19], a[160:163], v[220:223]
    ds_read_b64_tr_b16 a[12:13], v21 offset:18432
    v_mul_u32_u24 v3, 1152, v3
    v_lshl_add_u32 v5, v5, 4, v3
    v_mfma_f32_16x16x32_bf16 v[212:215], a[16:19], a[156:159], v[212:215]
    ds_read_b64_tr_b16 a[14:15], v21 offset:19968
    s_waitcnt lgkmcnt(4)
    v_mfma_f32_16x16x32_bf16 v[224:227], a[20:23], a[156:159], v[224:227]
    ds_read_b64_tr_b16 a[16:17], v22 offset:18432
    v_subrev_u32 v12, 2048, v5
    v_mfma_f32_16x16x32_bf16 v[232:235], a[20:23], a[160:163], v[232:235]
    ds_read_b64_tr_b16 a[18:19], v22 offset:19968
    s_mul_i32 s55, s30, 384
    v_mfma_f32_16x16x32_bf16 v[236:239], a[24:27], a[160:163], v[236:239]
    ds_read_b64_tr_b16 a[20:21], v23 offset:18432
    s_mul_i32 s33, s31, 96
    v_mfma_f32_16x16x32_bf16 v[228:231], a[24:27], a[156:159], v[228:231]
    ds_read_b64_tr_b16 a[22:23], v23 offset:19968
    s_add_u32 s55, s55, s33
    v_mfma_f32_16x16x32_bf16 v[240:243], a[0:3], a[156:159], v[240:243]
    ds_read_b64_tr_b16 a[24:25], v20 offset:18560
    buffer_load_dwordx4 v31, s[12:15], s37 offen offset:1024 lds
    v_mfma_f32_16x16x32_bf16 v[248:251], a[0:3], a[160:163], v[248:251]
    ds_read_b64_tr_b16 a[26:27], v20 offset:20096
    s_add_u32 s55, s55, s35
    v_mfma_f32_16x16x32_bf16 v[252:255], a[4:7], a[160:163], v[252:255]
    ds_read_b64_tr_b16 a[0:1], v21 offset:18560
    v_and_b32 v2, 15, v1
    v_mfma_f32_16x16x32_bf16 v[244:247], a[4:7], a[156:159], v[244:247]
    ds_read_b64_tr_b16 a[2:3], v21 offset:20096
    s_waitcnt lgkmcnt(4)
L_stage17:
    v_mfma_f32_16x16x32_bf16 v[160:163], a[8:11], a[164:167], v[160:163]
    ds_read_b64_tr_b16 a[4:5], v22 offset:18560
    v_lshrrev_b32 v3, 4, v1
    v_mfma_f32_16x16x32_bf16 v[168:171], a[8:11], a[168:171], v[168:171]
    ds_read_b64_tr_b16 a[6:7], v22 offset:20096
    s_add_u32 s37, s40, 221184
    v_mfma_f32_16x16x32_bf16 v[172:175], a[12:15], a[168:171], v[172:175]
    ds_read_b64_tr_b16 a[8:9], v23 offset:18560
    s_add_u32 m0, s36, 6144
    v_mfma_f32_16x16x32_bf16 v[164:167], a[12:15], a[164:167], v[164:167]
    ds_read_b64_tr_b16 a[10:11], v23 offset:20096
    buffer_load_dwordx4 v26, s[12:15], s37 offen offset:0 lds
    v_mfma_f32_16x16x32_bf16 v[176:179], a[16:19], a[164:167], v[176:179]
    ds_read_b64_tr_b16 a[12:13], v20 offset:18688
    v_mul_u32_u24 v13, 96, v2
    v_mfma_f32_16x16x32_bf16 v[184:187], a[16:19], a[168:171], v[184:187]
    ds_read_b64_tr_b16 a[14:15], v20 offset:20224
    v_lshl_add_u32 v13, v3, 3, v13
    v_mfma_f32_16x16x32_bf16 v[188:191], a[20:23], a[168:171], v[188:191]
    ds_read_b64_tr_b16 a[16:17], v21 offset:18688
    s_add_u32 s33, s36, 36864
    v_mfma_f32_16x16x32_bf16 v[180:183], a[20:23], a[164:167], v[180:183]
    ds_read_b64_tr_b16 a[18:19], v21 offset:20224
    s_waitcnt lgkmcnt(4)
    buffer_load_dwordx4 v27, s[12:15], s37 offen offset:1024 lds
    v_mfma_f32_16x16x32_bf16 v[192:195], a[24:27], a[164:167], v[192:195]
    ds_read_b64_tr_b16 a[20:21], v22 offset:18688
    v_add_u32 v13, s33, v13
    v_mfma_f32_16x16x32_bf16 v[200:203], a[24:27], a[168:171], v[200:203]
    ds_read_b64_tr_b16 a[22:23], v22 offset:20224
    s_waitcnt vmcnt(8)
    v_cmp_gt_u32 vcc, 1, v63
    s_nop 0
    s_cbranch_vccnz L_ph0_slow
L_ph0_ok:
    v_add_u32 v14, s33, v38
    v_mfma_f32_16x16x32_bf16 v[204:207], a[0:3], a[168:171], v[204:207]
    ds_read_b64_tr_b16 a[24:25], v23 offset:18688
    s_add_u32 s53, s44, 0
    v_and_b32 v8, 1, v1
    v_mfma_f32_16x16x32_bf16 v[196:199], a[0:3], a[164:167], v[196:199]
    ds_read_b64_tr_b16 a[26:27], v23 offset:20224
    v_mfma_f32_16x16x32_bf16 v[208:211], a[4:7], a[164:167], v[208:211]
    ds_read_b64_tr_b16 a[0:1], v20 offset:21504
    buffer_load_dwordx4 a[36:39], v38, s[16:19], s53 offen offset:0 sc1
    v_mfma_f32_16x16x32_bf16 v[216:219], a[4:7], a[168:171], v[216:219]
    ds_read_b64_tr_b16 a[2:3], v20 offset:23040
    v_lshlrev_b32 v15, 3, v2
    v_mfma_f32_16x16x32_bf16 v[220:223], a[8:11], a[168:171], v[220:223]
    ds_read_b64_tr_b16 a[4:5], v21 offset:21504
    v_lshl_add_u32 v15, v3, 14, v15
    v_lshl_add_u32 v8, s3, 1, v8
    v_mfma_f32_16x16x32_bf16 v[212:215], a[8:11], a[164:167], v[212:215]
    ds_read_b64_tr_b16 a[6:7], v21 offset:23040
    s_waitcnt lgkmcnt(4)
    v_mfma_f32_16x16x32_bf16 v[224:227], a[12:15], a[164:167], v[224:227]
    ds_read_b64_tr_b16 a[8:9], v22 offset:21504
    s_lshl_b32 s33, s30, 2
    v_mfma_f32_16x16x32_bf16 v[232:235], a[12:15], a[168:171], v[232:235]
    ds_read_b64_tr_b16 a[10:11], v22 offset:23040
    buffer_load_dwordx4 a[40:43], v38, s[16:19], s53 offen offset:1024 sc1
    v_mfma_f32_16x16x32_bf16 v[236:239], a[16:19], a[168:171], v[236:239]
    ds_read_b64_tr_b16 a[12:13], v23 offset:21504
    s_add_u32 s33, s33, s31
    v_lshlrev_b32 v8, 7, v8
    v_mfma_f32_16x16x32_bf16 v[228:231], a[16:19], a[164:167], v[228:231]
    ds_read_b64_tr_b16 a[14:15], v23 offset:23040
    buffer_load_dwordx4 v28, s[12:15], s37 offen offset:2048 lds
    v_mfma_f32_16x16x32_bf16 v[240:243], a[20:23], a[164:167], v[240:243]
    ds_read_b64_tr_b16 a[16:17], v20 offset:21632
    s_mul_i32 s62, s33, 196608
    v_mfma_f32_16x16x32_bf16 v[248:251], a[20:23], a[168:171], v[248:251]
    ds_read_b64_tr_b16 a[18:19], v20 offset:23168
    s_lshl_b32 s34, s29, 2
    v_mfma_f32_16x16x32_bf16 v[252:255], a[24:27], a[168:171], v[252:255]
    ds_read_b64_tr_b16 a[20:21], v21 offset:21632
    buffer_load_dwordx4 a[44:47], v38, s[16:19], s53 offen offset:2048 sc1
    v_add_u32 v8, L_stage21-L_pc, v8
    v_mfma_f32_16x16x32_bf16 v[244:247], a[24:27], a[164:167], v[244:247]
    ds_read_b64_tr_b16 a[22:23], v21 offset:23168
    s_waitcnt lgkmcnt(4)
    v_mfma_f32_16x16x32_bf16 v[160:163], a[0:3], a[172:175], v[160:163]
    ds_read_b64_tr_b16 a[24:25], v22 offset:21632
    s_add_u32 s34, s34, s28
    buffer_load_dwordx4 v29, s[12:15], s37 offen offset:3072 lds
    v_mfma_f32_16x16x32_bf16 v[168:171], a[0:3], a[176:179], v[168:171]
    ds_read_b64_tr_b16 a[26:27], v22 offset:23168
    s_lshl_b32 s34, s34, 8
    v_mfma_f32_16x16x32_bf16 v[172:175], a[4:7], a[176:179], v[172:175]
    ds_read_b64_tr_b16 a[0:1], v23 offset:21632
    global_load_dword v9, v8, s[0:1]
    v_mfma_f32_16x16x32_bf16 v[164:167], a[4:7], a[172:175], v[164:167]
    ds_read_b64_tr_b16 a[2:3], v23 offset:23168
    v_mfma_f32_16x16x32_bf16 v[176:179], a[8:11], a[172:175], v[176:179]
    ds_read_b64_tr_b16 a[4:5], v20 offset:21760
    s_add_u32 s62, s62, s34
    s_add_u32 s62, s62, 2424832
    v_mfma_f32_16x16x32_bf16 v[184:187], a[8:11], a[176:179], v[184:187]
    ds_read_b64_tr_b16 a[6:7], v20 offset:23296
    s_lshl_b32 s33, s33, 4
    buffer_load_dwordx4 a[48:51], v38, s[16:19], s53 offen offset:3072 sc1
    v_mfma_f32_16x16x32_bf16 v[188:191], a[12:15], a[176:179], v[188:191]
    ds_read_b64_tr_b16 a[8:9], v21 offset:21760
    s_add_u32 s53, s44, 4096
    v_mfma_f32_16x16x32_bf16 v[180:183], a[12:15], a[172:175], v[180:183]
    ds_read_b64_tr_b16 a[10:11], v21 offset:23296
    s_waitcnt lgkmcnt(4)
    v_mfma_f32_16x16x32_bf16 v[192:195], a[16:19], a[172:175], v[192:195]
    ds_read_b64_tr_b16 a[12:13], v22 offset:21760
    buffer_load_dwordx4 a[52:55], v38, s[16:19], s53 offen offset:0 sc1
    v_mfma_f32_16x16x32_bf16 v[200:203], a[16:19], a[176:179], v[200:203]
    ds_read_b64_tr_b16 a[14:15], v22 offset:23296
    s_add_u32 m0, s36, 10240
    v_mfma_f32_16x16x32_bf16 v[204:207], a[20:23], a[176:179], v[204:207]
    ds_read_b64_tr_b16 a[16:17], v23 offset:21760
    v_mfma_f32_16x16x32_bf16 v[196:199], a[20:23], a[172:175], v[196:199]
    ds_read_b64_tr_b16 a[18:19], v23 offset:23296
    s_barrier
    v_mfma_f32_16x16x32_bf16 v[208:211], a[24:27], a[172:175], v[208:211]
    ds_read_b64_tr_b16 a[20:21], v32 offset:24576
    s_lshl_b32 s34, s29, 8
    buffer_load_dwordx4 v30, s[12:15], s37 offen offset:0 lds
    v_mfma_f32_16x16x32_bf16 v[216:219], a[24:27], a[176:179], v[216:219]
    ds_read_b64_tr_b16 a[22:23], v32 offset:26112
    s_add_u32 s33, s33, s34
    v_mfma_f32_16x16x32_bf16 v[220:223], a[0:3], a[176:179], v[220:223]
    ds_read_b64_tr_b16 a[24:25], v33 offset:24576
    s_add_u32 s48, s33, 57344
    v_mfma_f32_16x16x32_bf16 v[212:215], a[0:3], a[172:175], v[212:215]
    ds_read_b64_tr_b16 a[26:27], v33 offset:26112
    s_waitcnt lgkmcnt(4)
    v_mfma_f32_16x16x32_bf16 v[224:227], a[4:7], a[172:175], v[224:227]
    ds_read_b64_tr_b16 a[0:1], v34 offset:24576
    buffer_load_dwordx4 a[56:59], v38, s[16:19], s53 offen offset:1024 sc1
    v_mfma_f32_16x16x32_bf16 v[232:235], a[4:7], a[176:179], v[232:235]
    ds_read_b64_tr_b16 a[2:3], v34 offset:26112
    s_mul_i32 s49, s31, 12288
    v_mfma_f32_16x16x32_bf16 v[236:239], a[8:11], a[176:179], v[236:239]
    ds_read_b64_tr_b16 a[4:5], v35 offset:24576
    s_mul_i32 s33, s28, 3072
    v_mfma_f32_16x16x32_bf16 v[228:231], a[8:11], a[172:175], v[228:231]
    ds_read_b64_tr_b16 a[6:7], v35 offset:26112
    buffer_load_dwordx4 v31, s[12:15], s37 offen offset:1024 lds
    v_mfma_f32_16x16x32_bf16 v[240:243], a[12:15], a[172:175], v[240:243]
    ds_read_b64_tr_b16 a[8:9], v36 offset:24576
    v_mfma_f32_16x16x32_bf16 v[248:251], a[12:15], a[176:179], v[248:251]
    ds_read_b64_tr_b16 a[10:11], v36 offset:26112
    s_add_u32 s49, s49, s33
    v_mfma_f32_16x16x32_bf16 v[252:255], a[16:19], a[176:179], v[252:255]
    ds_read_b64_tr_b16 a[12:13], v37 offset:24576
    s_add_u32 s49, s49, s50
    v_mfma_f32_16x16x32_bf16 v[244:247], a[16:19], a[172:175], v[244:247]
    ds_read_b64_tr_b16 a[14:15], v37 offset:26112
    s_waitcnt lgkmcnt(4)
L_stage18:
    v_mfma_f32_16x16x32_bf16 v[112:115], a[20:23], v[64:67], 0
    ds_read_b64_tr_b16 a[16:17], v16 offset:24576
    buffer_load_dwordx4 a[60:63], v38, s[16:19], s53 offen offset:2048 sc1
    v_mfma_f32_16x16x32_bf16 v[116:119], a[20:23], v[68:71], 0
    ds_read_b64_tr_b16 a[18:19], v16 offset:26112
    s_add_u32 s37, s40, 294912
    v_mfma_f32_16x16x32_bf16 v[124:127], a[24:27], v[68:71], 0
    ds_read_b64_tr_b16 a[20:21], v17 offset:24576
    s_add_u32 m0, s36, 12288
    v_mfma_f32_16x16x32_bf16 v[120:123], a[24:27], v[64:67], 0
    ds_read_b64_tr_b16 a[22:23], v17 offset:26112
    buffer_load_dwordx4 v26, s[12:15], s37 offen offset:0 lds
    v_mfma_f32_16x16x32_bf16 v[128:131], a[0:3], v[64:67], 0
    ds_read_b64_tr_b16 a[24:25], v18 offset:24576
    ds_read_b128 v[44:47], v39 offset:768
    v_mfma_f32_16x16x32_bf16 v[132:135], a[0:3], v[68:71], 0
    ds_read_b64_tr_b16 a[26:27], v18 offset:26112
    ds_read_b128 v[48:51], v39 offset:832
    s_add_u32 s52, s43, 12288
    v_mfma_f32_16x16x32_bf16 v[140:143], a[4:7], v[68:71], 0
    ds_read_b64_tr_b16 a[0:1], v19 offset:24576
    ds_read_b128 v[52:55], v39 offset:896
    ds_read_b128 v[56:59], v39 offset:960
    v_mfma_f32_16x16x32_bf16 v[136:139], a[4:7], v[64:67], 0
    ds_read_b64_tr_b16 a[2:3], v19 offset:26112
    s_waitcnt lgkmcnt(8)
    s_waitcnt lgkmcnt(4)
    v_mfma_f32_16x16x32_bf16 v[144:147], a[8:11], v[64:67], 0
    ds_read_b64_tr_b16 a[4:5], v24 offset:24576
    v_fmac_f32 v160, v40, v44
    v_mfma_f32_16x16x32_bf16 v[148:151], a[8:11], v[68:71], 0
    ds_read_b64_tr_b16 a[6:7], v24 offset:26112
    v_fmac_f32 v161, v40, v45
    v_fmac_f32 v162, v40, v46
    v_mfma_f32_16x16x32_bf16 v[156:159], a[12:15], v[68:71], 0
    ds_read_b64_tr_b16 a[8:9], v25 offset:24576
    v_fmac_f32 v163, v40, v47
    v_fmac_f32 v164, v40, v48
    v_mfma_f32_16x16x32_bf16 v[152:155], a[12:15], v[64:67], 0
    ds_read_b64_tr_b16 a[10:11], v25 offset:26112
    buffer_load_dwordx4 v27, s[12:15], s37 offen offset:1024 lds
    v_fmac_f32 v165, v40, v49
    v_mfma_f32_16x16x32_bf16 a[180:183], a[16:19], v[64:67], 0
    ds_read_b64_tr_b16 a[12:13], v32 offset:27648
    v_fmac_f32 v166, v40, v50
    v_mfma_f32_16x16x32_bf16 a[184:187], a[16:19], v[68:71], 0
    ds_read_b64_tr_b16 a[14:15], v32 offset:29184
    v_fmac_f32 v167, v40, v51
    v_cvt_pk_bf16_f32 v160, v160, v161
    v_mfma_f32_16x16x32_bf16 a[192:195], a[20:23], v[68:71], 0
    ds_read_b64_tr_b16 a[16:17], v33 offset:27648
    v_cvt_pk_bf16_f32 v161, v162, v163
    v_cvt_pk_bf16_f32 v162, v164, v165
    v_mfma_f32_16x16x32_bf16 a[188:191], a[20:23], v[64:67], 0
    ds_read_b64_tr_b16 a[18:19], v33 offset:29184
    s_waitcnt lgkmcnt(4)
    v_cvt_pk_bf16_f32 v163, v166, v167
    v_mfma_f32_16x16x32_bf16 a[196:199], a[24:27], v[64:67], 0
    ds_read_b64_tr_b16 a[20:21], v34 offset:27648
    v_pk_max_i16 v160, v160, 0
    v_pk_max_i16 v161, v161, 0
    v_mfma_f32_16x16x32_bf16 a[200:203], a[24:27], v[68:71], 0
    ds_read_b64_tr_b16 a[22:23], v34 offset:29184
    v_pk_max_i16 v162, v162, 0
    buffer_load_dwordx4 v28, s[12:15], s37 offen offset:2048 lds
    v_mfma_f32_16x16x32_bf16 a[208:211], a[0:3], v[68:71], 0
    ds_read_b64_tr_b16 a[24:25], v35 offset:27648
    v_pk_max_i16 v163, v163, 0
    v_mfma_f32_16x16x32_bf16 a[204:207], a[0:3], v[64:67], 0
    ds_read_b64_tr_b16 a[26:27], v35 offset:29184
    buffer_store_dwordx4 v[160:163], v38, s[16:19], s52 offen offset:0 sc1
    v_mfma_f32_16x16x32_bf16 a[212:215], a[4:7], v[64:67], 0
    ds_read_b64_tr_b16 a[0:1], v36 offset:27648
    v_fmac_f32 v168, v42, v44
    v_fmac_f32 v169, v42, v45
    v_mfma_f32_16x16x32_bf16 a[216:219], a[4:7], v[68:71], 0
    ds_read_b64_tr_b16 a[2:3], v36 offset:29184
    v_fmac_f32 v170, v42, v46
    v_mfma_f32_16x16x32_bf16 a[224:227], a[8:11], v[68:71], 0
    ds_read_b64_tr_b16 a[4:5], v37 offset:27648
    v_fmac_f32 v171, v42, v47
    v_fmac_f32 v172, v42, v48
    v_mfma_f32_16x16x32_bf16 a[220:223], a[8:11], v[64:67], 0
    ds_read_b64_tr_b16 a[6:7], v37 offset:29184
    s_waitcnt lgkmcnt(4)
    v_fmac_f32 v173, v42, v49
    v_mfma_f32_16x16x32_bf16 v[112:115], a[12:15], v[72:75], v[112:115]
    ds_read_b64_tr_b16 a[8:9], v16 offset:27648
    v_fmac_f32 v174, v42, v50
    v_fmac_f32 v175, v42, v51
    v_mfma_f32_16x16x32_bf16 v[116:119], a[12:15], v[76:79], v[116:119]
    ds_read_b64_tr_b16 a[10:11], v16 offset:29184
    v_cvt_pk_bf16_f32 v164, v168, v169
    v_cvt_pk_bf16_f32 v165, v170, v171
    v_mfma_f32_16x16x32_bf16 v[124:127], a[16:19], v[76:79], v[124:127]
    ds_read_b64_tr_b16 a[12:13], v17 offset:27648
    buffer_load_dwordx4 v29, s[12:15], s37 offen offset:3072 lds
    v_mfma_f32_16x16x32_bf16 v[120:123], a[16:19], v[72:75], v[120:123]
    ds_read_b64_tr_b16 a[14:15], v17 offset:29184
    v_cvt_pk_bf16_f32 v166, v172, v173
    v_cvt_pk_bf16_f32 v167, v174, v175
    v_mfma_f32_16x16x32_bf16 v[128:131], a[20:23], v[72:75], v[128:131]
    ds_read_b64_tr_b16 a[16:17], v18 offset:27648
    v_pk_max_i16 v164, v164, 0
    v_pk_max_i16 v165, v165, 0
    v_mfma_f32_16x16x32_bf16 v[132:135], a[20:23], v[76:79], v[132:135]
    ds_read_b64_tr_b16 a[18:19], v18 offset:29184
    v_pk_max_i16 v166, v166, 0
    v_pk_max_i16 v167, v167, 0
    v_mfma_f32_16x16x32_bf16 v[140:143], a[24:27], v[76:79], v[140:143]
    ds_read_b64_tr_b16 a[20:21], v19 offset:27648
    buffer_load_dwordx4 a[64:67], v38, s[16:19], s53 offen offset:3072 sc1
    v_mfma_f32_16x16x32_bf16 v[136:139], a[24:27], v[72:75], v[136:139]
    ds_read_b64_tr_b16 a[22:23], v19 offset:29184
    s_waitcnt lgkmcnt(4)
    buffer_store_dwordx4 v[164:167], v38, s[16:19], s52 offen offset:1024 sc1
    v_mfma_f32_16x16x32_bf16 v[144:147], a[0:3], v[72:75], v[144:147]
    ds_read_b64_tr_b16 a[24:25], v24 offset:27648
    ds_read_b128 v[44:47], v39 offset:1024
    v_mfma_f32_16x16x32_bf16 v[148:151], a[0:3], v[76:79], v[148:151]
    ds_read_b64_tr_b16 a[26:27], v24 offset:29184
    s_add_u32 m0, s36, 16384
    ds_read_b128 v[48:51], v39 offset:1088
    v_mfma_f32_16x16x32_bf16 v[156:159], a[4:7], v[76:79], v[156:159]
    ds_read_b64_tr_b16 a[0:1], v25 offset:27648
    buffer_load_dwordx4 v30, s[12:15], s37 offen offset:0 lds
    v_mfma_f32_16x16x32_bf16 v[152:155], a[4:7], v[72:75], v[152:155]
    ds_read_b64_tr_b16 a[2:3], v25 offset:29184
    s_barrier
    v_mfma_f32_16x16x32_bf16 a[180:183], a[8:11], v[72:75], a[180:183]
    ds_read_b64_tr_b16 a[4:5], v32 offset:30720
    v_fmac_f32 v176, v40, v52
    v_fmac_f32 v177, v40, v53
    v_mfma_f32_16x16x32_bf16 a[184:187], a[8:11], v[76:79], a[184:187]
    ds_read_b64_tr_b16 a[6:7], v32 offset:32256
    v_fmac_f32 v178, v40, v54
    v_fmac_f32 v179, v40, v55
    v_mfma_f32_16x16x32_bf16 a[192:195], a[12:15], v[76:79], a[192:195]
    ds_read_b64_tr_b16 a[8:9], v33 offset:30720
    v_fmac_f32 v180, v40, v56
    v_fmac_f32 v181, v40, v57
    v_mfma_f32_16x16x32_bf16 a[188:191], a[12:15], v[72:75], a[188:191]
    ds_read_b64_tr_b16 a[10:11], v33 offset:32256
    s_waitcnt lgkmcnt(4)
    buffer_load_dwordx4 v31, s[12:15], s37 offen offset:1024 lds
    v_mfma_f32_16x16x32_bf16 a[196:199], a[16:19], v[72:75], a[196:199]
    ds_read_b64_tr_b16 a[12:13], v34 offset:30720
    v_fmac_f32 v182, v40, v58
    v_fmac_f32 v183, v40, v59
    v_mfma_f32_16x16x32_bf16 a[200:203], a[16:19], v[76:79], a[200:203]
    ds_read_b64_tr_b16 a[14:15], v34 offset:32256
    v_cvt_pk_bf16_f32 v168, v176, v177
    v_cvt_pk_bf16_f32 v169, v178, v179
    v_mfma_f32_16x16x32_bf16 a[208:211], a[20:23], v[76:79], a[208:211]
    ds_read_b64_tr_b16 a[16:17], v35 offset:30720
    v_cvt_pk_bf16_f32 v170, v180, v181
    v_cvt_pk_bf16_f32 v171, v182, v183
    v_mfma_f32_16x16x32_bf16 a[204:207], a[20:23], v[72:75], a[204:207]
    ds_read_b64_tr_b16 a[18:19], v35 offset:32256
    v_mfma_f32_16x16x32_bf16 a[212:215], a[24:27], v[72:75], a[212:215]
    ds_read_b64_tr_b16 a[20:21], v36 offset:30720
    v_pk_max_i16 v168, v168, 0
    v_pk_max_i16 v169, v169, 0
    v_mfma_f32_16x16x32_bf16 a[216:219], a[24:27], v[76:79], a[216:219]
    ds_read_b64_tr_b16 a[22:23], v36 offset:32256
    v_pk_max_i16 v170, v170, 0
    v_pk_max_i16 v171, v171, 0
    v_mfma_f32_16x16x32_bf16 a[224:227], a[0:3], v[76:79], a[224:227]
    ds_read_b64_tr_b16 a[24:25], v37 offset:30720
    buffer_store_dwordx4 v[168:171], v38, s[16:19], s52 offen offset:2048 sc1
    v_mfma_f32_16x16x32_bf16 a[220:223], a[0:3], v[72:75], a[220:223]
    ds_read_b64_tr_b16 a[26:27], v37 offset:32256
    s_waitcnt lgkmcnt(4)
    v_fmac_f32 v184, v42, v52
L_stage19:
    v_mfma_f32_16x16x32_bf16 v[112:115], a[4:7], v[80:83], v[112:115]
    ds_read_b64_tr_b16 a[0:1], v16 offset:30720
    v_fmac_f32 v185, v42, v53
    v_mfma_f32_16x16x32_bf16 v[116:119], a[4:7], v[84:87], v[116:119]
    ds_read_b64_tr_b16 a[2:3], v16 offset:32256
    s_add_u32 s37, s40, 368640
    v_fmac_f32 v186, v42, v54
    v_mfma_f32_16x16x32_bf16 v[124:127], a[8:11], v[84:87], v[124:127]
    ds_read_b64_tr_b16 a[4:5], v17 offset:30720
    s_add_u32 m0, s36, 18432
    v_fmac_f32 v187, v42, v55
    v_mfma_f32_16x16x32_bf16 v[120:123], a[8:11], v[80:83], v[120:123]
    ds_read_b64_tr_b16 a[6:7], v17 offset:32256
    buffer_load_dwordx4 v26, s[12:15], s37 offen offset:0 lds
    v_fmac_f32 v188, v42, v56
    v_mfma_f32_16x16x32_bf16 v[128:131], a[12:15], v[80:83], v[128:131]
    ds_read_b64_tr_b16 a[8:9], v18 offset:30720
    v_fmac_f32 v189, v42, v57
    v_mfma_f32_16x16x32_bf16 v[132:135], a[12:15], v[84:87], v[132:135]
    ds_read_b64_tr_b16 a[10:11], v18 offset:32256
    v_fmac_f32 v190, v42, v58
    v_fmac_f32 v191, v42, v59
    v_mfma_f32_16x16x32_bf16 v[140:143], a[16:19], v[84:87], v[140:143]
    ds_read_b64_tr_b16 a[12:13], v19 offset:30720
    v_cvt_pk_bf16_f32 v172, v184, v185
    v_cvt_pk_bf16_f32 v173, v186, v187
    v_mfma_f32_16x16x32_bf16 v[136:139], a[16:19], v[80:83], v[136:139]
    ds_read_b64_tr_b16 a[14:15], v19 offset:32256
    s_waitcnt lgkmcnt(4)
    v_cvt_pk_bf16_f32 v174, v188, v189
    v_mfma_f32_16x16x32_bf16 v[144:147], a[20:23], v[80:83], v[144:147]
    ds_read_b64_tr_b16 a[16:17], v24 offset:30720
    v_cvt_pk_bf16_f32 v175, v190, v191
    v_pk_max_i16 v172, v172, 0
    v_mfma_f32_16x16x32_bf16 v[148:151], a[20:23], v[84:87], v[148:151]
    ds_read_b64_tr_b16 a[18:19], v24 offset:32256
    v_pk_max_i16 v173, v173, 0
    buffer_load_dwordx4 v27, s[12:15], s37 offen offset:1024 lds
    v_mfma_f32_16x16x32_bf16 v[156:159], a[24:27], v[84:87], v[156:159]
    ds_read_b64_tr_b16 a[20:21], v25 offset:30720
    v_pk_max_i16 v174, v174, 0
    v_pk_max_i16 v175, v175, 0
    v_mfma_f32_16x16x32_bf16 v[152:155], a[24:27], v[80:83], v[152:155]
    ds_read_b64_tr_b16 a[22:23], v25 offset:32256
    v_mfma_f32_16x16x32_bf16 a[180:183], a[0:3], v[80:83], a[180:183]
    ds_read_b64_tr_b16 a[24:25], v32 offset:33792
    buffer_store_dwordx4 v[172:175], v38, s[16:19], s52 offen offset:3072 sc1
    v_mfma_f32_16x16x32_bf16 a[184:187], a[0:3], v[84:87], a[184:187]
    ds_read_b64_tr_b16 a[26:27], v32 offset:35328
    s_add_u32 s52, s52, 4096
    v_mfma_f32_16x16x32_bf16 a[192:195], a[4:7], v[84:87], a[192:195]
    ds_read_b64_tr_b16 a[0:1], v33 offset:33792
    ds_read_b128 v[52:55], v39 offset:1152
    ds_read_b128 v[56:59], v39 offset:1216
    v_mfma_f32_16x16x32_bf16 a[188:191], a[4:7], v[80:83], a[188:191]
    ds_read_b64_tr_b16 a[2:3], v33 offset:35328
    s_waitcnt lgkmcnt(6)
    v_mfma_f32_16x16x32_bf16 a[196:199], a[8:11], v[80:83], a[196:199]
    ds_read_b64_tr_b16 a[4:5], v34 offset:33792
    v_fmac_f32 v192, v40, v44
    v_fmac_f32 v193, v40, v45
    v_mfma_f32_16x16x32_bf16 a[200:203], a[8:11], v[84:87], a[200:203]
    ds_read_b64_tr_b16 a[6:7], v34 offset:35328
    v_fmac_f32 v194, v40, v46
    buffer_load_dwordx4 v28, s[12:15], s37 offen offset:2048 lds
    v_mfma_f32_16x16x32_bf16 a[208:211], a[12:15], v[84:87], a[208:211]
    ds_read_b64_tr_b16 a[8:9], v35 offset:33792
    v_fmac_f32 v195, v40, v47
    v_fmac_f32 v196, v40, v48
    v_mfma_f32_16x16x32_bf16 a[204:207], a[12:15], v[80:83], a[204:207]
    ds_read_b64_tr_b16 a[10:11], v35 offset:35328
    v_fmac_f32 v197, v40, v49
    v_mfma_f32_16x16x32_bf16 a[212:215], a[16:19], v[80:83], a[212:215]
    ds_read_b64_tr_b16 a[12:13], v36 offset:33792
    v_fmac_f32 v198, v40, v50
    v_fmac_f32 v199, v40, v51
    v_mfma_f32_16x16x32_bf16 a[216:219], a[16:19], v[84:87], a[216:219]
    ds_read_b64_tr_b16 a[14:15], v36 offset:35328
    v_cvt_pk_bf16_f32 v176, v192, v193
    v_cvt_pk_bf16_f32 v177, v194, v195
    v_mfma_f32_16x16x32_bf16 a[224:227], a[20:23], v[84:87], a[224:227]
    ds_read_b64_tr_b16 a[16:17], v37 offset:33792
    v_cvt_pk_bf16_f32 v178, v196, v197
    buffer_load_dwordx4 v29, s[12:15], s37 offen offset:3072 lds
    v_mfma_f32_16x16x32_bf16 a[220:223], a[20:23], v[80:83], a[220:223]
    ds_read_b64_tr_b16 a[18:19], v37 offset:35328
    s_waitcnt lgkmcnt(4)
    v_cvt_pk_bf16_f32 v179, v198, v199
    v_mfma_f32_16x16x32_bf16 v[112:115], a[24:27], v[88:91], v[112:115]
    ds_read_b64_tr_b16 a[20:21], v16 offset:33792
    v_pk_max_i16 v176, v176, 0
    v_pk_max_i16 v177, v177, 0
    v_mfma_f32_16x16x32_bf16 v[116:119], a[24:27], v[92:95], v[116:119]
    ds_read_b64_tr_b16 a[22:23], v16 offset:35328
    v_pk_max_i16 v178, v178, 0
    v_pk_max_i16 v179, v179, 0
    v_mfma_f32_16x16x32_bf16 v[124:127], a[0:3], v[92:95], v[124:127]
    ds_read_b64_tr_b16 a[24:25], v17 offset:33792
    v_mfma_f32_16x16x32_bf16 v[120:123], a[0:3], v[88:91], v[120:123]
    ds_read_b64_tr_b16 a[26:27], v17 offset:35328
    buffer_store_dwordx4 v[176:179], v38, s[16:19], s52 offen offset:0 sc1
    v_mfma_f32_16x16x32_bf16 v[128:131], a[4:7], v[88:91], v[128:131]
    ds_read_b64_tr_b16 a[0:1], v18 offset:33792
    v_fmac_f32 v200, v42, v44
    v_fmac_f32 v201, v42, v45
    v_mfma_f32_16x16x32_bf16 v[132:135], a[4:7], v[92:95], v[132:135]
    ds_read_b64_tr_b16 a[2:3], v18 offset:35328
    v_fmac_f32 v202, v42, v46
    v_fmac_f32 v203, v42, v47
    v_mfma_f32_16x16x32_bf16 v[140:143], a[8:11], v[92:95], v[140:143]
    ds_read_b64_tr_b16 a[4:5], v19 offset:33792
    v_fmac_f32 v204, v42, v48
    v_fmac_f32 v205, v42, v49
    v_mfma_f32_16x16x32_bf16 v[136:139], a[8:11], v[88:91], v[136:139]
    ds_read_b64_tr_b16 a[6:7], v19 offset:35328
    s_waitcnt vmcnt(30) lgkmcnt(4)
    v_mfma_f32_16x16x32_bf16 v[144:147], a[12:15], v[88:91], v[144:147]
    ds_read_b64_tr_b16 a[8:9], v24 offset:33792
    v_fmac_f32 v206, v42, v50
    v_fmac_f32 v207, v42, v51
    v_mfma_f32_16x16x32_bf16 v[148:151], a[12:15], v[92:95], v[148:151]
    ds_read_b64_tr_b16 a[10:11], v24 offset:35328
    s_add_u32 m0, s36, 22528
    v_cvt_pk_bf16_f32 v180, v200, v201
    v_mfma_f32_16x16x32_bf16 v[156:159], a[16:19], v[92:95], v[156:159]
    ds_read_b64_tr_b16 a[12:13], v25 offset:33792
    buffer_load_dwordx4 v30, s[12:15], s37 offen offset:0 lds
    v_cvt_pk_bf16_f32 v181, v202, v203
    v_mfma_f32_16x16x32_bf16 v[152:155], a[16:19], v[88:91], v[152:155]
    ds_read_b64_tr_b16 a[14:15], v25 offset:35328
    s_barrier
    v_mfma_f32_16x16x32_bf16 a[180:183], a[20:23], v[88:91], a[180:183]
    ds_read_b64_tr_b16 a[16:17], v32 offset:0
    v_cvt_pk_bf16_f32 v182, v204, v205
    v_cvt_pk_bf16_f32 v183, v206, v207
    v_mfma_f32_16x16x32_bf16 a[184:187], a[20:23], v[92:95], a[184:187]
    ds_read_b64_tr_b16 a[18:19], v32 offset:1536
    v_pk_max_i16 v180, v180, 0
    v_pk_max_i16 v181, v181, 0
    v_mfma_f32_16x16x32_bf16 a[192:195], a[24:27], v[92:95], a[192:195]
    ds_read_b64_tr_b16 a[20:21], v33 offset:0
    v_pk_max_i16 v182, v182, 0
    v_pk_max_i16 v183, v183, 0
    v_mfma_f32_16x16x32_bf16 a[188:191], a[24:27], v[88:91], a[188:191]
    ds_read_b64_tr_b16 a[22:23], v33 offset:1536
    s_waitcnt lgkmcnt(4)
    v_mfma_f32_16x16x32_bf16 a[196:199], a[0:3], v[88:91], a[196:199]
    ds_read_b64_tr_b16 a[24:25], v34 offset:0
    buffer_store_dwordx4 v[180:183], v38, s[16:19], s52 offen offset:1024 sc1
    v_mfma_f32_16x16x32_bf16 a[200:203], a[0:3], v[92:95], a[200:203]
    ds_read_b64_tr_b16 a[26:27], v34 offset:1536
    ds_read_b128 v[44:47], v39 offset:1280
    v_mfma_f32_16x16x32_bf16 a[208:211], a[4:7], v[92:95], a[208:211]
    ds_read_b64_tr_b16 a[0:1], v35 offset:0
    ds_read_b128 v[48:51], v39 offset:1344
    v_mfma_f32_16x16x32_bf16 a[204:207], a[4:7], v[88:91], a[204:207]
    ds_read_b64_tr_b16 a[2:3], v35 offset:1536
    buffer_load_dwordx4 v31, s[12:15], s37 offen offset:1024 lds
    v_fmac_f32 v208, v40, v52
    v_mfma_f32_16x16x32_bf16 a[212:215], a[8:11], v[88:91], a[212:215]
    ds_read_b64_tr_b16 a[4:5], v36 offset:0
    v_fmac_f32 v209, v40, v53
    v_mfma_f32_16x16x32_bf16 a[216:219], a[8:11], v[92:95], a[216:219]
    ds_read_b64_tr_b16 a[6:7], v36 offset:1536
    v_fmac_f32 v210, v40, v54
    v_fmac_f32 v211, v40, v55
    v_mfma_f32_16x16x32_bf16 a[224:227], a[12:15], v[92:95], a[224:227]
    ds_read_b64_tr_b16 a[8:9], v37 offset:0
    v_fmac_f32 v212, v40, v56
    v_fmac_f32 v213, v40, v57
    v_mfma_f32_16x16x32_bf16 a[220:223], a[12:15], v[88:91], a[220:223]
    ds_read_b64_tr_b16 a[10:11], v37 offset:1536
    s_waitcnt lgkmcnt(4)
    v_fmac_f32 v214, v40, v58
L_stage20:
    v_mfma_f32_16x16x32_bf16 v[112:115], a[16:19], v[96:99], v[112:115]
    ds_read_b64_tr_b16 a[12:13], v16 offset:0
    v_fmac_f32 v215, v40, v59
    v_mfma_f32_16x16x32_bf16 v[116:119], a[16:19], v[100:103], v[116:119]
    ds_read_b64_tr_b16 a[14:15], v16 offset:1536
    s_add_u32 s37, s41, 0
    v_cvt_pk_bf16_f32 v184, v208, v209
    v_mfma_f32_16x16x32_bf16 v[124:127], a[20:23], v[100:103], v[124:127]
    ds_read_b64_tr_b16 a[16:17], v17 offset:0
    s_add_u32 m0, s36, 24576
    v_cvt_pk_bf16_f32 v185, v210, v211
    v_mfma_f32_16x16x32_bf16 v[120:123], a[20:23], v[96:99], v[120:123]
    ds_read_b64_tr_b16 a[18:19], v17 offset:1536
    buffer_load_dwordx4 v26, s[12:15], s37 offen offset:0 lds
    v_cvt_pk_bf16_f32 v186, v212, v213
    v_mfma_f32_16x16x32_bf16 v[128:131], a[24:27], v[96:99], v[128:131]
    ds_read_b64_tr_b16 a[20:21], v18 offset:0
    v_cvt_pk_bf16_f32 v187, v214, v215
    v_pk_max_i16 v184, v184, 0
    v_mfma_f32_16x16x32_bf16 v[132:135], a[24:27], v[100:103], v[132:135]
    ds_read_b64_tr_b16 a[22:23], v18 offset:1536
    v_pk_max_i16 v185, v185, 0
    v_mfma_f32_16x16x32_bf16 v[140:143], a[0:3], v[100:103], v[140:143]
    ds_read_b64_tr_b16 a[24:25], v19 offset:0
    v_pk_max_i16 v186, v186, 0
    v_pk_max_i16 v187, v187, 0
    v_mfma_f32_16x16x32_bf16 v[136:139], a[0:3], v[96:99], v[136:139]
    ds_read_b64_tr_b16 a[26:27], v19 offset:1536
    s_waitcnt lgkmcnt(4)
    v_mfma_f32_16x16x32_bf16 v[144:147], a[4:7], v[96:99], v[144:147]
    ds_read_b64_tr_b16 a[0:1], v24 offset:0
    buffer_store_dwordx4 v[184:187], v38, s[16:19], s52 offen offset:2048 sc1
    v_fmac_f32 v216, v42, v52
    v_mfma_f32_16x16x32_bf16 v[148:151], a[4:7], v[100:103], v[148:151]
    ds_read_b64_tr_b16 a[2:3], v24 offset:1536
    v_fmac_f32 v217, v42, v53
    v_mfma_f32_16x16x32_bf16 v[156:159], a[8:11], v[100:103], v[156:159]
    ds_read_b64_tr_b16 a[4:5], v25 offset:0
    v_fmac_f32 v218, v42, v54
    v_fmac_f32 v219, v42, v55
    v_mfma_f32_16x16x32_bf16 v[152:155], a[8:11], v[96:99], v[152:155]
    ds_read_b64_tr_b16 a[6:7], v25 offset:1536
    v_fmac_f32 v220, v42, v56
    v_mfma_f32_16x16x32_bf16 a[180:183], a[12:15], v[96:99], a[180:183]
    ds_read_b64_tr_b16 a[8:9], v32 offset:3072
    v_fmac_f32 v221, v42, v57
    v_fmac_f32 v222, v42, v58
    v_mfma_f32_16x16x32_bf16 a[184:187], a[12:15], v[100:103], a[184:187]
    ds_read_b64_tr_b16 a[10:11], v32 offset:4608
    v_fmac_f32 v223, v42, v59
    v_cvt_pk_bf16_f32 v188, v216, v217
    v_mfma_f32_16x16x32_bf16 a[192:195], a[16:19], v[100:103], a[192:195]
    ds_read_b64_tr_b16 a[12:13], v33 offset:3072
    v_cvt_pk_bf16_f32 v189, v218, v219
    buffer_load_dwordx4 v27, s[12:15], s37 offen offset:1024 lds
    v_mfma_f32_16x16x32_bf16 a[188:191], a[16:19], v[96:99], a[188:191]
    ds_read_b64_tr_b16 a[14:15], v33 offset:4608
    s_waitcnt lgkmcnt(4)
    v_cvt_pk_bf16_f32 v190, v220, v221
    v_mfma_f32_16x16x32_bf16 a[196:199], a[20:23], v[96:99], a[196:199]
    ds_read_b64_tr_b16 a[16:17], v34 offset:3072
    v_cvt_pk_bf16_f32 v191, v222, v223
    v_pk_max_i16 v188, v188, 0
    v_mfma_f32_16x16x32_bf16 a[200:203], a[20:23], v[100:103], a[200:203]
    ds_read_b64_tr_b16 a[18:19], v34 offset:4608
    v_pk_max_i16 v189, v189, 0
    v_pk_max_i16 v190, v190, 0
    v_mfma_f32_16x16x32_bf16 a[208:211], a[24:27], v[100:103], a[208:211]
    ds_read_b64_tr_b16 a[20:21], v35 offset:3072
    v_pk_max_i16 v191, v191, 0
    v_mfma_f32_16x16x32_bf16 a[204:207], a[24:27], v[96:99], a[204:207]
    ds_read_b64_tr_b16 a[22:23], v35 offset:4608
    buffer_load_dwordx4 v28, s[12:15], s37 offen offset:2048 lds
    v_mfma_f32_16x16x32_bf16 a[212:215], a[0:3], v[96:99], a[212:215]
    ds_read_b64_tr_b16 a[24:25], v36 offset:3072
    buffer_store_dwordx4 v[188:191], v38, s[16:19], s52 offen offset:3072 sc1
    v_mfma_f32_16x16x32_bf16 a[216:219], a[0:3], v[100:103], a[216:219]
    ds_read_b64_tr_b16 a[26:27], v36 offset:4608
    s_add_u32 s52, s52, 4096
    ds_read_b128 v[52:55], v39 offset:1408
    v_mfma_f32_16x16x32_bf16 a[224:227], a[4:7], v[100:103], a[224:227]
    ds_read_b64_tr_b16 a[0:1], v37 offset:3072
    ds_read_b128 v[56:59], v39 offset:1472
    v_mfma_f32_16x16x32_bf16 a[220:223], a[4:7], v[96:99], a[220:223]
    ds_read_b64_tr_b16 a[2:3], v37 offset:4608
    s_waitcnt lgkmcnt(6)
    v_mfma_f32_16x16x32_bf16 v[112:115], a[8:11], v[104:107], v[112:115]
    ds_read_b64_tr_b16 a[4:5], v16 offset:3072
    v_fmac_f32 v224, v40, v44
    v_fmac_f32 v225, v40, v45
    v_mfma_f32_16x16x32_bf16 v[116:119], a[8:11], v[108:111], v[116:119]
    ds_read_b64_tr_b16 a[6:7], v16 offset:4608
    v_fmac_f32 v226, v40, v46
    v_fmac_f32 v227, v40, v47
    v_mfma_f32_16x16x32_bf16 v[124:127], a[12:15], v[108:111], v[124:127]
    ds_read_b64_tr_b16 a[8:9], v17 offset:3072
    buffer_load_dwordx4 v29, s[12:15], s37 offen offset:3072 lds
    v_fmac_f32 v228, v40, v48
    v_mfma_f32_16x16x32_bf16 v[120:123], a[12:15], v[104:107], v[120:123]
    ds_read_b64_tr_b16 a[10:11], v17 offset:4608
    v_fmac_f32 v229, v40, v49
    v_mfma_f32_16x16x32_bf16 v[128:131], a[16:19], v[104:107], v[128:131]
    ds_read_b64_tr_b16 a[12:13], v18 offset:3072
    v_fmac_f32 v230, v40, v50
    v_fmac_f32 v231, v40, v51
    v_mfma_f32_16x16x32_bf16 v[132:135], a[16:19], v[108:111], v[132:135]
    ds_read_b64_tr_b16 a[14:15], v18 offset:4608
    v_cvt_pk_bf16_f32 v192, v224, v225
    v_cvt_pk_bf16_f32 v193, v226, v227
    v_mfma_f32_16x16x32_bf16 v[140:143], a[20:23], v[108:111], v[140:143]
    ds_read_b64_tr_b16 a[16:17], v19 offset:3072
    v_cvt_pk_bf16_f32 v194, v228, v229
    v_cvt_pk_bf16_f32 v195, v230, v231
    v_mfma_f32_16x16x32_bf16 v[136:139], a[20:23], v[104:107], v[136:139]
    ds_read_b64_tr_b16 a[18:19], v19 offset:4608
    s_waitcnt vmcnt(26) lgkmcnt(4)
    v_mfma_f32_16x16x32_bf16 v[144:147], a[24:27], v[104:107], v[144:147]
    ds_read_b64_tr_b16 a[20:21], v24 offset:3072
    v_pk_max_i16 v192, v192, 0
    v_pk_max_i16 v193, v193, 0
    v_mfma_f32_16x16x32_bf16 v[148:151], a[24:27], v[108:111], v[148:151]
    ds_read_b64_tr_b16 a[22:23], v24 offset:4608
    s_add_u32 m0, s36, 28672
    v_pk_max_i16 v194, v194, 0
    v_mfma_f32_16x16x32_bf16 v[156:159], a[0:3], v[108:111], v[156:159]
    ds_read_b64_tr_b16 a[24:25], v25 offset:3072
    buffer_load_dwordx4 v30, s[12:15], s37 offen offset:0 lds
    v_pk_max_i16 v195, v195, 0
    v_mfma_f32_16x16x32_bf16 v[152:155], a[0:3], v[104:107], v[152:155]
    ds_read_b64_tr_b16 a[26:27], v25 offset:4608
    s_barrier
    v_mfma_f32_16x16x32_bf16 a[180:183], a[4:7], v[104:107], a[180:183]
    ds_read_b64_tr_b16 a[0:1], v32 offset:6144
    buffer_store_dwordx4 v[192:195], v38, s[16:19], s52 offen offset:0 sc1
    v_mfma_f32_16x16x32_bf16 a[184:187], a[4:7], v[108:111], a[184:187]
    ds_read_b64_tr_b16 a[2:3], v32 offset:7680
    v_fmac_f32 v232, v42, v44
    v_fmac_f32 v233, v42, v45
    v_mfma_f32_16x16x32_bf16 a[192:195], a[8:11], v[108:111], a[192:195]
    ds_read_b64_tr_b16 a[4:5], v33 offset:6144
    v_fmac_f32 v234, v42, v46
    v_fmac_f32 v235, v42, v47
    v_mfma_f32_16x16x32_bf16 a[188:191], a[8:11], v[104:107], a[188:191]
    ds_read_b64_tr_b16 a[6:7], v33 offset:7680
    s_waitcnt lgkmcnt(4)
    v_fmac_f32 v236, v42, v48
    v_mfma_f32_16x16x32_bf16 a[196:199], a[12:15], v[104:107], a[196:199]
    ds_read_b64_tr_b16 a[8:9], v34 offset:6144
    v_fmac_f32 v237, v42, v49
    v_mfma_f32_16x16x32_bf16 a[200:203], a[12:15], v[108:111], a[200:203]
    ds_read_b64_tr_b16 a[10:11], v34 offset:7680
    v_fmac_f32 v238, v42, v50
    v_fmac_f32 v239, v42, v51
    v_mfma_f32_16x16x32_bf16 a[208:211], a[16:19], v[108:111], a[208:211]
    ds_read_b64_tr_b16 a[12:13], v35 offset:6144
    v_cvt_pk_bf16_f32 v196, v232, v233
    v_cvt_pk_bf16_f32 v197, v234, v235
    v_mfma_f32_16x16x32_bf16 a[204:207], a[16:19], v[104:107], a[204:207]
    ds_read_b64_tr_b16 a[14:15], v35 offset:7680
    buffer_load_dwordx4 v31, s[12:15], s37 offen offset:1024 lds
    v_cvt_pk_bf16_f32 v198, v236, v237
    v_mfma_f32_16x16x32_bf16 a[212:215], a[20:23], v[104:107], a[212:215]
    ds_read_b64_tr_b16 a[16:17], v36 offset:6144
    v_cvt_pk_bf16_f32 v199, v238, v239
    v_pk_max_i16 v196, v196, 0
    v_mfma_f32_16x16x32_bf16 a[216:219], a[20:23], v[108:111], a[216:219]
    ds_read_b64_tr_b16 a[18:19], v36 offset:7680
    v_pk_max_i16 v197, v197, 0
    v_mfma_f32_16x16x32_bf16 a[224:227], a[24:27], v[108:111], a[224:227]
    ds_read_b64_tr_b16 a[20:21], v37 offset:6144
    v_pk_max_i16 v198, v198, 0
    v_pk_max_i16 v199, v199, 0
    v_mfma_f32_16x16x32_bf16 a[220:223], a[24:27], v[104:107], a[220:223]
    ds_read_b64_tr_b16 a[22:23], v37 offset:7680
    s_waitcnt lgkmcnt(4)
L_stage21:
    v_mfma_f32_16x16x32_bf16 v[112:115], a[0:3], v[160:163], v[112:115]
    ds_read_b64_tr_b16 a[24:25], v16 offset:6144
    buffer_store_dwordx4 v[196:199], v38, s[16:19], s52 offen offset:1024 sc1
    v_mfma_f32_16x16x32_bf16 v[116:119], a[0:3], v[164:167], v[116:119]
    ds_read_b64_tr_b16 a[26:27], v16 offset:7680
    s_add_u32 s37, s41, 73728
    v_mfma_f32_16x16x32_bf16 v[124:127], a[4:7], v[164:167], v[124:127]
    ds_read_b64_tr_b16 a[0:1], v17 offset:6144
    s_add_u32 m0, s36, 30720
    v_mfma_f32_16x16x32_bf16 v[120:123], a[4:7], v[160:163], v[120:123]
    ds_read_b64_tr_b16 a[2:3], v17 offset:7680
    v_fmac_f32 v240, v40, v52
    v_mfma_f32_16x16x32_bf16 v[128:131], a[8:11], v[160:163], v[128:131]
    ds_read_b64_tr_b16 a[4:5], v18 offset:6144
    v_fmac_f32 v241, v40, v53
    v_fmac_f32 v242, v40, v54
    v_mfma_f32_16x16x32_bf16 v[132:135], a[8:11], v[164:167], v[132:135]
    ds_read_b64_tr_b16 a[6:7], v18 offset:7680
    v_fmac_f32 v243, v40, v55
    buffer_load_dwordx4 v26, s[12:15], s37 offen offset:0 lds
    v_mfma_f32_16x16x32_bf16 v[140:143], a[12:15], v[164:167], v[140:143]
    ds_read_b64_tr_b16 a[8:9], v19 offset:6144
    v_fmac_f32 v244, v40, v56
    v_fmac_f32 v245, v40, v57
    v_mfma_f32_16x16x32_bf16 v[136:139], a[12:15], v[160:163], v[136:139]
    ds_read_b64_tr_b16 a[10:11], v19 offset:7680
    s_waitcnt lgkmcnt(4)
    v_fmac_f32 v246, v40, v58
    v_mfma_f32_16x16x32_bf16 v[144:147], a[16:19], v[160:163], v[144:147]
    ds_read_b64_tr_b16 a[12:13], v24 offset:6144
    v_fmac_f32 v247, v40, v59
    v_cvt_pk_bf16_f32 v200, v240, v241
    v_mfma_f32_16x16x32_bf16 v[148:151], a[16:19], v[164:167], v[148:151]
    ds_read_b64_tr_b16 a[14:15], v24 offset:7680
    v_cvt_pk_bf16_f32 v201, v242, v243
    v_cvt_pk_bf16_f32 v202, v244, v245
    v_mfma_f32_16x16x32_bf16 v[156:159], a[20:23], v[164:167], v[156:159]
    ds_read_b64_tr_b16 a[16:17], v25 offset:6144
    v_cvt_pk_bf16_f32 v203, v246, v247
    v_mfma_f32_16x16x32_bf16 v[152:155], a[20:23], v[160:163], v[152:155]
    ds_read_b64_tr_b16 a[18:19], v25 offset:7680
    buffer_load_dwordx4 v27, s[12:15], s37 offen offset:1024 lds
    v_pk_max_i16 v200, v200, 0
    v_mfma_f32_16x16x32_bf16 a[180:183], a[24:27], v[160:163], a[180:183]
    ds_read_b64_tr_b16 a[20:21], v32 offset:9216
    v_pk_max_i16 v201, v201, 0
    v_pk_max_i16 v202, v202, 0
    v_mfma_f32_16x16x32_bf16 a[184:187], a[24:27], v[164:167], a[184:187]
    ds_read_b64_tr_b16 a[22:23], v32 offset:10752
    v_pk_max_i16 v203, v203, 0
    v_mfma_f32_16x16x32_bf16 a[192:195], a[0:3], v[164:167], a[192:195]
    ds_read_b64_tr_b16 a[24:25], v33 offset:9216
    buffer_store_dwordx4 v[200:203], v38, s[16:19], s52 offen offset:2048 sc1
    v_mfma_f32_16x16x32_bf16 a[188:191], a[0:3], v[160:163], a[188:191]
    ds_read_b64_tr_b16 a[26:27], v33 offset:10752
    s_waitcnt lgkmcnt(4)
    v_fmac_f32 v248, v42, v52
    v_mfma_f32_16x16x32_bf16 a[196:199], a[4:7], v[160:163], a[196:199]
    ds_read_b64_tr_b16 a[0:1], v34 offset:9216
    v_fmac_f32 v249, v42, v53
    v_fmac_f32 v250, v42, v54
    v_mfma_f32_16x16x32_bf16 a[200:203], a[4:7], v[164:167], a[200:203]
    ds_read_b64_tr_b16 a[2:3], v34 offset:10752
    v_fmac_f32 v251, v42, v55
    v_fmac_f32 v252, v42, v56
    v_mfma_f32_16x16x32_bf16 a[208:211], a[8:11], v[164:167], a[208:211]
    ds_read_b64_tr_b16 a[4:5], v35 offset:9216
    v_fmac_f32 v253, v42, v57
    v_fmac_f32 v254, v42, v58
    v_mfma_f32_16x16x32_bf16 a[204:207], a[8:11], v[160:163], a[204:207]
    ds_read_b64_tr_b16 a[6:7], v35 offset:10752
    buffer_load_dwordx4 v28, s[12:15], s37 offen offset:2048 lds
    v_mfma_f32_16x16x32_bf16 a[212:215], a[12:15], v[160:163], a[212:215]
    ds_read_b64_tr_b16 a[8:9], v36 offset:9216
    v_fmac_f32 v255, v42, v59
    v_cvt_pk_bf16_f32 v204, v248, v249
    v_mfma_f32_16x16x32_bf16 a[216:219], a[12:15], v[164:167], a[216:219]
    ds_read_b64_tr_b16 a[10:11], v36 offset:10752
    v_cvt_pk_bf16_f32 v205, v250, v251
    v_cvt_pk_bf16_f32 v206, v252, v253
    v_mfma_f32_16x16x32_bf16 a[224:227], a[16:19], v[164:167], a[224:227]
    ds_read_b64_tr_b16 a[12:13], v37 offset:9216
    v_cvt_pk_bf16_f32 v207, v254, v255
    v_pk_max_i16 v204, v204, 0
    v_mfma_f32_16x16x32_bf16 a[220:223], a[16:19], v[160:163], a[220:223]
    ds_read_b64_tr_b16 a[14:15], v37 offset:10752
    s_waitcnt lgkmcnt(4)
    v_mfma_f32_16x16x32_bf16 v[112:115], a[20:23], v[168:171], v[112:115]
    ds_read_b64_tr_b16 a[16:17], v16 offset:9216
    v_pk_max_i16 v205, v205, 0
    v_pk_max_i16 v206, v206, 0
    v_mfma_f32_16x16x32_bf16 v[116:119], a[20:23], v[172:175], v[116:119]
    ds_read_b64_tr_b16 a[18:19], v16 offset:10752
    v_pk_max_i16 v207, v207, 0
    v_mfma_f32_16x16x32_bf16 v[124:127], a[24:27], v[172:175], v[124:127]
    ds_read_b64_tr_b16 a[20:21], v17 offset:9216
    buffer_store_dwordx4 v[204:207], v38, s[16:19], s52 offen offset:3072 sc1
    v_mfma_f32_16x16x32_bf16 v[120:123], a[24:27], v[168:171], v[120:123]
    ds_read_b64_tr_b16 a[22:23], v17 offset:10752
    v_mfma_f32_16x16x32_bf16 v[128:131], a[0:3], v[168:171], v[128:131]
    ds_read_b64_tr_b16 a[24:25], v18 offset:9216
    buffer_load_dwordx4 v29, s[12:15], s37 offen offset:3072 lds
    v_mfma_f32_16x16x32_bf16 v[132:135], a[0:3], v[172:175], v[132:135]
    ds_read_b64_tr_b16 a[26:27], v18 offset:10752
    s_add_u32 s53, s44, 8192
    v_mfma_f32_16x16x32_bf16 v[140:143], a[4:7], v[172:175], v[140:143]
    ds_read_b64_tr_b16 a[0:1], v19 offset:9216
    buffer_load_dwordx4 a[68:71], v38, s[16:19], s53 offen offset:0 sc1
    v_mfma_f32_16x16x32_bf16 v[136:139], a[4:7], v[168:171], v[136:139]
    ds_read_b64_tr_b16 a[2:3], v19 offset:10752
    s_waitcnt vmcnt(27) lgkmcnt(4)
    v_mfma_f32_16x16x32_bf16 v[144:147], a[8:11], v[168:171], v[144:147]
    ds_read_b64_tr_b16 a[4:5], v24 offset:9216
    v_mfma_f32_16x16x32_bf16 v[148:151], a[8:11], v[172:175], v[148:151]
    ds_read_b64_tr_b16 a[6:7], v24 offset:10752
    s_add_u32 m0, s36, 34816
    v_mfma_f32_16x16x32_bf16 v[156:159], a[12:15], v[172:175], v[156:159]
    ds_read_b64_tr_b16 a[8:9], v25 offset:9216
    buffer_load_dwordx4 v30, s[12:15], s37 offen offset:0 lds
    v_mfma_f32_16x16x32_bf16 v[152:155], a[12:15], v[168:171], v[152:155]
    ds_read_b64_tr_b16 a[10:11], v25 offset:10752
    s_barrier
    v_mfma_f32_16x16x32_bf16 a[180:183], a[16:19], v[168:171], a[180:183]
    ds_read_b64_tr_b16 a[12:13], v32 offset:12288
    v_mfma_f32_16x16x32_bf16 a[184:187], a[16:19], v[172:175], a[184:187]
    ds_read_b64_tr_b16 a[14:15], v32 offset:13824
    buffer_load_dwordx4 a[72:75], v38, s[16:19], s53 offen offset:1024 sc1
    v_mfma_f32_16x16x32_bf16 a[192:195], a[20:23], v[172:175], a[192:195]
    ds_read_b64_tr_b16 a[16:17], v33 offset:12288
    v_mfma_f32_16x16x32_bf16 a[188:191], a[20:23], v[168:171], a[188:191]
    ds_read_b64_tr_b16 a[18:19], v33 offset:13824
    s_waitcnt lgkmcnt(4)
    v_mfma_f32_16x16x32_bf16 a[196:199], a[24:27], v[168:171], a[196:199]
    ds_read_b64_tr_b16 a[20:21], v34 offset:12288
    buffer_load_dwordx4 v31, s[12:15], s37 offen offset:1024 lds
    v_mfma_f32_16x16x32_bf16 a[200:203], a[24:27], v[172:175], a[200:203]
    ds_read_b64_tr_b16 a[22:23], v34 offset:13824
    v_mfma_f32_16x16x32_bf16 a[208:211], a[0:3], v[172:175], a[208:211]
    ds_read_b64_tr_b16 a[24:25], v35 offset:12288
    v_mfma_f32_16x16x32_bf16 a[204:207], a[0:3], v[168:171], a[204:207]
    ds_read_b64_tr_b16 a[26:27], v35 offset:13824
    v_mfma_f32_16x16x32_bf16 a[212:215], a[4:7], v[168:171], a[212:215]
    ds_read_b64_tr_b16 a[0:1], v36 offset:12288
    v_mfma_f32_16x16x32_bf16 a[216:219], a[4:7], v[172:175], a[216:219]
    ds_read_b64_tr_b16 a[2:3], v36 offset:13824
    buffer_load_dwordx4 a[76:79], v38, s[16:19], s53 offen offset:2048 sc1
    v_mfma_f32_16x16x32_bf16 a[224:227], a[8:11], v[172:175], a[224:227]
    ds_read_b64_tr_b16 a[4:5], v37 offset:12288
    v_mfma_f32_16x16x32_bf16 a[220:223], a[8:11], v[168:171], a[220:223]
    ds_read_b64_tr_b16 a[6:7], v37 offset:13824
    s_waitcnt lgkmcnt(4)
L_stage22:
    v_mfma_f32_16x16x32_bf16 v[112:115], a[12:15], v[176:179], v[112:115]
    ds_read_b64_tr_b16 a[8:9], v16 offset:12288
    s_mul_i32 s56, s31, 49152
    v_mfma_f32_16x16x32_bf16 v[116:119], a[12:15], v[180:183], v[116:119]
    ds_read_b64_tr_b16 a[10:11], v16 offset:13824
    s_add_u32 s37, s41, 147456
    v_mfma_f32_16x16x32_bf16 v[124:127], a[16:19], v[180:183], v[124:127]
    ds_read_b64_tr_b16 a[12:13], v17 offset:12288
    s_add_u32 m0, s36, 0
    v_mfma_f32_16x16x32_bf16 v[120:123], a[16:19], v[176:179], v[120:123]
    ds_read_b64_tr_b16 a[14:15], v17 offset:13824
    buffer_load_dwordx4 v26, s[12:15], s37 offen offset:0 lds
    v_mfma_f32_16x16x32_bf16 v[128:131], a[20:23], v[176:179], v[128:131]
    ds_read_b64_tr_b16 a[16:17], v18 offset:12288
    s_mul_i32 s57, s28, 3072
    v_mfma_f32_16x16x32_bf16 v[132:135], a[20:23], v[180:183], v[132:135]
    ds_read_b64_tr_b16 a[18:19], v18 offset:13824
    s_add_u32 s56, s56, s57
    v_mfma_f32_16x16x32_bf16 v[140:143], a[24:27], v[180:183], v[140:143]
    ds_read_b64_tr_b16 a[20:21], v19 offset:12288
    s_add_u32 s63, s56, s50
    v_mfma_f32_16x16x32_bf16 v[136:139], a[24:27], v[176:179], v[136:139]
    ds_read_b64_tr_b16 a[22:23], v19 offset:13824
    s_waitcnt lgkmcnt(4)
    v_mfma_f32_16x16x32_bf16 v[144:147], a[0:3], v[176:179], v[144:147]
    ds_read_b64_tr_b16 a[24:25], v24 offset:12288
    buffer_load_dwordx4 a[80:83], v38, s[16:19], s53 offen offset:3072 sc1
    v_mfma_f32_16x16x32_bf16 v[148:151], a[0:3], v[180:183], v[148:151]
    ds_read_b64_tr_b16 a[26:27], v24 offset:13824
    v_mfma_f32_16x16x32_bf16 v[156:159], a[4:7], v[180:183], v[156:159]
    ds_read_b64_tr_b16 a[0:1], v25 offset:12288
    v_and_b32 v23, 1, v1
    v_mfma_f32_16x16x32_bf16 v[152:155], a[4:7], v[176:179], v[152:155]
    ds_read_b64_tr_b16 a[2:3], v25 offset:13824
    buffer_load_dwordx4 v27, s[12:15], s37 offen offset:1024 lds
    v_mfma_f32_16x16x32_bf16 a[180:183], a[8:11], v[176:179], a[180:183]
    ds_read_b64_tr_b16 a[4:5], v32 offset:15360
    v_lshl_add_u32 v23, s3, 1, v23
    v_mfma_f32_16x16x32_bf16 a[184:187], a[8:11], v[180:183], a[184:187]
    ds_read_b64_tr_b16 a[6:7], v32 offset:16896
    v_lshlrev_b32 v23, 7, v23
    v_mfma_f32_16x16x32_bf16 a[192:195], a[12:15], v[180:183], a[192:195]
    ds_read_b64_tr_b16 a[8:9], v33 offset:15360
    s_add_u32 s53, s45, 0
    v_mfma_f32_16x16x32_bf16 a[188:191], a[12:15], v[176:179], a[188:191]
    ds_read_b64_tr_b16 a[10:11], v33 offset:16896
    s_waitcnt lgkmcnt(4)
    v_mfma_f32_16x16x32_bf16 a[196:199], a[16:19], v[176:179], a[196:199]
    ds_read_b64_tr_b16 a[12:13], v34 offset:15360
    buffer_load_dwordx4 a[84:87], v38, s[16:19], s53 offen offset:0 sc1
    v_mfma_f32_16x16x32_bf16 a[200:203], a[16:19], v[180:183], a[200:203]
    ds_read_b64_tr_b16 a[14:15], v34 offset:16896
    v_add_u32 v23, L_stage26-L_pc, v23
    v_mfma_f32_16x16x32_bf16 a[208:211], a[20:23], v[180:183], a[208:211]
    ds_read_b64_tr_b16 a[16:17], v35 offset:15360
    global_load_dword v20, v23, s[0:1]
    v_mfma_f32_16x16x32_bf16 a[204:207], a[20:23], v[176:179], a[204:207]
    ds_read_b64_tr_b16 a[18:19], v35 offset:16896
    v_mfma_f32_16x16x32_bf16 a[212:215], a[24:27], v[176:179], a[212:215]
    ds_read_b64_tr_b16 a[20:21], v36 offset:15360
    v_mfma_f32_16x16x32_bf16 a[216:219], a[24:27], v[180:183], a[216:219]
    ds_read_b64_tr_b16 a[22:23], v36 offset:16896
    v_mfma_f32_16x16x32_bf16 a[224:227], a[0:3], v[180:183], a[224:227]
    ds_read_b64_tr_b16 a[24:25], v37 offset:15360
    buffer_load_dwordx4 v28, s[12:15], s37 offen offset:2048 lds
    v_mfma_f32_16x16x32_bf16 a[220:223], a[0:3], v[176:179], a[220:223]
    ds_read_b64_tr_b16 a[26:27], v37 offset:16896
    s_waitcnt lgkmcnt(4)
    v_mfma_f32_16x16x32_bf16 v[112:115], a[4:7], v[184:187], v[112:115]
    ds_read_b64_tr_b16 a[0:1], v16 offset:15360
    v_mfma_f32_16x16x32_bf16 v[116:119], a[4:7], v[188:191], v[116:119]
    ds_read_b64_tr_b16 a[2:3], v16 offset:16896
    v_mfma_f32_16x16x32_bf16 v[124:127], a[8:11], v[188:191], v[124:127]
    ds_read_b64_tr_b16 a[4:5], v17 offset:15360
    buffer_load_dwordx4 v29, s[12:15], s37 offen offset:3072 lds
    v_mfma_f32_16x16x32_bf16 v[120:123], a[8:11], v[184:187], v[120:123]
    ds_read_b64_tr_b16 a[6:7], v17 offset:16896
    v_mfma_f32_16x16x32_bf16 v[128:131], a[12:15], v[184:187], v[128:131]
    ds_read_b64_tr_b16 a[8:9], v18 offset:15360
    v_mfma_f32_16x16x32_bf16 v[132:135], a[12:15], v[188:191], v[132:135]
    ds_read_b64_tr_b16 a[10:11], v18 offset:16896
    buffer_load_dwordx4 a[88:91], v38, s[16:19], s53 offen offset:1024 sc1
    v_mfma_f32_16x16x32_bf16 v[140:143], a[16:19], v[188:191], v[140:143]
    ds_read_b64_tr_b16 a[12:13], v19 offset:15360
    s_add_u32 m0, s36, 4096
    v_mfma_f32_16x16x32_bf16 v[136:139], a[16:19], v[184:187], v[136:139]
    ds_read_b64_tr_b16 a[14:15], v19 offset:16896
    s_waitcnt vmcnt(29) lgkmcnt(4)
    v_mfma_f32_16x16x32_bf16 v[144:147], a[20:23], v[184:187], v[144:147]
    ds_read_b64_tr_b16 a[16:17], v24 offset:15360
    v_mfma_f32_16x16x32_bf16 v[148:151], a[20:23], v[188:191], v[148:151]
    ds_read_b64_tr_b16 a[18:19], v24 offset:16896
    v_mfma_f32_16x16x32_bf16 v[156:159], a[24:27], v[188:191], v[156:159]
    ds_read_b64_tr_b16 a[20:21], v25 offset:15360
    buffer_load_dwordx4 v30, s[12:15], s37 offen offset:0 lds
    v_mfma_f32_16x16x32_bf16 v[152:155], a[24:27], v[184:187], v[152:155]
    ds_read_b64_tr_b16 a[22:23], v25 offset:16896
    s_barrier
    v_mfma_f32_16x16x32_bf16 a[180:183], a[0:3], v[184:187], a[180:183]
    ds_read_b64_tr_b16 a[24:25], v32 offset:18432
    v_mfma_f32_16x16x32_bf16 a[184:187], a[0:3], v[188:191], a[184:187]
    ds_read_b64_tr_b16 a[26:27], v32 offset:19968
    v_mfma_f32_16x16x32_bf16 a[192:195], a[4:7], v[188:191], a[192:195]
    ds_read_b64_tr_b16 a[0:1], v33 offset:18432
    v_mfma_f32_16x16x32_bf16 a[188:191], a[4:7], v[184:187], a[188:191]
    ds_read_b64_tr_b16 a[2:3], v33 offset:19968
    s_waitcnt lgkmcnt(4)
    v_mfma_f32_16x16x32_bf16 a[196:199], a[8:11], v[184:187], a[196:199]
    ds_read_b64_tr_b16 a[4:5], v34 offset:18432
    buffer_load_dwordx4 v31, s[12:15], s37 offen offset:1024 lds
    v_mfma_f32_16x16x32_bf16 a[200:203], a[8:11], v[188:191], a[200:203]
    ds_read_b64_tr_b16 a[6:7], v34 offset:19968
    v_mfma_f32_16x16x32_bf16 a[208:211], a[12:15], v[188:191], a[208:211]
    ds_read_b64_tr_b16 a[8:9], v35 offset:18432
    v_mfma_f32_16x16x32_bf16 a[204:207], a[12:15], v[184:187], a[204:207]
    ds_read_b64_tr_b16 a[10:11], v35 offset:19968
    v_mfma_f32_16x16x32_bf16 a[212:215], a[16:19], v[184:187], a[212:215]
    ds_read_b64_tr_b16 a[12:13], v36 offset:18432
    v_mfma_f32_16x16x32_bf16 a[216:219], a[16:19], v[188:191], a[216:219]
    ds_read_b64_tr_b16 a[14:15], v36 offset:19968
    v_mfma_f32_16x16x32_bf16 a[224:227], a[20:23], v[188:191], a[224:227]
    ds_read_b64_tr_b16 a[16:17], v37 offset:18432
    buffer_load_dwordx4 a[92:95], v38, s[16:19], s53 offen offset:2048 sc1
    v_mfma_f32_16x16x32_bf16 a[220:223], a[20:23], v[184:187], a[220:223]
    ds_read_b64_tr_b16 a[18:19], v37 offset:19968
    s_waitcnt lgkmcnt(4)
L_stage23:
    v_mfma_f32_16x16x32_bf16 v[112:115], a[24:27], v[192:195], v[112:115]
    ds_read_b64_tr_b16 a[20:21], v16 offset:18432
    v_mov_b32 v61, 2
    v_mfma_f32_16x16x32_bf16 v[116:119], a[24:27], v[196:199], v[116:119]
    ds_read_b64_tr_b16 a[22:23], v16 offset:19968
    s_add_u32 s37, s42, 0
    v_mfma_f32_16x16x32_bf16 v[124:127], a[0:3], v[196:199], v[124:127]
    ds_read_b64_tr_b16 a[24:25], v17 offset:18432
    s_add_u32 m0, s36, 6144
    v_mfma_f32_16x16x32_bf16 v[120:123], a[0:3], v[192:195], v[120:123]
    ds_read_b64_tr_b16 a[26:27], v17 offset:19968
    buffer_load_dwordx4 v26, s[12:15], s37 offen offset:0 lds
    v_mfma_f32_16x16x32_bf16 v[128:131], a[4:7], v[192:195], v[128:131]
    ds_read_b64_tr_b16 a[0:1], v18 offset:18432
    s_waitcnt vmcnt(18)
    v_mfma_f32_16x16x32_bf16 v[132:135], a[4:7], v[196:199], v[132:135]
    ds_read_b64_tr_b16 a[2:3], v18 offset:19968
    buffer_store_dword v61, v60, s[16:19], s51 offen sc1
    v_mfma_f32_16x16x32_bf16 v[140:143], a[8:11], v[196:199], v[140:143]
    ds_read_b64_tr_b16 a[4:5], v19 offset:18432
    v_mfma_f32_16x16x32_bf16 v[136:139], a[8:11], v[192:195], v[136:139]
    ds_read_b64_tr_b16 a[6:7], v19 offset:19968
    s_waitcnt lgkmcnt(4)
    v_mfma_f32_16x16x32_bf16 v[144:147], a[12:15], v[192:195], v[144:147]
    ds_read_b64_tr_b16 a[8:9], v24 offset:18432
    v_mfma_f32_16x16x32_bf16 v[148:151], a[12:15], v[196:199], v[148:151]
    ds_read_b64_tr_b16 a[10:11], v24 offset:19968
    v_mfma_f32_16x16x32_bf16 v[156:159], a[16:19], v[196:199], v[156:159]
    ds_read_b64_tr_b16 a[12:13], v25 offset:18432
    v_mfma_f32_16x16x32_bf16 v[152:155], a[16:19], v[192:195], v[152:155]
    ds_read_b64_tr_b16 a[14:15], v25 offset:19968
    buffer_load_dwordx4 v27, s[12:15], s37 offen offset:1024 lds
    v_mfma_f32_16x16x32_bf16 a[180:183], a[20:23], v[192:195], a[180:183]
    ds_read_b64_tr_b16 a[16:17], v32 offset:21504
    v_mfma_f32_16x16x32_bf16 a[184:187], a[20:23], v[196:199], a[184:187]
    ds_read_b64_tr_b16 a[18:19], v32 offset:23040
    v_mfma_f32_16x16x32_bf16 a[192:195], a[24:27], v[196:199], a[192:195]
    ds_read_b64_tr_b16 a[20:21], v33 offset:21504
    v_mfma_f32_16x16x32_bf16 a[188:191], a[24:27], v[192:195], a[188:191]
    ds_read_b64_tr_b16 a[22:23], v33 offset:23040
    s_waitcnt lgkmcnt(4)
    v_mfma_f32_16x16x32_bf16 a[196:199], a[0:3], v[192:195], a[196:199]
    ds_read_b64_tr_b16 a[24:25], v34 offset:21504
    buffer_load_dwordx4 a[96:99], v38, s[16:19], s53 offen offset:3072 sc1
    v_mfma_f32_16x16x32_bf16 a[200:203], a[0:3], v[196:199], a[200:203]
    ds_read_b64_tr_b16 a[26:27], v34 offset:23040
    v_mfma_f32_16x16x32_bf16 a[208:211], a[4:7], v[196:199], a[208:211]
    ds_read_b64_tr_b16 a[0:1], v35 offset:21504
    v_mfma_f32_16x16x32_bf16 a[204:207], a[4:7], v[192:195], a[204:207]
    ds_read_b64_tr_b16 a[2:3], v35 offset:23040
    v_mfma_f32_16x16x32_bf16 a[212:215], a[8:11], v[192:195], a[212:215]
    ds_read_b64_tr_b16 a[4:5], v36 offset:21504
    v_mfma_f32_16x16x32_bf16 a[216:219], a[8:11], v[196:199], a[216:219]
    ds_read_b64_tr_b16 a[6:7], v36 offset:23040
    v_mfma_f32_16x16x32_bf16 a[224:227], a[12:15], v[196:199], a[224:227]
    ds_read_b64_tr_b16 a[8:9], v37 offset:21504
    buffer_load_dwordx4 v28, s[12:15], s37 offen offset:2048 lds
    v_mfma_f32_16x16x32_bf16 a[220:223], a[12:15], v[192:195], a[220:223]
    ds_read_b64_tr_b16 a[10:11], v37 offset:23040
    s_waitcnt lgkmcnt(4)
    v_mfma_f32_16x16x32_bf16 v[112:115], a[16:19], v[200:203], v[112:115]
    ds_read_b64_tr_b16 a[12:13], v16 offset:21504
    v_mfma_f32_16x16x32_bf16 v[116:119], a[16:19], v[204:207], v[116:119]
    ds_read_b64_tr_b16 a[14:15], v16 offset:23040
    v_mfma_f32_16x16x32_bf16 v[124:127], a[20:23], v[204:207], v[124:127]
    ds_read_b64_tr_b16 a[16:17], v17 offset:21504
    v_mfma_f32_16x16x32_bf16 v[120:123], a[20:23], v[200:203], v[120:123]
    ds_read_b64_tr_b16 a[18:19], v17 offset:23040
    buffer_load_dwordx4 v29, s[12:15], s37 offen offset:3072 lds
    v_mfma_f32_16x16x32_bf16 v[128:131], a[24:27], v[200:203], v[128:131]
    ds_read_b64_tr_b16 a[20:21], v18 offset:21504
    v_mfma_f32_16x16x32_bf16 v[132:135], a[24:27], v[204:207], v[132:135]
    ds_read_b64_tr_b16 a[22:23], v18 offset:23040
    v_mfma_f32_16x16x32_bf16 v[140:143], a[0:3], v[204:207], v[140:143]
    ds_read_b64_tr_b16 a[24:25], v19 offset:21504
    s_add_u32 m0, s36, 10240
    v_mfma_f32_16x16x32_bf16 v[136:139], a[0:3], v[200:203], v[136:139]
    ds_read_b64_tr_b16 a[26:27], v19 offset:23040
    s_waitcnt lgkmcnt(4)
    v_mfma_f32_16x16x32_bf16 v[144:147], a[4:7], v[200:203], v[144:147]
    ds_read_b64_tr_b16 a[0:1], v24 offset:21504
    s_add_u32 s53, s45, 4096
    v_mfma_f32_16x16x32_bf16 v[148:151], a[4:7], v[204:207], v[148:151]
    ds_read_b64_tr_b16 a[2:3], v24 offset:23040
    buffer_load_dwordx4 v30, s[12:15], s37 offen offset:0 lds
    v_mfma_f32_16x16x32_bf16 v[156:159], a[8:11], v[204:207], v[156:159]
    ds_read_b64_tr_b16 a[4:5], v25 offset:21504
    v_mfma_f32_16x16x32_bf16 v[152:155], a[8:11], v[200:203], v[152:155]
    ds_read_b64_tr_b16 a[6:7], v25 offset:23040
    s_barrier
    v_mfma_f32_16x16x32_bf16 a[180:183], a[12:15], v[200:203], a[180:183]
    ds_read_b64_tr_b16 a[8:9], v32 offset:24576
    v_mfma_f32_16x16x32_bf16 a[184:187], a[12:15], v[204:207], a[184:187]
    ds_read_b64_tr_b16 a[10:11], v32 offset:26112
    v_mfma_f32_16x16x32_bf16 a[192:195], a[16:19], v[204:207], a[192:195]
    ds_read_b64_tr_b16 a[12:13], v33 offset:24576
    buffer_load_dwordx4 a[100:103], v38, s[16:19], s53 offen offset:0 sc1
    v_mfma_f32_16x16x32_bf16 a[188:191], a[16:19], v[200:203], a[188:191]
    ds_read_b64_tr_b16 a[14:15], v33 offset:26112
    s_waitcnt lgkmcnt(4)
    v_mfma_f32_16x16x32_bf16 a[196:199], a[20:23], v[200:203], a[196:199]
    ds_read_b64_tr_b16 a[16:17], v34 offset:24576
    v_mfma_f32_16x16x32_bf16 a[200:203], a[20:23], v[204:207], a[200:203]
    ds_read_b64_tr_b16 a[18:19], v34 offset:26112
    v_mfma_f32_16x16x32_bf16 a[208:211], a[24:27], v[204:207], a[208:211]
    ds_read_b64_tr_b16 a[20:21], v35 offset:24576
    v_mfma_f32_16x16x32_bf16 a[204:207], a[24:27], v[200:203], a[204:207]
    ds_read_b64_tr_b16 a[22:23], v35 offset:26112
    buffer_load_dwordx4 v31, s[12:15], s37 offen offset:1024 lds
    v_mfma_f32_16x16x32_bf16 a[212:215], a[0:3], v[200:203], a[212:215]
    ds_read_b64_tr_b16 a[24:25], v36 offset:24576
    v_mfma_f32_16x16x32_bf16 a[216:219], a[0:3], v[204:207], a[216:219]
    ds_read_b64_tr_b16 a[26:27], v36 offset:26112
    v_mfma_f32_16x16x32_bf16 a[224:227], a[4:7], v[204:207], a[224:227]
    ds_read_b64_tr_b16 a[0:1], v37 offset:24576
    v_mfma_f32_16x16x32_bf16 a[220:223], a[4:7], v[200:203], a[220:223]
    ds_read_b64_tr_b16 a[2:3], v37 offset:26112
    s_waitcnt lgkmcnt(4)
L_stage24:
    v_mfma_f32_16x16x32_bf16 v[112:115], a[8:11], a[36:39], v[112:115]
    ds_read_b64_tr_b16 a[4:5], v16 offset:24576
    buffer_load_dwordx4 a[104:107], v38, s[16:19], s53 offen offset:1024 sc1
    v_mfma_f32_16x16x32_bf16 v[116:119], a[8:11], a[40:43], v[116:119]
    ds_read_b64_tr_b16 a[6:7], v16 offset:26112
    s_add_u32 s37, s42, 73728
    v_mfma_f32_16x16x32_bf16 v[124:127], a[12:15], a[40:43], v[124:127]
    ds_read_b64_tr_b16 a[8:9], v17 offset:24576
    v_mfma_f32_16x16x32_bf16 v[120:123], a[12:15], a[36:39], v[120:123]
    ds_read_b64_tr_b16 a[10:11], v17 offset:26112
    s_add_u32 m0, s36, 12288
    v_mfma_f32_16x16x32_bf16 v[128:131], a[16:19], a[36:39], v[128:131]
    ds_read_b64_tr_b16 a[12:13], v18 offset:24576
    v_mfma_f32_16x16x32_bf16 v[132:135], a[16:19], a[40:43], v[132:135]
    ds_read_b64_tr_b16 a[14:15], v18 offset:26112
    v_mfma_f32_16x16x32_bf16 v[140:143], a[20:23], a[40:43], v[140:143]
    ds_read_b64_tr_b16 a[16:17], v19 offset:24576
    buffer_load_dwordx4 v26, s[12:15], s37 offen offset:0 lds
    v_mfma_f32_16x16x32_bf16 v[136:139], a[20:23], a[36:39], v[136:139]
    ds_read_b64_tr_b16 a[18:19], v19 offset:26112
    s_waitcnt lgkmcnt(4)
    v_mfma_f32_16x16x32_bf16 v[144:147], a[24:27], a[36:39], v[144:147]
    ds_read_b64_tr_b16 a[20:21], v24 offset:24576
    v_mfma_f32_16x16x32_bf16 v[148:151], a[24:27], a[40:43], v[148:151]
    ds_read_b64_tr_b16 a[22:23], v24 offset:26112
    v_mfma_f32_16x16x32_bf16 v[156:159], a[0:3], a[40:43], v[156:159]
    ds_read_b64_tr_b16 a[24:25], v25 offset:24576
    v_mfma_f32_16x16x32_bf16 v[152:155], a[0:3], a[36:39], v[152:155]
    ds_read_b64_tr_b16 a[26:27], v25 offset:26112
    buffer_load_dwordx4 v27, s[12:15], s37 offen offset:1024 lds
    v_mfma_f32_16x16x32_bf16 a[180:183], a[4:7], a[36:39], a[180:183]
    ds_read_b64_tr_b16 a[0:1], v32 offset:27648
    v_mfma_f32_16x16x32_bf16 a[184:187], a[4:7], a[40:43], a[184:187]
    ds_read_b64_tr_b16 a[2:3], v32 offset:29184
    v_mfma_f32_16x16x32_bf16 a[192:195], a[8:11], a[40:43], a[192:195]
    ds_read_b64_tr_b16 a[4:5], v33 offset:27648
    v_mfma_f32_16x16x32_bf16 a[188:191], a[8:11], a[36:39], a[188:191]
    ds_read_b64_tr_b16 a[6:7], v33 offset:29184
    s_waitcnt lgkmcnt(4)
    v_mfma_f32_16x16x32_bf16 a[196:199], a[12:15], a[36:39], a[196:199]
    ds_read_b64_tr_b16 a[8:9], v34 offset:27648
    buffer_load_dwordx4 a[108:111], v38, s[16:19], s53 offen offset:2048 sc1
    v_mfma_f32_16x16x32_bf16 a[200:203], a[12:15], a[40:43], a[200:203]
    ds_read_b64_tr_b16 a[10:11], v34 offset:29184
    v_mfma_f32_16x16x32_bf16 a[208:211], a[16:19], a[40:43], a[208:211]
    ds_read_b64_tr_b16 a[12:13], v35 offset:27648
    v_mfma_f32_16x16x32_bf16 a[204:207], a[16:19], a[36:39], a[204:207]
    ds_read_b64_tr_b16 a[14:15], v35 offset:29184
    v_mfma_f32_16x16x32_bf16 a[212:215], a[20:23], a[36:39], a[212:215]
    ds_read_b64_tr_b16 a[16:17], v36 offset:27648
    v_mfma_f32_16x16x32_bf16 a[216:219], a[20:23], a[40:43], a[216:219]
    ds_read_b64_tr_b16 a[18:19], v36 offset:29184
    v_mfma_f32_16x16x32_bf16 a[224:227], a[24:27], a[40:43], a[224:227]
    ds_read_b64_tr_b16 a[20:21], v37 offset:27648
    buffer_load_dwordx4 v28, s[12:15], s37 offen offset:2048 lds
    v_mfma_f32_16x16x32_bf16 a[220:223], a[24:27], a[36:39], a[220:223]
    ds_read_b64_tr_b16 a[22:23], v37 offset:29184
    s_waitcnt lgkmcnt(4)
    v_mfma_f32_16x16x32_bf16 v[112:115], a[0:3], a[44:47], v[112:115]
    ds_read_b64_tr_b16 a[24:25], v16 offset:27648
    v_mfma_f32_16x16x32_bf16 v[116:119], a[0:3], a[48:51], v[116:119]
    ds_read_b64_tr_b16 a[26:27], v16 offset:29184
    v_mfma_f32_16x16x32_bf16 v[124:127], a[4:7], a[48:51], v[124:127]
    ds_read_b64_tr_b16 a[0:1], v17 offset:27648
    v_mfma_f32_16x16x32_bf16 v[120:123], a[4:7], a[44:47], v[120:123]
    ds_read_b64_tr_b16 a[2:3], v17 offset:29184
    buffer_load_dwordx4 v29, s[12:15], s37 offen offset:3072 lds
    v_mfma_f32_16x16x32_bf16 v[128:131], a[8:11], a[44:47], v[128:131]
    ds_read_b64_tr_b16 a[4:5], v18 offset:27648
    v_mfma_f32_16x16x32_bf16 v[132:135], a[8:11], a[48:51], v[132:135]
    ds_read_b64_tr_b16 a[6:7], v18 offset:29184
    v_mfma_f32_16x16x32_bf16 v[140:143], a[12:15], a[48:51], v[140:143]
    ds_read_b64_tr_b16 a[8:9], v19 offset:27648
    v_mfma_f32_16x16x32_bf16 v[136:139], a[12:15], a[44:47], v[136:139]
    ds_read_b64_tr_b16 a[10:11], v19 offset:29184
    s_waitcnt vmcnt(27) lgkmcnt(4)
    v_mfma_f32_16x16x32_bf16 v[144:147], a[16:19], a[44:47], v[144:147]
    ds_read_b64_tr_b16 a[12:13], v24 offset:27648
    buffer_load_dwordx4 a[112:115], v38, s[16:19], s53 offen offset:3072 sc1
    v_mfma_f32_16x16x32_bf16 v[148:151], a[16:19], a[48:51], v[148:151]
    ds_read_b64_tr_b16 a[14:15], v24 offset:29184
    s_add_u32 m0, s36, 16384
    v_mfma_f32_16x16x32_bf16 v[156:159], a[20:23], a[48:51], v[156:159]
    ds_read_b64_tr_b16 a[16:17], v25 offset:27648
    v_mfma_f32_16x16x32_bf16 v[152:155], a[20:23], a[44:47], v[152:155]
    ds_read_b64_tr_b16 a[18:19], v25 offset:29184
    s_barrier
    v_mfma_f32_16x16x32_bf16 a[180:183], a[24:27], a[44:47], a[180:183]
    ds_read_b64_tr_b16 a[20:21], v32 offset:30720
    v_mfma_f32_16x16x32_bf16 a[184:187], a[24:27], a[48:51], a[184:187]
    ds_read_b64_tr_b16 a[22:23], v32 offset:32256
    buffer_load_dwordx4 v30, s[12:15], s37 offen offset:0 lds
    v_mfma_f32_16x16x32_bf16 a[192:195], a[0:3], a[48:51], a[192:195]
    ds_read_b64_tr_b16 a[24:25], v33 offset:30720
    v_mfma_f32_16x16x32_bf16 a[188:191], a[0:3], a[44:47], a[188:191]
    ds_read_b64_tr_b16 a[26:27], v33 offset:32256
    s_waitcnt lgkmcnt(4)
    v_mfma_f32_16x16x32_bf16 a[196:199], a[4:7], a[44:47], a[196:199]
    ds_read_b64_tr_b16 a[0:1], v34 offset:30720
    s_add_u32 s53, s45, 8192
    v_mfma_f32_16x16x32_bf16 a[200:203], a[4:7], a[48:51], a[200:203]
    ds_read_b64_tr_b16 a[2:3], v34 offset:32256
    v_accvgpr_read_b32 v208, a180
    v_accvgpr_read_b32 v212, a184
    v_mfma_f32_16x16x32_bf16 a[208:211], a[8:11], a[48:51], a[208:211]
    ds_read_b64_tr_b16 a[4:5], v35 offset:30720
    v_accvgpr_read_b32 v209, a181
    v_mfma_f32_16x16x32_bf16 a[204:207], a[8:11], a[44:47], a[204:207]
    ds_read_b64_tr_b16 a[6:7], v35 offset:32256
    buffer_load_dwordx4 v31, s[12:15], s37 offen offset:1024 lds
    v_accvgpr_read_b32 v216, a188
    v_accvgpr_read_b32 v220, a192
    v_mfma_f32_16x16x32_bf16 a[212:215], a[12:15], a[44:47], a[212:215]
    ds_read_b64_tr_b16 a[8:9], v36 offset:30720
    v_accvgpr_read_b32 v210, a182
    v_mfma_f32_16x16x32_bf16 a[216:219], a[12:15], a[48:51], a[216:219]
    ds_read_b64_tr_b16 a[10:11], v36 offset:32256
    v_accvgpr_read_b32 v211, a183
    v_accvgpr_read_b32 v224, a196
    v_accvgpr_read_b32 v228, a200
    v_mfma_f32_16x16x32_bf16 a[224:227], a[16:19], a[48:51], a[224:227]
    ds_read_b64_tr_b16 a[12:13], v37 offset:30720
    v_accvgpr_read_b32 v213, a185
    v_mfma_f32_16x16x32_bf16 a[220:223], a[16:19], a[44:47], a[220:223]
    ds_read_b64_tr_b16 a[14:15], v37 offset:32256
    s_waitcnt lgkmcnt(4)
    v_accvgpr_read_b32 v221, a193
L_stage25:
    v_mfma_f32_16x16x32_bf16 v[112:115], a[20:23], a[52:55], v[112:115]
    ds_read_b64_tr_b16 a[16:17], v16 offset:30720
    buffer_load_dwordx4 a[116:119], v38, s[16:19], s53 offen offset:0 sc1
    v_mfma_f32_16x16x32_bf16 v[116:119], a[20:23], a[56:59], v[116:119]
    ds_read_b64_tr_b16 a[18:19], v16 offset:32256
    s_add_u32 s37, s42, 147456
    v_accvgpr_read_b32 v229, a201
    v_mfma_f32_16x16x32_bf16 v[124:127], a[24:27], a[56:59], v[124:127]
    ds_read_b64_tr_b16 a[20:21], v17 offset:30720
    s_add_u32 m0, s36, 18432
    v_accvgpr_read_b32 v225, a197
    v_mfma_f32_16x16x32_bf16 v[120:123], a[24:27], a[52:55], v[120:123]
    ds_read_b64_tr_b16 a[22:23], v17 offset:32256
    buffer_load_dwordx4 v26, s[12:15], s37 offen offset:0 lds
    v_accvgpr_read_b32 v217, a189
    v_accvgpr_read_b32 v222, a194
    v_mfma_f32_16x16x32_bf16 v[128:131], a[0:3], a[52:55], v[128:131]
    ds_read_b64_tr_b16 a[24:25], v18 offset:30720
    v_mfma_f32_16x16x32_bf16 v[132:135], a[0:3], a[56:59], v[132:135]
    ds_read_b64_tr_b16 a[26:27], v18 offset:32256
    buffer_load_dword v63, v62, s[16:19], s54 offen sc1
    v_accvgpr_read_b32 v230, a202
    v_mfma_f32_16x16x32_bf16 v[140:143], a[4:7], a[56:59], v[140:143]
    ds_read_b64_tr_b16 a[0:1], v19 offset:30720
    v_accvgpr_read_b32 v214, a186
    v_mfma_f32_16x16x32_bf16 v[136:139], a[4:7], a[52:55], v[136:139]
    ds_read_b64_tr_b16 a[2:3], v19 offset:32256
    s_waitcnt lgkmcnt(4)
    v_accvgpr_read_b32 v223, a195
    v_accvgpr_read_b32 v226, a198
    v_mfma_f32_16x16x32_bf16 v[144:147], a[8:11], a[52:55], v[144:147]
    ds_read_b64_tr_b16 a[4:5], v24 offset:30720
    v_accvgpr_read_b32 v215, a187
    v_mfma_f32_16x16x32_bf16 v[148:151], a[8:11], a[56:59], v[148:151]
    ds_read_b64_tr_b16 a[6:7], v24 offset:32256
    v_accvgpr_read_b32 v218, a190
    v_accvgpr_read_b32 v231, a203
    v_mfma_f32_16x16x32_bf16 v[156:159], a[12:15], a[56:59], v[156:159]
    ds_read_b64_tr_b16 a[8:9], v25 offset:30720
    v_accvgpr_read_b32 v219, a191
    v_mfma_f32_16x16x32_bf16 v[152:155], a[12:15], a[52:55], v[152:155]
    ds_read_b64_tr_b16 a[10:11], v25 offset:32256
    buffer_load_dwordx4 v27, s[12:15], s37 offen offset:1024 lds
    v_mfma_f32_16x16x32_bf16 v[208:211], a[16:19], a[52:55], v[208:211]
    ds_read_b64_tr_b16 a[12:13], v32 offset:33792
    v_accvgpr_read_b32 v227, a199
    v_mfma_f32_16x16x32_bf16 v[212:215], a[16:19], a[56:59], v[212:215]
    ds_read_b64_tr_b16 a[14:15], v32 offset:35328
    v_mfma_f32_16x16x32_bf16 v[220:223], a[20:23], a[56:59], v[220:223]
    ds_read_b64_tr_b16 a[16:17], v33 offset:33792
    v_mfma_f32_16x16x32_bf16 v[216:219], a[20:23], a[52:55], v[216:219]
    ds_read_b64_tr_b16 a[18:19], v33 offset:35328
    s_waitcnt lgkmcnt(4)
    v_mfma_f32_16x16x32_bf16 v[224:227], a[24:27], a[52:55], v[224:227]
    ds_read_b64_tr_b16 a[20:21], v34 offset:33792
    buffer_load_dwordx4 a[120:123], v38, s[16:19], s53 offen offset:1024 sc1
    v_mfma_f32_16x16x32_bf16 v[228:231], a[24:27], a[56:59], v[228:231]
    ds_read_b64_tr_b16 a[22:23], v34 offset:35328
    v_mfma_f32_16x16x32_bf16 a[208:211], a[0:3], a[56:59], a[208:211]
    ds_read_b64_tr_b16 a[24:25], v35 offset:33792
    v_mfma_f32_16x16x32_bf16 a[204:207], a[0:3], a[52:55], a[204:207]
    ds_read_b64_tr_b16 a[26:27], v35 offset:35328
    v_mfma_f32_16x16x32_bf16 a[212:215], a[4:7], a[52:55], a[212:215]
    ds_read_b64_tr_b16 a[0:1], v36 offset:33792
    v_mfma_f32_16x16x32_bf16 a[216:219], a[4:7], a[56:59], a[216:219]
    ds_read_b64_tr_b16 a[2:3], v36 offset:35328
    buffer_load_dwordx4 v28, s[12:15], s37 offen offset:2048 lds
    v_mfma_f32_16x16x32_bf16 a[224:227], a[8:11], a[56:59], a[224:227]
    ds_read_b64_tr_b16 a[4:5], v37 offset:33792
    v_mfma_f32_16x16x32_bf16 a[220:223], a[8:11], a[52:55], a[220:223]
    ds_read_b64_tr_b16 a[6:7], v37 offset:35328
    s_waitcnt lgkmcnt(4)
    v_mfma_f32_16x16x32_bf16 v[112:115], a[12:15], a[60:63], v[112:115]
    ds_read_b64_tr_b16 a[8:9], v16 offset:33792
    v_mfma_f32_16x16x32_bf16 v[116:119], a[12:15], a[64:67], v[116:119]
    ds_read_b64_tr_b16 a[10:11], v16 offset:35328
    v_mfma_f32_16x16x32_bf16 v[124:127], a[16:19], a[64:67], v[124:127]
    ds_read_b64_tr_b16 a[12:13], v17 offset:33792
    buffer_load_dwordx4 v29, s[12:15], s37 offen offset:3072 lds
    v_mfma_f32_16x16x32_bf16 v[120:123], a[16:19], a[60:63], v[120:123]
    ds_read_b64_tr_b16 a[14:15], v17 offset:35328
    v_mfma_f32_16x16x32_bf16 v[128:131], a[20:23], a[60:63], v[128:131]
    ds_read_b64_tr_b16 a[16:17], v18 offset:33792
    v_mfma_f32_16x16x32_bf16 v[132:135], a[20:23], a[64:67], v[132:135]
    ds_read_b64_tr_b16 a[18:19], v18 offset:35328
    v_mfma_f32_16x16x32_bf16 v[140:143], a[24:27], a[64:67], v[140:143]
    ds_read_b64_tr_b16 a[20:21], v19 offset:33792
    v_mfma_f32_16x16x32_bf16 v[136:139], a[24:27], a[60:63], v[136:139]
    ds_read_b64_tr_b16 a[22:23], v19 offset:35328
    s_waitcnt vmcnt(26) lgkmcnt(4)
    v_mfma_f32_16x16x32_bf16 v[144:147], a[0:3], a[60:63], v[144:147]
    ds_read_b64_tr_b16 a[24:25], v24 offset:33792
    buffer_load_dwordx4 a[124:127], v38, s[16:19], s53 offen offset:2048 sc1
    v_mfma_f32_16x16x32_bf16 v[148:151], a[0:3], a[64:67], v[148:151]
    ds_read_b64_tr_b16 a[26:27], v24 offset:35328
    s_add_u32 m0, s36, 22528
    v_mfma_f32_16x16x32_bf16 v[156:159], a[4:7], a[64:67], v[156:159]
    ds_read_b64_tr_b16 a[0:1], v25 offset:33792
    v_mfma_f32_16x16x32_bf16 v[152:155], a[4:7], a[60:63], v[152:155]
    ds_read_b64_tr_b16 a[2:3], v25 offset:35328
    s_barrier
    v_mfma_f32_16x16x32_bf16 v[208:211], a[8:11], a[60:63], v[208:211]
    ds_read_b64_tr_b16 a[4:5], v32 offset:0
    v_mfma_f32_16x16x32_bf16 v[212:215], a[8:11], a[64:67], v[212:215]
    ds_read_b64_tr_b16 a[6:7], v32 offset:1536
    buffer_load_dwordx4 v30, s[12:15], s37 offen offset:0 lds
    v_mfma_f32_16x16x32_bf16 v[220:223], a[12:15], a[64:67], v[220:223]
    ds_read_b64_tr_b16 a[8:9], v33 offset:0
    v_mfma_f32_16x16x32_bf16 v[216:219], a[12:15], a[60:63], v[216:219]
    ds_read_b64_tr_b16 a[10:11], v33 offset:1536
    s_waitcnt lgkmcnt(4)
    v_mfma_f32_16x16x32_bf16 v[224:227], a[16:19], a[60:63], v[224:227]
    ds_read_b64_tr_b16 a[12:13], v34 offset:0
    v_mfma_f32_16x16x32_bf16 v[228:231], a[16:19], a[64:67], v[228:231]
    ds_read_b64_tr_b16 a[14:15], v34 offset:1536
    v_mfma_f32_16x16x32_bf16 a[208:211], a[20:23], a[64:67], a[208:211]
    ds_read_b64_tr_b16 a[16:17], v35 offset:0
    v_mfma_f32_16x16x32_bf16 a[204:207], a[20:23], a[60:63], a[204:207]
    ds_read_b64_tr_b16 a[18:19], v35 offset:1536
    buffer_load_dwordx4 v31, s[12:15], s37 offen offset:1024 lds
    v_mfma_f32_16x16x32_bf16 a[212:215], a[24:27], a[60:63], a[212:215]
    ds_read_b64_tr_b16 a[20:21], v36 offset:0
    v_mfma_f32_16x16x32_bf16 a[216:219], a[24:27], a[64:67], a[216:219]
    ds_read_b64_tr_b16 a[22:23], v36 offset:1536
    v_mfma_f32_16x16x32_bf16 a[224:227], a[0:3], a[64:67], a[224:227]
    ds_read_b64_tr_b16 a[24:25], v37 offset:0
    v_mfma_f32_16x16x32_bf16 a[220:223], a[0:3], a[60:63], a[220:223]
    ds_read_b64_tr_b16 a[26:27], v37 offset:1536
    s_waitcnt lgkmcnt(4)
L_stage26:
    v_mfma_f32_16x16x32_bf16 v[112:115], a[4:7], a[68:71], v[112:115]
    ds_read_b64_tr_b16 a[0:1], v16 offset:0
    buffer_load_dwordx4 a[128:131], v38, s[16:19], s53 offen offset:3072 sc1
    v_mfma_f32_16x16x32_bf16 v[116:119], a[4:7], a[72:75], v[116:119]
    ds_read_b64_tr_b16 a[2:3], v16 offset:1536
    s_add_u32 s37, s41, 221184
    v_accvgpr_read_b32 v240, a212
    v_accvgpr_read_b32 v244, a216
    v_mfma_f32_16x16x32_bf16 v[124:127], a[8:11], a[72:75], v[124:127]
    ds_read_b64_tr_b16 a[4:5], v17 offset:0
    s_add_u32 m0, s36, 24576
    v_mfma_f32_16x16x32_bf16 v[120:123], a[8:11], a[68:71], v[120:123]
    ds_read_b64_tr_b16 a[6:7], v17 offset:1536
    buffer_load_dwordx4 v26, s[12:15], s37 offen offset:0 lds
    v_accvgpr_read_b32 v248, a220
    v_accvgpr_read_b32 v252, a224
    v_mfma_f32_16x16x32_bf16 v[128:131], a[12:15], a[68:71], v[128:131]
    ds_read_b64_tr_b16 a[8:9], v18 offset:0
    v_accvgpr_read_b32 v232, a204
    v_mfma_f32_16x16x32_bf16 v[132:135], a[12:15], a[72:75], v[132:135]
    ds_read_b64_tr_b16 a[10:11], v18 offset:1536
    v_accvgpr_read_b32 v233, a205
    v_accvgpr_read_b32 v245, a217
    v_mfma_f32_16x16x32_bf16 v[140:143], a[16:19], a[72:75], v[140:143]
    ds_read_b64_tr_b16 a[12:13], v19 offset:0
    v_accvgpr_read_b32 v234, a206
    v_mfma_f32_16x16x32_bf16 v[136:139], a[16:19], a[68:71], v[136:139]
    ds_read_b64_tr_b16 a[14:15], v19 offset:1536
    s_waitcnt lgkmcnt(4)
    v_accvgpr_read_b32 v253, a225
    v_mfma_f32_16x16x32_bf16 v[144:147], a[20:23], a[68:71], v[144:147]
    ds_read_b64_tr_b16 a[16:17], v24 offset:0
    v_accvgpr_read_b32 v235, a207
    v_accvgpr_read_b32 v249, a221
    v_mfma_f32_16x16x32_bf16 v[148:151], a[20:23], a[72:75], v[148:151]
    ds_read_b64_tr_b16 a[18:19], v24 offset:1536
    v_accvgpr_read_b32 v236, a208
    v_accvgpr_read_b32 v241, a213
    v_accvgpr_read_b32 v246, a218
    v_mfma_f32_16x16x32_bf16 v[156:159], a[24:27], a[72:75], v[156:159]
    ds_read_b64_tr_b16 a[20:21], v25 offset:0
    buffer_load_dwordx4 v27, s[12:15], s37 offen offset:1024 lds
    v_mfma_f32_16x16x32_bf16 v[152:155], a[24:27], a[68:71], v[152:155]
    ds_read_b64_tr_b16 a[22:23], v25 offset:1536
    v_accvgpr_read_b32 v237, a209
    v_accvgpr_read_b32 v254, a226
    v_mfma_f32_16x16x32_bf16 v[208:211], a[0:3], a[68:71], v[208:211]
    ds_read_b64_tr_b16 a[24:25], v32 offset:3072
    v_accvgpr_read_b32 v238, a210
    v_mfma_f32_16x16x32_bf16 v[212:215], a[0:3], a[72:75], v[212:215]
    ds_read_b64_tr_b16 a[26:27], v32 offset:4608
    v_accvgpr_read_b32 v239, a211
    v_accvgpr_read_b32 v247, a219
    v_accvgpr_read_b32 v250, a222
    v_mfma_f32_16x16x32_bf16 v[220:223], a[4:7], a[72:75], v[220:223]
    ds_read_b64_tr_b16 a[0:1], v33 offset:3072
    v_accvgpr_read_b32 v242, a214
    v_mfma_f32_16x16x32_bf16 v[216:219], a[4:7], a[68:71], v[216:219]
    ds_read_b64_tr_b16 a[2:3], v33 offset:4608
    s_waitcnt lgkmcnt(4)
    v_accvgpr_read_b32 v255, a227
    v_mfma_f32_16x16x32_bf16 v[224:227], a[8:11], a[68:71], v[224:227]
    ds_read_b64_tr_b16 a[4:5], v34 offset:3072
    v_accvgpr_read_b32 v243, a215
    v_mfma_f32_16x16x32_bf16 v[228:231], a[8:11], a[72:75], v[228:231]
    ds_read_b64_tr_b16 a[6:7], v34 offset:4608
    buffer_load_dwordx4 v28, s[12:15], s37 offen offset:2048 lds
    v_mfma_f32_16x16x32_bf16 v[236:239], a[12:15], a[72:75], v[236:239]
    ds_read_b64_tr_b16 a[8:9], v35 offset:3072
    v_accvgpr_read_b32 v251, a223
    v_mfma_f32_16x16x32_bf16 v[232:235], a[12:15], a[68:71], v[232:235]
    ds_read_b64_tr_b16 a[10:11], v35 offset:4608
    v_mfma_f32_16x16x32_bf16 v[240:243], a[16:19], a[68:71], v[240:243]
    ds_read_b64_tr_b16 a[12:13], v36 offset:3072
    v_mfma_f32_16x16x32_bf16 v[244:247], a[16:19], a[72:75], v[244:247]
    ds_read_b64_tr_b16 a[14:15], v36 offset:4608
    v_mfma_f32_16x16x32_bf16 v[252:255], a[20:23], a[72:75], v[252:255]
    ds_read_b64_tr_b16 a[16:17], v37 offset:3072
    buffer_load_dwordx4 v29, s[12:15], s37 offen offset:3072 lds
    v_mfma_f32_16x16x32_bf16 v[248:251], a[20:23], a[68:71], v[248:251]
    ds_read_b64_tr_b16 a[18:19], v37 offset:4608
    s_waitcnt lgkmcnt(4)
    v_mfma_f32_16x16x32_bf16 v[112:115], a[24:27], a[76:79], v[112:115]
    ds_read_b64_tr_b16 a[20:21], v16 offset:3072
    v_mfma_f32_16x16x32_bf16 v[116:119], a[24:27], a[80:83], v[116:119]
    ds_read_b64_tr_b16 a[22:23], v16 offset:4608
    s_waitcnt vmcnt(12)
    v_cmp_gt_u32 vcc, 2, v63
    s_nop 0
    s_cbranch_vccnz L_ph1_slow
L_ph1_ok:
    v_mfma_f32_16x16x32_bf16 v[124:127], a[0:3], a[80:83], v[124:127]
    ds_read_b64_tr_b16 a[24:25], v17 offset:3072
    s_add_u32 s53, s44, 12288
    v_mfma_f32_16x16x32_bf16 v[120:123], a[0:3], a[76:79], v[120:123]
    ds_read_b64_tr_b16 a[26:27], v17 offset:4608
    buffer_load_dwordx4 a[132:135], v38, s[16:19], s53 offen offset:0 sc1
    v_mfma_f32_16x16x32_bf16 v[128:131], a[4:7], a[76:79], v[128:131]
    ds_read_b64_tr_b16 a[0:1], v18 offset:3072
    v_mfma_f32_16x16x32_bf16 v[132:135], a[4:7], a[80:83], v[132:135]
    ds_read_b64_tr_b16 a[2:3], v18 offset:4608
    s_add_u32 m0, s36, 28672
    v_mfma_f32_16x16x32_bf16 v[140:143], a[8:11], a[80:83], v[140:143]
    ds_read_b64_tr_b16 a[4:5], v19 offset:3072
    buffer_load_dwordx4 v30, s[12:15], s37 offen offset:0 lds
    v_mfma_f32_16x16x32_bf16 v[136:139], a[8:11], a[76:79], v[136:139]
    ds_read_b64_tr_b16 a[6:7], v19 offset:4608
    s_waitcnt lgkmcnt(4)
    v_mfma_f32_16x16x32_bf16 v[144:147], a[12:15], a[76:79], v[144:147]
    ds_read_b64_tr_b16 a[8:9], v24 offset:3072
    v_mfma_f32_16x16x32_bf16 v[148:151], a[12:15], a[80:83], v[148:151]
    ds_read_b64_tr_b16 a[10:11], v24 offset:4608
    buffer_load_dwordx4 a[136:139], v38, s[16:19], s53 offen offset:1024 sc1
    v_mfma_f32_16x16x32_bf16 v[156:159], a[16:19], a[80:83], v[156:159]
    ds_read_b64_tr_b16 a[12:13], v25 offset:3072
    v_mfma_f32_16x16x32_bf16 v[152:155], a[16:19], a[76:79], v[152:155]
    ds_read_b64_tr_b16 a[14:15], v25 offset:4608
    s_barrier
    v_mfma_f32_16x16x32_bf16 v[208:211], a[20:23], a[76:79], v[208:211]
    ds_read_b64_tr_b16 a[16:17], v35 offset:6144
    buffer_load_dwordx4 a[140:143], v38, s[16:19], s53 offen offset:2048 sc1
    v_mfma_f32_16x16x32_bf16 v[212:215], a[20:23], a[80:83], v[212:215]
    ds_read_b64_tr_b16 a[18:19], v35 offset:7680
    ds_read_b64_tr_b16 a[180:181], v32 offset:6144
    v_mfma_f32_16x16x32_bf16 v[220:223], a[24:27], a[80:83], v[220:223]
    ds_read_b64_tr_b16 a[20:21], v36 offset:6144
    v_mfma_f32_16x16x32_bf16 v[216:219], a[24:27], a[76:79], v[216:219]
    ds_read_b64_tr_b16 a[22:23], v36 offset:7680
    s_waitcnt lgkmcnt(5)
    v_mfma_f32_16x16x32_bf16 v[224:227], a[0:3], a[76:79], v[224:227]
    ds_read_b64_tr_b16 a[24:25], v37 offset:6144
    ds_read_b64_tr_b16 a[182:183], v32 offset:7680
    v_mfma_f32_16x16x32_bf16 v[228:231], a[0:3], a[80:83], v[228:231]
    ds_read_b64_tr_b16 a[26:27], v37 offset:7680
    buffer_load_dwordx4 v31, s[12:15], s37 offen offset:1024 lds
    v_mfma_f32_16x16x32_bf16 v[236:239], a[4:7], a[80:83], v[236:239]
    ds_read_b64_tr_b16 a[0:1], v16 offset:6144
    ds_read_b64_tr_b16 a[184:185], v33 offset:6144
    v_mfma_f32_16x16x32_bf16 v[232:235], a[4:7], a[76:79], v[232:235]
    ds_read_b64_tr_b16 a[2:3], v16 offset:7680
    v_mfma_f32_16x16x32_bf16 v[240:243], a[8:11], a[76:79], v[240:243]
    ds_read_b64_tr_b16 a[4:5], v17 offset:6144
    ds_read_b64_tr_b16 a[186:187], v33 offset:7680
    v_mfma_f32_16x16x32_bf16 v[244:247], a[8:11], a[80:83], v[244:247]
    ds_read_b64_tr_b16 a[6:7], v17 offset:7680
    buffer_load_dwordx4 a[144:147], v38, s[16:19], s53 offen offset:3072 sc1
    v_mfma_f32_16x16x32_bf16 v[252:255], a[12:15], a[80:83], v[252:255]
    ds_read_b64_tr_b16 a[8:9], v18 offset:6144
    ds_read_b64_tr_b16 a[188:189], v34 offset:6144
    v_mfma_f32_16x16x32_bf16 v[248:251], a[12:15], a[76:79], v[248:251]
    ds_read_b64_tr_b16 a[10:11], v18 offset:7680
    s_waitcnt lgkmcnt(6)
L_stage27:
    v_mfma_f32_16x16x32_bf16 v[136:139], a[16:19], a[84:87], v[136:139]
    ds_read_b64_tr_b16 a[12:13], v19 offset:6144
    s_add_u32 s37, s41, 294912
    v_mfma_f32_16x16x32_bf16 v[140:143], a[16:19], a[88:91], v[140:143]
    ds_read_b64_tr_b16 a[14:15], v19 offset:7680
    ds_read_b64_tr_b16 a[190:191], v34 offset:7680
    v_mfma_f32_16x16x32_bf16 v[148:151], a[20:23], a[88:91], v[148:151]
    ds_read_b64_tr_b16 a[16:17], v24 offset:6144
    s_add_u32 m0, s36, 30720
    v_mfma_f32_16x16x32_bf16 v[144:147], a[20:23], a[84:87], v[144:147]
    ds_read_b64_tr_b16 a[18:19], v24 offset:7680
    ds_read_b64_tr_b16 a[192:193], v32 offset:9216
    v_mfma_f32_16x16x32_bf16 v[152:155], a[24:27], a[84:87], v[152:155]
    ds_read_b64_tr_b16 a[20:21], v25 offset:6144
    buffer_load_dwordx4 v26, s[12:15], s37 offen offset:0 lds
    v_mfma_f32_16x16x32_bf16 v[156:159], a[24:27], a[88:91], v[156:159]
    ds_read_b64_tr_b16 a[22:23], v25 offset:7680
    ds_read_b64_tr_b16 a[194:195], v32 offset:10752
    v_mfma_f32_16x16x32_bf16 v[212:215], a[0:3], a[88:91], v[212:215]
    ds_read_b64_tr_b16 a[24:25], v35 offset:9216
    v_mfma_f32_16x16x32_bf16 v[208:211], a[0:3], a[84:87], v[208:211]
    ds_read_b64_tr_b16 a[26:27], v35 offset:10752
    s_waitcnt lgkmcnt(6)
    v_mfma_f32_16x16x32_bf16 v[216:219], a[4:7], a[84:87], v[216:219]
    ds_read_b64_tr_b16 a[0:1], v36 offset:9216
    ds_read_b64_tr_b16 a[196:197], v33 offset:9216
    v_mfma_f32_16x16x32_bf16 v[220:223], a[4:7], a[88:91], v[220:223]
    ds_read_b64_tr_b16 a[2:3], v36 offset:10752
    buffer_load_dwordx4 v27, s[12:15], s37 offen offset:1024 lds
    v_mfma_f32_16x16x32_bf16 v[228:231], a[8:11], a[88:91], v[228:231]
    ds_read_b64_tr_b16 a[4:5], v37 offset:9216
    ds_read_b64_tr_b16 a[198:199], v33 offset:10752
    v_and_b32 v23, 1, v1
    v_mfma_f32_16x16x32_bf16 v[224:227], a[8:11], a[84:87], v[224:227]
    ds_read_b64_tr_b16 a[6:7], v37 offset:10752
    s_add_u32 s53, s44, 16384
    v_mfma_f32_16x16x32_bf16 v[232:235], a[12:15], a[84:87], v[232:235]
    ds_read_b64_tr_b16 a[8:9], v16 offset:9216
    ds_read_b64_tr_b16 a[200:201], v34 offset:9216
    v_mfma_f32_16x16x32_bf16 v[236:239], a[12:15], a[88:91], v[236:239]
    ds_read_b64_tr_b16 a[10:11], v16 offset:10752
    buffer_load_dwordx4 a[148:151], v38, s[16:19], s53 offen offset:0 sc1
    v_mfma_f32_16x16x32_bf16 v[244:247], a[16:19], a[88:91], v[244:247]
    ds_read_b64_tr_b16 a[12:13], v17 offset:9216
    ds_read_b64_tr_b16 a[202:203], v34 offset:10752
    v_mfma_f32_16x16x32_bf16 v[240:243], a[16:19], a[84:87], v[240:243]
    ds_read_b64_tr_b16 a[14:15], v17 offset:10752
    s_waitcnt lgkmcnt(6)
    v_mfma_f32_16x16x32_bf16 v[248:251], a[20:23], a[84:87], v[248:251]
    ds_read_b64_tr_b16 a[16:17], v18 offset:9216
    buffer_load_dwordx4 v28, s[12:15], s37 offen offset:2048 lds
    v_mfma_f32_16x16x32_bf16 v[252:255], a[20:23], a[88:91], v[252:255]
    ds_read_b64_tr_b16 a[18:19], v18 offset:10752
    v_lshl_add_u32 v23, s3, 1, v23
    v_mfma_f32_16x16x32_bf16 v[140:143], a[24:27], a[96:99], v[140:143]
    ds_read_b64_tr_b16 a[20:21], v19 offset:9216
    buffer_load_dwordx4 a[152:155], v38, s[16:19], s53 offen offset:1024 sc1
    v_mfma_f32_16x16x32_bf16 v[136:139], a[24:27], a[92:95], v[136:139]
    ds_read_b64_tr_b16 a[22:23], v19 offset:10752
    v_lshlrev_b32 v23, 7, v23
    v_mfma_f32_16x16x32_bf16 v[144:147], a[0:3], a[92:95], v[144:147]
    ds_read_b64_tr_b16 a[24:25], v24 offset:9216
    buffer_load_dwordx4 v29, s[12:15], s37 offen offset:3072 lds
    v_mfma_f32_16x16x32_bf16 v[148:151], a[0:3], a[96:99], v[148:151]
    ds_read_b64_tr_b16 a[26:27], v24 offset:10752
    v_add_u32 v23, L_stage31-L_pc, v23
    v_mfma_f32_16x16x32_bf16 v[156:159], a[4:7], a[96:99], v[156:159]
    ds_read_b64_tr_b16 a[0:1], v25 offset:9216
    s_add_u32 m0, s36, 34816
    v_mfma_f32_16x16x32_bf16 v[152:155], a[4:7], a[92:95], v[152:155]
    ds_read_b64_tr_b16 a[2:3], v25 offset:10752
    s_waitcnt lgkmcnt(4)
    s_barrier
    v_mfma_f32_16x16x32_bf16 v[208:211], a[8:11], a[92:95], v[208:211]
    ds_read_b64_tr_b16 a[4:5], v35 offset:12288
    buffer_load_dwordx4 v30, s[12:15], s37 offen offset:0 lds
    v_mfma_f32_16x16x32_bf16 v[212:215], a[8:11], a[96:99], v[212:215]
    ds_read_b64_tr_b16 a[6:7], v35 offset:13824
    ds_read_b64_tr_b16 a[204:205], v32 offset:12288
    v_mfma_f32_16x16x32_bf16 v[220:223], a[12:15], a[96:99], v[220:223]
    ds_read_b64_tr_b16 a[8:9], v36 offset:12288
    buffer_load_dwordx4 a[156:159], v38, s[16:19], s53 offen offset:2048 sc1
    v_mfma_f32_16x16x32_bf16 v[216:219], a[12:15], a[92:95], v[216:219]
    ds_read_b64_tr_b16 a[10:11], v36 offset:13824
    ds_read_b64_tr_b16 a[206:207], v32 offset:13824
    v_mfma_f32_16x16x32_bf16 v[224:227], a[16:19], a[92:95], v[224:227]
    ds_read_b64_tr_b16 a[12:13], v37 offset:12288
    global_load_dword v20, v23, s[0:1]
    v_mfma_f32_16x16x32_bf16 v[228:231], a[16:19], a[96:99], v[228:231]
    ds_read_b64_tr_b16 a[14:15], v37 offset:13824
    ds_read_b64_tr_b16 a[208:209], v33 offset:12288
    v_mfma_f32_16x16x32_bf16 v[236:239], a[20:23], a[96:99], v[236:239]
    ds_read_b64_tr_b16 a[16:17], v16 offset:12288
    buffer_load_dwordx4 v31, s[12:15], s37 offen offset:1024 lds
    v_mfma_f32_16x16x32_bf16 v[232:235], a[20:23], a[92:95], v[232:235]
    ds_read_b64_tr_b16 a[18:19], v16 offset:13824
    s_waitcnt lgkmcnt(6)
    v_mfma_f32_16x16x32_bf16 v[240:243], a[24:27], a[92:95], v[240:243]
    ds_read_b64_tr_b16 a[20:21], v17 offset:12288
    ds_read_b64_tr_b16 a[210:211], v33 offset:13824
    v_mfma_f32_16x16x32_bf16 v[244:247], a[24:27], a[96:99], v[244:247]
    ds_read_b64_tr_b16 a[22:23], v17 offset:13824
    v_mfma_f32_16x16x32_bf16 v[252:255], a[0:3], a[96:99], v[252:255]
    ds_read_b64_tr_b16 a[24:25], v18 offset:12288
    ds_read_b64_tr_b16 a[212:213], v34 offset:12288
    v_mfma_f32_16x16x32_bf16 v[248:251], a[0:3], a[92:95], v[248:251]
    ds_read_b64_tr_b16 a[26:27], v18 offset:13824
    buffer_load_dwordx4 a[160:163], v38, s[16:19], s53 offen offset:3072 sc1
L_stage28:
    v_mfma_f32_16x16x32_bf16 v[136:139], a[4:7], a[100:103], v[136:139]
    ds_read_b64_tr_b16 a[0:1], v19 offset:12288
    ds_read_b64_tr_b16 a[214:215], v34 offset:13824
    v_mfma_f32_16x16x32_bf16 v[140:143], a[4:7], a[104:107], v[140:143]
    ds_read_b64_tr_b16 a[2:3], v19 offset:13824
    s_add_u32 s37, s41, 368640
    v_mfma_f32_16x16x32_bf16 v[148:151], a[8:11], a[104:107], v[148:151]
    ds_read_b64_tr_b16 a[4:5], v24 offset:12288
    ds_read_b64_tr_b16 a[216:217], v32 offset:15360
    v_mfma_f32_16x16x32_bf16 v[144:147], a[8:11], a[100:103], v[144:147]
    ds_read_b64_tr_b16 a[6:7], v24 offset:13824
    s_waitcnt lgkmcnt(6)
    v_mfma_f32_16x16x32_bf16 v[152:155], a[12:15], a[100:103], v[152:155]
    ds_read_b64_tr_b16 a[8:9], v25 offset:12288
    s_add_u32 m0, s36, 0
    v_mfma_f32_16x16x32_bf16 v[156:159], a[12:15], a[104:107], v[156:159]
    ds_read_b64_tr_b16 a[10:11], v25 offset:13824
    ds_read_b64_tr_b16 a[218:219], v32 offset:16896
    v_mfma_f32_16x16x32_bf16 v[212:215], a[16:19], a[104:107], v[212:215]
    ds_read_b64_tr_b16 a[12:13], v35 offset:15360
    buffer_load_dwordx4 v26, s[12:15], s37 offen offset:0 lds
    v_mfma_f32_16x16x32_bf16 v[208:211], a[16:19], a[100:103], v[208:211]
    ds_read_b64_tr_b16 a[14:15], v35 offset:16896
    ds_read_b64_tr_b16 a[220:221], v33 offset:15360
    v_mfma_f32_16x16x32_bf16 v[216:219], a[20:23], a[100:103], v[216:219]
    ds_read_b64_tr_b16 a[16:17], v36 offset:15360
    s_add_u32 s53, s44, 20480
    v_mfma_f32_16x16x32_bf16 v[220:223], a[20:23], a[104:107], v[220:223]
    ds_read_b64_tr_b16 a[18:19], v36 offset:16896
    ds_read_b64_tr_b16 a[222:223], v33 offset:16896
    v_mfma_f32_16x16x32_bf16 v[228:231], a[24:27], a[104:107], v[228:231]
    ds_read_b64_tr_b16 a[20:21], v37 offset:15360
    buffer_load_dwordx4 v27, s[12:15], s37 offen offset:1024 lds
    v_mfma_f32_16x16x32_bf16 v[224:227], a[24:27], a[100:103], v[224:227]
    ds_read_b64_tr_b16 a[22:23], v37 offset:16896
    s_waitcnt lgkmcnt(6)
    v_mfma_f32_16x16x32_bf16 v[232:235], a[0:3], a[100:103], v[232:235]
    ds_read_b64_tr_b16 a[24:25], v16 offset:15360
    ds_read_b64_tr_b16 a[224:225], v34 offset:15360
    v_mfma_f32_16x16x32_bf16 v[236:239], a[0:3], a[104:107], v[236:239]
    ds_read_b64_tr_b16 a[26:27], v16 offset:16896
    buffer_load_dwordx4 a[164:167], v38, s[16:19], s53 offen offset:0 sc1
    v_mfma_f32_16x16x32_bf16 v[244:247], a[4:7], a[104:107], v[244:247]
    ds_read_b64_tr_b16 a[0:1], v17 offset:15360
    ds_read_b64_tr_b16 a[226:227], v34 offset:16896
    v_mfma_f32_16x16x32_bf16 v[240:243], a[4:7], a[100:103], v[240:243]
    ds_read_b64_tr_b16 a[2:3], v17 offset:16896
    v_mfma_f32_16x16x32_bf16 v[248:251], a[8:11], a[100:103], v[248:251]
    ds_read_b64_tr_b16 a[4:5], v18 offset:15360
    buffer_load_dwordx4 v28, s[12:15], s37 offen offset:2048 lds
    v_mfma_f32_16x16x32_bf16 v[252:255], a[8:11], a[104:107], v[252:255]
    ds_read_b64_tr_b16 a[6:7], v18 offset:16896
    v_mfma_f32_16x16x32_bf16 v[140:143], a[12:15], a[112:115], v[140:143]
    ds_read_b64_tr_b16 a[8:9], v19 offset:15360
    buffer_load_dwordx4 a[168:171], v38, s[16:19], s53 offen offset:1024 sc1
    v_mfma_f32_16x16x32_bf16 v[136:139], a[12:15], a[108:111], v[136:139]
    ds_read_b64_tr_b16 a[10:11], v19 offset:16896
    s_waitcnt vmcnt(27) lgkmcnt(4)
    v_mfma_f32_16x16x32_bf16 v[144:147], a[16:19], a[108:111], v[144:147]
    ds_read_b64_tr_b16 a[12:13], v24 offset:15360
    v_mfma_f32_16x16x32_bf16 v[148:151], a[16:19], a[112:115], v[148:151]
    ds_read_b64_tr_b16 a[14:15], v24 offset:16896
    buffer_load_dwordx4 v29, s[12:15], s37 offen offset:3072 lds
    v_mfma_f32_16x16x32_bf16 v[156:159], a[20:23], a[112:115], v[156:159]
    ds_read_b64_tr_b16 a[16:17], v25 offset:15360
    s_add_u32 m0, s36, 4096
    v_mfma_f32_16x16x32_bf16 v[152:155], a[20:23], a[108:111], v[152:155]
    ds_read_b64_tr_b16 a[18:19], v25 offset:16896
    s_barrier
    v_mfma_f32_16x16x32_bf16 v[208:211], a[24:27], a[108:111], v[208:211]
    ds_read_b64_tr_b16 a[20:21], v35 offset:18432
    buffer_load_dwordx4 v30, s[12:15], s37 offen offset:0 lds
    v_mfma_f32_16x16x32_bf16 v[212:215], a[24:27], a[112:115], v[212:215]
    ds_read_b64_tr_b16 a[22:23], v35 offset:19968
    ds_read_b64_tr_b16 a[228:229], v32 offset:18432
    v_mfma_f32_16x16x32_bf16 v[220:223], a[0:3], a[112:115], v[220:223]
    ds_read_b64_tr_b16 a[24:25], v36 offset:18432
    v_mfma_f32_16x16x32_bf16 v[216:219], a[0:3], a[108:111], v[216:219]
    ds_read_b64_tr_b16 a[26:27], v36 offset:19968
    s_waitcnt lgkmcnt(5)
    v_mfma_f32_16x16x32_bf16 v[224:227], a[4:7], a[108:111], v[224:227]
    ds_read_b64_tr_b16 a[0:1], v37 offset:18432
    ds_read_b64_tr_b16 a[230:231], v32 offset:19968
    v_mfma_f32_16x16x32_bf16 v[228:231], a[4:7], a[112:115], v[228:231]
    ds_read_b64_tr_b16 a[2:3], v37 offset:19968
    buffer_load_dwordx4 a[172:175], v38, s[16:19], s53 offen offset:2048 sc1
    v_mfma_f32_16x16x32_bf16 v[236:239], a[8:11], a[112:115], v[236:239]
    ds_read_b64_tr_b16 a[4:5], v16 offset:18432
    ds_read_b64_tr_b16 a[232:233], v33 offset:18432
    v_mfma_f32_16x16x32_bf16 v[232:235], a[8:11], a[108:111], v[232:235]
    ds_read_b64_tr_b16 a[6:7], v16 offset:19968
    buffer_load_dwordx4 v31, s[12:15], s37 offen offset:1024 lds
    v_mfma_f32_16x16x32_bf16 v[240:243], a[12:15], a[108:111], v[240:243]
    ds_read_b64_tr_b16 a[8:9], v17 offset:18432
    ds_read_b64_tr_b16 a[234:235], v33 offset:19968
    v_mfma_f32_16x16x32_bf16 v[244:247], a[12:15], a[112:115], v[244:247]
    ds_read_b64_tr_b16 a[10:11], v17 offset:19968
    v_mfma_f32_16x16x32_bf16 v[252:255], a[16:19], a[112:115], v[252:255]
    ds_read_b64_tr_b16 a[12:13], v18 offset:18432
    ds_read_b64_tr_b16 a[236:237], v34 offset:18432
    v_mfma_f32_16x16x32_bf16 v[248:251], a[16:19], a[108:111], v[248:251]
    ds_read_b64_tr_b16 a[14:15], v18 offset:19968
    s_waitcnt vmcnt(30) lgkmcnt(6)
L_stage29:
    v_mfma_f32_16x16x32_bf16 v[136:139], a[20:23], a[116:119], v[136:139]
    ds_read_b64_tr_b16 a[16:17], v19 offset:18432
    s_add_u32 s37, s42, 221184
    v_mfma_f32_16x16x32_bf16 v[140:143], a[20:23], a[120:123], v[140:143]
    ds_read_b64_tr_b16 a[18:19], v19 offset:19968
    ds_read_b64_tr_b16 a[238:239], v34 offset:19968
    v_mfma_f32_16x16x32_bf16 v[148:151], a[24:27], a[120:123], v[148:151]
    ds_read_b64_tr_b16 a[20:21], v24 offset:18432
    s_add_u32 m0, s36, 6144
    s_nop 0
    buffer_load_dwordx4 v26, s[12:15], s37 offen offset:0 lds
    v_mfma_f32_16x16x32_bf16 v[144:147], a[24:27], a[116:119], v[144:147]
    ds_read_b64_tr_b16 a[22:23], v24 offset:19968
    ds_read_b64_tr_b16 a[240:241], v32 offset:21504
    v_mfma_f32_16x16x32_bf16 v[152:155], a[0:3], a[116:119], v[152:155]
    ds_read_b64_tr_b16 a[24:25], v25 offset:18432
    v_mfma_f32_16x16x32_bf16 v[156:159], a[0:3], a[120:123], v[156:159]
    ds_read_b64_tr_b16 a[26:27], v25 offset:19968
    ds_read_b64_tr_b16 a[242:243], v32 offset:23040
    v_mfma_f32_16x16x32_bf16 v[212:215], a[4:7], a[120:123], v[212:215]
    ds_read_b64_tr_b16 a[0:1], v35 offset:21504
    buffer_load_dwordx4 v27, s[12:15], s37 offen offset:1024 lds
    v_mfma_f32_16x16x32_bf16 v[208:211], a[4:7], a[116:119], v[208:211]
    ds_read_b64_tr_b16 a[2:3], v35 offset:23040
    s_waitcnt lgkmcnt(6)
    v_mfma_f32_16x16x32_bf16 v[216:219], a[8:11], a[116:119], v[216:219]
    ds_read_b64_tr_b16 a[4:5], v36 offset:21504
    ds_read_b64_tr_b16 a[244:245], v33 offset:21504
    v_mfma_f32_16x16x32_bf16 v[220:223], a[8:11], a[120:123], v[220:223]
    ds_read_b64_tr_b16 a[6:7], v36 offset:23040
    buffer_load_dwordx4 a[176:179], v38, s[16:19], s53 offen offset:3072 sc1
    v_mfma_f32_16x16x32_bf16 v[228:231], a[12:15], a[120:123], v[228:231]
    ds_read_b64_tr_b16 a[8:9], v37 offset:21504
    ds_read_b64_tr_b16 a[246:247], v33 offset:23040
    v_mfma_f32_16x16x32_bf16 v[224:227], a[12:15], a[116:119], v[224:227]
    ds_read_b64_tr_b16 a[10:11], v37 offset:23040
    v_mfma_f32_16x16x32_bf16 v[232:235], a[16:19], a[116:119], v[232:235]
    ds_read_b64_tr_b16 a[12:13], v16 offset:21504
    ds_read_b64_tr_b16 a[248:249], v34 offset:21504
    v_mfma_f32_16x16x32_bf16 v[236:239], a[16:19], a[120:123], v[236:239]
    ds_read_b64_tr_b16 a[14:15], v16 offset:23040
    buffer_load_dwordx4 v28, s[12:15], s37 offen offset:2048 lds
    v_mfma_f32_16x16x32_bf16 v[244:247], a[20:23], a[120:123], v[244:247]
    ds_read_b64_tr_b16 a[16:17], v17 offset:21504
    ds_read_b64_tr_b16 a[250:251], v34 offset:23040
    v_mfma_f32_16x16x32_bf16 v[240:243], a[20:23], a[116:119], v[240:243]
    ds_read_b64_tr_b16 a[18:19], v17 offset:23040
    s_waitcnt lgkmcnt(6)
    v_mfma_f32_16x16x32_bf16 v[248:251], a[24:27], a[116:119], v[248:251]
    ds_read_b64_tr_b16 a[20:21], v18 offset:21504
    buffer_load_dwordx4 v29, s[12:15], s37 offen offset:3072 lds
    v_mfma_f32_16x16x32_bf16 v[252:255], a[24:27], a[120:123], v[252:255]
    ds_read_b64_tr_b16 a[22:23], v18 offset:23040
    s_add_u32 m0, s36, 10240
    v_mfma_f32_16x16x32_bf16 v[140:143], a[0:3], a[128:131], v[140:143]
    ds_read_b64_tr_b16 a[24:25], v19 offset:21504
    buffer_load_dwordx4 v30, s[12:15], s37 offen offset:0 lds
    v_mfma_f32_16x16x32_bf16 v[136:139], a[0:3], a[124:127], v[136:139]
    ds_read_b64_tr_b16 a[26:27], v19 offset:23040
    v_mfma_f32_16x16x32_bf16 v[144:147], a[4:7], a[124:127], v[144:147]
    ds_read_b64_tr_b16 a[0:1], v24 offset:21504
    buffer_load_dwordx4 v31, s[12:15], s37 offen offset:1024 lds
    v_mfma_f32_16x16x32_bf16 v[148:151], a[4:7], a[128:131], v[148:151]
    ds_read_b64_tr_b16 a[2:3], v24 offset:23040
    s_add_u32 s37, s42, 294912
    v_mfma_f32_16x16x32_bf16 v[156:159], a[8:11], a[128:131], v[156:159]
    ds_read_b64_tr_b16 a[4:5], v25 offset:21504
    s_add_u32 m0, s36, 12288
    v_mfma_f32_16x16x32_bf16 v[152:155], a[8:11], a[124:127], v[152:155]
    ds_read_b64_tr_b16 a[6:7], v25 offset:23040
    s_waitcnt vmcnt(28) lgkmcnt(4)
    s_barrier
    v_mfma_f32_16x16x32_bf16 v[208:211], a[12:15], a[124:127], v[208:211]
    ds_read_b64_tr_b16 a[8:9], v35 offset:24576
    buffer_load_dwordx4 v26, s[12:15], s37 offen offset:0 lds
    v_mfma_f32_16x16x32_bf16 v[212:215], a[12:15], a[128:131], v[212:215]
    ds_read_b64_tr_b16 a[10:11], v35 offset:26112
    buffer_load_dwordx4 v27, s[12:15], s37 offen offset:1024 lds
    v_mfma_f32_16x16x32_bf16 v[220:223], a[16:19], a[128:131], v[220:223]
    ds_read_b64_tr_b16 a[12:13], v36 offset:24576
    s_add_u32 s53, s45, 12288
    v_mfma_f32_16x16x32_bf16 v[216:219], a[16:19], a[124:127], v[216:219]
    ds_read_b64_tr_b16 a[14:15], v36 offset:26112
    buffer_load_dwordx4 v28, s[12:15], s37 offen offset:2048 lds
    v_mfma_f32_16x16x32_bf16 v[224:227], a[20:23], a[124:127], v[224:227]
    ds_read_b64_tr_b16 a[16:17], v37 offset:24576
    buffer_load_dwordx4 a[36:39], v38, s[16:19], s53 offen offset:0 sc1
    v_mfma_f32_16x16x32_bf16 v[228:231], a[20:23], a[128:131], v[228:231]
    ds_read_b64_tr_b16 a[18:19], v37 offset:26112
    buffer_load_dwordx4 v29, s[12:15], s37 offen offset:3072 lds
    v_mfma_f32_16x16x32_bf16 v[236:239], a[24:27], a[128:131], v[236:239]
    ds_read_b64_tr_b16 a[20:21], v16 offset:24576
    s_add_u32 m0, s36, 16384
    v_mfma_f32_16x16x32_bf16 v[232:235], a[24:27], a[124:127], v[232:235]
    ds_read_b64_tr_b16 a[22:23], v16 offset:26112
    s_waitcnt vmcnt(32) lgkmcnt(4)
    v_mfma_f32_16x16x32_bf16 v[240:243], a[0:3], a[124:127], v[240:243]
    ds_read_b64_tr_b16 a[24:25], v17 offset:24576
    buffer_load_dwordx4 v30, s[12:15], s37 offen offset:0 lds
    v_mfma_f32_16x16x32_bf16 v[244:247], a[0:3], a[128:131], v[244:247]
    ds_read_b64_tr_b16 a[26:27], v17 offset:26112
    v_mfma_f32_16x16x32_bf16 v[252:255], a[4:7], a[128:131], v[252:255]
    ds_read_b64_tr_b16 a[0:1], v18 offset:24576
    buffer_load_dwordx4 v31, s[12:15], s37 offen offset:1024 lds
    v_mfma_f32_16x16x32_bf16 v[248:251], a[4:7], a[124:127], v[248:251]
    ds_read_b64_tr_b16 a[2:3], v18 offset:26112
L_stage30:
    v_mfma_f32_16x16x32_bf16 v[136:139], a[8:11], a[132:135], v[136:139]
    ds_read_b64_tr_b16 a[4:5], v19 offset:24576
    s_add_u32 s37, s42, 368640
    v_mfma_f32_16x16x32_bf16 v[140:143], a[8:11], a[136:139], v[140:143]
    ds_read_b64_tr_b16 a[6:7], v19 offset:26112
    s_add_u32 m0, s36, 18432
    v_mfma_f32_16x16x32_bf16 v[148:151], a[12:15], a[136:139], v[148:151]
    ds_read_b64_tr_b16 a[8:9], v24 offset:24576
    buffer_load_dwordx4 v26, s[12:15], s37 offen offset:0 lds
    v_mfma_f32_16x16x32_bf16 v[144:147], a[12:15], a[132:135], v[144:147]
    ds_read_b64_tr_b16 a[10:11], v24 offset:26112
    s_waitcnt lgkmcnt(4)
    v_mfma_f32_16x16x32_bf16 v[152:155], a[16:19], a[132:135], v[152:155]
    ds_read_b64_tr_b16 a[12:13], v25 offset:24576
    v_min_u32 v21, 3, v1
    v_mfma_f32_16x16x32_bf16 v[156:159], a[16:19], a[136:139], v[156:159]
    ds_read_b64_tr_b16 a[14:15], v25 offset:26112
    v_lshlrev_b32 v22, 2, v21
    v_mfma_f32_16x16x32_bf16 v[212:215], a[20:23], a[136:139], v[212:215]
    ds_read_b64_tr_b16 a[16:17], v35 offset:27648
    v_lshlrev_b32 v21, 4, v21
    v_mfma_f32_16x16x32_bf16 v[208:211], a[20:23], a[132:135], v[208:211]
    ds_read_b64_tr_b16 a[18:19], v35 offset:29184
    buffer_load_dwordx4 a[40:43], v38, s[16:19], s53 offen offset:1024 sc1
    v_mfma_f32_16x16x32_bf16 v[216:219], a[24:27], a[132:135], v[216:219]
    ds_read_b64_tr_b16 a[20:21], v36 offset:27648
    v_mfma_f32_16x16x32_bf16 v[220:223], a[24:27], a[136:139], v[220:223]
    ds_read_b64_tr_b16 a[22:23], v36 offset:29184
    s_lshl_b32 s61, s28, 2
    v_mfma_f32_16x16x32_bf16 v[228:231], a[0:3], a[136:139], v[228:231]
    ds_read_b64_tr_b16 a[24:25], v37 offset:27648
    s_add_u32 s61, s61, s47
    v_mfma_f32_16x16x32_bf16 v[224:227], a[0:3], a[132:135], v[224:227]
    ds_read_b64_tr_b16 a[26:27], v37 offset:29184
    s_waitcnt lgkmcnt(4)
    v_mfma_f32_16x16x32_bf16 v[232:235], a[4:7], a[132:135], v[232:235]
    ds_read_b64_tr_b16 a[0:1], v16 offset:27648
    buffer_load_dwordx4 v27, s[12:15], s37 offen offset:1024 lds
    v_mfma_f32_16x16x32_bf16 v[236:239], a[4:7], a[136:139], v[236:239]
    ds_read_b64_tr_b16 a[2:3], v16 offset:29184
    v_mfma_f32_16x16x32_bf16 v[244:247], a[8:11], a[136:139], v[244:247]
    ds_read_b64_tr_b16 a[4:5], v17 offset:27648
    buffer_load_dwordx4 v28, s[12:15], s37 offen offset:2048 lds
    v_mfma_f32_16x16x32_bf16 v[240:243], a[8:11], a[132:135], v[240:243]
    ds_read_b64_tr_b16 a[6:7], v17 offset:29184
    v_mfma_f32_16x16x32_bf16 v[248:251], a[12:15], a[132:135], v[248:251]
    ds_read_b64_tr_b16 a[8:9], v18 offset:27648
    v_mfma_f32_16x16x32_bf16 v[252:255], a[12:15], a[136:139], v[252:255]
    ds_read_b64_tr_b16 a[10:11], v18 offset:29184
    buffer_load_dwordx4 a[44:47], v38, s[16:19], s53 offen offset:2048 sc1
    v_mfma_f32_16x16x32_bf16 v[140:143], a[16:19], a[144:147], v[140:143]
    ds_read_b64_tr_b16 a[12:13], v19 offset:27648
    v_mfma_f32_16x16x32_bf16 v[136:139], a[16:19], a[140:143], v[136:139]
    ds_read_b64_tr_b16 a[14:15], v19 offset:29184
    s_waitcnt vmcnt(29) lgkmcnt(4)
    v_mfma_f32_16x16x32_bf16 v[144:147], a[20:23], a[140:143], v[144:147]
    ds_read_b64_tr_b16 a[16:17], v24 offset:27648
    v_mfma_f32_16x16x32_bf16 v[148:151], a[20:23], a[144:147], v[148:151]
    ds_read_b64_tr_b16 a[18:19], v24 offset:29184
    buffer_load_dwordx4 v29, s[12:15], s37 offen offset:3072 lds
    v_mfma_f32_16x16x32_bf16 v[156:159], a[24:27], a[144:147], v[156:159]
    ds_read_b64_tr_b16 a[20:21], v25 offset:27648
    v_mfma_f32_16x16x32_bf16 v[152:155], a[24:27], a[140:143], v[152:155]
    ds_read_b64_tr_b16 a[22:23], v25 offset:29184
    s_barrier
    v_mfma_f32_16x16x32_bf16 v[208:211], a[0:3], a[140:143], v[208:211]
    ds_read_b64_tr_b16 a[24:25], v35 offset:30720
    v_mfma_f32_16x16x32_bf16 v[212:215], a[0:3], a[144:147], v[212:215]
    ds_read_b64_tr_b16 a[26:27], v35 offset:32256
    s_add_u32 m0, s36, 22528
    v_mfma_f32_16x16x32_bf16 v[220:223], a[4:7], a[144:147], v[220:223]
    ds_read_b64_tr_b16 a[0:1], v36 offset:30720
    buffer_load_dwordx4 v30, s[12:15], s37 offen offset:0 lds
    v_mfma_f32_16x16x32_bf16 v[216:219], a[4:7], a[140:143], v[216:219]
    ds_read_b64_tr_b16 a[2:3], v36 offset:32256
    s_waitcnt lgkmcnt(4)
    v_mfma_f32_16x16x32_bf16 v[224:227], a[8:11], a[140:143], v[224:227]
    ds_read_b64_tr_b16 a[4:5], v37 offset:30720
    v_mfma_f32_16x16x32_bf16 v[228:231], a[8:11], a[144:147], v[228:231]
    ds_read_b64_tr_b16 a[6:7], v37 offset:32256
    buffer_load_dwordx4 a[48:51], v38, s[16:19], s53 offen offset:3072 sc1
    v_mfma_f32_16x16x32_bf16 v[236:239], a[12:15], a[144:147], v[236:239]
    ds_read_b64_tr_b16 a[8:9], v16 offset:30720
    v_mfma_f32_16x16x32_bf16 v[232:235], a[12:15], a[140:143], v[232:235]
    ds_read_b64_tr_b16 a[10:11], v16 offset:32256
    v_mfma_f32_16x16x32_bf16 v[240:243], a[16:19], a[140:143], v[240:243]
    ds_read_b64_tr_b16 a[12:13], v17 offset:30720
    buffer_load_dwordx4 v31, s[12:15], s37 offen offset:1024 lds
    v_mfma_f32_16x16x32_bf16 v[244:247], a[16:19], a[144:147], v[244:247]
    ds_read_b64_tr_b16 a[14:15], v17 offset:32256
    s_add_u32 s53, s45, 16384
    v_mfma_f32_16x16x32_bf16 v[252:255], a[20:23], a[144:147], v[252:255]
    ds_read_b64_tr_b16 a[16:17], v18 offset:30720
    v_mfma_f32_16x16x32_bf16 v[248:251], a[20:23], a[140:143], v[248:251]
    ds_read_b64_tr_b16 a[18:19], v18 offset:32256
    s_waitcnt vmcnt(32) lgkmcnt(4)
L_stage31:
    v_mfma_f32_16x16x32_bf16 v[136:139], a[24:27], a[148:151], v[136:139]
    ds_read_b64_tr_b16 a[20:21], v19 offset:30720
    v_mfma_f32_16x16x32_bf16 v[140:143], a[24:27], a[152:155], v[140:143]
    ds_read_b64_tr_b16 a[22:23], v19 offset:32256
    buffer_load_dwordx4 a[52:55], v38, s[16:19], s53 offen offset:0 sc1
    v_mfma_f32_16x16x32_bf16 v[148:151], a[0:3], a[152:155], v[148:151]
    ds_read_b64_tr_b16 a[24:25], v24 offset:30720
    v_mfma_f32_16x16x32_bf16 v[144:147], a[0:3], a[148:151], v[144:147]
    ds_read_b64_tr_b16 a[26:27], v24 offset:32256
    v_mfma_f32_16x16x32_bf16 v[152:155], a[4:7], a[148:151], v[152:155]
    ds_read_b64_tr_b16 a[0:1], v25 offset:30720
    v_mfma_f32_16x16x32_bf16 v[156:159], a[4:7], a[152:155], v[156:159]
    ds_read_b64_tr_b16 a[2:3], v25 offset:32256
    buffer_load_dwordx4 a[56:59], v38, s[16:19], s53 offen offset:1024 sc1
    v_mfma_f32_16x16x32_bf16 v[212:215], a[8:11], a[152:155], v[212:215]
    ds_read_b64_tr_b16 a[4:5], v35 offset:33792
    v_mfma_f32_16x16x32_bf16 v[208:211], a[8:11], a[148:151], v[208:211]
    ds_read_b64_tr_b16 a[6:7], v35 offset:35328
    s_waitcnt lgkmcnt(4)
    v_mfma_f32_16x16x32_bf16 v[216:219], a[12:15], a[148:151], v[216:219]
    ds_read_b64_tr_b16 a[8:9], v36 offset:33792
    v_mfma_f32_16x16x32_bf16 v[220:223], a[12:15], a[152:155], v[220:223]
    ds_read_b64_tr_b16 a[10:11], v36 offset:35328
    buffer_load_dword v9, v21, s[16:19], s61 offen sc1
    v_mfma_f32_16x16x32_bf16 v[228:231], a[16:19], a[152:155], v[228:231]
    ds_read_b64_tr_b16 a[12:13], v37 offset:33792
    v_and_b32 v23, 1, v1
    v_mfma_f32_16x16x32_bf16 v[224:227], a[16:19], a[148:151], v[224:227]
    ds_read_b64_tr_b16 a[14:15], v37 offset:35328
    v_lshl_add_u32 v23, s3, 1, v23
    v_mfma_f32_16x16x32_bf16 v[232:235], a[20:23], a[148:151], v[232:235]
    ds_read_b64_tr_b16 a[16:17], v16 offset:33792
    v_lshlrev_b32 v23, 7, v23
    v_mfma_f32_16x16x32_bf16 v[236:239], a[20:23], a[152:155], v[236:239]
    ds_read_b64_tr_b16 a[18:19], v16 offset:35328
    buffer_load_dwordx4 a[60:63], v38, s[16:19], s53 offen offset:2048 sc1
    v_mfma_f32_16x16x32_bf16 v[244:247], a[24:27], a[152:155], v[244:247]
    ds_read_b64_tr_b16 a[20:21], v17 offset:33792
    v_add_u32 v23, L_stage35-L_pc, v23
    v_mfma_f32_16x16x32_bf16 v[240:243], a[24:27], a[148:151], v[240:243]
    ds_read_b64_tr_b16 a[22:23], v17 offset:35328
    s_waitcnt lgkmcnt(4)
    v_mfma_f32_16x16x32_bf16 v[248:251], a[0:3], a[148:151], v[248:251]
    ds_read_b64_tr_b16 a[24:25], v18 offset:33792
    global_load_dword v20, v23, s[0:1]
    v_mfma_f32_16x16x32_bf16 v[252:255], a[0:3], a[152:155], v[252:255]
    ds_read_b64_tr_b16 a[26:27], v18 offset:35328
    v_mfma_f32_16x16x32_bf16 v[140:143], a[4:7], a[160:163], v[140:143]
    ds_read_b64_tr_b16 a[0:1], v19 offset:33792
    v_mfma_f32_16x16x32_bf16 v[136:139], a[4:7], a[156:159], v[136:139]
    ds_read_b64_tr_b16 a[2:3], v19 offset:35328
    v_mfma_f32_16x16x32_bf16 v[144:147], a[8:11], a[156:159], v[144:147]
    ds_read_b64_tr_b16 a[4:5], v24 offset:33792
    v_mfma_f32_16x16x32_bf16 v[148:151], a[8:11], a[160:163], v[148:151]
    ds_read_b64_tr_b16 a[6:7], v24 offset:35328
    buffer_load_dwordx4 a[64:67], v38, s[16:19], s53 offen offset:3072 sc1
    v_mfma_f32_16x16x32_bf16 v[156:159], a[12:15], a[160:163], v[156:159]
    ds_read_b64_tr_b16 a[8:9], v25 offset:33792
    v_mfma_f32_16x16x32_bf16 v[152:155], a[12:15], a[156:159], v[152:155]
    ds_read_b64_tr_b16 a[10:11], v25 offset:35328
    s_waitcnt vmcnt(29) lgkmcnt(4)
    s_barrier
    v_mfma_f32_16x16x32_bf16 v[208:211], a[16:19], a[156:159], v[208:211]
    ds_read_b64_tr_b16 a[12:13], v35 offset:0
    s_add_u32 s53, s45, 20480
    v_mfma_f32_16x16x32_bf16 v[212:215], a[16:19], a[160:163], v[212:215]
    ds_read_b64_tr_b16 a[14:15], v35 offset:1536
    v_mfma_f32_16x16x32_bf16 v[220:223], a[20:23], a[160:163], v[220:223]
    ds_read_b64_tr_b16 a[16:17], v36 offset:0
    v_mfma_f32_16x16x32_bf16 v[216:219], a[20:23], a[156:159], v[216:219]
    ds_read_b64_tr_b16 a[18:19], v36 offset:1536
    buffer_load_dwordx4 a[68:71], v38, s[16:19], s53 offen offset:0 sc1
    v_mfma_f32_16x16x32_bf16 v[224:227], a[24:27], a[156:159], v[224:227]
    ds_read_b64_tr_b16 a[20:21], v37 offset:0
    v_mfma_f32_16x16x32_bf16 v[228:231], a[24:27], a[160:163], v[228:231]
    ds_read_b64_tr_b16 a[22:23], v37 offset:1536
    v_mfma_f32_16x16x32_bf16 v[236:239], a[0:3], a[160:163], v[236:239]
    ds_read_b64_tr_b16 a[24:25], v16 offset:0
    v_mfma_f32_16x16x32_bf16 v[232:235], a[0:3], a[156:159], v[232:235]
    ds_read_b64_tr_b16 a[26:27], v16 offset:1536
    s_waitcnt vmcnt(27) lgkmcnt(4)
    v_mfma_f32_16x16x32_bf16 v[240:243], a[4:7], a[156:159], v[240:243]
    ds_read_b64_tr_b16 a[0:1], v17 offset:0
    v_mfma_f32_16x16x32_bf16 v[244:247], a[4:7], a[160:163], v[244:247]
    ds_read_b64_tr_b16 a[2:3], v17 offset:1536
    v_mfma_f32_16x16x32_bf16 v[252:255], a[8:11], a[160:163], v[252:255]
    ds_read_b64_tr_b16 a[4:5], v18 offset:0
    buffer_load_dwordx4 a[72:75], v38, s[16:19], s53 offen offset:1024 sc1
    v_mfma_f32_16x16x32_bf16 v[248:251], a[8:11], a[156:159], v[248:251]
    ds_read_b64_tr_b16 a[6:7], v18 offset:1536
L_stage32:
    v_mfma_f32_16x16x32_bf16 v[136:139], a[12:15], a[164:167], v[136:139]
    ds_read_b64_tr_b16 a[8:9], v19 offset:0
    v_mfma_f32_16x16x32_bf16 v[140:143], a[12:15], a[168:171], v[140:143]
    ds_read_b64_tr_b16 a[10:11], v19 offset:1536
    v_mfma_f32_16x16x32_bf16 v[148:151], a[16:19], a[168:171], v[148:151]
    ds_read_b64_tr_b16 a[12:13], v24 offset:0
    v_mfma_f32_16x16x32_bf16 v[144:147], a[16:19], a[164:167], v[144:147]
    ds_read_b64_tr_b16 a[14:15], v24 offset:1536
    s_waitcnt lgkmcnt(4)
    v_mfma_f32_16x16x32_bf16 v[152:155], a[20:23], a[164:167], v[152:155]
    ds_read_b64_tr_b16 a[16:17], v25 offset:0
    v_mfma_f32_16x16x32_bf16 v[156:159], a[20:23], a[168:171], v[156:159]
    ds_read_b64_tr_b16 a[18:19], v25 offset:1536
    buffer_load_dwordx4 a[76:79], v38, s[16:19], s53 offen offset:2048 sc1
    v_mfma_f32_16x16x32_bf16 v[212:215], a[24:27], a[168:171], v[212:215]
    ds_read_b64_tr_b16 a[20:21], v35 offset:3072
    v_mfma_f32_16x16x32_bf16 v[208:211], a[24:27], a[164:167], v[208:211]
    ds_read_b64_tr_b16 a[22:23], v35 offset:4608
    v_mfma_f32_16x16x32_bf16 v[216:219], a[0:3], a[164:167], v[216:219]
    ds_read_b64_tr_b16 a[24:25], v36 offset:3072
    v_mfma_f32_16x16x32_bf16 v[220:223], a[0:3], a[168:171], v[220:223]
    ds_read_b64_tr_b16 a[26:27], v36 offset:4608
    v_mfma_f32_16x16x32_bf16 v[228:231], a[4:7], a[168:171], v[228:231]
    ds_read_b64_tr_b16 a[0:1], v37 offset:3072
    v_mfma_f32_16x16x32_bf16 v[224:227], a[4:7], a[164:167], v[224:227]
    ds_read_b64_tr_b16 a[2:3], v37 offset:4608
    s_waitcnt lgkmcnt(4)
    v_mfma_f32_16x16x32_bf16 v[232:235], a[8:11], a[164:167], v[232:235]
    ds_read_b64_tr_b16 a[4:5], v16 offset:3072
    buffer_load_dwordx4 a[80:83], v38, s[16:19], s53 offen offset:3072 sc1
    v_mfma_f32_16x16x32_bf16 v[236:239], a[8:11], a[168:171], v[236:239]
    ds_read_b64_tr_b16 a[6:7], v16 offset:4608
    v_mfma_f32_16x16x32_bf16 v[244:247], a[12:15], a[168:171], v[244:247]
    ds_read_b64_tr_b16 a[8:9], v17 offset:3072
    v_mfma_f32_16x16x32_bf16 v[240:243], a[12:15], a[164:167], v[240:243]
    ds_read_b64_tr_b16 a[10:11], v17 offset:4608
    v_mfma_f32_16x16x32_bf16 v[248:251], a[16:19], a[164:167], v[248:251]
    ds_read_b64_tr_b16 a[12:13], v18 offset:3072
    v_mfma_f32_16x16x32_bf16 v[252:255], a[16:19], a[168:171], v[252:255]
    ds_read_b64_tr_b16 a[14:15], v18 offset:4608
    v_mfma_f32_16x16x32_bf16 v[140:143], a[20:23], a[176:179], v[140:143]
    ds_read_b64_tr_b16 a[16:17], v19 offset:3072
    v_mfma_f32_16x16x32_bf16 v[136:139], a[20:23], a[172:175], v[136:139]
    ds_read_b64_tr_b16 a[18:19], v19 offset:4608
    s_waitcnt vmcnt(10) lgkmcnt(4)
    v_mfma_f32_16x16x32_bf16 v[144:147], a[24:27], a[172:175], v[144:147]
    ds_read_b64_tr_b16 a[20:21], v24 offset:3072
    v_mfma_f32_16x16x32_bf16 v[148:151], a[24:27], a[176:179], v[148:151]
    ds_read_b64_tr_b16 a[22:23], v24 offset:4608
    v_mfma_f32_16x16x32_bf16 v[156:159], a[0:3], a[176:179], v[156:159]
    ds_read_b64_tr_b16 a[24:25], v25 offset:3072
    v_mfma_f32_16x16x32_bf16 v[152:155], a[0:3], a[172:175], v[152:155]
    ds_read_b64_tr_b16 a[26:27], v25 offset:4608
    s_barrier
    v_mfma_f32_16x16x32_bf16 v[208:211], a[4:7], a[172:175], v[208:211]
    ds_read_b64_tr_b16 a[0:1], v35 offset:6144
    v_mfma_f32_16x16x32_bf16 v[212:215], a[4:7], a[176:179], v[212:215]
    ds_read_b64_tr_b16 a[2:3], v35 offset:7680
    v_mfma_f32_16x16x32_bf16 v[220:223], a[8:11], a[176:179], v[220:223]
    ds_read_b64_tr_b16 a[4:5], v36 offset:6144
    v_mfma_f32_16x16x32_bf16 v[216:219], a[8:11], a[172:175], v[216:219]
    ds_read_b64_tr_b16 a[6:7], v36 offset:7680
    s_waitcnt lgkmcnt(4)
    v_mfma_f32_16x16x32_bf16 v[224:227], a[12:15], a[172:175], v[224:227]
    ds_read_b64_tr_b16 a[8:9], v37 offset:6144
    v_mfma_f32_16x16x32_bf16 v[228:231], a[12:15], a[176:179], v[228:231]
    ds_read_b64_tr_b16 a[10:11], v37 offset:7680
    v_mfma_f32_16x16x32_bf16 v[236:239], a[16:19], a[176:179], v[236:239]
    ds_read_b64_tr_b16 a[12:13], v35 offset:9216
    v_mfma_f32_16x16x32_bf16 v[232:235], a[16:19], a[172:175], v[232:235]
    ds_read_b64_tr_b16 a[14:15], v35 offset:10752
    v_mfma_f32_16x16x32_bf16 v[240:243], a[20:23], a[172:175], v[240:243]
    ds_read_b64_tr_b16 a[16:17], v36 offset:9216
    v_mfma_f32_16x16x32_bf16 v[244:247], a[20:23], a[176:179], v[244:247]
    ds_read_b64_tr_b16 a[18:19], v36 offset:10752
    v_mfma_f32_16x16x32_bf16 v[252:255], a[24:27], a[176:179], v[252:255]
    ds_read_b64_tr_b16 a[20:21], v37 offset:9216
    v_mfma_f32_16x16x32_bf16 v[248:251], a[24:27], a[172:175], v[248:251]
    ds_read_b64_tr_b16 a[22:23], v37 offset:10752
    s_waitcnt vmcnt(0) lgkmcnt(4)
L_stage33:
    v_mfma_f32_16x16x32_bf16 v[136:139], a[0:3], a[36:39], v[136:139]
    ds_read_b64_tr_b16 a[24:25], v35 offset:12288
    v_mfma_f32_16x16x32_bf16 v[140:143], a[0:3], a[40:43], v[140:143]
    ds_read_b64_tr_b16 a[26:27], v35 offset:13824
    v_mfma_f32_16x16x32_bf16 v[148:151], a[4:7], a[40:43], v[148:151]
    ds_read_b64_tr_b16 a[0:1], v36 offset:12288
    v_mfma_f32_16x16x32_bf16 v[144:147], a[4:7], a[36:39], v[144:147]
    ds_read_b64_tr_b16 a[2:3], v36 offset:13824
    s_add_u32 m0, s36, 36864
    v_mfma_f32_16x16x32_bf16 v[152:155], a[8:11], a[36:39], v[152:155]
    ds_read_b64_tr_b16 a[4:5], v37 offset:12288
    s_add_u32 s32, s55, 4096
    v_mfma_f32_16x16x32_bf16 v[156:159], a[8:11], a[40:43], v[156:159]
    ds_read_b64_tr_b16 a[6:7], v37 offset:13824
    buffer_load_dwordx4 v10, s[4:7], s32 offen offset:0 lds
    v_mfma_f32_16x16x32_bf16 v[140:143], a[12:15], a[48:51], v[140:143]
    ds_read_b64_tr_b16 a[8:9], v35 offset:15360
    v_cmp_ne_u32 vcc, 1, v9
    s_nop 0
    s_cbranch_vccnz L_pp_slow
L_pp_ok:
    v_mfma_f32_16x16x32_bf16 v[136:139], a[12:15], a[44:47], v[136:139]
    ds_read_b64_tr_b16 a[10:11], v35 offset:16896
    s_waitcnt lgkmcnt(4)
    v_mfma_f32_16x16x32_bf16 v[144:147], a[16:19], a[44:47], v[144:147]
    ds_read_b64_tr_b16 a[12:13], v36 offset:15360
    v_mfma_f32_16x16x32_bf16 v[148:151], a[16:19], a[48:51], v[148:151]
    ds_read_b64_tr_b16 a[14:15], v36 offset:16896
    v_mfma_f32_16x16x32_bf16 v[156:159], a[20:23], a[48:51], v[156:159]
    ds_read_b64_tr_b16 a[16:17], v37 offset:15360
    v_mfma_f32_16x16x32_bf16 v[152:155], a[20:23], a[44:47], v[152:155]
    ds_read_b64_tr_b16 a[18:19], v37 offset:16896
    v_mfma_f32_16x16x32_bf16 v[136:139], a[24:27], a[52:55], v[136:139]
    ds_read_b64_tr_b16 a[20:21], v35 offset:18432
    v_mfma_f32_16x16x32_bf16 v[140:143], a[24:27], a[56:59], v[140:143]
    ds_read_b64_tr_b16 a[22:23], v35 offset:19968
    v_mfma_f32_16x16x32_bf16 v[148:151], a[0:3], a[56:59], v[148:151]
    ds_read_b64_tr_b16 a[24:25], v36 offset:18432
    v_mfma_f32_16x16x32_bf16 v[144:147], a[0:3], a[52:55], v[144:147]
    ds_read_b64_tr_b16 a[26:27], v36 offset:19968
    s_waitcnt lgkmcnt(4)
    v_mfma_f32_16x16x32_bf16 v[152:155], a[4:7], a[52:55], v[152:155]
    ds_read_b64_tr_b16 a[0:1], v37 offset:18432
    v_mfma_f32_16x16x32_bf16 v[156:159], a[4:7], a[56:59], v[156:159]
    ds_read_b64_tr_b16 a[2:3], v37 offset:19968
    buffer_load_dwordx4 v11, s[4:7], s32 offen offset:1024 lds
    v_mfma_f32_16x16x32_bf16 v[140:143], a[8:11], a[64:67], v[140:143]
    ds_read_b64_tr_b16 a[4:5], v35 offset:21504
    v_mfma_f32_16x16x32_bf16 v[136:139], a[8:11], a[60:63], v[136:139]
    ds_read_b64_tr_b16 a[6:7], v35 offset:23040
    s_nop 0
    v_mfma_f32_16x16x32_bf16 v[144:147], a[12:15], a[60:63], v[144:147]
    ds_read_b64_tr_b16 a[8:9], v36 offset:21504
    v_mfma_f32_16x16x32_bf16 v[148:151], a[12:15], a[64:67], v[148:151]
    ds_read_b64_tr_b16 a[10:11], v36 offset:23040
    v_mfma_f32_16x16x32_bf16 v[156:159], a[16:19], a[64:67], v[156:159]
    ds_read_b64_tr_b16 a[12:13], v37 offset:21504
    v_mfma_f32_16x16x32_bf16 v[152:155], a[16:19], a[60:63], v[152:155]
    ds_read_b64_tr_b16 a[14:15], v37 offset:23040
    s_waitcnt lgkmcnt(4)
    v_mfma_f32_16x16x32_bf16 v[136:139], a[20:23], a[68:71], v[136:139]
    ds_read_b64_tr_b16 a[16:17], v16 offset:6144
    v_mfma_f32_16x16x32_bf16 v[140:143], a[20:23], a[72:75], v[140:143]
    ds_read_b64_tr_b16 a[18:19], v16 offset:7680
    v_mfma_f32_16x16x32_bf16 v[148:151], a[24:27], a[72:75], v[148:151]
    ds_read_b64_tr_b16 a[20:21], v17 offset:6144
    v_mfma_f32_16x16x32_bf16 v[144:147], a[24:27], a[68:71], v[144:147]
    ds_read_b64_tr_b16 a[22:23], v17 offset:7680
    v_mfma_f32_16x16x32_bf16 v[152:155], a[0:3], a[68:71], v[152:155]
    ds_read_b64_tr_b16 a[24:25], v18 offset:6144
    buffer_load_dwordx4 v12, s[4:7], s32 offen offset:2048 lds
    v_mfma_f32_16x16x32_bf16 v[156:159], a[0:3], a[72:75], v[156:159]
    ds_read_b64_tr_b16 a[26:27], v18 offset:7680
    v_mfma_f32_16x16x32_bf16 v[140:143], a[4:7], a[80:83], v[140:143]
    ds_read_b64_tr_b16 a[0:1], v16 offset:9216
    v_mfma_f32_16x16x32_bf16 v[136:139], a[4:7], a[76:79], v[136:139]
    ds_read_b64_tr_b16 a[2:3], v16 offset:10752
    s_waitcnt lgkmcnt(4)
    v_mfma_f32_16x16x32_bf16 v[144:147], a[8:11], a[76:79], v[144:147]
    ds_read_b64_tr_b16 a[4:5], v17 offset:9216
    v_mfma_f32_16x16x32_bf16 v[148:151], a[8:11], a[80:83], v[148:151]
    ds_read_b64_tr_b16 a[6:7], v17 offset:10752
    v_mfma_f32_16x16x32_bf16 v[156:159], a[12:15], a[80:83], v[156:159]
    ds_read_b64_tr_b16 a[8:9], v18 offset:9216
    v_mfma_f32_16x16x32_bf16 v[152:155], a[12:15], a[76:79], v[152:155]
    ds_read_b64_tr_b16 a[10:11], v18 offset:10752
L_stage34:
    v_mfma_f32_16x16x32_bf16 v[208:211], a[16:19], a[36:39], v[208:211]
    ds_read_b64_tr_b16 a[12:13], v16 offset:12288
    v_mfma_f32_16x16x32_bf16 v[212:215], a[16:19], a[40:43], v[212:215]
    ds_read_b64_tr_b16 a[14:15], v16 offset:13824
    s_xor_b32 s60, s31, 1
    s_mul_i32 s60, s60, 49152
    v_mfma_f32_16x16x32_bf16 v[220:223], a[20:23], a[40:43], v[220:223]
    ds_read_b64_tr_b16 a[16:17], v17 offset:12288
    s_add_u32 s60, s60, s49
    v_mfma_f32_16x16x32_bf16 v[216:219], a[20:23], a[36:39], v[216:219]
    ds_read_b64_tr_b16 a[18:19], v17 offset:13824
    s_waitcnt lgkmcnt(4)
    v_mfma_f32_16x16x32_bf16 v[224:227], a[24:27], a[36:39], v[224:227]
    ds_read_b64_tr_b16 a[20:21], v18 offset:12288
    v_cvt_pk_bf16_f32 v136, v136, v137
    v_mfma_f32_16x16x32_bf16 v[228:231], a[24:27], a[40:43], v[228:231]
    ds_read_b64_tr_b16 a[22:23], v18 offset:13824
    v_cvt_pk_bf16_f32 v137, v138, v139
    v_mfma_f32_16x16x32_bf16 v[212:215], a[0:3], a[48:51], v[212:215]
    ds_read_b64_tr_b16 a[24:25], v16 offset:15360
    v_cvt_pk_bf16_f32 v138, v140, v141
    v_mfma_f32_16x16x32_bf16 v[208:211], a[0:3], a[44:47], v[208:211]
    ds_read_b64_tr_b16 a[26:27], v16 offset:16896
    v_cvt_pk_bf16_f32 v139, v142, v143
    v_mfma_f32_16x16x32_bf16 v[216:219], a[4:7], a[44:47], v[216:219]
    ds_read_b64_tr_b16 a[0:1], v17 offset:15360
    buffer_store_dwordx4 v[136:139], v38, s[16:19], s60 offen offset:0 sc1
    v_mfma_f32_16x16x32_bf16 v[220:223], a[4:7], a[48:51], v[220:223]
    ds_read_b64_tr_b16 a[2:3], v17 offset:16896
    v_cvt_pk_bf16_f32 v144, v144, v145
    v_mfma_f32_16x16x32_bf16 v[228:231], a[8:11], a[48:51], v[228:231]
    ds_read_b64_tr_b16 a[4:5], v18 offset:15360
    v_cvt_pk_bf16_f32 v145, v146, v147
    v_cvt_pk_bf16_f32 v146, v148, v149
    v_mfma_f32_16x16x32_bf16 v[224:227], a[8:11], a[44:47], v[224:227]
    ds_read_b64_tr_b16 a[6:7], v18 offset:16896
    s_waitcnt lgkmcnt(4)
    v_mfma_f32_16x16x32_bf16 v[208:211], a[12:15], a[52:55], v[208:211]
    ds_read_b64_tr_b16 a[8:9], v16 offset:18432
    v_cvt_pk_bf16_f32 v147, v150, v151
    v_mfma_f32_16x16x32_bf16 v[212:215], a[12:15], a[56:59], v[212:215]
    ds_read_b64_tr_b16 a[10:11], v16 offset:19968
    buffer_store_dwordx4 v[144:147], v38, s[16:19], s60 offen offset:1024 sc1
    v_mfma_f32_16x16x32_bf16 v[220:223], a[16:19], a[56:59], v[220:223]
    ds_read_b64_tr_b16 a[12:13], v17 offset:18432
    v_cvt_pk_bf16_f32 v152, v152, v153
    v_mfma_f32_16x16x32_bf16 v[216:219], a[16:19], a[52:55], v[216:219]
    ds_read_b64_tr_b16 a[14:15], v17 offset:19968
    v_cvt_pk_bf16_f32 v153, v154, v155
    v_mfma_f32_16x16x32_bf16 v[224:227], a[20:23], a[52:55], v[224:227]
    ds_read_b64_tr_b16 a[16:17], v18 offset:18432
    v_cvt_pk_bf16_f32 v154, v156, v157
    v_mfma_f32_16x16x32_bf16 v[228:231], a[20:23], a[56:59], v[228:231]
    ds_read_b64_tr_b16 a[18:19], v18 offset:19968
    v_cvt_pk_bf16_f32 v155, v158, v159
    v_mfma_f32_16x16x32_bf16 v[212:215], a[24:27], a[64:67], v[212:215]
    ds_read_b64_tr_b16 a[20:21], v16 offset:21504
    buffer_store_dwordx4 v[152:155], v38, s[16:19], s60 offen offset:2048 sc1
    v_mfma_f32_16x16x32_bf16 v[208:211], a[24:27], a[60:63], v[208:211]
    ds_read_b64_tr_b16 a[22:23], v16 offset:23040
    s_waitcnt lgkmcnt(4)
    v_mfma_f32_16x16x32_bf16 v[216:219], a[0:3], a[60:63], v[216:219]
    ds_read_b64_tr_b16 a[24:25], v17 offset:21504
    v_mfma_f32_16x16x32_bf16 v[220:223], a[0:3], a[64:67], v[220:223]
    ds_read_b64_tr_b16 a[26:27], v17 offset:23040
    v_mfma_f32_16x16x32_bf16 v[228:231], a[4:7], a[64:67], v[228:231]
    ds_read_b64_tr_b16 a[0:1], v18 offset:21504
    v_mfma_f32_16x16x32_bf16 v[224:227], a[4:7], a[60:63], v[224:227]
    ds_read_b64_tr_b16 a[2:3], v18 offset:23040
    v_mfma_f32_16x16x32_bf16 v[208:211], a[8:11], a[68:71], v[208:211]
    ds_read_b64_tr_b16 a[4:5], v19 offset:6144
    v_mfma_f32_16x16x32_bf16 v[212:215], a[8:11], a[72:75], v[212:215]
    ds_read_b64_tr_b16 a[6:7], v19 offset:7680
    v_mfma_f32_16x16x32_bf16 v[220:223], a[12:15], a[72:75], v[220:223]
    ds_read_b64_tr_b16 a[8:9], v24 offset:6144
    v_mfma_f32_16x16x32_bf16 v[216:219], a[12:15], a[68:71], v[216:219]
    ds_read_b64_tr_b16 a[10:11], v24 offset:7680
    s_waitcnt lgkmcnt(4)
    v_mfma_f32_16x16x32_bf16 v[224:227], a[16:19], a[68:71], v[224:227]
    ds_read_b64_tr_b16 a[12:13], v25 offset:6144
    v_mfma_f32_16x16x32_bf16 v[228:231], a[16:19], a[72:75], v[228:231]
    ds_read_b64_tr_b16 a[14:15], v25 offset:7680
    v_mfma_f32_16x16x32_bf16 v[212:215], a[20:23], a[80:83], v[212:215]
    ds_read_b64_tr_b16 a[16:17], v19 offset:9216
    v_mfma_f32_16x16x32_bf16 v[208:211], a[20:23], a[76:79], v[208:211]
    ds_read_b64_tr_b16 a[18:19], v19 offset:10752
    v_mfma_f32_16x16x32_bf16 v[216:219], a[24:27], a[76:79], v[216:219]
    ds_read_b64_tr_b16 a[20:21], v24 offset:9216
    v_mfma_f32_16x16x32_bf16 v[220:223], a[24:27], a[80:83], v[220:223]
    ds_read_b64_tr_b16 a[22:23], v24 offset:10752
    v_mfma_f32_16x16x32_bf16 v[228:231], a[0:3], a[80:83], v[228:231]
    ds_read_b64_tr_b16 a[24:25], v25 offset:9216
    v_mfma_f32_16x16x32_bf16 v[224:227], a[0:3], a[76:79], v[224:227]
    ds_read_b64_tr_b16 a[26:27], v25 offset:10752
    s_waitcnt lgkmcnt(4)
L_stage35:
    v_mfma_f32_16x16x32_bf16 v[232:235], a[4:7], a[36:39], v[232:235]
    ds_read_b64_tr_b16 a[0:1], v19 offset:12288
    s_waitcnt vmcnt(3)
    v_mfma_f32_16x16x32_bf16 v[236:239], a[4:7], a[40:43], v[236:239]
    ds_read_b64_tr_b16 a[2:3], v19 offset:13824
    s_xor_b32 s60, s31, 2
    s_mul_i32 s60, s60, 49152
    v_mfma_f32_16x16x32_bf16 v[244:247], a[8:11], a[40:43], v[244:247]
    ds_read_b64_tr_b16 a[4:5], v24 offset:12288
    s_add_u32 s60, s60, s49
    v_mfma_f32_16x16x32_bf16 v[240:243], a[8:11], a[36:39], v[240:243]
    ds_read_b64_tr_b16 a[6:7], v24 offset:13824
    v_cvt_pk_bf16_f32 v208, v208, v209
    v_mfma_f32_16x16x32_bf16 v[248:251], a[12:15], a[36:39], v[248:251]
    ds_read_b64_tr_b16 a[8:9], v25 offset:12288
    v_cvt_pk_bf16_f32 v209, v210, v211
    v_mfma_f32_16x16x32_bf16 v[252:255], a[12:15], a[40:43], v[252:255]
    ds_read_b64_tr_b16 a[10:11], v25 offset:13824
    v_cvt_pk_bf16_f32 v210, v212, v213
    v_cvt_pk_bf16_f32 v211, v214, v215
    v_mfma_f32_16x16x32_bf16 v[236:239], a[16:19], a[48:51], v[236:239]
    ds_read_b64_tr_b16 a[12:13], v19 offset:15360
    ds_read_b64 v[160:161], v13 offset:0
    v_mfma_f32_16x16x32_bf16 v[232:235], a[16:19], a[44:47], v[232:235]
    ds_read_b64_tr_b16 a[14:15], v19 offset:16896
    s_waitcnt lgkmcnt(5)
    v_mfma_f32_16x16x32_bf16 v[240:243], a[20:23], a[44:47], v[240:243]
    ds_read_b64_tr_b16 a[16:17], v24 offset:15360
    buffer_store_dwordx4 v[208:211], v38, s[16:19], s60 offen offset:0 sc1
    v_mfma_f32_16x16x32_bf16 v[244:247], a[20:23], a[48:51], v[244:247]
    ds_read_b64_tr_b16 a[18:19], v24 offset:16896
    v_cvt_pk_bf16_f32 v216, v216, v217
    v_mfma_f32_16x16x32_bf16 v[252:255], a[24:27], a[48:51], v[252:255]
    ds_read_b64_tr_b16 a[20:21], v25 offset:15360
    v_cvt_pk_bf16_f32 v217, v218, v219
    v_cvt_pk_bf16_f32 v218, v220, v221
    v_mfma_f32_16x16x32_bf16 v[248:251], a[24:27], a[44:47], v[248:251]
    ds_read_b64_tr_b16 a[22:23], v25 offset:16896
    v_cvt_pk_bf16_f32 v219, v222, v223
    v_mfma_f32_16x16x32_bf16 v[232:235], a[0:3], a[52:55], v[232:235]
    ds_read_b64_tr_b16 a[24:25], v19 offset:18432
    buffer_store_dwordx4 v[216:219], v38, s[16:19], s60 offen offset:1024 sc1
    v_mfma_f32_16x16x32_bf16 v[236:239], a[0:3], a[56:59], v[236:239]
    ds_read_b64_tr_b16 a[26:27], v19 offset:19968
    ds_read_b64 v[162:163], v13 offset:1536
    v_mfma_f32_16x16x32_bf16 v[244:247], a[4:7], a[56:59], v[244:247]
    ds_read_b64_tr_b16 a[0:1], v24 offset:18432
    v_cvt_pk_bf16_f32 v224, v224, v225
    v_cvt_pk_bf16_f32 v225, v226, v227
    v_mfma_f32_16x16x32_bf16 v[240:243], a[4:7], a[52:55], v[240:243]
    ds_read_b64_tr_b16 a[2:3], v24 offset:19968
    s_waitcnt lgkmcnt(5)
    v_mfma_f32_16x16x32_bf16 v[248:251], a[8:11], a[52:55], v[248:251]
    ds_read_b64_tr_b16 a[4:5], v25 offset:18432
    v_cvt_pk_bf16_f32 v226, v228, v229
    v_mfma_f32_16x16x32_bf16 v[252:255], a[8:11], a[56:59], v[252:255]
    ds_read_b64_tr_b16 a[6:7], v25 offset:19968
    v_cvt_pk_bf16_f32 v227, v230, v231
    v_mfma_f32_16x16x32_bf16 v[236:239], a[12:15], a[64:67], v[236:239]
    ds_read_b64_tr_b16 a[8:9], v19 offset:21504
    buffer_store_dwordx4 v[224:227], v38, s[16:19], s60 offen offset:2048 sc1
    v_mfma_f32_16x16x32_bf16 v[232:235], a[12:15], a[60:63], v[232:235]
    ds_read_b64_tr_b16 a[10:11], v19 offset:23040
    v_mfma_f32_16x16x32_bf16 v[240:243], a[16:19], a[60:63], v[240:243]
    ds_read_b64_tr_b16 a[12:13], v24 offset:21504
    ds_read_b64 v[164:165], v13 offset:32
    v_mfma_f32_16x16x32_bf16 v[244:247], a[16:19], a[64:67], v[244:247]
    ds_read_b64_tr_b16 a[14:15], v24 offset:23040
    v_mfma_f32_16x16x32_bf16 v[252:255], a[20:23], a[64:67], v[252:255]
    ds_read_b64_tr_b16 a[16:17], v25 offset:21504
    v_mfma_f32_16x16x32_bf16 v[248:251], a[20:23], a[60:63], v[248:251]
    ds_read_b64_tr_b16 a[18:19], v25 offset:23040
    s_waitcnt lgkmcnt(5)
    v_mfma_f32_16x16x32_bf16 v[232:235], a[24:27], a[68:71], v[232:235]
    v_mfma_f32_16x16x32_bf16 v[236:239], a[24:27], a[72:75], v[236:239]
    v_mfma_f32_16x16x32_bf16 v[244:247], a[0:3], a[72:75], v[244:247]
    ds_read_b64 v[166:167], v13 offset:1568
    v_mfma_f32_16x16x32_bf16 v[240:243], a[0:3], a[68:71], v[240:243]
    v_mfma_f32_16x16x32_bf16 v[248:251], a[4:7], a[68:71], v[248:251]
    v_mfma_f32_16x16x32_bf16 v[252:255], a[4:7], a[72:75], v[252:255]
    ds_read_b64 v[168:169], v13 offset:64
    v_mfma_f32_16x16x32_bf16 v[236:239], a[8:11], a[80:83], v[236:239]
    v_mfma_f32_16x16x32_bf16 v[232:235], a[8:11], a[76:79], v[232:235]
    s_waitcnt lgkmcnt(2)
    v_mfma_f32_16x16x32_bf16 v[240:243], a[12:15], a[76:79], v[240:243]
    ds_read_b64 v[170:171], v13 offset:1600
    v_mfma_f32_16x16x32_bf16 v[244:247], a[12:15], a[80:83], v[244:247]
    v_mfma_f32_16x16x32_bf16 v[252:255], a[16:19], a[80:83], v[252:255]
    v_mfma_f32_16x16x32_bf16 v[248:251], a[16:19], a[76:79], v[248:251]
L_stage36:
    v_mfma_f32_16x16x32_bf16 v[112:115], a[180:183], a[84:87], v[112:115]
    s_waitcnt lgkmcnt(0)
    v_mfma_f32_16x16x32_bf16 v[116:119], a[180:183], a[88:91], v[116:119]
    v_lshlrev_b32 v184, 16, v160
    s_xor_b32 s60, s31, 3
    s_mul_i32 s60, s60, 49152
    v_mfma_f32_16x16x32_bf16 v[124:127], a[184:187], a[88:91], v[124:127]
    v_and_b32 v185, s58, v160
    s_add_u32 s60, s60, s49
    v_mfma_f32_16x16x32_bf16 v[120:123], a[184:187], a[84:87], v[120:123]
    v_lshlrev_b32 v186, 16, v161
    v_mfma_f32_16x16x32_bf16 v[128:131], a[188:191], a[84:87], v[128:131]
    v_and_b32 v187, s58, v161
    v_cvt_pk_bf16_f32 v232, v232, v233
    v_mfma_f32_16x16x32_bf16 v[132:135], a[188:191], a[88:91], v[132:135]
    v_lshlrev_b32 v188, 16, v162
    v_cvt_pk_bf16_f32 v233, v234, v235
    v_mfma_f32_16x16x32_bf16 v[116:119], a[192:195], a[96:99], v[116:119]
    v_and_b32 v189, s58, v162
    v_cvt_pk_bf16_f32 v234, v236, v237
    v_mfma_f32_16x16x32_bf16 v[112:115], a[192:195], a[92:95], v[112:115]
    v_lshlrev_b32 v190, 16, v163
    v_cvt_pk_bf16_f32 v235, v238, v239
    v_mfma_f32_16x16x32_bf16 v[120:123], a[196:199], a[92:95], v[120:123]
    v_and_b32 v191, s58, v163
    buffer_store_dwordx4 v[232:235], v38, s[16:19], s60 offen offset:0 sc1
    v_mfma_f32_16x16x32_bf16 v[124:127], a[196:199], a[96:99], v[124:127]
    v_lshlrev_b32 v192, 16, v164
    v_cvt_pk_bf16_f32 v240, v240, v241
    v_mfma_f32_16x16x32_bf16 v[132:135], a[200:203], a[96:99], v[132:135]
    v_and_b32 v193, s58, v164
    v_cvt_pk_bf16_f32 v241, v242, v243
    v_mfma_f32_16x16x32_bf16 v[128:131], a[200:203], a[92:95], v[128:131]
    v_cvt_pk_bf16_f32 v242, v244, v245
    v_mfma_f32_16x16x32_bf16 v[112:115], a[204:207], a[100:103], v[112:115]
    v_lshlrev_b32 v194, 16, v165
    v_cvt_pk_bf16_f32 v243, v246, v247
    v_mfma_f32_16x16x32_bf16 v[116:119], a[204:207], a[104:107], v[116:119]
    v_and_b32 v195, s58, v165
    buffer_store_dwordx4 v[240:243], v38, s[16:19], s60 offen offset:1024 sc1
    v_mfma_f32_16x16x32_bf16 v[124:127], a[208:211], a[104:107], v[124:127]
    v_lshlrev_b32 v196, 16, v166
    v_cvt_pk_bf16_f32 v248, v248, v249
    v_mfma_f32_16x16x32_bf16 v[120:123], a[208:211], a[100:103], v[120:123]
    v_and_b32 v197, s58, v166
    v_cvt_pk_bf16_f32 v249, v250, v251
    v_mfma_f32_16x16x32_bf16 v[128:131], a[212:215], a[100:103], v[128:131]
    v_lshlrev_b32 v198, 16, v167
    v_cvt_pk_bf16_f32 v250, v252, v253
    v_mfma_f32_16x16x32_bf16 v[132:135], a[212:215], a[104:107], v[132:135]
    v_and_b32 v199, s58, v167
    v_cvt_pk_bf16_f32 v251, v254, v255
    v_mfma_f32_16x16x32_bf16 v[116:119], a[216:219], a[112:115], v[116:119]
    v_lshlrev_b32 v200, 16, v168
    buffer_store_dwordx4 v[248:251], v38, s[16:19], s60 offen offset:2048 sc1
    v_mfma_f32_16x16x32_bf16 v[112:115], a[216:219], a[108:111], v[112:115]
    v_and_b32 v201, s58, v168
    v_mfma_f32_16x16x32_bf16 v[120:123], a[220:223], a[108:111], v[120:123]
    v_lshlrev_b32 v202, 16, v169
    v_mfma_f32_16x16x32_bf16 v[124:127], a[220:223], a[112:115], v[124:127]
    v_and_b32 v203, s58, v169
    v_mfma_f32_16x16x32_bf16 v[132:135], a[224:227], a[112:115], v[132:135]
    v_lshlrev_b32 v204, 16, v170
    v_mfma_f32_16x16x32_bf16 v[128:131], a[224:227], a[108:111], v[128:131]
    v_and_b32 v205, s58, v170
    s_add_u32 s52, s62, 0
    v_mfma_f32_16x16x32_bf16 v[112:115], a[228:231], a[116:119], v[112:115]
    ds_read_b64_tr_b16 a[8:9], v32 offset:24576
    buffer_load_dwordx2 v[100:101], v15, s[16:19], s52 offen offset:0 sc1
    v_mfma_f32_16x16x32_bf16 v[116:119], a[228:231], a[120:123], v[116:119]
    ds_read_b64_tr_b16 a[10:11], v32 offset:26112
    v_lshlrev_b32 v206, 16, v171
    v_mfma_f32_16x16x32_bf16 v[124:127], a[232:235], a[120:123], v[124:127]
    ds_read_b64_tr_b16 a[12:13], v33 offset:24576
    v_mfma_f32_16x16x32_bf16 v[120:123], a[232:235], a[116:119], v[120:123]
    ds_read_b64_tr_b16 a[14:15], v33 offset:26112
    v_mfma_f32_16x16x32_bf16 v[128:131], a[236:239], a[116:119], v[128:131]
    ds_read_b64_tr_b16 a[16:17], v34 offset:24576
    v_and_b32 v207, s58, v171
    v_mfma_f32_16x16x32_bf16 v[132:135], a[236:239], a[120:123], v[132:135]
    ds_read_b64_tr_b16 a[18:19], v34 offset:26112
    v_mfma_f32_16x16x32_bf16 v[116:119], a[240:243], a[128:131], v[116:119]
    ds_read_b64_tr_b16 a[20:21], v32 offset:27648
    s_mov_b32 s56, 0x00003f80
    v_mfma_f32_16x16x32_bf16 v[112:115], a[240:243], a[124:127], v[112:115]
    ds_read_b64_tr_b16 a[22:23], v32 offset:29184
    v_mfma_f32_16x16x32_bf16 v[120:123], a[244:247], a[124:127], v[120:123]
    ds_read_b64_tr_b16 a[24:25], v33 offset:27648
    s_mov_b32 s57, 0x3f800000
    v_mfma_f32_16x16x32_bf16 v[124:127], a[244:247], a[128:131], v[124:127]
    ds_read_b64_tr_b16 a[26:27], v33 offset:29184
    v_mfma_f32_16x16x32_bf16 v[132:135], a[248:251], a[128:131], v[132:135]
    ds_read_b64_tr_b16 a[0:1], v34 offset:27648
    buffer_load_dwordx2 v[102:103], v15, s[16:19], s52 offen offset:128 sc1
    v_mfma_f32_16x16x32_bf16 v[128:131], a[248:251], a[124:127], v[128:131]
    ds_read_b64_tr_b16 a[2:3], v34 offset:29184
    s_waitcnt lgkmcnt(4)
    v_mfma_f32_16x16x32_bf16 v[112:115], a[8:11], a[132:135], v[112:115]
    ds_read_b64_tr_b16 a[4:5], v32 offset:30720
    v_mfma_f32_16x16x32_bf16 v[116:119], a[8:11], a[136:139], v[116:119]
    ds_read_b64_tr_b16 a[6:7], v32 offset:32256
    s_add_u32 s52, s62, 65536
    v_mfma_f32_16x16x32_bf16 v[124:127], a[12:15], a[136:139], v[124:127]
    ds_read_b64_tr_b16 a[8:9], v33 offset:30720
    v_mfma_f32_16x16x32_bf16 v[120:123], a[12:15], a[132:135], v[120:123]
    ds_read_b64_tr_b16 a[10:11], v33 offset:32256
    v_mfma_f32_16x16x32_bf16 v[128:131], a[16:19], a[132:135], v[128:131]
    ds_read_b64_tr_b16 a[12:13], v34 offset:30720
    buffer_load_dwordx2 v[104:105], v15, s[16:19], s52 offen offset:0 sc1
    v_mfma_f32_16x16x32_bf16 v[132:135], a[16:19], a[136:139], v[132:135]
    ds_read_b64_tr_b16 a[14:15], v34 offset:32256
    v_mfma_f32_16x16x32_bf16 v[116:119], a[20:23], a[144:147], v[116:119]
    ds_read_b64_tr_b16 a[16:17], v32 offset:33792
    v_mfma_f32_16x16x32_bf16 v[112:115], a[20:23], a[140:143], v[112:115]
    ds_read_b64_tr_b16 a[18:19], v32 offset:35328
    s_waitcnt lgkmcnt(4)
    v_mfma_f32_16x16x32_bf16 v[120:123], a[24:27], a[140:143], v[120:123]
    ds_read_b64_tr_b16 a[20:21], v33 offset:33792
    v_mfma_f32_16x16x32_bf16 v[124:127], a[24:27], a[144:147], v[124:127]
    ds_read_b64_tr_b16 a[22:23], v33 offset:35328
    v_mfma_f32_16x16x32_bf16 v[132:135], a[0:3], a[144:147], v[132:135]
    ds_read_b64_tr_b16 a[24:25], v34 offset:33792
    buffer_load_dwordx2 v[106:107], v15, s[16:19], s52 offen offset:128 sc1
    v_mfma_f32_16x16x32_bf16 v[128:131], a[0:3], a[140:143], v[128:131]
    ds_read_b64_tr_b16 a[26:27], v34 offset:35328
    v_mfma_f32_16x16x32_bf16 v[112:115], a[4:7], a[148:151], v[112:115]
    ds_read_b64_tr_b16 a[0:1], v32 offset:0
    v_mfma_f32_16x16x32_bf16 v[116:119], a[4:7], a[152:155], v[116:119]
    ds_read_b64_tr_b16 a[2:3], v32 offset:1536
    v_mfma_f32_16x16x32_bf16 v[124:127], a[8:11], a[152:155], v[124:127]
    ds_read_b64_tr_b16 a[4:5], v33 offset:0
    v_mfma_f32_16x16x32_bf16 v[120:123], a[8:11], a[148:151], v[120:123]
    ds_read_b64_tr_b16 a[6:7], v33 offset:1536
    s_waitcnt lgkmcnt(4)
    v_mfma_f32_16x16x32_bf16 v[128:131], a[12:15], a[148:151], v[128:131]
    ds_read_b64_tr_b16 a[8:9], v34 offset:0
    v_mfma_f32_16x16x32_bf16 v[132:135], a[12:15], a[152:155], v[132:135]
    ds_read_b64_tr_b16 a[10:11], v34 offset:1536
    v_mfma_f32_16x16x32_bf16 v[116:119], a[16:19], a[160:163], v[116:119]
    ds_read_b64_tr_b16 a[12:13], v32 offset:3072
    v_mfma_f32_16x16x32_bf16 v[112:115], a[16:19], a[156:159], v[112:115]
    ds_read_b64_tr_b16 a[14:15], v32 offset:4608
    v_mfma_f32_16x16x32_bf16 v[120:123], a[20:23], a[156:159], v[120:123]
    ds_read_b64_tr_b16 a[16:17], v33 offset:3072
    v_mfma_f32_16x16x32_bf16 v[124:127], a[20:23], a[160:163], v[124:127]
    ds_read_b64_tr_b16 a[18:19], v33 offset:4608
    v_mfma_f32_16x16x32_bf16 v[132:135], a[24:27], a[160:163], v[132:135]
    ds_read_b64_tr_b16 a[20:21], v34 offset:3072
    v_mfma_f32_16x16x32_bf16 v[128:131], a[24:27], a[156:159], v[128:131]
    ds_read_b64_tr_b16 a[22:23], v34 offset:4608
    s_waitcnt lgkmcnt(4)
    v_mfma_f32_16x16x32_bf16 v[112:115], a[0:3], a[164:167], v[112:115]
    ds_read_b64_tr_b16 a[24:25], v32 offset:6144
    v_mfma_f32_16x16x32_bf16 v[116:119], a[0:3], a[168:171], v[116:119]
    ds_read_b64_tr_b16 a[26:27], v32 offset:7680
    v_mfma_f32_16x16x32_bf16 v[124:127], a[4:7], a[168:171], v[124:127]
    ds_read_b64_tr_b16 a[0:1], v33 offset:6144
    v_mfma_f32_16x16x32_bf16 v[120:123], a[4:7], a[164:167], v[120:123]
    ds_read_b64_tr_b16 a[2:3], v33 offset:7680
    v_mfma_f32_16x16x32_bf16 v[128:131], a[8:11], a[164:167], v[128:131]
    ds_read_b64_tr_b16 a[4:5], v34 offset:6144
    v_mfma_f32_16x16x32_bf16 v[132:135], a[8:11], a[168:171], v[132:135]
    ds_read_b64_tr_b16 a[6:7], v34 offset:7680
    v_mfma_f32_16x16x32_bf16 v[116:119], a[12:15], a[176:179], v[116:119]
    ds_read_b64_tr_b16 a[8:9], v32 offset:9216
    v_mfma_f32_16x16x32_bf16 v[112:115], a[12:15], a[172:175], v[112:115]
    ds_read_b64_tr_b16 a[10:11], v32 offset:10752
    s_waitcnt lgkmcnt(4)
    v_mfma_f32_16x16x32_bf16 v[120:123], a[16:19], a[172:175], v[120:123]
    ds_read_b64_tr_b16 a[12:13], v33 offset:9216
    v_mfma_f32_16x16x32_bf16 v[124:127], a[16:19], a[176:179], v[124:127]
    ds_read_b64_tr_b16 a[14:15], v33 offset:10752
    v_mfma_f32_16x16x32_bf16 v[132:135], a[20:23], a[176:179], v[132:135]
    ds_read_b64_tr_b16 a[16:17], v34 offset:9216
    v_mfma_f32_16x16x32_bf16 v[128:131], a[20:23], a[172:175], v[128:131]
    ds_read_b64_tr_b16 a[18:19], v34 offset:10752
    v_mfma_f32_16x16x32_bf16 v[112:115], a[24:27], a[36:39], v[112:115]
    ds_read_b64_tr_b16 a[20:21], v32 offset:12288
    v_mfma_f32_16x16x32_bf16 v[116:119], a[24:27], a[40:43], v[116:119]
    ds_read_b64_tr_b16 a[22:23], v32 offset:13824
    v_mfma_f32_16x16x32_bf16 v[124:127], a[0:3], a[40:43], v[124:127]
    ds_read_b64_tr_b16 a[24:25], v33 offset:12288
    v_mfma_f32_16x16x32_bf16 v[120:123], a[0:3], a[36:39], v[120:123]
    ds_read_b64_tr_b16 a[26:27], v33 offset:13824
    s_waitcnt lgkmcnt(4)
    v_mfma_f32_16x16x32_bf16 v[128:131], a[4:7], a[36:39], v[128:131]
    ds_read_b64_tr_b16 a[0:1], v34 offset:12288
    v_mfma_f32_16x16x32_bf16 v[132:135], a[4:7], a[40:43], v[132:135]
    ds_read_b64_tr_b16 a[2:3], v34 offset:13824
    v_mfma_f32_16x16x32_bf16 v[116:119], a[8:11], a[48:51], v[116:119]
    ds_read_b64_tr_b16 a[4:5], v32 offset:15360
    v_mfma_f32_16x16x32_bf16 v[112:115], a[8:11], a[44:47], v[112:115]
    ds_read_b64_tr_b16 a[6:7], v32 offset:16896
    v_mfma_f32_16x16x32_bf16 v[120:123], a[12:15], a[44:47], v[120:123]
    ds_read_b64_tr_b16 a[8:9], v33 offset:15360
    v_mfma_f32_16x16x32_bf16 v[124:127], a[12:15], a[48:51], v[124:127]
    ds_read_b64_tr_b16 a[10:11], v33 offset:16896
    v_mfma_f32_16x16x32_bf16 v[132:135], a[16:19], a[48:51], v[132:135]
    ds_read_b64_tr_b16 a[12:13], v34 offset:15360
    v_mfma_f32_16x16x32_bf16 v[128:131], a[16:19], a[44:47], v[128:131]
    ds_read_b64_tr_b16 a[14:15], v34 offset:16896
    s_waitcnt lgkmcnt(4)
    v_mfma_f32_16x16x32_bf16 v[112:115], a[20:23], a[52:55], v[112:115]
    ds_read_b64_tr_b16 a[16:17], v32 offset:18432
    v_mfma_f32_16x16x32_bf16 v[116:119], a[20:23], a[56:59], v[116:119]
    ds_read_b64_tr_b16 a[18:19], v32 offset:19968
    v_mfma_f32_16x16x32_bf16 v[124:127], a[24:27], a[56:59], v[124:127]
    ds_read_b64_tr_b16 a[20:21], v33 offset:18432
    v_mfma_f32_16x16x32_bf16 v[120:123], a[24:27], a[52:55], v[120:123]
    ds_read_b64_tr_b16 a[22:23], v33 offset:19968
    v_mfma_f32_16x16x32_bf16 v[128:131], a[0:3], a[52:55], v[128:131]
    ds_read_b64_tr_b16 a[24:25], v34 offset:18432
    v_mfma_f32_16x16x32_bf16 v[132:135], a[0:3], a[56:59], v[132:135]
    ds_read_b64_tr_b16 a[26:27], v34 offset:19968
    v_mfma_f32_16x16x32_bf16 v[116:119], a[4:7], a[64:67], v[116:119]
    ds_read_b64_tr_b16 a[0:1], v32 offset:21504
    v_mfma_f32_16x16x32_bf16 v[112:115], a[4:7], a[60:63], v[112:115]
    ds_read_b64_tr_b16 a[2:3], v32 offset:23040
    s_waitcnt lgkmcnt(4)
    v_mfma_f32_16x16x32_bf16 v[120:123], a[8:11], a[60:63], v[120:123]
    ds_read_b64_tr_b16 a[4:5], v33 offset:21504
    s_xor_b32 s52, s31, 1
    v_mfma_f32_16x16x32_bf16 v[124:127], a[8:11], a[64:67], v[124:127]
    ds_read_b64_tr_b16 a[6:7], v33 offset:23040
    s_mul_i32 s52, s52, 12288
    v_mfma_f32_16x16x32_bf16 v[132:135], a[12:15], a[64:67], v[132:135]
    ds_read_b64_tr_b16 a[8:9], v34 offset:21504
    s_add_u32 s52, s52, s63
    v_mfma_f32_16x16x32_bf16 v[128:131], a[12:15], a[60:63], v[128:131]
    ds_read_b64_tr_b16 a[10:11], v34 offset:23040
    buffer_load_dwordx4 v[64:67], v38, s[16:19], s52 offen offset:0 sc1
    v_mfma_f32_16x16x32_bf16 v[112:115], a[16:19], a[68:71], v[112:115]
    buffer_load_dwordx4 v[68:71], v38, s[16:19], s52 offen offset:1024 sc1
    buffer_load_dwordx4 v[72:75], v38, s[16:19], s52 offen offset:2048 sc1
    v_mfma_f32_16x16x32_bf16 v[116:119], a[16:19], a[72:75], v[116:119]
    s_xor_b32 s52, s31, 2
    s_mul_i32 s52, s52, 12288
    v_mfma_f32_16x16x32_bf16 v[124:127], a[20:23], a[72:75], v[124:127]
    s_add_u32 s52, s52, s63
    buffer_load_dwordx4 v[76:79], v38, s[16:19], s52 offen offset:0 sc1
    v_mfma_f32_16x16x32_bf16 v[120:123], a[20:23], a[68:71], v[120:123]
    s_waitcnt lgkmcnt(0)
    buffer_load_dwordx4 v[80:83], v38, s[16:19], s52 offen offset:1024 sc1
    v_mfma_f32_16x16x32_bf16 v[128:131], a[24:27], a[68:71], v[128:131]
    buffer_load_dwordx4 v[84:87], v38, s[16:19], s52 offen offset:2048 sc1
    s_xor_b32 s52, s31, 3
    v_mfma_f32_16x16x32_bf16 v[132:135], a[24:27], a[72:75], v[132:135]
    s_mul_i32 s52, s52, 12288
    s_add_u32 s52, s52, s63
    v_mfma_f32_16x16x32_bf16 v[116:119], a[0:3], a[80:83], v[116:119]
    buffer_load_dwordx4 v[88:91], v38, s[16:19], s52 offen offset:0 sc1
    buffer_load_dwordx4 v[92:95], v38, s[16:19], s52 offen offset:1024 sc1
    v_mfma_f32_16x16x32_bf16 v[112:115], a[0:3], a[76:79], v[112:115]
    buffer_load_dwordx4 v[96:99], v38, s[16:19], s52 offen offset:2048 sc1
    s_add_u32 s52, s62, 131072
    v_mfma_f32_16x16x32_bf16 v[120:123], a[4:7], a[76:79], v[120:123]
    buffer_load_dwordx2 v[108:109], v15, s[16:19], s52 offen offset:0 sc1
    buffer_load_dwordx2 v[110:111], v15, s[16:19], s52 offen offset:128 sc1
    v_mfma_f32_16x16x32_bf16 v[124:127], a[4:7], a[80:83], v[124:127]
    v_mfma_f32_16x16x32_bf16 v[132:135], a[8:11], a[80:83], v[132:135]
    v_mfma_f32_16x16x32_bf16 v[128:131], a[8:11], a[76:79], v[128:131]
    s_waitcnt vmcnt(11)
    v_max3_u32 v6, v100, v101, v102
    v_max3_u32 v6, v6, v103, v104
    v_max3_u32 v6, v6, v105, v106
    v_max_u32 v6, v6, v107
    v_cmp_eq_u32 vcc, -1, v6
    s_nop 0
    s_cbranch_vccnz L_src3_slow
L_src3_ok:
    v_dot2_f32_bf16 v184, v100, s56, v184
    v_dot2_f32_bf16 v185, v100, s57, v185
    v_dot2_f32_bf16 v186, v101, s56, v186
    v_dot2_f32_bf16 v187, v101, s57, v187
    v_dot2_f32_bf16 v188, v102, s56, v188
    v_dot2_f32_bf16 v189, v102, s57, v189
    v_dot2_f32_bf16 v190, v103, s56, v190
    v_dot2_f32_bf16 v191, v103, s57, v191
    v_dot2_f32_bf16 v192, v104, s56, v192
    v_dot2_f32_bf16 v193, v104, s57, v193
    v_dot2_f32_bf16 v194, v105, s56, v194
    v_dot2_f32_bf16 v195, v105, s57, v195
    v_dot2_f32_bf16 v196, v106, s56, v196
    v_dot2_f32_bf16 v197, v106, s57, v197
    v_dot2_f32_bf16 v198, v107, s56, v198
    v_dot2_f32_bf16 v199, v107, s57, v199
    s_waitcnt vmcnt(8)
    v_max3_u32 v6, v64, v65, v66
    v_max3_u32 v6, v6, v67, v68
    v_max3_u32 v6, v6, v69, v70
    v_max3_u32 v6, v6, v71, v72
    v_max3_u32 v6, v6, v73, v74
    v_max_u32 v6, v6, v75
    v_cmp_eq_u32 vcc, -1, v6
    s_nop 0
    s_cbranch_vccnz L_src0_slow
L_src0_ok:
    v_dot2_f32_bf16 v112, v64, s56, v112
    v_dot2_f32_bf16 v113, v64, s57, v113
    v_dot2_f32_bf16 v114, v65, s56, v114
    v_dot2_f32_bf16 v115, v65, s57, v115
    v_dot2_f32_bf16 v116, v66, s56, v116
    v_dot2_f32_bf16 v117, v66, s57, v117
    v_dot2_f32_bf16 v118, v67, s56, v118
    v_dot2_f32_bf16 v119, v67, s57, v119
    v_dot2_f32_bf16 v120, v68, s56, v120
    v_dot2_f32_bf16 v121, v68, s57, v121
    v_dot2_f32_bf16 v122, v69, s56, v122
    v_dot2_f32_bf16 v123, v69, s57, v123
    v_dot2_f32_bf16 v124, v70, s56, v124
    v_dot2_f32_bf16 v125, v70, s57, v125
    v_dot2_f32_bf16 v126, v71, s56, v126
    v_dot2_f32_bf16 v127, v71, s57, v127
    v_dot2_f32_bf16 v128, v72, s56, v128
    v_dot2_f32_bf16 v129, v72, s57, v129
    v_dot2_f32_bf16 v130, v73, s56, v130
    v_dot2_f32_bf16 v131, v73, s57, v131
    v_dot2_f32_bf16 v132, v74, s56, v132
    v_dot2_f32_bf16 v133, v74, s57, v133
    v_dot2_f32_bf16 v134, v75, s56, v134
    v_dot2_f32_bf16 v135, v75, s57, v135
    s_waitcnt vmcnt(5)
    v_max3_u32 v6, v76, v77, v78
    v_max3_u32 v6, v6, v79, v80
    v_max3_u32 v6, v6, v81, v82
    v_max3_u32 v6, v6, v83, v84
    v_max3_u32 v6, v6, v85, v86
    v_max_u32 v6, v6, v87
    v_cmp_eq_u32 vcc, -1, v6
    s_nop 0
    s_cbranch_vccnz L_src1_slow
L_src1_ok:
    v_dot2_f32_bf16 v112, v76, s56, v112
    v_dot2_f32_bf16 v113, v76, s57, v113
    v_dot2_f32_bf16 v114, v77, s56, v114
    v_dot2_f32_bf16 v115, v77, s57, v115
    v_dot2_f32_bf16 v116, v78, s56, v116
    v_dot2_f32_bf16 v117, v78, s57, v117
    v_dot2_f32_bf16 v118, v79, s56, v118
    v_dot2_f32_bf16 v119, v79, s57, v119
    v_dot2_f32_bf16 v120, v80, s56, v120
    v_dot2_f32_bf16 v121, v80, s57, v121
    v_dot2_f32_bf16 v122, v81, s56, v122
    v_dot2_f32_bf16 v123, v81, s57, v123
    v_dot2_f32_bf16 v124, v82, s56, v124
    v_dot2_f32_bf16 v125, v82, s57, v125
    v_dot2_f32_bf16 v126, v83, s56, v126
    v_dot2_f32_bf16 v127, v83, s57, v127
    v_dot2_f32_bf16 v128, v84, s56, v128
    v_dot2_f32_bf16 v129, v84, s57, v129
    v_dot2_f32_bf16 v130, v85, s56, v130
    v_dot2_f32_bf16 v131, v85, s57, v131
    v_dot2_f32_bf16 v132, v86, s56, v132
    v_dot2_f32_bf16 v133, v86, s57, v133
    v_dot2_f32_bf16 v134, v87, s56, v134
    v_dot2_f32_bf16 v135, v87, s57, v135
    s_waitcnt vmcnt(2)
    v_max3_u32 v6, v88, v89, v90
    v_max3_u32 v6, v6, v91, v92
    v_max3_u32 v6, v6, v93, v94
    v_max3_u32 v6, v6, v95, v96
    v_max3_u32 v6, v6, v97, v98
    v_max_u32 v6, v6, v99
    v_cmp_eq_u32 vcc, -1, v6
    s_nop 0
    s_cbranch_vccnz L_src2_slow
L_src2_ok:
    v_dot2_f32_bf16 v112, v88, s56, v112
    v_dot2_f32_bf16 v113, v88, s57, v113
    v_dot2_f32_bf16 v114, v89, s56, v114
    v_dot2_f32_bf16 v115, v89, s57, v115
    v_dot2_f32_bf16 v116, v90, s56, v116
    v_dot2_f32_bf16 v117, v90, s57, v117
    v_dot2_f32_bf16 v118, v91, s56, v118
    v_dot2_f32_bf16 v119, v91, s57, v119
    v_dot2_f32_bf16 v120, v92, s56, v120
    v_dot2_f32_bf16 v121, v92, s57, v121
    v_dot2_f32_bf16 v122, v93, s56, v122
    v_dot2_f32_bf16 v123, v93, s57, v123
    v_dot2_f32_bf16 v124, v94, s56, v124
    v_dot2_f32_bf16 v125, v94, s57, v125
    v_dot2_f32_bf16 v126, v95, s56, v126
    v_dot2_f32_bf16 v127, v95, s57, v127
    v_dot2_f32_bf16 v128, v96, s56, v128
    v_dot2_f32_bf16 v129, v96, s57, v129
    v_dot2_f32_bf16 v130, v97, s56, v130
    v_dot2_f32_bf16 v131, v97, s57, v131
    v_dot2_f32_bf16 v132, v98, s56, v132
    v_dot2_f32_bf16 v133, v98, s57, v133
    v_dot2_f32_bf16 v134, v99, s56, v134
    v_dot2_f32_bf16 v135, v99, s57, v135
    v_pk_fma_f32 v[112:113], v[112:113], v[40:41], v[184:185] op_sel:[0,1,0] op_sel_hi:[1,1,1]
    v_pk_fma_f32 v[114:115], v[114:115], v[40:41], v[186:187] op_sel:[0,1,0] op_sel_hi:[1,1,1]
    v_cvt_pk_bf16_f32 v160, v112, v113
    v_cvt_pk_bf16_f32 v161, v114, v115
    ds_write_b64 v13, v[160:161] offset:0
    v_pk_fma_f32 v[116:117], v[116:117], v[42:43], v[188:189] op_sel:[0,1,0] op_sel_hi:[1,1,1]
    v_pk_fma_f32 v[118:119], v[118:119], v[42:43], v[190:191] op_sel:[0,1,0] op_sel_hi:[1,1,1]
    v_cvt_pk_bf16_f32 v162, v116, v117
    v_cvt_pk_bf16_f32 v163, v118, v119
    ds_write_b64 v13, v[162:163] offset:1536
    v_pk_fma_f32 v[120:121], v[120:121], v[40:41], v[192:193] op_sel:[0,1,0] op_sel_hi:[1,1,1]
    v_pk_fma_f32 v[122:123], v[122:123], v[40:41], v[194:195] op_sel:[0,1,0] op_sel_hi:[1,1,1]
    v_cvt_pk_bf16_f32 v164, v120, v121
    v_cvt_pk_bf16_f32 v165, v122, v123
    ds_write_b64 v13, v[164:165] offset:32
    v_pk_fma_f32 v[124:125], v[124:125], v[42:43], v[196:197] op_sel:[0,1,0] op_sel_hi:[1,1,1]
    v_pk_fma_f32 v[126:127], v[126:127], v[42:43], v[198:199] op_sel:[0,1,0] op_sel_hi:[1,1,1]
    v_cvt_pk_bf16_f32 v166, v124, v125
    v_cvt_pk_bf16_f32 v167, v126, v127
    ds_write_b64 v13, v[166:167] offset:1568
    s_waitcnt vmcnt(0)
    v_max3_u32 v6, v108, v109, v110
    v_max_u32 v6, v6, v111
    v_cmp_eq_u32 vcc, -1, v6
    s_nop 0
    s_cbranch_vccnz L_src4_slow
L_src4_ok:
    v_dot2_f32_bf16 v200, v108, s56, v200
    v_dot2_f32_bf16 v201, v108, s57, v201
    v_dot2_f32_bf16 v202, v109, s56, v202
    v_dot2_f32_bf16 v203, v109, s57, v203
    v_dot2_f32_bf16 v204, v110, s56, v204
    v_dot2_f32_bf16 v205, v110, s57, v205
    v_dot2_f32_bf16 v206, v111, s56, v206
    v_dot2_f32_bf16 v207, v111, s57, v207
    v_pk_fma_f32 v[128:129], v[128:129], v[40:41], v[200:201] op_sel:[0,1,0] op_sel_hi:[1,1,1]
    v_pk_fma_f32 v[130:131], v[130:131], v[40:41], v[202:203] op_sel:[0,1,0] op_sel_hi:[1,1,1]
    v_cvt_pk_bf16_f32 v168, v128, v129
    v_cvt_pk_bf16_f32 v169, v130, v131
    ds_write_b64 v13, v[168:169] offset:64
    v_pk_fma_f32 v[132:133], v[132:133], v[42:43], v[204:205] op_sel:[0,1,0] op_sel_hi:[1,1,1]
    v_pk_fma_f32 v[134:135], v[134:135], v[42:43], v[206:207] op_sel:[0,1,0] op_sel_hi:[1,1,1]
    v_cvt_pk_bf16_f32 v170, v132, v133
    v_cvt_pk_bf16_f32 v171, v134, v135
    ds_write_b64 v13, v[170:171] offset:1600
    ds_read_b128 v[64:67], v14 offset:0
    ds_read_b128 v[68:71], v14 offset:1024
    ds_read_b128 v[72:75], v14 offset:2048
    s_waitcnt lgkmcnt(2)
    buffer_store_dwordx4 v[64:67], v10, s[20:23], s55 offen offset:0
    s_waitcnt lgkmcnt(1)
    buffer_store_dwordx4 v[68:71], v11, s[20:23], s55 offen offset:1024
    s_waitcnt lgkmcnt(0)
    buffer_store_dwordx4 v[72:75], v12, s[20:23], s55 offen offset:2048
    s_endpgm
L_src4_slow:
    s_mov_b32 s59, 0
L_src4_spin:
    s_add_u32 s52, s62, 131072
    buffer_load_dwordx2 v[108:109], v15, s[16:19], s52 offen offset:0 sc1
    buffer_load_dwordx2 v[110:111], v15, s[16:19], s52 offen offset:128 sc1
    s_waitcnt vmcnt(0)
    v_max3_u32 v6, v108, v109, v110
    v_max_u32 v6, v6, v111
    v_cmp_eq_u32 vcc, -1, v6
    s_nop 0
    s_cbranch_vccz L_src4_ok
    s_add_u32 s59, s59, 1
    s_cmp_lt_u32 s59, 131072
    s_cbranch_scc1 L_src4_spin
    s_branch L_src4_ok
L_src2_slow:
    s_mov_b32 s59, 0
L_src2_spin:
    s_xor_b32 s52, s31, 3
    s_mul_i32 s52, s52, 12288
    s_add_u32 s52, s52, s63
    buffer_load_dwordx4 v[88:91], v38, s[16:19], s52 offen offset:0 sc1
    buffer_load_dwordx4 v[92:95], v38, s[16:19], s52 offen offset:1024 sc1
    buffer_load_dwordx4 v[96:99], v38, s[16:19], s52 offen offset:2048 sc1
    s_waitcnt vmcnt(0)
    v_max3_u32 v6, v88, v89, v90
    v_max3_u32 v6, v6, v91, v92
    v_max3_u32 v6, v6, v93, v94
    v_max3_u32 v6, v6, v95, v96
    v_max3_u32 v6, v6, v97, v98
    v_max_u32 v6, v6, v99
    v_cmp_eq_u32 vcc, -1, v6
    s_nop 0
    s_cbranch_vccz L_src2_ok
    s_add_u32 s59, s59, 1
    s_cmp_lt_u32 s59, 131072
    s_cbranch_scc1 L_src2_spin
    s_branch L_src2_ok
L_src1_slow:
    s_mov_b32 s59, 0
L_src1_spin:
    s_xor_b32 s52, s31, 2
    s_mul_i32 s52, s52, 12288
    s_add_u32 s52, s52, s63
    buffer_load_dwordx4 v[76:79], v38, s[16:19], s52 offen offset:0 sc1
    buffer_load_dwordx4 v[80:83], v38, s[16:19], s52 offen offset:1024 sc1
    buffer_load_dwordx4 v[84:87], v38, s[16:19], s52 offen offset:2048 sc1
    s_waitcnt vmcnt(0)
    v_max3_u32 v6, v76, v77, v78
    v_max3_u32 v6, v6, v79, v80
    v_max3_u32 v6, v6, v81, v82
    v_max3_u32 v6, v6, v83, v84
    v_max3_u32 v6, v6, v85, v86
    v_max_u32 v6, v6, v87
    v_cmp_eq_u32 vcc, -1, v6
    s_nop 0
    s_cbranch_vccz L_src1_ok
    s_add_u32 s59, s59, 1
    s_cmp_lt_u32 s59, 131072
    s_cbranch_scc1 L_src1_spin
    s_branch L_src1_ok
L_src0_slow:
    s_mov_b32 s59, 0
L_src0_spin:
    s_xor_b32 s52, s31, 1
    s_mul_i32 s52, s52, 12288
    s_add_u32 s52, s52, s63
    buffer_load_dwordx4 v[64:67], v38, s[16:19], s52 offen offset:0 sc1
    buffer_load_dwordx4 v[68:71], v38, s[16:19], s52 offen offset:1024 sc1
    buffer_load_dwordx4 v[72:75], v38, s[16:19], s52 offen offset:2048 sc1
    s_waitcnt vmcnt(0)
    v_max3_u32 v6, v64, v65, v66
    v_max3_u32 v6, v6, v67, v68
    v_max3_u32 v6, v6, v69, v70
    v_max3_u32 v6, v6, v71, v72
    v_max3_u32 v6, v6, v73, v74
    v_max_u32 v6, v6, v75
    v_cmp_eq_u32 vcc, -1, v6
    s_nop 0
    s_cbranch_vccz L_src0_ok
    s_add_u32 s59, s59, 1
    s_cmp_lt_u32 s59, 131072
    s_cbranch_scc1 L_src0_spin
    s_branch L_src0_ok
L_src3_slow:
    s_mov_b32 s59, 0
L_src3_spin:
    s_add_u32 s52, s62, 0
    buffer_load_dwordx2 v[100:101], v15, s[16:19], s52 offen offset:0 sc1
    buffer_load_dwordx2 v[102:103], v15, s[16:19], s52 offen offset:128 sc1
    s_add_u32 s52, s62, 65536
    buffer_load_dwordx2 v[104:105], v15, s[16:19], s52 offen offset:0 sc1
    buffer_load_dwordx2 v[106:107], v15, s[16:19], s52 offen offset:128 sc1
    s_waitcnt vmcnt(0)
    v_max3_u32 v6, v100, v101, v102
    v_max3_u32 v6, v6, v103, v104
    v_max3_u32 v6, v6, v105, v106
    v_max_u32 v6, v6, v107
    v_cmp_eq_u32 vcc, -1, v6
    s_nop 0
    s_cbranch_vccz L_src3_ok
    s_add_u32 s59, s59, 1
    s_cmp_lt_u32 s59, 131072
    s_cbranch_scc1 L_src3_spin
    s_branch L_src3_ok
L_pa_slow:
    s_mov_b32 s59, 0
L_pa_spin:
    s_sleep 4
    buffer_load_dword v63, v7, s[16:19], 0 offen sc1
    s_waitcnt vmcnt(0)
    v_cmp_eq_u32 vcc, v6, v63
    s_nop 0
    s_and_b64 vcc, vcc, 0x7f
    s_cbranch_vccz L_pa_ok
    s_add_u32 s59, s59, 1
    s_and_b32 s32, s59, 15
    s_cbranch_scc1 L_pa_spin
    buffer_load_dword v63, v62, s[24:27], 0 offen sc1
    s_waitcnt vmcnt(0)
    v_cmp_eq_u32 vcc, 0, v63
    s_nop 0
    s_cbranch_vccz L_pa_ok
    s_cmp_lt_u32 s59, 131072
    s_cbranch_scc1 L_pa_spin
    s_branch L_pa_ok
L_pb_slow:
    s_mov_b32 s59, 0
L_pb_spin:
    s_sleep 4
    buffer_load_dword v3, v7, s[16:19], 0 offen sc1
    s_waitcnt vmcnt(0)
    v_cmp_eq_u32 vcc, v6, v3
    s_nop 0
    s_and_b64 vcc, vcc, 0x380
    s_cbranch_vccz L_pb_ok
    s_add_u32 s59, s59, 1
    s_and_b32 s32, s59, 15
    s_cbranch_scc1 L_pb_spin
    v_lshlrev_b32 v2, 2, v1
    buffer_load_dword v3, v2, s[24:27], 0 offen sc1
    s_waitcnt vmcnt(0)
    v_lshrrev_b32 v2, 3, v1
    v_cmp_eq_u32 vcc, 6, v2
    s_nop 1
    v_cndmask_b32 v2, 1, 3, vcc
    v_cmp_gt_u32 vcc, v2, v3
    s_nop 0
    s_cbranch_vccz L_pb_ok
    s_cmp_lt_u32 s59, 131072
    s_cbranch_scc1 L_pb_spin
    s_branch L_pb_ok
L_ph0_slow:
    s_mov_b32 s59, 0
L_ph0_spin:
    s_sleep 4
    buffer_load_dword v63, v62, s[16:19], s54 offen sc1
    s_waitcnt vmcnt(0)
    v_cmp_gt_u32 vcc, 1, v63
    s_nop 0
    s_cbranch_vccz L_ph0_ok
    s_add_u32 s59, s59, 1
    s_cmp_lt_u32 s59, 131072
    s_cbranch_scc1 L_ph0_spin
    s_branch L_ph0_ok
L_ph1_slow:
    s_mov_b32 s59, 0
L_ph1_spin:
    s_sleep 4
    buffer_load_dword v63, v62, s[16:19], s54 offen sc1
    s_waitcnt vmcnt(0)
    v_cmp_gt_u32 vcc, 2, v63
    s_nop 0
    s_cbranch_vccz L_ph1_ok
    s_add_u32 s59, s59, 1
    s_cmp_lt_u32 s59, 131072
    s_cbranch_scc1 L_ph1_spin
    s_branch L_ph1_ok
L_pp_slow:
    s_mov_b32 s59, 0
L_pp_spin:
    s_sleep 4
    buffer_load_dword v9, v21, s[16:19], s61 offen sc1
    s_waitcnt vmcnt(0)
    v_cmp_ne_u32 vcc, 1, v9
    s_nop 0
    s_cbranch_vccz L_pp_ok
    s_add_u32 s59, s59, 1
    s_cmp_lt_u32 s59, 131072
    s_cbranch_scc1 L_pp_spin
    s_branch L_pp_ok
L_aux:
    s_load_dwordx8 s[36:43], s[0:1], 8
    s_load_dwordx4 s[44:47], s[0:1], 40
    s_sub_u32 s35, s3, 24
    s_and_b32 s30, s2, 7
    s_lshl_b32 s29, s35, 3
    s_add_u32 s29, s29, s30
    s_lshl_b32 s53, s30, 3
    s_add_u32 s53, s53, s35
    s_and_b32 s54, s30, 3
    s_mul_i32 s54, s54, 18
    s_lshr_b32 s34, s30, 2
    s_mul_i32 s34, s34, 9
    s_add_u32 s54, s54, s34
    s_cmp_eq_u32 s34, 0
    s_cselect_b32 s34, 5, 8
    s_add_u32 s63, s54, s34
    s_cmp_ge_u32 s35, s34
    s_addc_u32 s54, s54, s35
    s_mov_b32 s6, 2359296
    s_mov_b32 s10, 5308416
    s_lshl_b32 s31, s53, 2
    s_add_u32 s31, s31, s28
    s_mul_i32 s32, s31, 9216
    v_lshrrev_b32 v2, 3, v1
    v_and_b32 v3, 7, v1
    v_mul_u32_u24 v4, 1152, v2
    v_lshl_add_u32 v4, v3, 4, v4
    s_waitcnt lgkmcnt(0)
    buffer_load_dwordx4 v[16:19], v4, s[4:7], s32 offen offset:0
    buffer_load_dwordx4 v[20:23], v4, s[4:7], s32 offen offset:128
    buffer_load_dwordx4 v[24:27], v4, s[4:7], s32 offen offset:256
    buffer_load_dwordx4 v[28:31], v4, s[4:7], s32 offen offset:384
    buffer_load_dwordx4 v[32:35], v4, s[4:7], s32 offen offset:512
    buffer_load_dwordx4 v[36:39], v4, s[4:7], s32 offen offset:640
    buffer_load_dwordx4 v[40:43], v4, s[4:7], s32 offen offset:768
    buffer_load_dwordx4 v[44:47], v4, s[4:7], s32 offen offset:896
    buffer_load_dwordx4 v[48:51], v4, s[4:7], s32 offen offset:1024
    s_mov_b32 s15, 0x20000
    s_mov_b32 s19, 0x20000
    s_mov_b32 s23, 0x20000
    s_mov_b32 s27, 0x20000
    s_mov_b32 s18, 0x10000000
    s_mov_b32 s22, 2359296
    s_mov_b32 s26, 256
    s_cmp_eq_u32 s28, 0
    s_cselect_b64 s[100:101], -1, 0
    v_mul_u32_u24 v11, 9216, v2
    v_lshl_add_u32 v11, v3, 4, v11
    v_mov_b32 v13, 2147483632
    s_mul_i32 s55, s28, 1327104
    s_lshl_b32 s35, s63, 7
    s_add_u32 s61, s55, s35
    s_lshl_b32 s35, s54, 7
    s_add_u32 s55, s55, s35
    s_mov_b32 s58, 0xffff0000
    v_mov_b32 v52, 0
    v_mov_b32 v53, 0
    v_mov_b32 v54, 0
    v_mov_b32 v55, 0
    v_mov_b32 v5, s54
    v_mov_b32 v6, s63
    v_cmp_eq_u32 vcc, 2, v1
    s_nop 1
    v_cndmask_b32 v5, v5, v6, vcc
    v_mul_u32_u24 v6, 43, v5
    v_lshrrev_b32 v6, 8, v6
    v_mul_u32_u24 v7, 6, v6
    v_sub_u32 v5, v5, v7
    v_lshlrev_b32 v5, 2, v5
    v_lshl_add_u32 v5, v6, 7, v5
    v_add_u32 v5, 55296, v5
    s_lshr_b32 s34, s53, 2
    s_lshl_b32 s34, s34, 7
    s_and_b32 s35, s53, 3
    s_lshl_b32 s35, s35, 2
    s_add_u32 s34, s34, s35
    s_add_u32 s34, s34, 53248
    v_mov_b32 v6, s34
    v_cmp_eq_u32 vcc, 0, v1
    s_nop 1
    v_cndmask_b32 v5, v5, v6, vcc
    v_cmp_gt_u32 vcc, 3, v0
    s_nop 1
    v_cndmask_b32 v166, v13, v5, vcc
    buffer_load_dword v167, v166, s[16:19], 0 offen sc1
    buffer_load_dwordx4 v[64:67], v11, s[8:11], s55 offen
    s_add_u32 s55, s55, 73728
    buffer_load_dwordx4 v[68:71], v11, s[8:11], s55 offen
    s_add_u32 s55, s55, 73728
    buffer_load_dwordx4 v[72:75], v11, s[8:11], s55 offen
    s_add_u32 s55, s55, 73728
    buffer_load_dwordx4 v[76:79], v11, s[8:11], s55 offen
    s_add_u32 s55, s55, 73728
    buffer_load_dwordx4 v[80:83], v11, s[8:11], s55 offen
    s_add_u32 s55, s55, 73728
    buffer_load_dwordx4 v[84:87], v11, s[8:11], s55 offen
    s_add_u32 s55, s55, 73728
    s_mul_i32 s34, s28, 4352
    s_add_u32 s34, s34, 33792
    v_lshl_add_u32 v15, v1, 4, s34
    s_mov_b64 exec, 0x7f
    ds_write_b128 v15, v[52:55] offset:0
    ds_write_b128 v15, v[52:55] offset:2176
    ds_write_b128 v15, v[52:55] offset:17408
    ds_write_b128 v15, v[52:55] offset:19584
    ds_write_b128 v15, v[52:55] offset:34816
    ds_write_b128 v15, v[52:55] offset:36992
    s_mov_b64 exec, -1
    s_waitcnt vmcnt(15)
    v_lshlrev_b32 v168, 16, v16
    v_and_b32 v169, s58, v16
    v_lshlrev_b32 v170, 16, v17
    v_and_b32 v171, s58, v17
    v_lshlrev_b32 v172, 16, v18
    v_and_b32 v173, s58, v18
    v_lshlrev_b32 v174, 16, v19
    v_and_b32 v175, s58, v19
    v_mov_b32 v56, v168
    v_mov_b32 v57, v169
    v_mov_b32 v58, v170
    v_mov_b32 v59, v171
    v_mov_b32 v60, v172
    v_mov_b32 v61, v173
    v_mov_b32 v62, v174
    v_mov_b32 v63, v175
    buffer_load_dwordx4 v[88:91], v11, s[8:11], s55 offen
    s_add_u32 s55, s55, 73728
    s_waitcnt vmcnt(15)
    v_lshlrev_b32 v176, 16, v20
    v_and_b32 v177, s58, v20
    v_lshlrev_b32 v178, 16, v21
    v_and_b32 v179, s58, v21
    v_lshlrev_b32 v180, 16, v22
    v_and_b32 v181, s58, v22
    v_lshlrev_b32 v182, 16, v23
    v_and_b32 v183, s58, v23
    v_pk_add_f32 v[56:57], v[56:57], v[176:177]
    v_pk_add_f32 v[58:59], v[58:59], v[178:179]
    v_pk_add_f32 v[60:61], v[60:61], v[180:181]
    v_pk_add_f32 v[62:63], v[62:63], v[182:183]
    buffer_load_dwordx4 v[92:95], v11, s[8:11], s55 offen
    s_add_u32 s55, s55, 73728
    s_waitcnt vmcnt(15)
    v_lshlrev_b32 v184, 16, v24
    v_and_b32 v185, s58, v24
    v_lshlrev_b32 v186, 16, v25
    v_and_b32 v187, s58, v25
    v_lshlrev_b32 v188, 16, v26
    v_and_b32 v189, s58, v26
    v_lshlrev_b32 v190, 16, v27
    v_and_b32 v191, s58, v27
    v_pk_add_f32 v[56:57], v[56:57], v[184:185]
    v_pk_add_f32 v[58:59], v[58:59], v[186:187]
    v_pk_add_f32 v[60:61], v[60:61], v[188:189]
    v_pk_add_f32 v[62:63], v[62:63], v[190:191]
    buffer_load_dwordx4 v[96:99], v11, s[8:11], s55 offen
    s_add_u32 s55, s55, 73728
    s_waitcnt vmcnt(15)
    v_lshlrev_b32 v192, 16, v28
    v_and_b32 v193, s58, v28
    v_lshlrev_b32 v194, 16, v29
    v_and_b32 v195, s58, v29
    v_lshlrev_b32 v196, 16, v30
    v_and_b32 v197, s58, v30
    v_lshlrev_b32 v198, 16, v31
    v_and_b32 v199, s58, v31
    v_pk_add_f32 v[56:57], v[56:57], v[192:193]
    v_pk_add_f32 v[58:59], v[58:59], v[194:195]
    v_pk_add_f32 v[60:61], v[60:61], v[196:197]
    v_pk_add_f32 v[62:63], v[62:63], v[198:199]
    buffer_load_dwordx4 v[100:103], v11, s[8:11], s55 offen
    s_add_u32 s55, s55, 73728
    s_waitcnt vmcnt(15)
    v_lshlrev_b32 v200, 16, v32
    v_and_b32 v201, s58, v32
    v_lshlrev_b32 v202, 16, v33
    v_and_b32 v203, s58, v33
    v_lshlrev_b32 v204, 16, v34
    v_and_b32 v205, s58, v34
    v_lshlrev_b32 v206, 16, v35
    v_and_b32 v207, s58, v35
    v_pk_add_f32 v[56:57], v[56:57], v[200:201]
    v_pk_add_f32 v[58:59], v[58:59], v[202:203]
    v_pk_add_f32 v[60:61], v[60:61], v[204:205]
    v_pk_add_f32 v[62:63], v[62:63], v[206:207]
    buffer_load_dwordx4 v[104:107], v11, s[8:11], s55 offen
    s_add_u32 s55, s55, 73728
    s_waitcnt vmcnt(15)
    v_lshlrev_b32 v208, 16, v36
    v_and_b32 v209, s58, v36
    v_lshlrev_b32 v210, 16, v37
    v_and_b32 v211, s58, v37
    v_lshlrev_b32 v212, 16, v38
    v_and_b32 v213, s58, v38
    v_lshlrev_b32 v214, 16, v39
    v_and_b32 v215, s58, v39
    v_pk_add_f32 v[56:57], v[56:57], v[208:209]
    v_pk_add_f32 v[58:59], v[58:59], v[210:211]
    v_pk_add_f32 v[60:61], v[60:61], v[212:213]
    v_pk_add_f32 v[62:63], v[62:63], v[214:215]
    buffer_load_dwordx4 v[108:111], v11, s[8:11], s55 offen
    s_add_u32 s55, s55, 73728
    s_waitcnt vmcnt(15)
    v_lshlrev_b32 v216, 16, v40
    v_and_b32 v217, s58, v40
    v_lshlrev_b32 v218, 16, v41
    v_and_b32 v219, s58, v41
    v_lshlrev_b32 v220, 16, v42
    v_and_b32 v221, s58, v42
    v_lshlrev_b32 v222, 16, v43
    v_and_b32 v223, s58, v43
    v_pk_add_f32 v[56:57], v[56:57], v[216:217]
    v_pk_add_f32 v[58:59], v[58:59], v[218:219]
    v_pk_add_f32 v[60:61], v[60:61], v[220:221]
    v_pk_add_f32 v[62:63], v[62:63], v[222:223]
    buffer_load_dwordx4 v[112:115], v11, s[8:11], s55 offen
    s_add_u32 s55, s55, 73728
    s_waitcnt vmcnt(15)
    v_lshlrev_b32 v224, 16, v44
    v_and_b32 v225, s58, v44
    v_lshlrev_b32 v226, 16, v45
    v_and_b32 v227, s58, v45
    v_lshlrev_b32 v228, 16, v46
    v_and_b32 v229, s58, v46
    v_lshlrev_b32 v230, 16, v47
    v_and_b32 v231, s58, v47
    v_pk_add_f32 v[56:57], v[56:57], v[224:225]
    v_pk_add_f32 v[58:59], v[58:59], v[226:227]
    v_pk_add_f32 v[60:61], v[60:61], v[228:229]
    v_pk_add_f32 v[62:63], v[62:63], v[230:231]
    buffer_load_dwordx4 v[116:119], v11, s[8:11], s55 offen
    s_add_u32 s55, s55, 73728
    s_waitcnt vmcnt(15)
    v_lshlrev_b32 v232, 16, v48
    v_and_b32 v233, s58, v48
    v_lshlrev_b32 v234, 16, v49
    v_and_b32 v235, s58, v49
    v_lshlrev_b32 v236, 16, v50
    v_and_b32 v237, s58, v50
    v_lshlrev_b32 v238, 16, v51
    v_and_b32 v239, s58, v51
    v_pk_add_f32 v[56:57], v[56:57], v[232:233]
    v_pk_add_f32 v[58:59], v[58:59], v[234:235]
    v_pk_add_f32 v[60:61], v[60:61], v[236:237]
    v_pk_add_f32 v[62:63], v[62:63], v[238:239]
    buffer_load_dwordx4 v[120:123], v11, s[8:11], s55 offen
    s_add_u32 s55, s55, 73728
    v_pk_add_f32 v[56:57], v[56:57], v[58:59]
    v_pk_add_f32 v[60:61], v[60:61], v[62:63]
    v_pk_add_f32 v[56:57], v[56:57], v[60:61]
    v_add_f32 v56, v56, v57
    s_nop 1
    v_add_f32_dpp v56, v56, v56 quad_perm:[1,0,3,2] row_mask:0xf bank_mask:0xf
    s_nop 1
    v_add_f32_dpp v56, v56, v56 quad_perm:[2,3,0,1] row_mask:0xf bank_mask:0xf
    s_nop 1
    v_add_f32_dpp v56, v56, v56 row_half_mirror row_mask:0xf bank_mask:0xf
    v_mul_f32 v240, 0x3ae38e39, v56
    v_pk_add_f32 v[244:245], v[168:169], v[240:241] op_sel_hi:[1,0] neg_lo:[0,1] neg_hi:[0,1]
    v_pk_add_f32 v[246:247], v[170:171], v[240:241] op_sel_hi:[1,0] neg_lo:[0,1] neg_hi:[0,1]
    v_pk_add_f32 v[248:249], v[172:173], v[240:241] op_sel_hi:[1,0] neg_lo:[0,1] neg_hi:[0,1]
    v_pk_mul_f32 v[56:57], v[244:245], v[244:245]
    v_pk_add_f32 v[250:251], v[174:175], v[240:241] op_sel_hi:[1,0] neg_lo:[0,1] neg_hi:[0,1]
    v_pk_mul_f32 v[58:59], v[246:247], v[246:247]
    v_pk_add_f32 v[244:245], v[176:177], v[240:241] op_sel_hi:[1,0] neg_lo:[0,1] neg_hi:[0,1]
    v_pk_mul_f32 v[60:61], v[248:249], v[248:249]
    v_pk_add_f32 v[246:247], v[178:179], v[240:241] op_sel_hi:[1,0] neg_lo:[0,1] neg_hi:[0,1]
    v_pk_mul_f32 v[62:63], v[250:251], v[250:251]
    buffer_load_dwordx4 v[124:127], v11, s[8:11], s55 offen
    s_add_u32 s55, s55, 73728
    v_pk_add_f32 v[248:249], v[180:181], v[240:241] op_sel_hi:[1,0] neg_lo:[0,1] neg_hi:[0,1]
    v_pk_fma_f32 v[56:57], v[244:245], v[244:245], v[56:57]
    v_pk_add_f32 v[250:251], v[182:183], v[240:241] op_sel_hi:[1,0] neg_lo:[0,1] neg_hi:[0,1]
    v_pk_fma_f32 v[58:59], v[246:247], v[246:247], v[58:59]
    v_pk_add_f32 v[244:245], v[184:185], v[240:241] op_sel_hi:[1,0] neg_lo:[0,1] neg_hi:[0,1]
    v_pk_fma_f32 v[60:61], v[248:249], v[248:249], v[60:61]
    v_pk_add_f32 v[246:247], v[186:187], v[240:241] op_sel_hi:[1,0] neg_lo:[0,1] neg_hi:[0,1]
    v_pk_fma_f32 v[62:63], v[250:251], v[250:251], v[62:63]
    v_pk_add_f32 v[248:249], v[188:189], v[240:241] op_sel_hi:[1,0] neg_lo:[0,1] neg_hi:[0,1]
    v_pk_fma_f32 v[56:57], v[244:245], v[244:245], v[56:57]
    v_pk_add_f32 v[250:251], v[190:191], v[240:241] op_sel_hi:[1,0] neg_lo:[0,1] neg_hi:[0,1]
    v_pk_fma_f32 v[58:59], v[246:247], v[246:247], v[58:59]
    buffer_load_dwordx4 v[128:131], v11, s[8:11], s55 offen
    s_add_u32 s55, s55, 73728
    v_pk_add_f32 v[244:245], v[192:193], v[240:241] op_sel_hi:[1,0] neg_lo:[0,1] neg_hi:[0,1]
    v_pk_fma_f32 v[60:61], v[248:249], v[248:249], v[60:61]
    v_pk_add_f32 v[246:247], v[194:195], v[240:241] op_sel_hi:[1,0] neg_lo:[0,1] neg_hi:[0,1]
    v_pk_fma_f32 v[62:63], v[250:251], v[250:251], v[62:63]
    v_pk_add_f32 v[248:249], v[196:197], v[240:241] op_sel_hi:[1,0] neg_lo:[0,1] neg_hi:[0,1]
    v_pk_fma_f32 v[56:57], v[244:245], v[244:245], v[56:57]
    v_pk_add_f32 v[250:251], v[198:199], v[240:241] op_sel_hi:[1,0] neg_lo:[0,1] neg_hi:[0,1]
    v_pk_fma_f32 v[58:59], v[246:247], v[246:247], v[58:59]
    v_pk_add_f32 v[244:245], v[200:201], v[240:241] op_sel_hi:[1,0] neg_lo:[0,1] neg_hi:[0,1]
    v_pk_fma_f32 v[60:61], v[248:249], v[248:249], v[60:61]
    v_pk_add_f32 v[246:247], v[202:203], v[240:241] op_sel_hi:[1,0] neg_lo:[0,1] neg_hi:[0,1]
    v_pk_fma_f32 v[62:63], v[250:251], v[250:251], v[62:63]
    buffer_load_dwordx4 v[132:135], v11, s[8:11], s55 offen
    v_pk_add_f32 v[248:249], v[204:205], v[240:241] op_sel_hi:[1,0] neg_lo:[0,1] neg_hi:[0,1]
    v_pk_fma_f32 v[56:57], v[244:245], v[244:245], v[56:57]
    v_pk_add_f32 v[250:251], v[206:207], v[240:241] op_sel_hi:[1,0] neg_lo:[0,1] neg_hi:[0,1]
    v_pk_fma_f32 v[58:59], v[246:247], v[246:247], v[58:59]
    v_pk_add_f32 v[244:245], v[208:209], v[240:241] op_sel_hi:[1,0] neg_lo:[0,1] neg_hi:[0,1]
    v_pk_fma_f32 v[60:61], v[248:249], v[248:249], v[60:61]
    v_pk_add_f32 v[246:247], v[210:211], v[240:241] op_sel_hi:[1,0] neg_lo:[0,1] neg_hi:[0,1]
    v_pk_fma_f32 v[62:63], v[250:251], v[250:251], v[62:63]
    v_pk_add_f32 v[248:249], v[212:213], v[240:241] op_sel_hi:[1,0] neg_lo:[0,1] neg_hi:[0,1]
    v_pk_fma_f32 v[56:57], v[244:245], v[244:245], v[56:57]
    v_pk_add_f32 v[250:251], v[214:215], v[240:241] op_sel_hi:[1,0] neg_lo:[0,1] neg_hi:[0,1]
    v_pk_fma_f32 v[58:59], v[246:247], v[246:247], v[58:59]
    v_pk_add_f32 v[244:245], v[216:217], v[240:241] op_sel_hi:[1,0] neg_lo:[0,1] neg_hi:[0,1]
    v_pk_fma_f32 v[60:61], v[248:249], v[248:249], v[60:61]
    v_pk_add_f32 v[246:247], v[218:219], v[240:241] op_sel_hi:[1,0] neg_lo:[0,1] neg_hi:[0,1]
    v_pk_fma_f32 v[62:63], v[250:251], v[250:251], v[62:63]
    v_pk_add_f32 v[248:249], v[220:221], v[240:241] op_sel_hi:[1,0] neg_lo:[0,1] neg_hi:[0,1]
    v_pk_fma_f32 v[56:57], v[244:245], v[244:245], v[56:57]
    v_pk_add_f32 v[250:251], v[222:223], v[240:241] op_sel_hi:[1,0] neg_lo:[0,1] neg_hi:[0,1]
    v_pk_fma_f32 v[58:59], v[246:247], v[246:247], v[58:59]
    v_pk_add_f32 v[244:245], v[224:225], v[240:241] op_sel_hi:[1,0] neg_lo:[0,1] neg_hi:[0,1]
    v_pk_fma_f32 v[60:61], v[248:249], v[248:249], v[60:61]
    v_pk_add_f32 v[246:247], v[226:227], v[240:241] op_sel_hi:[1,0] neg_lo:[0,1] neg_hi:[0,1]
    v_pk_fma_f32 v[62:63], v[250:251], v[250:251], v[62:63]
    v_pk_add_f32 v[248:249], v[228:229], v[240:241] op_sel_hi:[1,0] neg_lo:[0,1] neg_hi:[0,1]
    v_pk_fma_f32 v[56:57], v[244:245], v[244:245], v[56:57]
    v_pk_add_f32 v[250:251], v[230:231], v[240:241] op_sel_hi:[1,0] neg_lo:[0,1] neg_hi:[0,1]
    v_pk_fma_f32 v[58:59], v[246:247], v[246:247], v[58:59]
    v_pk_add_f32 v[244:245], v[232:233], v[240:241] op_sel_hi:[1,0] neg_lo:[0,1] neg_hi:[0,1]
    v_pk_fma_f32 v[60:61], v[248:249], v[248:249], v[60:61]
    v_pk_add_f32 v[246:247], v[234:235], v[240:241] op_sel_hi:[1,0] neg_lo:[0,1] neg_hi:[0,1]
    v_pk_fma_f32 v[62:63], v[250:251], v[250:251], v[62:63]
    v_pk_add_f32 v[248:249], v[236:237], v[240:241] op_sel_hi:[1,0] neg_lo:[0,1] neg_hi:[0,1]
    v_pk_fma_f32 v[56:57], v[244:245], v[244:245], v[56:57]
    v_pk_add_f32 v[250:251], v[238:239], v[240:241] op_sel_hi:[1,0] neg_lo:[0,1] neg_hi:[0,1]
    v_pk_fma_f32 v[58:59], v[246:247], v[246:247], v[58:59]
    v_pk_fma_f32 v[60:61], v[248:249], v[248:249], v[60:61]
    v_pk_fma_f32 v[62:63], v[250:251], v[250:251], v[62:63]
    v_pk_add_f32 v[56:57], v[56:57], v[58:59]
    v_pk_add_f32 v[60:61], v[60:61], v[62:63]
    v_pk_add_f32 v[56:57], v[56:57], v[60:61]
    v_add_f32 v56, v56, v57
    s_nop 1
    v_add_f32_dpp v56, v56, v56 quad_perm:[1,0,3,2] row_mask:0xf bank_mask:0xf
    s_nop 1
    v_add_f32_dpp v56, v56, v56 quad_perm:[2,3,0,1] row_mask:0xf bank_mask:0xf
    s_nop 1
    v_add_f32_dpp v56, v56, v56 row_half_mirror row_mask:0xf bank_mask:0xf
    v_mul_f32 v241, 0x3ae38e39, v56
    v_cvt_pk_bf16_f32 v242, v240, v241
    v_lshlrev_b32 v240, 16, v242
    v_and_b32 v241, s58, v242
    v_add_f32 v241, 0x3727c5ac, v241
    v_cvt_pk_bf16_f32 v241, v241, v241
    v_and_b32 v241, s58, v241
    v_sqrt_f32 v241, v241
    s_nop 0
    v_cvt_pk_bf16_f32 v241, v241, v241
    v_and_b32 v241, s58, v241
    v_rcp_f32 v241, v241
    v_lshlrev_b32 v5, 3, v2
    v_cmp_eq_u32 vcc, 0, v3
    s_nop 1
    v_cndmask_b32 v5, v13, v5, vcc
    s_lshl_b32 s34, s31, 6
    s_add_u32 s34, s34, 16384
    buffer_store_dwordx2 v[240:241], v5, s[16:19], s34 offen sc1
    s_lshr_b32 s34, s53, 2
    s_mul_i32 s34, s34, 3
    s_and_b32 s35, s53, 3
    s_min_u32 s35, s35, 2
    s_add_u32 s34, s34, s35
    s_lshl_b32 s34, s34, 7
    s_add_u32 s34, s34, 8064
    s_lshl_b32 s35, s53, 7
    v_mov_b32 v5, s34
    v_mov_b32 v6, s35
    v_cmp_gt_u32 vcc, 8, v1
    s_nop 1
    v_cndmask_b32 v5, v5, v6, vcc
    s_lshl_b32 s35, s53, 6
    s_add_u32 s35, s35, 57088
    v_mov_b32 v6, s35
    v_cmp_gt_u32 vcc, 16, v1
    s_nop 1
    v_cndmask_b32 v5, v6, v5, vcc
    v_lshl_add_u32 v5, v1, 4, v5
    v_cmp_gt_u32 vcc, 20, v0
    s_nop 1
    v_cndmask_b32 v14, v13, v5, vcc
    buffer_store_dwordx4 v[52:55], v14, s[16:19], 0 offen sc1
    s_min_u32 s33, s29, 47
    s_lshr_b32 s34, s33, 2
    s_mul_i32 s34, s34, 48
    s_and_b32 s33, s33, 3
    s_lshl_b32 s33, s33, 2
    s_add_u32 s33, s33, s34
    s_mov_b32 s35, 16
    s_add_u32 s33, s33, s28
    s_lshl_b32 s34, s33, 8
    v_lshl_add_u32 v7, v1, 2, s34
    s_lshl_b32 s34, s33, 1
    v_mov_b32 v8, s34
    global_load_dword v148, v7, s[36:37]
    global_load_dword v149, v7, s[38:39]
    global_load_dword v150, v7, s[40:41]
    global_load_dword v151, v7, s[42:43]
    global_load_ushort v160, v8, s[44:45]
    global_load_ushort v161, v8, s[46:47]
    v_lshl_add_u32 v7, s35, 8, v7
    v_lshl_add_u32 v8, s35, 1, v8
    global_load_dword v152, v7, s[36:37]
    global_load_dword v153, v7, s[38:39]
    global_load_dword v154, v7, s[40:41]
    global_load_dword v155, v7, s[42:43]
    global_load_ushort v162, v8, s[44:45]
    global_load_ushort v163, v8, s[46:47]
    v_lshl_add_u32 v7, s35, 8, v7
    v_lshl_add_u32 v8, s35, 1, v8
    global_load_dword v156, v7, s[36:37]
    global_load_dword v157, v7, s[38:39]
    global_load_dword v158, v7, s[40:41]
    global_load_dword v159, v7, s[42:43]
    global_load_ushort v164, v8, s[44:45]
    global_load_ushort v165, v8, s[46:47]
    v_lshlrev_b32 v15, 5, v1
    s_mov_b32 s34, 0x00003f80
    s_mov_b32 s35, 0x3f800000
    s_waitcnt vmcnt(37)
    v_dot2_f32_bf16 v56, v64, s34, 0
    v_dot2_f32_bf16 v57, v64, s35, 0
    v_dot2_f32_bf16 v58, v65, s34, 0
    v_dot2_f32_bf16 v59, v65, s35, 0
    v_dot2_f32_bf16 v60, v66, s34, 0
    v_dot2_f32_bf16 v61, v66, s35, 0
    v_dot2_f32_bf16 v62, v67, s34, 0
    v_dot2_f32_bf16 v63, v67, s35, 0
    s_waitcnt vmcnt(36)
    v_dot2_f32_bf16 v56, v68, s34, v56
    v_dot2_f32_bf16 v57, v68, s35, v57
    v_dot2_f32_bf16 v58, v69, s34, v58
    v_dot2_f32_bf16 v59, v69, s35, v59
    v_dot2_f32_bf16 v60, v70, s34, v60
    v_dot2_f32_bf16 v61, v70, s35, v61
    v_dot2_f32_bf16 v62, v71, s34, v62
    v_dot2_f32_bf16 v63, v71, s35, v63
    s_waitcnt vmcnt(35)
    v_dot2_f32_bf16 v56, v72, s34, v56
    v_dot2_f32_bf16 v57, v72, s35, v57
    v_dot2_f32_bf16 v58, v73, s34, v58
    v_dot2_f32_bf16 v59, v73, s35, v59
    v_dot2_f32_bf16 v60, v74, s34, v60
    v_dot2_f32_bf16 v61, v74, s35, v61
    v_dot2_f32_bf16 v62, v75, s34, v62
    v_dot2_f32_bf16 v63, v75, s35, v63
    s_waitcnt vmcnt(34)
    v_dot2_f32_bf16 v56, v76, s34, v56
    v_dot2_f32_bf16 v57, v76, s35, v57
    v_dot2_f32_bf16 v58, v77, s34, v58
    v_dot2_f32_bf16 v59, v77, s35, v59
    v_dot2_f32_bf16 v60, v78, s34, v60
    v_dot2_f32_bf16 v61, v78, s35, v61
    v_dot2_f32_bf16 v62, v79, s34, v62
    v_dot2_f32_bf16 v63, v79, s35, v63
    s_waitcnt vmcnt(33)
    v_dot2_f32_bf16 v56, v80, s34, v56
    v_dot2_f32_bf16 v57, v80, s35, v57
    v_dot2_f32_bf16 v58, v81, s34, v58
    v_dot2_f32_bf16 v59, v81, s35, v59
    v_dot2_f32_bf16 v60, v82, s34, v60
    v_dot2_f32_bf16 v61, v82, s35, v61
    v_dot2_f32_bf16 v62, v83, s34, v62
    v_dot2_f32_bf16 v63, v83, s35, v63
    s_waitcnt vmcnt(32)
    v_dot2_f32_bf16 v56, v84, s34, v56
    v_dot2_f32_bf16 v57, v84, s35, v57
    v_dot2_f32_bf16 v58, v85, s34, v58
    v_dot2_f32_bf16 v59, v85, s35, v59
    v_dot2_f32_bf16 v60, v86, s34, v60
    v_dot2_f32_bf16 v61, v86, s35, v61
    v_dot2_f32_bf16 v62, v87, s34, v62
    v_dot2_f32_bf16 v63, v87, s35, v63
    s_waitcnt vmcnt(31)
    v_dot2_f32_bf16 v56, v88, s34, v56
    v_dot2_f32_bf16 v57, v88, s35, v57
    v_dot2_f32_bf16 v58, v89, s34, v58
    v_dot2_f32_bf16 v59, v89, s35, v59
    v_dot2_f32_bf16 v60, v90, s34, v60
    v_dot2_f32_bf16 v61, v90, s35, v61
    v_dot2_f32_bf16 v62, v91, s34, v62
    v_dot2_f32_bf16 v63, v91, s35, v63
    s_waitcnt vmcnt(30)
    v_dot2_f32_bf16 v56, v92, s34, v56
    v_dot2_f32_bf16 v57, v92, s35, v57
    v_dot2_f32_bf16 v58, v93, s34, v58
    v_dot2_f32_bf16 v59, v93, s35, v59
    v_dot2_f32_bf16 v60, v94, s34, v60
    v_dot2_f32_bf16 v61, v94, s35, v61
    v_dot2_f32_bf16 v62, v95, s34, v62
    v_dot2_f32_bf16 v63, v95, s35, v63
    s_waitcnt vmcnt(29)
    v_dot2_f32_bf16 v56, v96, s34, v56
    v_dot2_f32_bf16 v57, v96, s35, v57
    v_dot2_f32_bf16 v58, v97, s34, v58
    v_dot2_f32_bf16 v59, v97, s35, v59
    v_dot2_f32_bf16 v60, v98, s34, v60
    v_dot2_f32_bf16 v61, v98, s35, v61
    v_dot2_f32_bf16 v62, v99, s34, v62
    v_dot2_f32_bf16 v63, v99, s35, v63
    s_waitcnt vmcnt(28)
    v_dot2_f32_bf16 v56, v100, s34, v56
    v_dot2_f32_bf16 v57, v100, s35, v57
    v_dot2_f32_bf16 v58, v101, s34, v58
    v_dot2_f32_bf16 v59, v101, s35, v59
    v_dot2_f32_bf16 v60, v102, s34, v60
    v_dot2_f32_bf16 v61, v102, s35, v61
    v_dot2_f32_bf16 v62, v103, s34, v62
    v_dot2_f32_bf16 v63, v103, s35, v63
    s_waitcnt vmcnt(27)
    v_dot2_f32_bf16 v56, v104, s34, v56
    v_dot2_f32_bf16 v57, v104, s35, v57
    v_dot2_f32_bf16 v58, v105, s34, v58
    v_dot2_f32_bf16 v59, v105, s35, v59
    v_dot2_f32_bf16 v60, v106, s34, v60
    v_dot2_f32_bf16 v61, v106, s35, v61
    v_dot2_f32_bf16 v62, v107, s34, v62
    v_dot2_f32_bf16 v63, v107, s35, v63
    s_waitcnt vmcnt(26)
    v_dot2_f32_bf16 v56, v108, s34, v56
    v_dot2_f32_bf16 v57, v108, s35, v57
    v_dot2_f32_bf16 v58, v109, s34, v58
    v_dot2_f32_bf16 v59, v109, s35, v59
    v_dot2_f32_bf16 v60, v110, s34, v60
    v_dot2_f32_bf16 v61, v110, s35, v61
    v_dot2_f32_bf16 v62, v111, s34, v62
    v_dot2_f32_bf16 v63, v111, s35, v63
    s_waitcnt vmcnt(25)
    v_dot2_f32_bf16 v56, v112, s34, v56
    v_dot2_f32_bf16 v57, v112, s35, v57
    v_dot2_f32_bf16 v58, v113, s34, v58
    v_dot2_f32_bf16 v59, v113, s35, v59
    v_dot2_f32_bf16 v60, v114, s34, v60
    v_dot2_f32_bf16 v61, v114, s35, v61
    v_dot2_f32_bf16 v62, v115, s34, v62
    v_dot2_f32_bf16 v63, v115, s35, v63
    s_waitcnt vmcnt(24)
    v_dot2_f32_bf16 v56, v116, s34, v56
    v_dot2_f32_bf16 v57, v116, s35, v57
    v_dot2_f32_bf16 v58, v117, s34, v58
    v_dot2_f32_bf16 v59, v117, s35, v59
    v_dot2_f32_bf16 v60, v118, s34, v60
    v_dot2_f32_bf16 v61, v118, s35, v61
    v_dot2_f32_bf16 v62, v119, s34, v62
    v_dot2_f32_bf16 v63, v119, s35, v63
    s_waitcnt vmcnt(23)
    v_dot2_f32_bf16 v56, v120, s34, v56
    v_dot2_f32_bf16 v57, v120, s35, v57
    v_dot2_f32_bf16 v58, v121, s34, v58
    v_dot2_f32_bf16 v59, v121, s35, v59
    v_dot2_f32_bf16 v60, v122, s34, v60
    v_dot2_f32_bf16 v61, v122, s35, v61
    v_dot2_f32_bf16 v62, v123, s34, v62
    v_dot2_f32_bf16 v63, v123, s35, v63
    s_waitcnt vmcnt(22)
    v_dot2_f32_bf16 v56, v124, s34, v56
    v_dot2_f32_bf16 v57, v124, s35, v57
    v_dot2_f32_bf16 v58, v125, s34, v58
    v_dot2_f32_bf16 v59, v125, s35, v59
    v_dot2_f32_bf16 v60, v126, s34, v60
    v_dot2_f32_bf16 v61, v126, s35, v61
    v_dot2_f32_bf16 v62, v127, s34, v62
    v_dot2_f32_bf16 v63, v127, s35, v63
    s_waitcnt vmcnt(21)
    v_dot2_f32_bf16 v56, v128, s34, v56
    v_dot2_f32_bf16 v57, v128, s35, v57
    v_dot2_f32_bf16 v58, v129, s34, v58
    v_dot2_f32_bf16 v59, v129, s35, v59
    v_dot2_f32_bf16 v60, v130, s34, v60
    v_dot2_f32_bf16 v61, v130, s35, v61
    v_dot2_f32_bf16 v62, v131, s34, v62
    v_dot2_f32_bf16 v63, v131, s35, v63
    s_waitcnt vmcnt(20)
    v_dot2_f32_bf16 v56, v132, s34, v56
    v_dot2_f32_bf16 v57, v132, s35, v57
    v_dot2_f32_bf16 v58, v133, s34, v58
    v_dot2_f32_bf16 v59, v133, s35, v59
    v_dot2_f32_bf16 v60, v134, s34, v60
    v_dot2_f32_bf16 v61, v134, s35, v61
    v_dot2_f32_bf16 v62, v135, s34, v62
    v_dot2_f32_bf16 v63, v135, s35, v63
    s_lshl_b32 s34, s28, 11
    s_add_u32 s34, s34, 124416
    v_add_u32 v5, s34, v15
    ds_write_b128 v5, v[56:59]
    ds_write_b128 v5, v[60:63] offset:16
    s_mov_b64 exec, 0xffff
    v_lshl_add_u32 v14, v1, 4, s34
    ds_read_b128 v[64:67], v14 offset:0
    ds_read_b128 v[68:71], v14 offset:256
    ds_read_b128 v[72:75], v14 offset:512
    ds_read_b128 v[76:79], v14 offset:768
    ds_read_b128 v[80:83], v14 offset:1024
    ds_read_b128 v[84:87], v14 offset:1280
    ds_read_b128 v[88:91], v14 offset:1536
    ds_read_b128 v[92:95], v14 offset:1792
    s_waitcnt lgkmcnt(6)
    v_pk_add_f32 v[64:65], v[64:65], v[68:69]
    v_pk_add_f32 v[66:67], v[66:67], v[70:71]
    s_waitcnt lgkmcnt(5)
    v_pk_add_f32 v[64:65], v[64:65], v[72:73]
    v_pk_add_f32 v[66:67], v[66:67], v[74:75]
    s_waitcnt lgkmcnt(4)
    v_pk_add_f32 v[64:65], v[64:65], v[76:77]
    v_pk_add_f32 v[66:67], v[66:67], v[78:79]
    s_waitcnt lgkmcnt(3)
    v_pk_add_f32 v[64:65], v[64:65], v[80:81]
    v_pk_add_f32 v[66:67], v[66:67], v[82:83]
    s_waitcnt lgkmcnt(2)
    v_pk_add_f32 v[64:65], v[64:65], v[84:85]
    v_pk_add_f32 v[66:67], v[66:67], v[86:87]
    s_waitcnt lgkmcnt(1)
    v_pk_add_f32 v[64:65], v[64:65], v[88:89]
    v_pk_add_f32 v[66:67], v[66:67], v[90:91]
    s_waitcnt lgkmcnt(0)
    v_pk_add_f32 v[64:65], v[64:65], v[92:93]
    v_pk_add_f32 v[66:67], v[66:67], v[94:95]
    ds_write_b128 v14, v[64:67]
    s_mov_b64 exec, -1
    s_lshl_b32 s49, s29, 2
    s_cmp_eq_u32 s3, 30
    s_cselect_b32 s34, 0, 2147483632
    v_or_b32 v254, s34, v11
    s_waitcnt vmcnt(18)
    s_waitcnt lgkmcnt(0)
    s_barrier
    s_mov_b64 exec, 0xffff
    v_lshlrev_b32 v14, 4, v1
    v_add_u32 v14, 124416, v14
    v_add_u32 v10, 8192, v14
    ds_read_b128 v[16:19], v14 offset:0
    ds_read_b128 v[20:23], v14 offset:2048
    ds_read_b128 v[24:27], v14 offset:4096
    ds_read_b128 v[28:31], v14 offset:6144
    s_lshl_b32 s34, s54, 8
    s_add_u32 s34, s34, 32768
    v_lshlrev_b32 v12, 4, v1
    v_lshl_add_u32 v12, s28, 30, v12
    s_waitcnt lgkmcnt(0)
    v_pk_add_f32 v[16:17], v[16:17], v[20:21]
    v_pk_add_f32 v[18:19], v[18:19], v[22:23]
    v_pk_add_f32 v[24:25], v[24:25], v[28:29]
    v_pk_add_f32 v[26:27], v[26:27], v[30:31]
    v_pk_add_f32 v[16:17], v[16:17], v[24:25]
    v_pk_add_f32 v[18:19], v[18:19], v[26:27]
    buffer_store_dwordx4 v[16:19], v12, s[16:19], s34 offen sc1
    s_mov_b64 exec, -1
    s_mul_i32 s34, s28, 9600
    s_add_u32 s34, s34, 86016
    v_mul_u32_u24 v5, 1184, v2
    v_lshl_add_u32 v5, v3, 4, v5
    v_add_u32 v5, s34, v5
    v_mul_f32 v242, v240, v241
    v_pk_fma_f32 v[168:169], v[168:169], v[240:241], v[242:243] op_sel:[0,1,0] op_sel_hi:[1,1,0] neg_lo:[0,0,1] neg_hi:[0,0,1]
    v_pk_fma_f32 v[170:171], v[170:171], v[240:241], v[242:243] op_sel:[0,1,0] op_sel_hi:[1,1,0] neg_lo:[0,0,1] neg_hi:[0,0,1]
    v_pk_fma_f32 v[172:173], v[172:173], v[240:241], v[242:243] op_sel:[0,1,0] op_sel_hi:[1,1,0] neg_lo:[0,0,1] neg_hi:[0,0,1]
    v_pk_fma_f32 v[174:175], v[174:175], v[240:241], v[242:243] op_sel:[0,1,0] op_sel_hi:[1,1,0] neg_lo:[0,0,1] neg_hi:[0,0,1]
    v_cvt_pk_bf16_f32 v16, v168, v169
    v_cvt_pk_bf16_f32 v17, v170, v171
    v_cvt_pk_bf16_f32 v18, v172, v173
    v_cvt_pk_bf16_f32 v19, v174, v175
    ds_write_b128 v5, v[16:19] offset:0
    v_pk_fma_f32 v[176:177], v[176:177], v[240:241], v[242:243] op_sel:[0,1,0] op_sel_hi:[1,1,0] neg_lo:[0,0,1] neg_hi:[0,0,1]
    v_pk_fma_f32 v[178:179], v[178:179], v[240:241], v[242:243] op_sel:[0,1,0] op_sel_hi:[1,1,0] neg_lo:[0,0,1] neg_hi:[0,0,1]
    v_pk_fma_f32 v[180:181], v[180:181], v[240:241], v[242:243] op_sel:[0,1,0] op_sel_hi:[1,1,0] neg_lo:[0,0,1] neg_hi:[0,0,1]
    v_pk_fma_f32 v[182:183], v[182:183], v[240:241], v[242:243] op_sel:[0,1,0] op_sel_hi:[1,1,0] neg_lo:[0,0,1] neg_hi:[0,0,1]
    v_cvt_pk_bf16_f32 v20, v176, v177
    v_cvt_pk_bf16_f32 v21, v178, v179
    v_cvt_pk_bf16_f32 v22, v180, v181
    v_cvt_pk_bf16_f32 v23, v182, v183
    ds_write_b128 v5, v[20:23] offset:128
    v_pk_fma_f32 v[184:185], v[184:185], v[240:241], v[242:243] op_sel:[0,1,0] op_sel_hi:[1,1,0] neg_lo:[0,0,1] neg_hi:[0,0,1]
    v_pk_fma_f32 v[186:187], v[186:187], v[240:241], v[242:243] op_sel:[0,1,0] op_sel_hi:[1,1,0] neg_lo:[0,0,1] neg_hi:[0,0,1]
    v_pk_fma_f32 v[188:189], v[188:189], v[240:241], v[242:243] op_sel:[0,1,0] op_sel_hi:[1,1,0] neg_lo:[0,0,1] neg_hi:[0,0,1]
    v_pk_fma_f32 v[190:191], v[190:191], v[240:241], v[242:243] op_sel:[0,1,0] op_sel_hi:[1,1,0] neg_lo:[0,0,1] neg_hi:[0,0,1]
    v_cvt_pk_bf16_f32 v24, v184, v185
    v_cvt_pk_bf16_f32 v25, v186, v187
    v_cvt_pk_bf16_f32 v26, v188, v189
    v_cvt_pk_bf16_f32 v27, v190, v191
    ds_write_b128 v5, v[24:27] offset:256
    v_lshlrev_b32 v6, 2, v0
    v_and_b32 v6, 0x300, v6
    v_mov_b32 v7, 1
    v_add_u32 v167, 1, v167
    s_waitcnt vmcnt(0)
    s_cmp_eq_u32 s3, 99
    s_cselect_b64 exec, 7, 3
    buffer_store_dword v167, v166, s[16:19], 0 offen sc1
    buffer_store_dword v7, v6, s[24:27], s49 offen sc1
    s_mov_b64 exec, -1
    v_pk_fma_f32 v[192:193], v[192:193], v[240:241], v[242:243] op_sel:[0,1,0] op_sel_hi:[1,1,0] neg_lo:[0,0,1] neg_hi:[0,0,1]
    v_pk_fma_f32 v[194:195], v[194:195], v[240:241], v[242:243] op_sel:[0,1,0] op_sel_hi:[1,1,0] neg_lo:[0,0,1] neg_hi:[0,0,1]
    v_pk_fma_f32 v[196:197], v[196:197], v[240:241], v[242:243] op_sel:[0,1,0] op_sel_hi:[1,1,0] neg_lo:[0,0,1] neg_hi:[0,0,1]
    v_pk_fma_f32 v[198:199], v[198:199], v[240:241], v[242:243] op_sel:[0,1,0] op_sel_hi:[1,1,0] neg_lo:[0,0,1] neg_hi:[0,0,1]
    v_cvt_pk_bf16_f32 v28, v192, v193
    v_cvt_pk_bf16_f32 v29, v194, v195
    v_cvt_pk_bf16_f32 v30, v196, v197
    v_cvt_pk_bf16_f32 v31, v198, v199
    ds_write_b128 v5, v[28:31] offset:384
    buffer_load_dwordx4 a[96:99], v254, s[8:11], s61 offen
    s_add_u32 s61, s61, 73728
    buffer_load_dwordx4 a[100:103], v254, s[8:11], s61 offen
    s_add_u32 s61, s61, 73728
    buffer_load_dwordx4 a[104:107], v254, s[8:11], s61 offen
    s_add_u32 s61, s61, 73728
    v_pk_fma_f32 v[200:201], v[200:201], v[240:241], v[242:243] op_sel:[0,1,0] op_sel_hi:[1,1,0] neg_lo:[0,0,1] neg_hi:[0,0,1]
    v_pk_fma_f32 v[202:203], v[202:203], v[240:241], v[242:243] op_sel:[0,1,0] op_sel_hi:[1,1,0] neg_lo:[0,0,1] neg_hi:[0,0,1]
    v_pk_fma_f32 v[204:205], v[204:205], v[240:241], v[242:243] op_sel:[0,1,0] op_sel_hi:[1,1,0] neg_lo:[0,0,1] neg_hi:[0,0,1]
    v_pk_fma_f32 v[206:207], v[206:207], v[240:241], v[242:243] op_sel:[0,1,0] op_sel_hi:[1,1,0] neg_lo:[0,0,1] neg_hi:[0,0,1]
    v_cvt_pk_bf16_f32 v32, v200, v201
    v_cvt_pk_bf16_f32 v33, v202, v203
    v_cvt_pk_bf16_f32 v34, v204, v205
    v_cvt_pk_bf16_f32 v35, v206, v207
    ds_write_b128 v5, v[32:35] offset:512
    buffer_load_dwordx4 a[108:111], v254, s[8:11], s61 offen
    s_add_u32 s61, s61, 73728
    buffer_load_dwordx4 a[112:115], v254, s[8:11], s61 offen
    s_add_u32 s61, s61, 73728
    buffer_load_dwordx4 a[116:119], v254, s[8:11], s61 offen
    s_add_u32 s61, s61, 73728
    v_pk_fma_f32 v[208:209], v[208:209], v[240:241], v[242:243] op_sel:[0,1,0] op_sel_hi:[1,1,0] neg_lo:[0,0,1] neg_hi:[0,0,1]
    v_pk_fma_f32 v[210:211], v[210:211], v[240:241], v[242:243] op_sel:[0,1,0] op_sel_hi:[1,1,0] neg_lo:[0,0,1] neg_hi:[0,0,1]
    v_pk_fma_f32 v[212:213], v[212:213], v[240:241], v[242:243] op_sel:[0,1,0] op_sel_hi:[1,1,0] neg_lo:[0,0,1] neg_hi:[0,0,1]
    v_pk_fma_f32 v[214:215], v[214:215], v[240:241], v[242:243] op_sel:[0,1,0] op_sel_hi:[1,1,0] neg_lo:[0,0,1] neg_hi:[0,0,1]
    v_cvt_pk_bf16_f32 v36, v208, v209
    v_cvt_pk_bf16_f32 v37, v210, v211
    v_cvt_pk_bf16_f32 v38, v212, v213
    v_cvt_pk_bf16_f32 v39, v214, v215
    ds_write_b128 v5, v[36:39] offset:640
    buffer_load_dwordx4 a[120:123], v254, s[8:11], s61 offen
    s_add_u32 s61, s61, 73728
    buffer_load_dwordx4 a[124:127], v254, s[8:11], s61 offen
    s_add_u32 s61, s61, 73728
    buffer_load_dwordx4 a[128:131], v254, s[8:11], s61 offen
    s_add_u32 s61, s61, 73728
    v_pk_fma_f32 v[216:217], v[216:217], v[240:241], v[242:243] op_sel:[0,1,0] op_sel_hi:[1,1,0] neg_lo:[0,0,1] neg_hi:[0,0,1]
    v_pk_fma_f32 v[218:219], v[218:219], v[240:241], v[242:243] op_sel:[0,1,0] op_sel_hi:[1,1,0] neg_lo:[0,0,1] neg_hi:[0,0,1]
    v_pk_fma_f32 v[220:221], v[220:221], v[240:241], v[242:243] op_sel:[0,1,0] op_sel_hi:[1,1,0] neg_lo:[0,0,1] neg_hi:[0,0,1]
    v_pk_fma_f32 v[222:223], v[222:223], v[240:241], v[242:243] op_sel:[0,1,0] op_sel_hi:[1,1,0] neg_lo:[0,0,1] neg_hi:[0,0,1]
    v_cvt_pk_bf16_f32 v40, v216, v217
    v_cvt_pk_bf16_f32 v41, v218, v219
    v_cvt_pk_bf16_f32 v42, v220, v221
    v_cvt_pk_bf16_f32 v43, v222, v223
    ds_write_b128 v5, v[40:43] offset:768
    buffer_load_dwordx4 a[132:135], v254, s[8:11], s61 offen
    s_add_u32 s61, s61, 73728
    buffer_load_dwordx4 a[136:139], v254, s[8:11], s61 offen
    s_add_u32 s61, s61, 73728
    buffer_load_dwordx4 a[140:143], v254, s[8:11], s61 offen
    s_add_u32 s61, s61, 73728
    v_pk_fma_f32 v[224:225], v[224:225], v[240:241], v[242:243] op_sel:[0,1,0] op_sel_hi:[1,1,0] neg_lo:[0,0,1] neg_hi:[0,0,1]
    v_pk_fma_f32 v[226:227], v[226:227], v[240:241], v[242:243] op_sel:[0,1,0] op_sel_hi:[1,1,0] neg_lo:[0,0,1] neg_hi:[0,0,1]
    v_pk_fma_f32 v[228:229], v[228:229], v[240:241], v[242:243] op_sel:[0,1,0] op_sel_hi:[1,1,0] neg_lo:[0,0,1] neg_hi:[0,0,1]
    v_pk_fma_f32 v[230:231], v[230:231], v[240:241], v[242:243] op_sel:[0,1,0] op_sel_hi:[1,1,0] neg_lo:[0,0,1] neg_hi:[0,0,1]
    v_cvt_pk_bf16_f32 v44, v224, v225
    v_cvt_pk_bf16_f32 v45, v226, v227
    v_cvt_pk_bf16_f32 v46, v228, v229
    v_cvt_pk_bf16_f32 v47, v230, v231
    ds_write_b128 v5, v[44:47] offset:896
    buffer_load_dwordx4 a[144:147], v254, s[8:11], s61 offen
    s_add_u32 s61, s61, 73728
    buffer_load_dwordx4 a[148:151], v254, s[8:11], s61 offen
    s_add_u32 s61, s61, 73728
    buffer_load_dwordx4 a[152:155], v254, s[8:11], s61 offen
    s_add_u32 s61, s61, 73728
    v_pk_fma_f32 v[232:233], v[232:233], v[240:241], v[242:243] op_sel:[0,1,0] op_sel_hi:[1,1,0] neg_lo:[0,0,1] neg_hi:[0,0,1]
    v_pk_fma_f32 v[234:235], v[234:235], v[240:241], v[242:243] op_sel:[0,1,0] op_sel_hi:[1,1,0] neg_lo:[0,0,1] neg_hi:[0,0,1]
    v_pk_fma_f32 v[236:237], v[236:237], v[240:241], v[242:243] op_sel:[0,1,0] op_sel_hi:[1,1,0] neg_lo:[0,0,1] neg_hi:[0,0,1]
    v_pk_fma_f32 v[238:239], v[238:239], v[240:241], v[242:243] op_sel:[0,1,0] op_sel_hi:[1,1,0] neg_lo:[0,0,1] neg_hi:[0,0,1]
    v_cvt_pk_bf16_f32 v48, v232, v233
    v_cvt_pk_bf16_f32 v49, v234, v235
    v_cvt_pk_bf16_f32 v50, v236, v237
    v_cvt_pk_bf16_f32 v51, v238, v239
    ds_write_b128 v5, v[48:51] offset:1024
    buffer_load_dwordx4 a[156:159], v254, s[8:11], s61 offen
    s_add_u32 s61, s61, 73728
    buffer_load_dwordx4 a[160:163], v254, s[8:11], s61 offen
    s_add_u32 s61, s61, 73728
    buffer_load_dwordx4 a[164:167], v254, s[8:11], s61 offen
    s_add_u32 s61, s61, 73728
    v_lshrrev_b32 v2, 4, v1
    v_bfe_u32 v3, v1, 2, 2
    s_mul_i32 s34, s28, 8448
    v_lshl_add_u32 v16, v1, 3, s34
    v_and_b32 v4, 15, v1
    v_lshrrev_b32 v5, 2, v4
    v_and_b32 v6, 3, v4
    v_lshl_add_u32 v7, v2, 4, s34
    v_mov_b32 v8, 528
    v_mad_u32_u24 v17, v4, v8, v7
    v_lshl_add_u32 v9, v5, 1, v6
    v_mad_u32_u24 v18, v9, v8, v7
    v_lshrrev_b32 v9, 1, v5
    v_mul_u32_u24 v9, 5, v9
    v_and_b32 v10, 1, v5
    v_lshl_add_u32 v9, v10, 1, v9
    v_add_u32 v9, v9, v6
    v_mad_u32_u24 v19, v9, v8, v7
    v_mul_u32_u24 v9, 3, v5
    v_add_u32 v9, v9, v6
    v_mad_u32_u24 v20, v9, v8, v7
    s_mul_i32 s34, s28, 4352
    s_add_u32 s34, s34, 33904
    v_lshl_add_u32 v7, v4, 4, s34
    v_lshl_add_u32 v21, v2, 2, v7
    v_lshrrev_b32 v9, 1, v2
    v_lshlrev_b32 v9, 8, v9
    v_and_b32 v10, 1, v2
    v_lshl_add_u32 v9, v10, 3, v9
    v_add_u32 v22, v9, v7
    v_lshl_add_u32 v23, v2, 8, v7
    s_sub_u32 s34, s3, 24
    s_mul_i32 s35, s34, 4
    s_sub_u32 s34, s34, 6
    s_mul_i32 s34, s34, 0
    s_add_u32 s34, s34, 24
    s_cmp_lt_u32 s29, 48
    s_cselect_b32 s34, s35, s34
    s_mul_i32 s34, s34, 27648
    s_mul_i32 s35, s28, 54
    v_min_u32 v253, 53, v1
    v_add_lshl_u32 v253, v253, s35, 7
    s_and_b32 s60, s2, 3
    s_lshl_b32 s60, s60, 1
    s_bfe_u32 s35, s2, 0x10002
    s_add_u32 s60, s60, s35
    s_mul_i32 s60, s60, 663552
    s_add_u32 s60, s60, s34
    s_mov_b32 s14, 5308416
    v_and_b32 v4, 3, v1
    v_mul_u32_u24 v5, 9600, v2
    v_mul_u32_u24 v6, 1184, v3
    v_lshl_add_u32 v5, v4, 3, v5
    s_mul_i32 s34, s28, 288
    s_add_u32 s34, s34, 86016
    v_add3_u32 v5, v5, v6, s34
    v_and_b32 v6, 15, v1
    v_lshlrev_b32 v6, 12, v6
    v_lshl_add_u32 v252, v2, 4, v6
    s_mul_i32 s55, s28, 589824
    s_lshl_b32 s35, s53, 6
    s_add_u32 s55, s55, s35
    s_add_u32 s55, s55, 65536
    s_waitcnt lgkmcnt(0)
    s_barrier
    s_cmp_ge_u32 s29, 48
    s_cbranch_scc1 L_rare_helper
L_back_helper:
L_ssm:
    ds_read_b64_tr_b16 v[64:65], v5 offset:0
    ds_read_b64_tr_b16 v[66:67], v5 offset:4736
    ds_read_b64_tr_b16 v[68:69], v5 offset:32
    ds_read_b64_tr_b16 v[70:71], v5 offset:4768
    ds_read_b64_tr_b16 v[72:73], v5 offset:64
    ds_read_b64_tr_b16 v[74:75], v5 offset:4800
    ds_read_b64_tr_b16 v[76:77], v5 offset:96
    ds_read_b64_tr_b16 v[78:79], v5 offset:4832
    ds_read_b64_tr_b16 v[80:81], v5 offset:128
    ds_read_b64_tr_b16 v[82:83], v5 offset:4864
    ds_read_b64_tr_b16 v[84:85], v5 offset:160
    ds_read_b64_tr_b16 v[86:87], v5 offset:4896
    ds_read_b64_tr_b16 v[88:89], v5 offset:192
    ds_read_b64_tr_b16 v[90:91], v5 offset:4928
    ds_read_b64_tr_b16 v[92:93], v5 offset:224
    ds_read_b64_tr_b16 v[94:95], v5 offset:4960
    ds_read_b64_tr_b16 v[96:97], v5 offset:256
    ds_read_b64_tr_b16 v[98:99], v5 offset:4992
    s_mul_i32 s34, s28, 32
    v_min_u32 v146, 31, v1
    v_add_lshl_u32 v146, v146, s34, 7
    v_add_u32 v146, L_ssm-L_pc, v146
    v_min_u32 v146, L_end-L_pc, v146
    global_load_dword v147, v146, s[56:57]
    v_lshlrev_b32 v136, 4, v1
    s_lshl_b32 s50, s33, 12
    s_add_u32 s50, s50, 65536
    s_mul_i32 s51, s28, 8448
    s_add_u32 s51, s51, 86016
    v_lshl_add_u32 v142, v1, 4, s51
    v_and_b32 v4, 3, v1
    v_and_b32 v5, 1, v3
    v_mul_u32_u24 v5, 4228, v5
    v_lshl_add_u32 v5, v4, 3, v5
    v_lshlrev_b32 v6, 5, v2
    v_lshl_add_u32 v6, v3, 2, v6
    v_sub_u32 v5, v5, v6
    s_add_u32 s34, s51, 112
    v_add_u32 v137, s34, v5
    v_and_b32 v4, 15, v1
    v_lshrrev_b32 v5, 2, v4
    v_bfe_u32 v6, v4, 1, 1
    v_lshl_add_u32 v5, v6, 2, v5
    v_add_u32 v5, v5, v2
    v_and_b32 v6, 1, v4
    v_mul_u32_u24 v6, 2176, v6
    v_lshl_add_u32 v5, v5, 4, v6
    s_mul_i32 s34, s28, 4352
    s_add_u32 s34, s34, 33792
    v_add_u32 v138, s34, v5
    s_lshl_b32 s34, s28, 1
    s_add_u32 s34, s34, 0
    v_lshl_add_u32 v139, v1, 3, s34
    s_mul_i32 s34, s28, 4352
    s_add_u32 s34, s34, 68608
    v_lshl_add_u32 v145, v1, 4, s34
    s_lshl_b32 s34, s28, 12
    v_add_u32 v140, s34, v136
    v_add_u32 v140, 0, v140
    s_sub_u32 s52, s33, s28
    s_lshl_b32 s52, s52, 12
    s_add_u32 s52, s52, s34
    s_add_u32 s52, s52, 2424832
    s_add_u32 s34, s51, 4256
    v_mov_b32 v141, s34
    s_lshl_b64 s[30:31], 1, 63
    v_lshlrev_b32 v143, 2, v0
    s_waitcnt lgkmcnt(0)
    v_lshlrev_b32 v4, 16, v160
    v_mul_f32 v5, 0x3fb8aa3b, v4
    v_exp_f32 v5, v5
    v_lshlrev_b32 v6, 16, v148
    v_and_b32 v7, s58, v148
    v_mul_f32 v6, 0x3fb8aa3b, v6
    v_mul_f32 v7, 0x3fb8aa3b, v7
    v_exp_f32 v6, v6
    v_exp_f32 v7, v7
    v_cvt_pk_bf16_f32 v5, v5, v5
    v_and_b32 v44, s58, v5
    v_cvt_pk_bf16_f32 v6, v6, v7
    v_and_b32 v7, s58, v6
    v_lshlrev_b32 v6, 16, v6
    v_mul_f32 v6, v6, v44
    v_mul_f32 v7, v7, v44
    v_mul_f32 v6, 0xbfb8aa3b, v6
    v_mul_f32 v7, 0xbfb8aa3b, v7
    v_lshlrev_b32 v8, 16, v149
    v_and_b32 v9, s58, v149
    v_mul_f32 v8, v8, v44
    v_mul_f32 v9, v9, v44
    v_mul_f32 v8, 0.15915494, v8
    v_mul_f32 v9, 0.15915494, v9
    v_add_f32 v5, v44, v44
    v_lshlrev_b32 v168, 16, v150
    v_lshlrev_b32 v169, 16, v151
    v_and_b32 v170, s58, v150
    v_and_b32 v171, s58, v151
    v_mul_f32 v168, v168, v5
    v_mul_f32 v169, v169, v5
    v_mul_f32 v170, v170, v5
    v_mul_f32 v171, v171, v5
    v_mul_f32 v40, 0x41800000, v6
    v_mul_f32 v41, 0x41800000, v8
    v_exp_f32 v40, v40
    v_fract_f32 v41, v41
    v_mul_f32 v42, 0x41800000, v7
    v_mul_f32 v43, 0x41800000, v9
    v_exp_f32 v42, v42
    v_fract_f32 v43, v43
    v_cos_f32 v28, v41
    v_sin_f32 v29, v41
    v_cos_f32 v30, v43
    v_sin_f32 v31, v43
    v_mul_f32 v28, v28, v40
    v_mul_f32 v29, -v29, v40
    v_mul_f32 v30, v30, v42
    v_mul_f32 v31, -v31, v42
    v_exp_f32 v40, v6
    v_fract_f32 v41, v8
    v_exp_f32 v42, v7
    v_fract_f32 v43, v9
    v_cos_f32 v24, v41
    v_sin_f32 v25, v41
    v_cos_f32 v26, v43
    v_sin_f32 v27, v43
    v_mul_f32 v24, v24, v40
    v_mul_f32 v25, v25, v40
    v_mul_f32 v26, v26, v42
    v_mul_f32 v27, v27, v42
    v_mul_f32 v40, 0x43800000, v6
    v_mul_f32 v41, 0x43800000, v8
    v_exp_f32 v40, v40
    v_fract_f32 v41, v41
    v_mul_f32 v42, 0x43800000, v7
    v_mul_f32 v43, 0x43800000, v9
    v_exp_f32 v42, v42
    v_fract_f32 v43, v43
    v_cos_f32 v32, v41
    v_sin_f32 v33, v41
    v_cos_f32 v34, v43
    v_sin_f32 v35, v43
    v_mul_f32 v32, v32, v40
    v_mul_f32 v33, v33, v40
    v_mul_f32 v34, v34, v42
    v_mul_f32 v35, v35, v42
    v_mov_b32 v100, 0x3f80
    v_mov_b32 v101, 0x3f80
    ds_write_b64 v16, v[100:101] offset:0
    buffer_store_dwordx4 v[64:67], v252, s[16:19], s55 offen sc1
    s_add_u32 s55, s55, 65536
    v_cvt_pk_bf16_f32 v102, v28, v29
    v_cvt_pk_bf16_f32 v103, v30, v31
    ds_write_b64 v16, v[102:103] offset:528
    v_pk_mul_f32 v[40:41], v[28:29], v[28:29] op_sel_hi:[1,0]
    v_pk_mul_f32 v[42:43], v[30:31], v[30:31] op_sel_hi:[1,0]
    v_pk_fma_f32 v[36:37], v[28:29], v[28:29], v[40:41] op_sel:[1,1,0] op_sel_hi:[0,1,1] neg_lo:[1,0,0]
    v_pk_fma_f32 v[38:39], v[30:31], v[30:31], v[42:43] op_sel:[1,1,0] op_sel_hi:[0,1,1] neg_lo:[1,0,0]
    v_cvt_pk_bf16_f32 v104, v36, v37
    v_cvt_pk_bf16_f32 v105, v38, v39
    ds_write_b64 v16, v[104:105] offset:1056
    v_pk_mul_f32 v[40:41], v[36:37], v[28:29] op_sel_hi:[1,0]
    v_pk_mul_f32 v[42:43], v[38:39], v[30:31] op_sel_hi:[1,0]
    v_pk_fma_f32 v[36:37], v[36:37], v[28:29], v[40:41] op_sel:[1,1,0] op_sel_hi:[0,1,1] neg_lo:[1,0,0]
    v_pk_fma_f32 v[38:39], v[38:39], v[30:31], v[42:43] op_sel:[1,1,0] op_sel_hi:[0,1,1] neg_lo:[1,0,0]
    v_cvt_pk_bf16_f32 v106, v36, v37
    v_cvt_pk_bf16_f32 v107, v38, v39
    ds_write_b64 v16, v[106:107] offset:1584
    v_pk_mul_f32 v[40:41], v[36:37], v[28:29] op_sel_hi:[1,0]
    v_pk_mul_f32 v[42:43], v[38:39], v[30:31] op_sel_hi:[1,0]
    v_pk_fma_f32 v[36:37], v[36:37], v[28:29], v[40:41] op_sel:[1,1,0] op_sel_hi:[0,1,1] neg_lo:[1,0,0]
    v_pk_fma_f32 v[38:39], v[38:39], v[30:31], v[42:43] op_sel:[1,1,0] op_sel_hi:[0,1,1] neg_lo:[1,0,0]
    v_cvt_pk_bf16_f32 v108, v36, v37
    v_cvt_pk_bf16_f32 v109, v38, v39
    ds_write_b64 v16, v[108:109] offset:2112
    v_pk_mul_f32 v[40:41], v[36:37], v[28:29] op_sel_hi:[1,0]
    v_pk_mul_f32 v[42:43], v[38:39], v[30:31] op_sel_hi:[1,0]
    v_pk_fma_f32 v[36:37], v[36:37], v[28:29], v[40:41] op_sel:[1,1,0] op_sel_hi:[0,1,1] neg_lo:[1,0,0]
    v_pk_fma_f32 v[38:39], v[38:39], v[30:31], v[42:43] op_sel:[1,1,0] op_sel_hi:[0,1,1] neg_lo:[1,0,0]
    v_cvt_pk_bf16_f32 v110, v36, v37
    v_cvt_pk_bf16_f32 v111, v38, v39
    ds_write_b64 v16, v[110:111] offset:2640
    v_pk_mul_f32 v[40:41], v[36:37], v[28:29] op_sel_hi:[1,0]
    v_pk_mul_f32 v[42:43], v[38:39], v[30:31] op_sel_hi:[1,0]
    v_pk_fma_f32 v[36:37], v[36:37], v[28:29], v[40:41] op_sel:[1,1,0] op_sel_hi:[0,1,1] neg_lo:[1,0,0]
    v_pk_fma_f32 v[38:39], v[38:39], v[30:31], v[42:43] op_sel:[1,1,0] op_sel_hi:[0,1,1] neg_lo:[1,0,0]
    v_cvt_pk_bf16_f32 v112, v36, v37
    v_cvt_pk_bf16_f32 v113, v38, v39
    ds_write_b64 v16, v[112:113] offset:3168
    v_pk_mul_f32 v[40:41], v[36:37], v[28:29] op_sel_hi:[1,0]
    v_pk_mul_f32 v[42:43], v[38:39], v[30:31] op_sel_hi:[1,0]
    v_pk_fma_f32 v[36:37], v[36:37], v[28:29], v[40:41] op_sel:[1,1,0] op_sel_hi:[0,1,1] neg_lo:[1,0,0]
    v_pk_fma_f32 v[38:39], v[38:39], v[30:31], v[42:43] op_sel:[1,1,0] op_sel_hi:[0,1,1] neg_lo:[1,0,0]
    v_cvt_pk_bf16_f32 v114, v36, v37
    v_cvt_pk_bf16_f32 v115, v38, v39
    ds_write_b64 v16, v[114:115] offset:3696
    buffer_store_dwordx4 v[68:71], v252, s[16:19], s55 offen sc1
    s_add_u32 s55, s55, 65536
    v_pk_mul_f32 v[40:41], v[36:37], v[28:29] op_sel_hi:[1,0]
    v_pk_mul_f32 v[42:43], v[38:39], v[30:31] op_sel_hi:[1,0]
    v_pk_fma_f32 v[36:37], v[36:37], v[28:29], v[40:41] op_sel:[1,1,0] op_sel_hi:[0,1,1] neg_lo:[1,0,0]
    v_pk_fma_f32 v[38:39], v[38:39], v[30:31], v[42:43] op_sel:[1,1,0] op_sel_hi:[0,1,1] neg_lo:[1,0,0]
    v_cvt_pk_bf16_f32 v116, v36, v37
    v_cvt_pk_bf16_f32 v117, v38, v39
    ds_write_b64 v16, v[116:117] offset:4224
    v_pk_mul_f32 v[40:41], v[36:37], v[28:29] op_sel_hi:[1,0]
    v_pk_mul_f32 v[42:43], v[38:39], v[30:31] op_sel_hi:[1,0]
    v_pk_fma_f32 v[36:37], v[36:37], v[28:29], v[40:41] op_sel:[1,1,0] op_sel_hi:[0,1,1] neg_lo:[1,0,0]
    v_pk_fma_f32 v[38:39], v[38:39], v[30:31], v[42:43] op_sel:[1,1,0] op_sel_hi:[0,1,1] neg_lo:[1,0,0]
    v_cvt_pk_bf16_f32 v118, v36, v37
    v_cvt_pk_bf16_f32 v119, v38, v39
    ds_write_b64 v16, v[118:119] offset:4752
    v_pk_mul_f32 v[40:41], v[36:37], v[28:29] op_sel_hi:[1,0]
    v_pk_mul_f32 v[42:43], v[38:39], v[30:31] op_sel_hi:[1,0]
    v_pk_fma_f32 v[36:37], v[36:37], v[28:29], v[40:41] op_sel:[1,1,0] op_sel_hi:[0,1,1] neg_lo:[1,0,0]
    v_pk_fma_f32 v[38:39], v[38:39], v[30:31], v[42:43] op_sel:[1,1,0] op_sel_hi:[0,1,1] neg_lo:[1,0,0]
    v_cvt_pk_bf16_f32 v100, v36, v37
    v_cvt_pk_bf16_f32 v101, v38, v39
    ds_write_b64 v16, v[100:101] offset:5280
    v_pk_mul_f32 v[40:41], v[36:37], v[28:29] op_sel_hi:[1,0]
    v_pk_mul_f32 v[42:43], v[38:39], v[30:31] op_sel_hi:[1,0]
    v_pk_fma_f32 v[36:37], v[36:37], v[28:29], v[40:41] op_sel:[1,1,0] op_sel_hi:[0,1,1] neg_lo:[1,0,0]
    v_pk_fma_f32 v[38:39], v[38:39], v[30:31], v[42:43] op_sel:[1,1,0] op_sel_hi:[0,1,1] neg_lo:[1,0,0]
    v_cvt_pk_bf16_f32 v102, v36, v37
    v_cvt_pk_bf16_f32 v103, v38, v39
    ds_write_b64 v16, v[102:103] offset:5808
    v_pk_mul_f32 v[40:41], v[36:37], v[28:29] op_sel_hi:[1,0]
    v_pk_mul_f32 v[42:43], v[38:39], v[30:31] op_sel_hi:[1,0]
    v_pk_fma_f32 v[36:37], v[36:37], v[28:29], v[40:41] op_sel:[1,1,0] op_sel_hi:[0,1,1] neg_lo:[1,0,0]
    v_pk_fma_f32 v[38:39], v[38:39], v[30:31], v[42:43] op_sel:[1,1,0] op_sel_hi:[0,1,1] neg_lo:[1,0,0]
    v_cvt_pk_bf16_f32 v104, v36, v37
    v_cvt_pk_bf16_f32 v105, v38, v39
    ds_write_b64 v16, v[104:105] offset:6336
    v_pk_mul_f32 v[40:41], v[36:37], v[28:29] op_sel_hi:[1,0]
    v_pk_mul_f32 v[42:43], v[38:39], v[30:31] op_sel_hi:[1,0]
    v_pk_fma_f32 v[36:37], v[36:37], v[28:29], v[40:41] op_sel:[1,1,0] op_sel_hi:[0,1,1] neg_lo:[1,0,0]
    v_pk_fma_f32 v[38:39], v[38:39], v[30:31], v[42:43] op_sel:[1,1,0] op_sel_hi:[0,1,1] neg_lo:[1,0,0]
    v_cvt_pk_bf16_f32 v106, v36, v37
    v_cvt_pk_bf16_f32 v107, v38, v39
    ds_write_b64 v16, v[106:107] offset:6864
    v_pk_mul_f32 v[40:41], v[36:37], v[28:29] op_sel_hi:[1,0]
    v_pk_mul_f32 v[42:43], v[38:39], v[30:31] op_sel_hi:[1,0]
    v_pk_fma_f32 v[36:37], v[36:37], v[28:29], v[40:41] op_sel:[1,1,0] op_sel_hi:[0,1,1] neg_lo:[1,0,0]
    v_pk_fma_f32 v[38:39], v[38:39], v[30:31], v[42:43] op_sel:[1,1,0] op_sel_hi:[0,1,1] neg_lo:[1,0,0]
    v_cvt_pk_bf16_f32 v108, v36, v37
    v_cvt_pk_bf16_f32 v109, v38, v39
    ds_write_b64 v16, v[108:109] offset:7392
    buffer_store_dwordx4 v[72:75], v252, s[16:19], s55 offen sc1
    s_add_u32 s55, s55, 65536
    v_pk_mul_f32 v[40:41], v[36:37], v[28:29] op_sel_hi:[1,0]
    v_pk_mul_f32 v[42:43], v[38:39], v[30:31] op_sel_hi:[1,0]
    v_pk_fma_f32 v[36:37], v[36:37], v[28:29], v[40:41] op_sel:[1,1,0] op_sel_hi:[0,1,1] neg_lo:[1,0,0]
    v_pk_fma_f32 v[38:39], v[38:39], v[30:31], v[42:43] op_sel:[1,1,0] op_sel_hi:[0,1,1] neg_lo:[1,0,0]
    v_cvt_pk_bf16_f32 v110, v36, v37
    v_cvt_pk_bf16_f32 v111, v38, v39
    ds_write_b64 v16, v[110:111] offset:7920
    v_cvt_pk_bf16_f32 v112, v168, v169
    ds_read_b128 a[0:3], v17 offset:0
    v_cvt_pk_bf16_f32 v113, v170, v171
    v_pk_mul_f32 v[40:41], v[168:169], v[24:25] op_sel_hi:[1,0]
    v_pk_mul_f32 v[42:43], v[170:171], v[26:27] op_sel_hi:[1,0]
    ds_read_b128 a[4:7], v17 offset:64
    v_pk_fma_f32 v[204:205], v[168:169], v[24:25], v[40:41] op_sel:[1,1,0] op_sel_hi:[0,1,1] neg_lo:[1,0,0]
    v_pk_fma_f32 v[206:207], v[170:171], v[26:27], v[42:43] op_sel:[1,1,0] op_sel_hi:[0,1,1] neg_lo:[1,0,0]
    v_cvt_pk_bf16_f32 v114, v204, v205
    ds_read_b128 a[8:11], v17 offset:128
    v_cvt_pk_bf16_f32 v115, v206, v207
    v_pk_mul_f32 v[40:41], v[204:205], v[24:25] op_sel_hi:[1,0]
    v_pk_mul_f32 v[42:43], v[206:207], v[26:27] op_sel_hi:[1,0]
    ds_read_b128 a[12:15], v17 offset:192
    v_pk_fma_f32 v[172:173], v[204:205], v[24:25], v[40:41] op_sel:[1,1,0] op_sel_hi:[0,1,1] neg_lo:[1,0,0]
    v_pk_fma_f32 v[174:175], v[206:207], v[26:27], v[42:43] op_sel:[1,1,0] op_sel_hi:[0,1,1] neg_lo:[1,0,0]
    v_cvt_pk_bf16_f32 v116, v172, v173
    ds_read_b128 a[16:19], v17 offset:256
    v_cvt_pk_bf16_f32 v117, v174, v175
    v_pk_mul_f32 v[40:41], v[172:173], v[24:25] op_sel_hi:[1,0]
    v_pk_mul_f32 v[42:43], v[174:175], v[26:27] op_sel_hi:[1,0]
    ds_read_b128 a[20:23], v17 offset:320
    v_pk_fma_f32 v[204:205], v[172:173], v[24:25], v[40:41] op_sel:[1,1,0] op_sel_hi:[0,1,1] neg_lo:[1,0,0]
    v_pk_fma_f32 v[206:207], v[174:175], v[26:27], v[42:43] op_sel:[1,1,0] op_sel_hi:[0,1,1] neg_lo:[1,0,0]
    v_cvt_pk_bf16_f32 v118, v204, v205
    ds_read_b128 a[24:27], v17 offset:384
    v_cvt_pk_bf16_f32 v119, v206, v207
    v_pk_mul_f32 v[40:41], v[204:205], v[24:25] op_sel_hi:[1,0]
    v_pk_mul_f32 v[42:43], v[206:207], v[26:27] op_sel_hi:[1,0]
    ds_read_b128 a[28:31], v17 offset:448
    v_pk_fma_f32 v[176:177], v[204:205], v[24:25], v[40:41] op_sel:[1,1,0] op_sel_hi:[0,1,1] neg_lo:[1,0,0]
    v_pk_fma_f32 v[178:179], v[206:207], v[26:27], v[42:43] op_sel:[1,1,0] op_sel_hi:[0,1,1] neg_lo:[1,0,0]
    v_cvt_pk_bf16_f32 v100, v176, v177
    ds_write_b64 v16, v[112:113] offset:0
    v_cvt_pk_bf16_f32 v101, v178, v179
    v_pk_mul_f32 v[40:41], v[176:177], v[24:25] op_sel_hi:[1,0]
    v_pk_mul_f32 v[42:43], v[178:179], v[26:27] op_sel_hi:[1,0]
    ds_write_b64 v16, v[114:115] offset:528
    v_pk_fma_f32 v[204:205], v[176:177], v[24:25], v[40:41] op_sel:[1,1,0] op_sel_hi:[0,1,1] neg_lo:[1,0,0]
    v_pk_fma_f32 v[206:207], v[178:179], v[26:27], v[42:43] op_sel:[1,1,0] op_sel_hi:[0,1,1] neg_lo:[1,0,0]
    v_cvt_pk_bf16_f32 v102, v204, v205
    ds_write_b64 v16, v[116:117] offset:1056
    v_cvt_pk_bf16_f32 v103, v206, v207
    buffer_store_dwordx4 v[76:79], v252, s[16:19], s55 offen sc1
    s_add_u32 s55, s55, 65536
    v_pk_mul_f32 v[40:41], v[204:205], v[24:25] op_sel_hi:[1,0]
    v_pk_mul_f32 v[42:43], v[206:207], v[26:27] op_sel_hi:[1,0]
    ds_write_b64 v16, v[118:119] offset:1584
    v_pk_fma_f32 v[180:181], v[204:205], v[24:25], v[40:41] op_sel:[1,1,0] op_sel_hi:[0,1,1] neg_lo:[1,0,0]
    v_pk_fma_f32 v[182:183], v[206:207], v[26:27], v[42:43] op_sel:[1,1,0] op_sel_hi:[0,1,1] neg_lo:[1,0,0]
    v_cvt_pk_bf16_f32 v104, v180, v181
    ds_write_b64 v16, v[100:101] offset:2112
    v_cvt_pk_bf16_f32 v105, v182, v183
    v_pk_mul_f32 v[40:41], v[180:181], v[24:25] op_sel_hi:[1,0]
    v_pk_mul_f32 v[42:43], v[182:183], v[26:27] op_sel_hi:[1,0]
    ds_write_b64 v16, v[102:103] offset:2640
    v_pk_fma_f32 v[204:205], v[180:181], v[24:25], v[40:41] op_sel:[1,1,0] op_sel_hi:[0,1,1] neg_lo:[1,0,0]
    v_pk_fma_f32 v[206:207], v[182:183], v[26:27], v[42:43] op_sel:[1,1,0] op_sel_hi:[0,1,1] neg_lo:[1,0,0]
    v_cvt_pk_bf16_f32 v106, v204, v205
    ds_write_b64 v16, v[104:105] offset:3168
    v_cvt_pk_bf16_f32 v107, v206, v207
    ds_write_b64 v16, v[106:107] offset:3696
    v_pk_mul_f32 v[40:41], v[204:205], v[24:25] op_sel_hi:[1,0]
    v_pk_mul_f32 v[42:43], v[206:207], v[26:27] op_sel_hi:[1,0]
    v_pk_fma_f32 v[184:185], v[204:205], v[24:25], v[40:41] op_sel:[1,1,0] op_sel_hi:[0,1,1] neg_lo:[1,0,0]
    v_pk_fma_f32 v[186:187], v[206:207], v[26:27], v[42:43] op_sel:[1,1,0] op_sel_hi:[0,1,1] neg_lo:[1,0,0]
    v_cvt_pk_bf16_f32 v108, v184, v185
    v_cvt_pk_bf16_f32 v109, v186, v187
    ds_write_b64 v16, v[108:109] offset:4224
    v_pk_mul_f32 v[40:41], v[184:185], v[24:25] op_sel_hi:[1,0]
    v_pk_mul_f32 v[42:43], v[186:187], v[26:27] op_sel_hi:[1,0]
    v_pk_fma_f32 v[204:205], v[184:185], v[24:25], v[40:41] op_sel:[1,1,0] op_sel_hi:[0,1,1] neg_lo:[1,0,0]
    v_pk_fma_f32 v[206:207], v[186:187], v[26:27], v[42:43] op_sel:[1,1,0] op_sel_hi:[0,1,1] neg_lo:[1,0,0]
    v_cvt_pk_bf16_f32 v110, v204, v205
    v_cvt_pk_bf16_f32 v111, v206, v207
    ds_write_b64 v16, v[110:111] offset:4752
    v_pk_mul_f32 v[40:41], v[204:205], v[24:25] op_sel_hi:[1,0]
    v_pk_mul_f32 v[42:43], v[206:207], v[26:27] op_sel_hi:[1,0]
    v_pk_fma_f32 v[188:189], v[204:205], v[24:25], v[40:41] op_sel:[1,1,0] op_sel_hi:[0,1,1] neg_lo:[1,0,0]
    v_pk_fma_f32 v[190:191], v[206:207], v[26:27], v[42:43] op_sel:[1,1,0] op_sel_hi:[0,1,1] neg_lo:[1,0,0]
    v_cvt_pk_bf16_f32 v112, v188, v189
    v_cvt_pk_bf16_f32 v113, v190, v191
    ds_write_b64 v16, v[112:113] offset:5280
    v_pk_mul_f32 v[40:41], v[188:189], v[24:25] op_sel_hi:[1,0]
    v_pk_mul_f32 v[42:43], v[190:191], v[26:27] op_sel_hi:[1,0]
    v_pk_fma_f32 v[204:205], v[188:189], v[24:25], v[40:41] op_sel:[1,1,0] op_sel_hi:[0,1,1] neg_lo:[1,0,0]
    v_pk_fma_f32 v[206:207], v[190:191], v[26:27], v[42:43] op_sel:[1,1,0] op_sel_hi:[0,1,1] neg_lo:[1,0,0]
    v_cvt_pk_bf16_f32 v114, v204, v205
    v_cvt_pk_bf16_f32 v115, v206, v207
    ds_write_b64 v16, v[114:115] offset:5808
    v_pk_mul_f32 v[40:41], v[204:205], v[24:25] op_sel_hi:[1,0]
    v_pk_mul_f32 v[42:43], v[206:207], v[26:27] op_sel_hi:[1,0]
    v_pk_fma_f32 v[192:193], v[204:205], v[24:25], v[40:41] op_sel:[1,1,0] op_sel_hi:[0,1,1] neg_lo:[1,0,0]
    v_pk_fma_f32 v[194:195], v[206:207], v[26:27], v[42:43] op_sel:[1,1,0] op_sel_hi:[0,1,1] neg_lo:[1,0,0]
    v_cvt_pk_bf16_f32 v116, v192, v193
    v_cvt_pk_bf16_f32 v117, v194, v195
    ds_write_b64 v16, v[116:117] offset:6336
    buffer_store_dwordx4 v[80:83], v252, s[16:19], s55 offen sc1
    s_add_u32 s55, s55, 65536
    v_pk_mul_f32 v[40:41], v[192:193], v[24:25] op_sel_hi:[1,0]
    v_pk_mul_f32 v[42:43], v[194:195], v[26:27] op_sel_hi:[1,0]
    v_pk_fma_f32 v[204:205], v[192:193], v[24:25], v[40:41] op_sel:[1,1,0] op_sel_hi:[0,1,1] neg_lo:[1,0,0]
    v_pk_fma_f32 v[206:207], v[194:195], v[26:27], v[42:43] op_sel:[1,1,0] op_sel_hi:[0,1,1] neg_lo:[1,0,0]
    v_cvt_pk_bf16_f32 v118, v204, v205
    v_cvt_pk_bf16_f32 v119, v206, v207
    ds_write_b64 v16, v[118:119] offset:6864
    v_pk_mul_f32 v[40:41], v[204:205], v[24:25] op_sel_hi:[1,0]
    v_pk_mul_f32 v[42:43], v[206:207], v[26:27] op_sel_hi:[1,0]
    v_pk_fma_f32 v[196:197], v[204:205], v[24:25], v[40:41] op_sel:[1,1,0] op_sel_hi:[0,1,1] neg_lo:[1,0,0]
    v_pk_fma_f32 v[198:199], v[206:207], v[26:27], v[42:43] op_sel:[1,1,0] op_sel_hi:[0,1,1] neg_lo:[1,0,0]
    v_cvt_pk_bf16_f32 v100, v196, v197
    v_cvt_pk_bf16_f32 v101, v198, v199
    ds_write_b64 v16, v[100:101] offset:7392
    v_pk_mul_f32 v[40:41], v[196:197], v[24:25] op_sel_hi:[1,0]
    v_pk_mul_f32 v[42:43], v[198:199], v[26:27] op_sel_hi:[1,0]
    v_pk_fma_f32 v[204:205], v[196:197], v[24:25], v[40:41] op_sel:[1,1,0] op_sel_hi:[0,1,1] neg_lo:[1,0,0]
    v_pk_fma_f32 v[206:207], v[198:199], v[26:27], v[42:43] op_sel:[1,1,0] op_sel_hi:[0,1,1] neg_lo:[1,0,0]
    v_cvt_pk_bf16_f32 v102, v204, v205
    v_cvt_pk_bf16_f32 v103, v206, v207
    ds_write_b64 v16, v[102:103] offset:7920
    v_pk_mul_f32 v[40:41], v[204:205], v[24:25] op_sel_hi:[1,0]
    v_pk_mul_f32 v[42:43], v[206:207], v[26:27] op_sel_hi:[1,0]
    v_pk_fma_f32 v[200:201], v[204:205], v[24:25], v[40:41] op_sel:[1,1,0] op_sel_hi:[0,1,1] neg_lo:[1,0,0]
    v_pk_fma_f32 v[202:203], v[206:207], v[26:27], v[42:43] op_sel:[1,1,0] op_sel_hi:[0,1,1] neg_lo:[1,0,0]
    v_pk_mul_f32 v[40:41], v[168:169], v[32:33] op_sel_hi:[1,0]
    ds_read_b128 a[32:35], v17 offset:0
    v_pk_mul_f32 v[42:43], v[170:171], v[34:35] op_sel_hi:[1,0]
    v_pk_fma_f32 v[168:169], v[168:169], v[32:33], v[40:41] op_sel:[1,1,0] op_sel_hi:[0,1,1] neg_lo:[1,0,0]
    v_pk_fma_f32 v[170:171], v[170:171], v[34:35], v[42:43] op_sel:[1,1,0] op_sel_hi:[0,1,1] neg_lo:[1,0,0]
    ds_read_b128 a[36:39], v17 offset:64
    v_cvt_pk_bf16_f32 v104, v168, v169
    v_cvt_pk_bf16_f32 v105, v170, v171
    v_pk_mul_f32 v[40:41], v[172:173], v[32:33] op_sel_hi:[1,0]
    ds_read_b128 a[40:43], v17 offset:128
    v_pk_mul_f32 v[42:43], v[174:175], v[34:35] op_sel_hi:[1,0]
    v_pk_fma_f32 v[172:173], v[172:173], v[32:33], v[40:41] op_sel:[1,1,0] op_sel_hi:[0,1,1] neg_lo:[1,0,0]
    v_pk_fma_f32 v[174:175], v[174:175], v[34:35], v[42:43] op_sel:[1,1,0] op_sel_hi:[0,1,1] neg_lo:[1,0,0]
    ds_read_b128 a[44:47], v17 offset:192
    v_cvt_pk_bf16_f32 v106, v172, v173
    v_cvt_pk_bf16_f32 v107, v174, v175
    v_pk_mul_f32 v[40:41], v[176:177], v[32:33] op_sel_hi:[1,0]
    ds_read_b128 a[48:51], v17 offset:256
    v_pk_mul_f32 v[42:43], v[178:179], v[34:35] op_sel_hi:[1,0]
    v_pk_fma_f32 v[176:177], v[176:177], v[32:33], v[40:41] op_sel:[1,1,0] op_sel_hi:[0,1,1] neg_lo:[1,0,0]
    v_pk_fma_f32 v[178:179], v[178:179], v[34:35], v[42:43] op_sel:[1,1,0] op_sel_hi:[0,1,1] neg_lo:[1,0,0]
    ds_read_b128 a[52:55], v17 offset:320
    v_cvt_pk_bf16_f32 v108, v176, v177
    v_cvt_pk_bf16_f32 v109, v178, v179
    v_pk_mul_f32 v[40:41], v[180:181], v[32:33] op_sel_hi:[1,0]
    ds_read_b128 a[56:59], v17 offset:384
    v_pk_mul_f32 v[42:43], v[182:183], v[34:35] op_sel_hi:[1,0]
    v_pk_fma_f32 v[180:181], v[180:181], v[32:33], v[40:41] op_sel:[1,1,0] op_sel_hi:[0,1,1] neg_lo:[1,0,0]
    v_pk_fma_f32 v[182:183], v[182:183], v[34:35], v[42:43] op_sel:[1,1,0] op_sel_hi:[0,1,1] neg_lo:[1,0,0]
    ds_read_b128 a[60:63], v17 offset:448
    s_waitcnt lgkmcnt(7)
    v_mfma_f32_16x16x32_bf16 v[208:211], a[32:35], a[0:3], 0
    v_cvt_pk_bf16_f32 v110, v180, v181
    v_cvt_pk_bf16_f32 v111, v182, v183
    ds_write_b64 v16, v[104:105] offset:0
    buffer_store_dwordx4 v[84:87], v252, s[16:19], s55 offen sc1
    s_add_u32 s55, s55, 65536
    v_pk_mul_f32 v[40:41], v[184:185], v[32:33] op_sel_hi:[1,0]
    v_pk_mul_f32 v[42:43], v[186:187], v[34:35] op_sel_hi:[1,0]
    v_pk_fma_f32 v[184:185], v[184:185], v[32:33], v[40:41] op_sel:[1,1,0] op_sel_hi:[0,1,1] neg_lo:[1,0,0]
    ds_write_b64 v16, v[106:107] offset:528
    v_pk_fma_f32 v[186:187], v[186:187], v[34:35], v[42:43] op_sel:[1,1,0] op_sel_hi:[0,1,1] neg_lo:[1,0,0]
    s_waitcnt lgkmcnt(8)
    v_mfma_f32_16x16x32_bf16 v[208:211], a[36:39], a[4:7], v[208:211]
    v_cvt_pk_bf16_f32 v112, v184, v185
    ds_write_b64 v16, v[108:109] offset:1056
    v_cvt_pk_bf16_f32 v113, v186, v187
    v_pk_mul_f32 v[40:41], v[188:189], v[32:33] op_sel_hi:[1,0]
    v_pk_mul_f32 v[42:43], v[190:191], v[34:35] op_sel_hi:[1,0]
    ds_write_b64 v16, v[110:111] offset:1584
    v_pk_fma_f32 v[188:189], v[188:189], v[32:33], v[40:41] op_sel:[1,1,0] op_sel_hi:[0,1,1] neg_lo:[1,0,0]
    v_pk_fma_f32 v[190:191], v[190:191], v[34:35], v[42:43] op_sel:[1,1,0] op_sel_hi:[0,1,1] neg_lo:[1,0,0]
    s_waitcnt lgkmcnt(9)
    v_mfma_f32_16x16x32_bf16 v[208:211], a[40:43], a[8:11], v[208:211]
    ds_write_b64 v16, v[112:113] offset:2112
    v_cvt_pk_bf16_f32 v114, v188, v189
    v_cvt_pk_bf16_f32 v115, v190, v191
    ds_write_b64 v16, v[114:115] offset:2640
    v_pk_mul_f32 v[40:41], v[192:193], v[32:33] op_sel_hi:[1,0]
    v_pk_mul_f32 v[42:43], v[194:195], v[34:35] op_sel_hi:[1,0]
    v_pk_fma_f32 v[192:193], v[192:193], v[32:33], v[40:41] op_sel:[1,1,0] op_sel_hi:[0,1,1] neg_lo:[1,0,0]
    v_pk_fma_f32 v[194:195], v[194:195], v[34:35], v[42:43] op_sel:[1,1,0] op_sel_hi:[0,1,1] neg_lo:[1,0,0]
    s_waitcnt lgkmcnt(10)
    v_mfma_f32_16x16x32_bf16 v[208:211], a[44:47], a[12:15], v[208:211]
    v_cvt_pk_bf16_f32 v116, v192, v193
    v_cvt_pk_bf16_f32 v117, v194, v195
    ds_write_b64 v16, v[116:117] offset:3168
    v_pk_mul_f32 v[40:41], v[196:197], v[32:33] op_sel_hi:[1,0]
    v_pk_mul_f32 v[42:43], v[198:199], v[34:35] op_sel_hi:[1,0]
    v_pk_fma_f32 v[196:197], v[196:197], v[32:33], v[40:41] op_sel:[1,1,0] op_sel_hi:[0,1,1] neg_lo:[1,0,0]
    v_pk_fma_f32 v[198:199], v[198:199], v[34:35], v[42:43] op_sel:[1,1,0] op_sel_hi:[0,1,1] neg_lo:[1,0,0]
    s_waitcnt lgkmcnt(10)
    v_mfma_f32_16x16x32_bf16 v[208:211], a[48:51], a[16:19], v[208:211]
    v_cvt_pk_bf16_f32 v118, v196, v197
    v_cvt_pk_bf16_f32 v119, v198, v199
    ds_write_b64 v16, v[118:119] offset:3696
    v_pk_mul_f32 v[40:41], v[200:201], v[32:33] op_sel_hi:[1,0]
    v_pk_mul_f32 v[42:43], v[202:203], v[34:35] op_sel_hi:[1,0]
    v_pk_fma_f32 v[200:201], v[200:201], v[32:33], v[40:41] op_sel:[1,1,0] op_sel_hi:[0,1,1] neg_lo:[1,0,0]
    v_pk_fma_f32 v[202:203], v[202:203], v[34:35], v[42:43] op_sel:[1,1,0] op_sel_hi:[0,1,1] neg_lo:[1,0,0]
    s_waitcnt lgkmcnt(10)
    v_mfma_f32_16x16x32_bf16 v[208:211], a[52:55], a[20:23], v[208:211]
    v_cvt_pk_bf16_f32 v100, v200, v201
    v_cvt_pk_bf16_f32 v101, v202, v203
    ds_write_b64 v16, v[100:101] offset:4224
    s_waitcnt lgkmcnt(10)
    v_mfma_f32_16x16x32_bf16 v[208:211], a[56:59], a[24:27], v[208:211]
    s_waitcnt lgkmcnt(9)
    v_mfma_f32_16x16x32_bf16 v[208:211], a[60:63], a[28:31], v[208:211]
    v_pk_mul_f32 v[40:41], v[168:169], v[32:33] op_sel_hi:[1,0]
    ds_read_b128 a[32:35], v18 offset:0
    v_pk_mul_f32 v[42:43], v[170:171], v[34:35] op_sel_hi:[1,0]
    v_pk_fma_f32 v[168:169], v[168:169], v[32:33], v[40:41] op_sel:[1,1,0] op_sel_hi:[0,1,1] neg_lo:[1,0,0]
    v_pk_fma_f32 v[170:171], v[170:171], v[34:35], v[42:43] op_sel:[1,1,0] op_sel_hi:[0,1,1] neg_lo:[1,0,0]
    ds_read_b128 a[36:39], v18 offset:64
    v_cvt_pk_bf16_f32 v102, v168, v169
    v_cvt_pk_bf16_f32 v103, v170, v171
    v_pk_mul_f32 v[40:41], v[176:177], v[32:33] op_sel_hi:[1,0]
    ds_read_b128 a[40:43], v18 offset:128
    v_pk_mul_f32 v[42:43], v[178:179], v[34:35] op_sel_hi:[1,0]
    v_pk_fma_f32 v[176:177], v[176:177], v[32:33], v[40:41] op_sel:[1,1,0] op_sel_hi:[0,1,1] neg_lo:[1,0,0]
    v_pk_fma_f32 v[178:179], v[178:179], v[34:35], v[42:43] op_sel:[1,1,0] op_sel_hi:[0,1,1] neg_lo:[1,0,0]
    ds_read_b128 a[44:47], v18 offset:192
    v_cvt_pk_bf16_f32 v104, v176, v177
    v_cvt_pk_bf16_f32 v105, v178, v179
    buffer_store_dwordx4 v[88:91], v252, s[16:19], s55 offen sc1
    s_add_u32 s55, s55, 65536
    v_pk_mul_f32 v[40:41], v[184:185], v[32:33] op_sel_hi:[1,0]
    ds_read_b128 a[48:51], v18 offset:256
    v_pk_mul_f32 v[42:43], v[186:187], v[34:35] op_sel_hi:[1,0]
    v_pk_fma_f32 v[184:185], v[184:185], v[32:33], v[40:41] op_sel:[1,1,0] op_sel_hi:[0,1,1] neg_lo:[1,0,0]
    v_pk_fma_f32 v[186:187], v[186:187], v[34:35], v[42:43] op_sel:[1,1,0] op_sel_hi:[0,1,1] neg_lo:[1,0,0]
    ds_read_b128 a[52:55], v18 offset:320
    s_waitcnt lgkmcnt(5)
    v_mfma_f32_16x16x32_bf16 v[212:215], a[32:35], a[0:3], 0
    v_cvt_pk_bf16_f32 v106, v184, v185
    v_cvt_pk_bf16_f32 v107, v186, v187
    ds_read_b128 a[56:59], v18 offset:384
    v_pk_mul_f32 v[40:41], v[192:193], v[32:33] op_sel_hi:[1,0]
    v_pk_mul_f32 v[42:43], v[194:195], v[34:35] op_sel_hi:[1,0]
    v_pk_fma_f32 v[192:193], v[192:193], v[32:33], v[40:41] op_sel:[1,1,0] op_sel_hi:[0,1,1] neg_lo:[1,0,0]
    ds_read_b128 a[60:63], v18 offset:448
    v_pk_fma_f32 v[194:195], v[194:195], v[34:35], v[42:43] op_sel:[1,1,0] op_sel_hi:[0,1,1] neg_lo:[1,0,0]
    s_waitcnt lgkmcnt(6)
    v_mfma_f32_16x16x32_bf16 v[212:215], a[36:39], a[4:7], v[212:215]
    v_cvt_pk_bf16_f32 v108, v192, v193
    ds_write_b64 v16, v[102:103] offset:0
    v_cvt_pk_bf16_f32 v109, v194, v195
    v_pk_mul_f32 v[40:41], v[200:201], v[32:33] op_sel_hi:[1,0]
    v_pk_mul_f32 v[42:43], v[202:203], v[34:35] op_sel_hi:[1,0]
    ds_write_b64 v16, v[104:105] offset:528
    v_pk_fma_f32 v[200:201], v[200:201], v[32:33], v[40:41] op_sel:[1,1,0] op_sel_hi:[0,1,1] neg_lo:[1,0,0]
    v_pk_fma_f32 v[202:203], v[202:203], v[34:35], v[42:43] op_sel:[1,1,0] op_sel_hi:[0,1,1] neg_lo:[1,0,0]
    s_waitcnt lgkmcnt(7)
    v_mfma_f32_16x16x32_bf16 v[212:215], a[40:43], a[8:11], v[212:215]
    ds_write_b64 v16, v[106:107] offset:1056
    v_cvt_pk_bf16_f32 v110, v200, v201
    v_cvt_pk_bf16_f32 v111, v202, v203
    v_pk_mul_f32 v[40:41], v[168:169], v[32:33] op_sel_hi:[1,0]
    ds_write_b64 v16, v[108:109] offset:1584
    v_pk_mul_f32 v[42:43], v[170:171], v[34:35] op_sel_hi:[1,0]
    v_pk_fma_f32 v[168:169], v[168:169], v[32:33], v[40:41] op_sel:[1,1,0] op_sel_hi:[0,1,1] neg_lo:[1,0,0]
    v_pk_fma_f32 v[170:171], v[170:171], v[34:35], v[42:43] op_sel:[1,1,0] op_sel_hi:[0,1,1] neg_lo:[1,0,0]
    ds_write_b64 v16, v[110:111] offset:2112
    s_waitcnt lgkmcnt(9)
    v_mfma_f32_16x16x32_bf16 v[212:215], a[44:47], a[12:15], v[212:215]
    v_cvt_pk_bf16_f32 v112, v168, v169
    v_cvt_pk_bf16_f32 v113, v170, v171
    ds_write_b64 v16, v[112:113] offset:2640
    v_pk_mul_f32 v[40:41], v[176:177], v[32:33] op_sel_hi:[1,0]
    v_pk_mul_f32 v[42:43], v[178:179], v[34:35] op_sel_hi:[1,0]
    v_pk_fma_f32 v[176:177], v[176:177], v[32:33], v[40:41] op_sel:[1,1,0] op_sel_hi:[0,1,1] neg_lo:[1,0,0]
    v_pk_fma_f32 v[178:179], v[178:179], v[34:35], v[42:43] op_sel:[1,1,0] op_sel_hi:[0,1,1] neg_lo:[1,0,0]
    s_waitcnt lgkmcnt(9)
    v_mfma_f32_16x16x32_bf16 v[212:215], a[48:51], a[16:19], v[212:215]
    v_cvt_pk_bf16_f32 v114, v176, v177
    v_cvt_pk_bf16_f32 v115, v178, v179
    ds_write_b64 v16, v[114:115] offset:3168
    v_pk_mul_f32 v[40:41], v[184:185], v[32:33] op_sel_hi:[1,0]
    v_pk_mul_f32 v[42:43], v[186:187], v[34:35] op_sel_hi:[1,0]
    v_pk_fma_f32 v[184:185], v[184:185], v[32:33], v[40:41] op_sel:[1,1,0] op_sel_hi:[0,1,1] neg_lo:[1,0,0]
    v_pk_fma_f32 v[186:187], v[186:187], v[34:35], v[42:43] op_sel:[1,1,0] op_sel_hi:[0,1,1] neg_lo:[1,0,0]
    s_waitcnt lgkmcnt(9)
    v_mfma_f32_16x16x32_bf16 v[212:215], a[52:55], a[20:23], v[212:215]
    v_cvt_pk_bf16_f32 v116, v184, v185
    v_cvt_pk_bf16_f32 v117, v186, v187
    ds_write_b64 v16, v[116:117] offset:3696
    v_pk_mul_f32 v[40:41], v[192:193], v[32:33] op_sel_hi:[1,0]
    v_pk_mul_f32 v[42:43], v[194:195], v[34:35] op_sel_hi:[1,0]
    v_pk_fma_f32 v[192:193], v[192:193], v[32:33], v[40:41] op_sel:[1,1,0] op_sel_hi:[0,1,1] neg_lo:[1,0,0]
    v_pk_fma_f32 v[194:195], v[194:195], v[34:35], v[42:43] op_sel:[1,1,0] op_sel_hi:[0,1,1] neg_lo:[1,0,0]
    s_waitcnt lgkmcnt(9)
    v_mfma_f32_16x16x32_bf16 v[212:215], a[56:59], a[24:27], v[212:215]
    v_cvt_pk_bf16_f32 v118, v192, v193
    v_cvt_pk_bf16_f32 v119, v194, v195
    ds_write_b64 v16, v[118:119] offset:4224
    buffer_store_dwordx4 v[92:95], v252, s[16:19], s55 offen sc1
    s_add_u32 s55, s55, 65536
    v_pk_mul_f32 v[40:41], v[200:201], v[32:33] op_sel_hi:[1,0]
    v_pk_mul_f32 v[42:43], v[202:203], v[34:35] op_sel_hi:[1,0]
    v_pk_fma_f32 v[200:201], v[200:201], v[32:33], v[40:41] op_sel:[1,1,0] op_sel_hi:[0,1,1] neg_lo:[1,0,0]
    v_pk_fma_f32 v[202:203], v[202:203], v[34:35], v[42:43] op_sel:[1,1,0] op_sel_hi:[0,1,1] neg_lo:[1,0,0]
    s_waitcnt lgkmcnt(9)
    v_mfma_f32_16x16x32_bf16 v[212:215], a[60:63], a[28:31], v[212:215]
    v_cvt_pk_bf16_f32 v100, v200, v201
    v_cvt_pk_bf16_f32 v101, v202, v203
    ds_write_b64 v16, v[100:101] offset:4752
    v_lshlrev_b32 v4, 16, v161
    ds_read_b128 a[32:35], v19 offset:0
    v_cmp_eq_u32 vcc, 0, v1
    s_nop 1
    v_cndmask_b32 v4, 0, v4, vcc
    v_add_f32 v208, v208, v4
    ds_read_b128 a[36:39], v19 offset:64
    v_cvt_pk_bf16_f32 v122, v208, v210
    v_cvt_pk_bf16_f32 v123, v209, v211
    v_pk_mul_f32 v[40:41], v[168:169], v[32:33] op_sel_hi:[1,0]
    ds_read_b128 a[40:43], v19 offset:128
    v_pk_mul_f32 v[42:43], v[170:171], v[34:35] op_sel_hi:[1,0]
    v_pk_fma_f32 v[168:169], v[168:169], v[32:33], v[40:41] op_sel:[1,1,0] op_sel_hi:[0,1,1] neg_lo:[1,0,0]
    v_pk_fma_f32 v[170:171], v[170:171], v[34:35], v[42:43] op_sel:[1,1,0] op_sel_hi:[0,1,1] neg_lo:[1,0,0]
    ds_read_b128 a[44:47], v19 offset:192
    v_cvt_pk_bf16_f32 v102, v168, v169
    v_cvt_pk_bf16_f32 v103, v170, v171
    v_pk_mul_f32 v[40:41], v[184:185], v[32:33] op_sel_hi:[1,0]
    ds_read_b128 a[48:51], v19 offset:256
    v_pk_mul_f32 v[42:43], v[186:187], v[34:35] op_sel_hi:[1,0]
    v_pk_fma_f32 v[184:185], v[184:185], v[32:33], v[40:41] op_sel:[1,1,0] op_sel_hi:[0,1,1] neg_lo:[1,0,0]
    v_pk_fma_f32 v[186:187], v[186:187], v[34:35], v[42:43] op_sel:[1,1,0] op_sel_hi:[0,1,1] neg_lo:[1,0,0]
    ds_read_b128 a[52:55], v19 offset:320
    v_cvt_pk_bf16_f32 v104, v184, v185
    v_cvt_pk_bf16_f32 v105, v186, v187
    v_pk_mul_f32 v[40:41], v[200:201], v[32:33] op_sel_hi:[1,0]
    ds_read_b128 a[56:59], v19 offset:384
    v_pk_mul_f32 v[42:43], v[202:203], v[34:35] op_sel_hi:[1,0]
    v_pk_fma_f32 v[200:201], v[200:201], v[32:33], v[40:41] op_sel:[1,1,0] op_sel_hi:[0,1,1] neg_lo:[1,0,0]
    v_pk_fma_f32 v[202:203], v[202:203], v[34:35], v[42:43] op_sel:[1,1,0] op_sel_hi:[0,1,1] neg_lo:[1,0,0]
    ds_read_b128 a[60:63], v19 offset:448
    v_cvt_pk_bf16_f32 v106, v200, v201
    v_cvt_pk_bf16_f32 v107, v202, v203
    v_pk_mul_f32 v[40:41], v[168:169], v[32:33] op_sel_hi:[1,0]
    ds_write_b32 v21, v122 offset:0
    v_pk_mul_f32 v[42:43], v[170:171], v[34:35] op_sel_hi:[1,0]
    v_pk_fma_f32 v[168:169], v[168:169], v[32:33], v[40:41] op_sel:[1,1,0] op_sel_hi:[0,1,1] neg_lo:[1,0,0]
    v_pk_fma_f32 v[170:171], v[170:171], v[34:35], v[42:43] op_sel:[1,1,0] op_sel_hi:[0,1,1] neg_lo:[1,0,0]
    ds_write_b32 v21, v123 offset:2176
    s_waitcnt lgkmcnt(9)
    v_mfma_f32_16x16x32_bf16 v[216:219], a[32:35], a[0:3], 0
    v_cvt_pk_bf16_f32 v108, v168, v169
    v_cvt_pk_bf16_f32 v109, v170, v171
    ds_write_b64 v16, v[102:103] offset:0
    v_pk_mul_f32 v[40:41], v[184:185], v[32:33] op_sel_hi:[1,0]
    v_pk_mul_f32 v[42:43], v[186:187], v[34:35] op_sel_hi:[1,0]
    v_pk_fma_f32 v[184:185], v[184:185], v[32:33], v[40:41] op_sel:[1,1,0] op_sel_hi:[0,1,1] neg_lo:[1,0,0]
    ds_write_b64 v16, v[104:105] offset:528
    v_pk_fma_f32 v[186:187], v[186:187], v[34:35], v[42:43] op_sel:[1,1,0] op_sel_hi:[0,1,1] neg_lo:[1,0,0]
    s_waitcnt lgkmcnt(10)
    v_mfma_f32_16x16x32_bf16 v[216:219], a[36:39], a[4:7], v[216:219]
    v_cvt_pk_bf16_f32 v110, v184, v185
    ds_write_b64 v16, v[106:107] offset:1056
    v_cvt_pk_bf16_f32 v111, v186, v187
    v_pk_mul_f32 v[40:41], v[200:201], v[32:33] op_sel_hi:[1,0]
    v_pk_mul_f32 v[42:43], v[202:203], v[34:35] op_sel_hi:[1,0]
    ds_write_b64 v16, v[108:109] offset:1584
    v_pk_fma_f32 v[200:201], v[200:201], v[32:33], v[40:41] op_sel:[1,1,0] op_sel_hi:[0,1,1] neg_lo:[1,0,0]
    v_pk_fma_f32 v[202:203], v[202:203], v[34:35], v[42:43] op_sel:[1,1,0] op_sel_hi:[0,1,1] neg_lo:[1,0,0]
    s_waitcnt lgkmcnt(11)
    v_mfma_f32_16x16x32_bf16 v[216:219], a[40:43], a[8:11], v[216:219]
    ds_write_b64 v16, v[110:111] offset:2112
    v_cvt_pk_bf16_f32 v112, v200, v201
    v_cvt_pk_bf16_f32 v113, v202, v203
    ds_write_b64 v16, v[112:113] offset:2640
    buffer_store_dwordx4 v[96:99], v252, s[16:19], s55 offen sc1
    v_pk_mul_f32 v[40:41], v[168:169], v[32:33] op_sel_hi:[1,0]
    v_pk_mul_f32 v[42:43], v[170:171], v[34:35] op_sel_hi:[1,0]
    v_pk_fma_f32 v[168:169], v[168:169], v[32:33], v[40:41] op_sel:[1,1,0] op_sel_hi:[0,1,1] neg_lo:[1,0,0]
    v_pk_fma_f32 v[170:171], v[170:171], v[34:35], v[42:43] op_sel:[1,1,0] op_sel_hi:[0,1,1] neg_lo:[1,0,0]
    s_waitcnt lgkmcnt(12)
    v_mfma_f32_16x16x32_bf16 v[216:219], a[44:47], a[12:15], v[216:219]
    v_cvt_pk_bf16_f32 v114, v168, v169
    v_cvt_pk_bf16_f32 v115, v170, v171
    ds_write_b64 v16, v[114:115] offset:3168
    v_pk_mul_f32 v[40:41], v[184:185], v[32:33] op_sel_hi:[1,0]
    v_pk_mul_f32 v[42:43], v[186:187], v[34:35] op_sel_hi:[1,0]
    v_pk_fma_f32 v[184:185], v[184:185], v[32:33], v[40:41] op_sel:[1,1,0] op_sel_hi:[0,1,1] neg_lo:[1,0,0]
    v_pk_fma_f32 v[186:187], v[186:187], v[34:35], v[42:43] op_sel:[1,1,0] op_sel_hi:[0,1,1] neg_lo:[1,0,0]
    s_waitcnt lgkmcnt(12)
    v_mfma_f32_16x16x32_bf16 v[216:219], a[48:51], a[16:19], v[216:219]
    v_cvt_pk_bf16_f32 v116, v184, v185
    v_cvt_pk_bf16_f32 v117, v186, v187
    ds_write_b64 v16, v[116:117] offset:3696
    v_pk_mul_f32 v[40:41], v[200:201], v[32:33] op_sel_hi:[1,0]
    v_pk_mul_f32 v[42:43], v[202:203], v[34:35] op_sel_hi:[1,0]
    v_pk_fma_f32 v[200:201], v[200:201], v[32:33], v[40:41] op_sel:[1,1,0] op_sel_hi:[0,1,1] neg_lo:[1,0,0]
    v_pk_fma_f32 v[202:203], v[202:203], v[34:35], v[42:43] op_sel:[1,1,0] op_sel_hi:[0,1,1] neg_lo:[1,0,0]
    s_waitcnt lgkmcnt(12)
    v_mfma_f32_16x16x32_bf16 v[216:219], a[52:55], a[20:23], v[216:219]
    v_cvt_pk_bf16_f32 v118, v200, v201
    v_cvt_pk_bf16_f32 v119, v202, v203
    ds_write_b64 v16, v[118:119] offset:4224
    v_pk_mul_f32 v[40:41], v[168:169], v[32:33] op_sel_hi:[1,0]
    v_pk_mul_f32 v[42:43], v[170:171], v[34:35] op_sel_hi:[1,0]
    v_pk_fma_f32 v[168:169], v[168:169], v[32:33], v[40:41] op_sel:[1,1,0] op_sel_hi:[0,1,1] neg_lo:[1,0,0]
    v_pk_fma_f32 v[170:171], v[170:171], v[34:35], v[42:43] op_sel:[1,1,0] op_sel_hi:[0,1,1] neg_lo:[1,0,0]
    s_waitcnt lgkmcnt(12)
    v_mfma_f32_16x16x32_bf16 v[216:219], a[56:59], a[24:27], v[216:219]
    v_cvt_pk_bf16_f32 v100, v168, v169
    v_cvt_pk_bf16_f32 v101, v170, v171
    ds_write_b64 v16, v[100:101] offset:4752
    v_pk_mul_f32 v[40:41], v[184:185], v[32:33] op_sel_hi:[1,0]
    v_pk_mul_f32 v[42:43], v[186:187], v[34:35] op_sel_hi:[1,0]
    v_pk_fma_f32 v[184:185], v[184:185], v[32:33], v[40:41] op_sel:[1,1,0] op_sel_hi:[0,1,1] neg_lo:[1,0,0]
    v_pk_fma_f32 v[186:187], v[186:187], v[34:35], v[42:43] op_sel:[1,1,0] op_sel_hi:[0,1,1] neg_lo:[1,0,0]
    s_waitcnt lgkmcnt(12)
    v_mfma_f32_16x16x32_bf16 v[216:219], a[60:63], a[28:31], v[216:219]
    v_cvt_pk_bf16_f32 v102, v184, v185
    v_cvt_pk_bf16_f32 v103, v186, v187
    ds_write_b64 v16, v[102:103] offset:5280
    v_pk_mul_f32 v[40:41], v[200:201], v[32:33] op_sel_hi:[1,0]
    v_pk_mul_f32 v[42:43], v[202:203], v[34:35] op_sel_hi:[1,0]
    v_pk_fma_f32 v[200:201], v[200:201], v[32:33], v[40:41] op_sel:[1,1,0] op_sel_hi:[0,1,1] neg_lo:[1,0,0]
    v_pk_fma_f32 v[202:203], v[202:203], v[34:35], v[42:43] op_sel:[1,1,0] op_sel_hi:[0,1,1] neg_lo:[1,0,0]
    v_cvt_pk_bf16_f32 v104, v200, v201
    v_cvt_pk_bf16_f32 v105, v202, v203
    ds_write_b64 v16, v[104:105] offset:5808
    v_cvt_pk_bf16_f32 v126, v212, v213
    ds_read_b128 a[32:35], v20 offset:0
    v_cvt_pk_bf16_f32 v127, v212, v214
    v_cvt_pk_bf16_f32 v128, v216, v216
    v_cvt_pk_bf16_f32 v129, v217, v218
    ds_read_b128 a[36:39], v20 offset:64
    v_cvt_pk_bf16_f32 v130, v216, v217
    v_cvt_pk_bf16_f32 v131, v217, v218
    s_waitcnt lgkmcnt(1)
    v_mfma_f32_16x16x32_bf16 v[220:223], a[32:35], a[0:3], 0
    ds_read_b128 a[40:43], v20 offset:128
    v_lshlrev_b32 v4, 16, v162
    v_mul_f32 v5, 0x3fb8aa3b, v4
    v_exp_f32 v5, v5
    ds_read_b128 a[44:47], v20 offset:192
    v_lshlrev_b32 v6, 16, v152
    v_and_b32 v7, s58, v152
    s_waitcnt lgkmcnt(2)
    v_mfma_f32_16x16x32_bf16 v[220:223], a[36:39], a[4:7], v[220:223]
    ds_read_b128 a[48:51], v20 offset:256
    v_mul_f32 v6, 0x3fb8aa3b, v6
    v_mul_f32 v7, 0x3fb8aa3b, v7
    v_exp_f32 v6, v6
    ds_read_b128 a[52:55], v20 offset:320
    v_exp_f32 v7, v7
    s_waitcnt lgkmcnt(3)
    v_mfma_f32_16x16x32_bf16 v[220:223], a[40:43], a[8:11], v[220:223]
    v_cvt_pk_bf16_f32 v5, v5, v5
    ds_read_b128 a[56:59], v20 offset:384
    v_and_b32 v44, s58, v5
    v_cvt_pk_bf16_f32 v6, v6, v7
    v_and_b32 v7, s58, v6
    ds_read_b128 a[60:63], v20 offset:448
    s_waitcnt lgkmcnt(4)
    v_mfma_f32_16x16x32_bf16 v[220:223], a[44:47], a[12:15], v[220:223]
    v_lshlrev_b32 v6, 16, v6
    v_mul_f32 v6, v6, v44
    ds_write_b32 v21, v126 offset:256
    v_mul_f32 v7, v7, v44
    v_mul_f32 v6, 0xbfb8aa3b, v6
    s_waitcnt lgkmcnt(4)
    v_mfma_f32_16x16x32_bf16 v[220:223], a[48:51], a[16:19], v[220:223]
    ds_write_b32 v21, v127 offset:2432
    v_mul_f32 v7, 0xbfb8aa3b, v7
    v_lshlrev_b32 v8, 16, v153
    v_and_b32 v9, s58, v153
    ds_write_b64 v22, v[128:129] offset:512
    v_mul_f32 v8, v8, v44
    s_waitcnt lgkmcnt(5)
    v_mfma_f32_16x16x32_bf16 v[220:223], a[52:55], a[20:23], v[220:223]
    v_mul_f32 v9, v9, v44
    ds_write_b64 v22, v[130:131] offset:2688
    v_mul_f32 v8, 0.15915494, v8
    v_mul_f32 v9, 0.15915494, v9
    v_add_f32 v5, v44, v44
    s_waitcnt lgkmcnt(5)
    v_mfma_f32_16x16x32_bf16 v[220:223], a[56:59], a[24:27], v[220:223]
    v_lshlrev_b32 v168, 16, v154
    v_lshlrev_b32 v169, 16, v155
    v_and_b32 v170, s58, v154
    v_and_b32 v171, s58, v155
    s_waitcnt lgkmcnt(4)
    v_mfma_f32_16x16x32_bf16 v[220:223], a[60:63], a[28:31], v[220:223]
    v_mul_f32 v168, v168, v5
    v_mul_f32 v169, v169, v5
    v_mul_f32 v170, v170, v5
    v_mul_f32 v171, v171, v5
    v_mul_f32 v40, 0x41800000, v6
    v_mul_f32 v41, 0x41800000, v8
    v_exp_f32 v40, v40
    v_fract_f32 v41, v41
    v_mul_f32 v42, 0x41800000, v7
    v_mul_f32 v43, 0x41800000, v9
    v_exp_f32 v42, v42
    v_fract_f32 v43, v43
    v_cos_f32 v28, v41
    v_sin_f32 v29, v41
    v_cos_f32 v30, v43
    v_sin_f32 v31, v43
    v_mul_f32 v28, v28, v40
    v_mul_f32 v29, -v29, v40
    v_mul_f32 v30, v30, v42
    v_mul_f32 v31, -v31, v42
    v_exp_f32 v40, v6
    v_fract_f32 v41, v8
    v_exp_f32 v42, v7
    v_fract_f32 v43, v9
    v_cos_f32 v24, v41
    v_sin_f32 v25, v41
    v_cos_f32 v26, v43
    v_sin_f32 v27, v43
    v_mul_f32 v24, v24, v40
    v_mul_f32 v25, v25, v40
    v_mul_f32 v26, v26, v42
    v_mul_f32 v27, v27, v42
    v_mul_f32 v40, 0x43800000, v6
    v_mul_f32 v41, 0x43800000, v8
    v_exp_f32 v40, v40
    v_fract_f32 v41, v41
    v_mul_f32 v42, 0x43800000, v7
    v_mul_f32 v43, 0x43800000, v9
    v_exp_f32 v42, v42
    v_fract_f32 v43, v43
    v_cos_f32 v32, v41
    v_sin_f32 v33, v41
    v_cos_f32 v34, v43
    v_sin_f32 v35, v43
    v_mul_f32 v32, v32, v40
    v_mul_f32 v33, v33, v40
    v_mul_f32 v34, v34, v42
    v_mul_f32 v35, v35, v42
    v_cvt_pk_bf16_f32 v4, v220, v220
    v_cvt_pk_bf16_f32 v5, v220, v221
    v_cvt_pk_bf16_f32 v6, v221, v221
    v_cvt_pk_bf16_f32 v7, v222, v222
    v_cvt_pk_bf16_f32 v8, v220, v220
    v_cvt_pk_bf16_f32 v9, v221, v221
    v_cvt_pk_bf16_f32 v10, v221, v221
    v_cvt_pk_bf16_f32 v11, v222, v222
    ds_write_b128 v23, v[4:7] offset:1024
    ds_write_b128 v23, v[8:11] offset:3200
    v_mov_b32 v106, 0x3f80
    v_mov_b32 v107, 0x3f80
    ds_write_b64 v16, v[106:107] offset:0
    v_cvt_pk_bf16_f32 v108, v28, v29
    v_cvt_pk_bf16_f32 v109, v30, v31
    ds_write_b64 v16, v[108:109] offset:528
    v_pk_mul_f32 v[40:41], v[28:29], v[28:29] op_sel_hi:[1,0]
    v_pk_mul_f32 v[42:43], v[30:31], v[30:31] op_sel_hi:[1,0]
    v_pk_fma_f32 v[36:37], v[28:29], v[28:29], v[40:41] op_sel:[1,1,0] op_sel_hi:[0,1,1] neg_lo:[1,0,0]
    v_pk_fma_f32 v[38:39], v[30:31], v[30:31], v[42:43] op_sel:[1,1,0] op_sel_hi:[0,1,1] neg_lo:[1,0,0]
    v_cvt_pk_bf16_f32 v110, v36, v37
    v_cvt_pk_bf16_f32 v111, v38, v39
    ds_write_b64 v16, v[110:111] offset:1056
    v_pk_mul_f32 v[40:41], v[36:37], v[28:29] op_sel_hi:[1,0]
    v_pk_mul_f32 v[42:43], v[38:39], v[30:31] op_sel_hi:[1,0]
    v_pk_fma_f32 v[36:37], v[36:37], v[28:29], v[40:41] op_sel:[1,1,0] op_sel_hi:[0,1,1] neg_lo:[1,0,0]
    v_pk_fma_f32 v[38:39], v[38:39], v[30:31], v[42:43] op_sel:[1,1,0] op_sel_hi:[0,1,1] neg_lo:[1,0,0]
    v_cvt_pk_bf16_f32 v112, v36, v37
    v_cvt_pk_bf16_f32 v113, v38, v39
    ds_write_b64 v16, v[112:113] offset:1584
    v_pk_mul_f32 v[40:41], v[36:37], v[28:29] op_sel_hi:[1,0]
    v_pk_mul_f32 v[42:43], v[38:39], v[30:31] op_sel_hi:[1,0]
    v_pk_fma_f32 v[36:37], v[36:37], v[28:29], v[40:41] op_sel:[1,1,0] op_sel_hi:[0,1,1] neg_lo:[1,0,0]
    v_pk_fma_f32 v[38:39], v[38:39], v[30:31], v[42:43] op_sel:[1,1,0] op_sel_hi:[0,1,1] neg_lo:[1,0,0]
    v_cvt_pk_bf16_f32 v114, v36, v37
    v_cvt_pk_bf16_f32 v115, v38, v39
    ds_write_b64 v16, v[114:115] offset:2112
    v_pk_mul_f32 v[40:41], v[36:37], v[28:29] op_sel_hi:[1,0]
    v_pk_mul_f32 v[42:43], v[38:39], v[30:31] op_sel_hi:[1,0]
    v_pk_fma_f32 v[36:37], v[36:37], v[28:29], v[40:41] op_sel:[1,1,0] op_sel_hi:[0,1,1] neg_lo:[1,0,0]
    v_pk_fma_f32 v[38:39], v[38:39], v[30:31], v[42:43] op_sel:[1,1,0] op_sel_hi:[0,1,1] neg_lo:[1,0,0]
    v_cvt_pk_bf16_f32 v116, v36, v37
    v_cvt_pk_bf16_f32 v117, v38, v39
    ds_write_b64 v16, v[116:117] offset:2640
    v_pk_mul_f32 v[40:41], v[36:37], v[28:29] op_sel_hi:[1,0]
    v_pk_mul_f32 v[42:43], v[38:39], v[30:31] op_sel_hi:[1,0]
    v_pk_fma_f32 v[36:37], v[36:37], v[28:29], v[40:41] op_sel:[1,1,0] op_sel_hi:[0,1,1] neg_lo:[1,0,0]
    v_pk_fma_f32 v[38:39], v[38:39], v[30:31], v[42:43] op_sel:[1,1,0] op_sel_hi:[0,1,1] neg_lo:[1,0,0]
    v_cvt_pk_bf16_f32 v118, v36, v37
    v_cvt_pk_bf16_f32 v119, v38, v39
    ds_write_b64 v16, v[118:119] offset:3168
    v_pk_mul_f32 v[40:41], v[36:37], v[28:29] op_sel_hi:[1,0]
    v_pk_mul_f32 v[42:43], v[38:39], v[30:31] op_sel_hi:[1,0]
    v_pk_fma_f32 v[36:37], v[36:37], v[28:29], v[40:41] op_sel:[1,1,0] op_sel_hi:[0,1,1] neg_lo:[1,0,0]
    v_pk_fma_f32 v[38:39], v[38:39], v[30:31], v[42:43] op_sel:[1,1,0] op_sel_hi:[0,1,1] neg_lo:[1,0,0]
    v_cvt_pk_bf16_f32 v100, v36, v37
    v_cvt_pk_bf16_f32 v101, v38, v39
    ds_write_b64 v16, v[100:101] offset:3696
    v_pk_mul_f32 v[40:41], v[36:37], v[28:29] op_sel_hi:[1,0]
    v_pk_mul_f32 v[42:43], v[38:39], v[30:31] op_sel_hi:[1,0]
    v_pk_fma_f32 v[36:37], v[36:37], v[28:29], v[40:41] op_sel:[1,1,0] op_sel_hi:[0,1,1] neg_lo:[1,0,0]
    v_pk_fma_f32 v[38:39], v[38:39], v[30:31], v[42:43] op_sel:[1,1,0] op_sel_hi:[0,1,1] neg_lo:[1,0,0]
    v_cvt_pk_bf16_f32 v102, v36, v37
    v_cvt_pk_bf16_f32 v103, v38, v39
    ds_write_b64 v16, v[102:103] offset:4224
    s_waitcnt vmcnt(0)
    s_barrier
    v_lshlrev_b32 v12, 2, v0
    v_and_b32 v12, 0x300, v12
    v_mov_b32 v13, 2
    buffer_store_dword v13, v12, s[24:27], s49 offen sc1
    v_pk_mul_f32 v[40:41], v[36:37], v[28:29] op_sel_hi:[1,0]
    v_pk_mul_f32 v[42:43], v[38:39], v[30:31] op_sel_hi:[1,0]
    v_pk_fma_f32 v[36:37], v[36:37], v[28:29], v[40:41] op_sel:[1,1,0] op_sel_hi:[0,1,1] neg_lo:[1,0,0]
    v_pk_fma_f32 v[38:39], v[38:39], v[30:31], v[42:43] op_sel:[1,1,0] op_sel_hi:[0,1,1] neg_lo:[1,0,0]
    v_cvt_pk_bf16_f32 v104, v36, v37
    v_cvt_pk_bf16_f32 v105, v38, v39
    ds_write_b64 v16, v[104:105] offset:4752
    v_pk_mul_f32 v[40:41], v[36:37], v[28:29] op_sel_hi:[1,0]
    v_pk_mul_f32 v[42:43], v[38:39], v[30:31] op_sel_hi:[1,0]
    v_pk_fma_f32 v[36:37], v[36:37], v[28:29], v[40:41] op_sel:[1,1,0] op_sel_hi:[0,1,1] neg_lo:[1,0,0]
    v_pk_fma_f32 v[38:39], v[38:39], v[30:31], v[42:43] op_sel:[1,1,0] op_sel_hi:[0,1,1] neg_lo:[1,0,0]
    v_cvt_pk_bf16_f32 v106, v36, v37
    v_cvt_pk_bf16_f32 v107, v38, v39
    ds_write_b64 v16, v[106:107] offset:5280
    v_pk_mul_f32 v[40:41], v[36:37], v[28:29] op_sel_hi:[1,0]
    v_pk_mul_f32 v[42:43], v[38:39], v[30:31] op_sel_hi:[1,0]
    v_pk_fma_f32 v[36:37], v[36:37], v[28:29], v[40:41] op_sel:[1,1,0] op_sel_hi:[0,1,1] neg_lo:[1,0,0]
    v_pk_fma_f32 v[38:39], v[38:39], v[30:31], v[42:43] op_sel:[1,1,0] op_sel_hi:[0,1,1] neg_lo:[1,0,0]
    v_cvt_pk_bf16_f32 v108, v36, v37
    v_cvt_pk_bf16_f32 v109, v38, v39
    ds_write_b64 v16, v[108:109] offset:5808
    v_pk_mul_f32 v[40:41], v[36:37], v[28:29] op_sel_hi:[1,0]
    v_pk_mul_f32 v[42:43], v[38:39], v[30:31] op_sel_hi:[1,0]
    v_pk_fma_f32 v[36:37], v[36:37], v[28:29], v[40:41] op_sel:[1,1,0] op_sel_hi:[0,1,1] neg_lo:[1,0,0]
    v_pk_fma_f32 v[38:39], v[38:39], v[30:31], v[42:43] op_sel:[1,1,0] op_sel_hi:[0,1,1] neg_lo:[1,0,0]
    v_cvt_pk_bf16_f32 v110, v36, v37
    v_cvt_pk_bf16_f32 v111, v38, v39
    ds_write_b64 v16, v[110:111] offset:6336
    v_pk_mul_f32 v[40:41], v[36:37], v[28:29] op_sel_hi:[1,0]
    v_pk_mul_f32 v[42:43], v[38:39], v[30:31] op_sel_hi:[1,0]
    v_pk_fma_f32 v[36:37], v[36:37], v[28:29], v[40:41] op_sel:[1,1,0] op_sel_hi:[0,1,1] neg_lo:[1,0,0]
    v_pk_fma_f32 v[38:39], v[38:39], v[30:31], v[42:43] op_sel:[1,1,0] op_sel_hi:[0,1,1] neg_lo:[1,0,0]
    v_cvt_pk_bf16_f32 v112, v36, v37
    v_cvt_pk_bf16_f32 v113, v38, v39
    ds_write_b64 v16, v[112:113] offset:6864
    v_pk_mul_f32 v[40:41], v[36:37], v[28:29] op_sel_hi:[1,0]
    v_pk_mul_f32 v[42:43], v[38:39], v[30:31] op_sel_hi:[1,0]
    v_pk_fma_f32 v[36:37], v[36:37], v[28:29], v[40:41] op_sel:[1,1,0] op_sel_hi:[0,1,1] neg_lo:[1,0,0]
    v_pk_fma_f32 v[38:39], v[38:39], v[30:31], v[42:43] op_sel:[1,1,0] op_sel_hi:[0,1,1] neg_lo:[1,0,0]
    v_cvt_pk_bf16_f32 v114, v36, v37
    v_cvt_pk_bf16_f32 v115, v38, v39
    ds_write_b64 v16, v[114:115] offset:7392
    v_pk_mul_f32 v[40:41], v[36:37], v[28:29] op_sel_hi:[1,0]
    v_pk_mul_f32 v[42:43], v[38:39], v[30:31] op_sel_hi:[1,0]
    v_pk_fma_f32 v[36:37], v[36:37], v[28:29], v[40:41] op_sel:[1,1,0] op_sel_hi:[0,1,1] neg_lo:[1,0,0]
    v_pk_fma_f32 v[38:39], v[38:39], v[30:31], v[42:43] op_sel:[1,1,0] op_sel_hi:[0,1,1] neg_lo:[1,0,0]
    v_cvt_pk_bf16_f32 v116, v36, v37
    v_cvt_pk_bf16_f32 v117, v38, v39
    ds_write_b64 v16, v[116:117] offset:7920
    v_cvt_pk_bf16_f32 v118, v168, v169
    ds_read_b128 a[0:3], v17 offset:0
    v_cvt_pk_bf16_f32 v119, v170, v171
    v_pk_mul_f32 v[40:41], v[168:169], v[24:25] op_sel_hi:[1,0]
    v_pk_mul_f32 v[42:43], v[170:171], v[26:27] op_sel_hi:[1,0]
    ds_read_b128 a[4:7], v17 offset:64
    v_pk_fma_f32 v[204:205], v[168:169], v[24:25], v[40:41] op_sel:[1,1,0] op_sel_hi:[0,1,1] neg_lo:[1,0,0]
    v_pk_fma_f32 v[206:207], v[170:171], v[26:27], v[42:43] op_sel:[1,1,0] op_sel_hi:[0,1,1] neg_lo:[1,0,0]
    v_cvt_pk_bf16_f32 v100, v204, v205
    ds_read_b128 a[8:11], v17 offset:128
    v_cvt_pk_bf16_f32 v101, v206, v207
    v_pk_mul_f32 v[40:41], v[204:205], v[24:25] op_sel_hi:[1,0]
    v_pk_mul_f32 v[42:43], v[206:207], v[26:27] op_sel_hi:[1,0]
    ds_read_b128 a[12:15], v17 offset:192
    v_pk_fma_f32 v[172:173], v[204:205], v[24:25], v[40:41] op_sel:[1,1,0] op_sel_hi:[0,1,1] neg_lo:[1,0,0]
    v_pk_fma_f32 v[174:175], v[206:207], v[26:27], v[42:43] op_sel:[1,1,0] op_sel_hi:[0,1,1] neg_lo:[1,0,0]
    v_cvt_pk_bf16_f32 v102, v172, v173
    ds_read_b128 a[16:19], v17 offset:256
    v_cvt_pk_bf16_f32 v103, v174, v175
    v_pk_mul_f32 v[40:41], v[172:173], v[24:25] op_sel_hi:[1,0]
    v_pk_mul_f32 v[42:43], v[174:175], v[26:27] op_sel_hi:[1,0]
    ds_read_b128 a[20:23], v17 offset:320
    v_pk_fma_f32 v[204:205], v[172:173], v[24:25], v[40:41] op_sel:[1,1,0] op_sel_hi:[0,1,1] neg_lo:[1,0,0]
    v_pk_fma_f32 v[206:207], v[174:175], v[26:27], v[42:43] op_sel:[1,1,0] op_sel_hi:[0,1,1] neg_lo:[1,0,0]
    v_cvt_pk_bf16_f32 v104, v204, v205
    ds_read_b128 a[24:27], v17 offset:384
    v_cvt_pk_bf16_f32 v105, v206, v207
    v_pk_mul_f32 v[40:41], v[204:205], v[24:25] op_sel_hi:[1,0]
    v_pk_mul_f32 v[42:43], v[206:207], v[26:27] op_sel_hi:[1,0]
    ds_read_b128 a[28:31], v17 offset:448
    v_pk_fma_f32 v[176:177], v[204:205], v[24:25], v[40:41] op_sel:[1,1,0] op_sel_hi:[0,1,1] neg_lo:[1,0,0]
    v_pk_fma_f32 v[178:179], v[206:207], v[26:27], v[42:43] op_sel:[1,1,0] op_sel_hi:[0,1,1] neg_lo:[1,0,0]
    v_cvt_pk_bf16_f32 v106, v176, v177
    ds_write_b64 v16, v[118:119] offset:0
    v_cvt_pk_bf16_f32 v107, v178, v179
    v_pk_mul_f32 v[40:41], v[176:177], v[24:25] op_sel_hi:[1,0]
    v_pk_mul_f32 v[42:43], v[178:179], v[26:27] op_sel_hi:[1,0]
    ds_write_b64 v16, v[100:101] offset:528
    v_pk_fma_f32 v[204:205], v[176:177], v[24:25], v[40:41] op_sel:[1,1,0] op_sel_hi:[0,1,1] neg_lo:[1,0,0]
    v_pk_fma_f32 v[206:207], v[178:179], v[26:27], v[42:43] op_sel:[1,1,0] op_sel_hi:[0,1,1] neg_lo:[1,0,0]
    v_cvt_pk_bf16_f32 v108, v204, v205
    ds_write_b64 v16, v[102:103] offset:1056
    v_cvt_pk_bf16_f32 v109, v206, v207
    v_pk_mul_f32 v[40:41], v[204:205], v[24:25] op_sel_hi:[1,0]
    v_pk_mul_f32 v[42:43], v[206:207], v[26:27] op_sel_hi:[1,0]
    ds_write_b64 v16, v[104:105] offset:1584
    v_pk_fma_f32 v[180:181], v[204:205], v[24:25], v[40:41] op_sel:[1,1,0] op_sel_hi:[0,1,1] neg_lo:[1,0,0]
    v_pk_fma_f32 v[182:183], v[206:207], v[26:27], v[42:43] op_sel:[1,1,0] op_sel_hi:[0,1,1] neg_lo:[1,0,0]
    v_cvt_pk_bf16_f32 v110, v180, v181
    ds_write_b64 v16, v[106:107] offset:2112
    v_cvt_pk_bf16_f32 v111, v182, v183
    v_pk_mul_f32 v[40:41], v[180:181], v[24:25] op_sel_hi:[1,0]
    v_pk_mul_f32 v[42:43], v[182:183], v[26:27] op_sel_hi:[1,0]
    ds_write_b64 v16, v[108:109] offset:2640
    v_pk_fma_f32 v[204:205], v[180:181], v[24:25], v[40:41] op_sel:[1,1,0] op_sel_hi:[0,1,1] neg_lo:[1,0,0]
    v_pk_fma_f32 v[206:207], v[182:183], v[26:27], v[42:43] op_sel:[1,1,0] op_sel_hi:[0,1,1] neg_lo:[1,0,0]
    v_cvt_pk_bf16_f32 v112, v204, v205
    ds_write_b64 v16, v[110:111] offset:3168
    v_cvt_pk_bf16_f32 v113, v206, v207
    ds_write_b64 v16, v[112:113] offset:3696
    v_pk_mul_f32 v[40:41], v[204:205], v[24:25] op_sel_hi:[1,0]
    v_pk_mul_f32 v[42:43], v[206:207], v[26:27] op_sel_hi:[1,0]
    v_pk_fma_f32 v[184:185], v[204:205], v[24:25], v[40:41] op_sel:[1,1,0] op_sel_hi:[0,1,1] neg_lo:[1,0,0]
    v_pk_fma_f32 v[186:187], v[206:207], v[26:27], v[42:43] op_sel:[1,1,0] op_sel_hi:[0,1,1] neg_lo:[1,0,0]
    v_cvt_pk_bf16_f32 v114, v184, v185
    v_cvt_pk_bf16_f32 v115, v186, v187
    ds_write_b64 v16, v[114:115] offset:4224
    v_pk_mul_f32 v[40:41], v[184:185], v[24:25] op_sel_hi:[1,0]
    v_pk_mul_f32 v[42:43], v[186:187], v[26:27] op_sel_hi:[1,0]
    v_pk_fma_f32 v[204:205], v[184:185], v[24:25], v[40:41] op_sel:[1,1,0] op_sel_hi:[0,1,1] neg_lo:[1,0,0]
    v_pk_fma_f32 v[206:207], v[186:187], v[26:27], v[42:43] op_sel:[1,1,0] op_sel_hi:[0,1,1] neg_lo:[1,0,0]
    v_cvt_pk_bf16_f32 v116, v204, v205
    v_cvt_pk_bf16_f32 v117, v206, v207
    ds_write_b64 v16, v[116:117] offset:4752
    v_pk_mul_f32 v[40:41], v[204:205], v[24:25] op_sel_hi:[1,0]
    v_pk_mul_f32 v[42:43], v[206:207], v[26:27] op_sel_hi:[1,0]
    v_pk_fma_f32 v[188:189], v[204:205], v[24:25], v[40:41] op_sel:[1,1,0] op_sel_hi:[0,1,1] neg_lo:[1,0,0]
    v_pk_fma_f32 v[190:191], v[206:207], v[26:27], v[42:43] op_sel:[1,1,0] op_sel_hi:[0,1,1] neg_lo:[1,0,0]
    v_cvt_pk_bf16_f32 v118, v188, v189
    v_cvt_pk_bf16_f32 v119, v190, v191
    ds_write_b64 v16, v[118:119] offset:5280
    v_pk_mul_f32 v[40:41], v[188:189], v[24:25] op_sel_hi:[1,0]
    v_pk_mul_f32 v[42:43], v[190:191], v[26:27] op_sel_hi:[1,0]
    v_pk_fma_f32 v[204:205], v[188:189], v[24:25], v[40:41] op_sel:[1,1,0] op_sel_hi:[0,1,1] neg_lo:[1,0,0]
    v_pk_fma_f32 v[206:207], v[190:191], v[26:27], v[42:43] op_sel:[1,1,0] op_sel_hi:[0,1,1] neg_lo:[1,0,0]
    v_cvt_pk_bf16_f32 v100, v204, v205
    v_cvt_pk_bf16_f32 v101, v206, v207
    ds_write_b64 v16, v[100:101] offset:5808
    v_pk_mul_f32 v[40:41], v[204:205], v[24:25] op_sel_hi:[1,0]
    v_pk_mul_f32 v[42:43], v[206:207], v[26:27] op_sel_hi:[1,0]
    v_pk_fma_f32 v[192:193], v[204:205], v[24:25], v[40:41] op_sel:[1,1,0] op_sel_hi:[0,1,1] neg_lo:[1,0,0]
    v_pk_fma_f32 v[194:195], v[206:207], v[26:27], v[42:43] op_sel:[1,1,0] op_sel_hi:[0,1,1] neg_lo:[1,0,0]
    v_cvt_pk_bf16_f32 v102, v192, v193
    v_cvt_pk_bf16_f32 v103, v194, v195
    ds_write_b64 v16, v[102:103] offset:6336
    v_pk_mul_f32 v[40:41], v[192:193], v[24:25] op_sel_hi:[1,0]
    v_pk_mul_f32 v[42:43], v[194:195], v[26:27] op_sel_hi:[1,0]
    v_pk_fma_f32 v[204:205], v[192:193], v[24:25], v[40:41] op_sel:[1,1,0] op_sel_hi:[0,1,1] neg_lo:[1,0,0]
    v_pk_fma_f32 v[206:207], v[194:195], v[26:27], v[42:43] op_sel:[1,1,0] op_sel_hi:[0,1,1] neg_lo:[1,0,0]
    v_cvt_pk_bf16_f32 v104, v204, v205
    v_cvt_pk_bf16_f32 v105, v206, v207
    ds_write_b64 v16, v[104:105] offset:6864
    v_pk_mul_f32 v[40:41], v[204:205], v[24:25] op_sel_hi:[1,0]
    v_pk_mul_f32 v[42:43], v[206:207], v[26:27] op_sel_hi:[1,0]
    v_pk_fma_f32 v[196:197], v[204:205], v[24:25], v[40:41] op_sel:[1,1,0] op_sel_hi:[0,1,1] neg_lo:[1,0,0]
    v_pk_fma_f32 v[198:199], v[206:207], v[26:27], v[42:43] op_sel:[1,1,0] op_sel_hi:[0,1,1] neg_lo:[1,0,0]
    v_cvt_pk_bf16_f32 v106, v196, v197
    v_cvt_pk_bf16_f32 v107, v198, v199
    ds_write_b64 v16, v[106:107] offset:7392
    v_pk_mul_f32 v[40:41], v[196:197], v[24:25] op_sel_hi:[1,0]
    v_pk_mul_f32 v[42:43], v[198:199], v[26:27] op_sel_hi:[1,0]
    v_pk_fma_f32 v[204:205], v[196:197], v[24:25], v[40:41] op_sel:[1,1,0] op_sel_hi:[0,1,1] neg_lo:[1,0,0]
    v_pk_fma_f32 v[206:207], v[198:199], v[26:27], v[42:43] op_sel:[1,1,0] op_sel_hi:[0,1,1] neg_lo:[1,0,0]
    v_cvt_pk_bf16_f32 v108, v204, v205
    v_cvt_pk_bf16_f32 v109, v206, v207
    ds_write_b64 v16, v[108:109] offset:7920
    v_pk_mul_f32 v[40:41], v[204:205], v[24:25] op_sel_hi:[1,0]
    v_pk_mul_f32 v[42:43], v[206:207], v[26:27] op_sel_hi:[1,0]
    v_pk_fma_f32 v[200:201], v[204:205], v[24:25], v[40:41] op_sel:[1,1,0] op_sel_hi:[0,1,1] neg_lo:[1,0,0]
    v_pk_fma_f32 v[202:203], v[206:207], v[26:27], v[42:43] op_sel:[1,1,0] op_sel_hi:[0,1,1] neg_lo:[1,0,0]
    v_pk_mul_f32 v[40:41], v[168:169], v[32:33] op_sel_hi:[1,0]
    ds_read_b128 a[32:35], v17 offset:0
    v_pk_mul_f32 v[42:43], v[170:171], v[34:35] op_sel_hi:[1,0]
    v_pk_fma_f32 v[168:169], v[168:169], v[32:33], v[40:41] op_sel:[1,1,0] op_sel_hi:[0,1,1] neg_lo:[1,0,0]
    v_pk_fma_f32 v[170:171], v[170:171], v[34:35], v[42:43] op_sel:[1,1,0] op_sel_hi:[0,1,1] neg_lo:[1,0,0]
    ds_read_b128 a[36:39], v17 offset:64
    v_cvt_pk_bf16_f32 v110, v168, v169
    v_cvt_pk_bf16_f32 v111, v170, v171
    v_pk_mul_f32 v[40:41], v[172:173], v[32:33] op_sel_hi:[1,0]
    ds_read_b128 a[40:43], v17 offset:128
    v_pk_mul_f32 v[42:43], v[174:175], v[34:35] op_sel_hi:[1,0]
    v_pk_fma_f32 v[172:173], v[172:173], v[32:33], v[40:41] op_sel:[1,1,0] op_sel_hi:[0,1,1] neg_lo:[1,0,0]
    v_pk_fma_f32 v[174:175], v[174:175], v[34:35], v[42:43] op_sel:[1,1,0] op_sel_hi:[0,1,1] neg_lo:[1,0,0]
    ds_read_b128 a[44:47], v17 offset:192
    v_cvt_pk_bf16_f32 v112, v172, v173
    v_cvt_pk_bf16_f32 v113, v174, v175
    v_pk_mul_f32 v[40:41], v[176:177], v[32:33] op_sel_hi:[1,0]
    ds_read_b128 a[48:51], v17 offset:256
    v_pk_mul_f32 v[42:43], v[178:179], v[34:35] op_sel_hi:[1,0]
    v_pk_fma_f32 v[176:177], v[176:177], v[32:33], v[40:41] op_sel:[1,1,0] op_sel_hi:[0,1,1] neg_lo:[1,0,0]
    v_pk_fma_f32 v[178:179], v[178:179], v[34:35], v[42:43] op_sel:[1,1,0] op_sel_hi:[0,1,1] neg_lo:[1,0,0]
    ds_read_b128 a[52:55], v17 offset:320
    v_cvt_pk_bf16_f32 v114, v176, v177
    v_cvt_pk_bf16_f32 v115, v178, v179
    v_pk_mul_f32 v[40:41], v[180:181], v[32:33] op_sel_hi:[1,0]
    ds_read_b128 a[56:59], v17 offset:384
    v_pk_mul_f32 v[42:43], v[182:183], v[34:35] op_sel_hi:[1,0]
    v_pk_fma_f32 v[180:181], v[180:181], v[32:33], v[40:41] op_sel:[1,1,0] op_sel_hi:[0,1,1] neg_lo:[1,0,0]
    v_pk_fma_f32 v[182:183], v[182:183], v[34:35], v[42:43] op_sel:[1,1,0] op_sel_hi:[0,1,1] neg_lo:[1,0,0]
    ds_read_b128 a[60:63], v17 offset:448
    s_waitcnt lgkmcnt(7)
    v_mfma_f32_16x16x32_bf16 v[208:211], a[32:35], a[0:3], 0
    v_cvt_pk_bf16_f32 v116, v180, v181
    v_cvt_pk_bf16_f32 v117, v182, v183
    ds_write_b64 v16, v[110:111] offset:0
    v_pk_mul_f32 v[40:41], v[184:185], v[32:33] op_sel_hi:[1,0]
    v_pk_mul_f32 v[42:43], v[186:187], v[34:35] op_sel_hi:[1,0]
    v_pk_fma_f32 v[184:185], v[184:185], v[32:33], v[40:41] op_sel:[1,1,0] op_sel_hi:[0,1,1] neg_lo:[1,0,0]
    ds_write_b64 v16, v[112:113] offset:528
    v_pk_fma_f32 v[186:187], v[186:187], v[34:35], v[42:43] op_sel:[1,1,0] op_sel_hi:[0,1,1] neg_lo:[1,0,0]
    s_waitcnt lgkmcnt(8)
    v_mfma_f32_16x16x32_bf16 v[208:211], a[36:39], a[4:7], v[208:211]
    v_cvt_pk_bf16_f32 v118, v184, v185
    ds_write_b64 v16, v[114:115] offset:1056
    v_cvt_pk_bf16_f32 v119, v186, v187
    v_pk_mul_f32 v[40:41], v[188:189], v[32:33] op_sel_hi:[1,0]
    v_pk_mul_f32 v[42:43], v[190:191], v[34:35] op_sel_hi:[1,0]
    ds_write_b64 v16, v[116:117] offset:1584
    v_pk_fma_f32 v[188:189], v[188:189], v[32:33], v[40:41] op_sel:[1,1,0] op_sel_hi:[0,1,1] neg_lo:[1,0,0]
    v_pk_fma_f32 v[190:191], v[190:191], v[34:35], v[42:43] op_sel:[1,1,0] op_sel_hi:[0,1,1] neg_lo:[1,0,0]
    s_waitcnt lgkmcnt(9)
    v_mfma_f32_16x16x32_bf16 v[208:211], a[40:43], a[8:11], v[208:211]
    ds_write_b64 v16, v[118:119] offset:2112
    v_cvt_pk_bf16_f32 v100, v188, v189
    v_cvt_pk_bf16_f32 v101, v190, v191
    ds_write_b64 v16, v[100:101] offset:2640
    v_pk_mul_f32 v[40:41], v[192:193], v[32:33] op_sel_hi:[1,0]
    v_pk_mul_f32 v[42:43], v[194:195], v[34:35] op_sel_hi:[1,0]
    v_pk_fma_f32 v[192:193], v[192:193], v[32:33], v[40:41] op_sel:[1,1,0] op_sel_hi:[0,1,1] neg_lo:[1,0,0]
    v_pk_fma_f32 v[194:195], v[194:195], v[34:35], v[42:43] op_sel:[1,1,0] op_sel_hi:[0,1,1] neg_lo:[1,0,0]
    s_waitcnt lgkmcnt(10)
    v_mfma_f32_16x16x32_bf16 v[208:211], a[44:47], a[12:15], v[208:211]
    v_cvt_pk_bf16_f32 v102, v192, v193
    v_cvt_pk_bf16_f32 v103, v194, v195
    ds_write_b64 v16, v[102:103] offset:3168
    v_pk_mul_f32 v[40:41], v[196:197], v[32:33] op_sel_hi:[1,0]
    v_pk_mul_f32 v[42:43], v[198:199], v[34:35] op_sel_hi:[1,0]
    v_pk_fma_f32 v[196:197], v[196:197], v[32:33], v[40:41] op_sel:[1,1,0] op_sel_hi:[0,1,1] neg_lo:[1,0,0]
    v_pk_fma_f32 v[198:199], v[198:199], v[34:35], v[42:43] op_sel:[1,1,0] op_sel_hi:[0,1,1] neg_lo:[1,0,0]
    s_waitcnt lgkmcnt(10)
    v_mfma_f32_16x16x32_bf16 v[208:211], a[48:51], a[16:19], v[208:211]
    v_cvt_pk_bf16_f32 v104, v196, v197
    v_cvt_pk_bf16_f32 v105, v198, v199
    ds_write_b64 v16, v[104:105] offset:3696
    v_pk_mul_f32 v[40:41], v[200:201], v[32:33] op_sel_hi:[1,0]
    v_pk_mul_f32 v[42:43], v[202:203], v[34:35] op_sel_hi:[1,0]
    v_pk_fma_f32 v[200:201], v[200:201], v[32:33], v[40:41] op_sel:[1,1,0] op_sel_hi:[0,1,1] neg_lo:[1,0,0]
    v_pk_fma_f32 v[202:203], v[202:203], v[34:35], v[42:43] op_sel:[1,1,0] op_sel_hi:[0,1,1] neg_lo:[1,0,0]
    s_waitcnt lgkmcnt(10)
    v_mfma_f32_16x16x32_bf16 v[208:211], a[52:55], a[20:23], v[208:211]
    v_cvt_pk_bf16_f32 v106, v200, v201
    v_cvt_pk_bf16_f32 v107, v202, v203
    ds_write_b64 v16, v[106:107] offset:4224
    s_waitcnt lgkmcnt(10)
    v_mfma_f32_16x16x32_bf16 v[208:211], a[56:59], a[24:27], v[208:211]
    s_waitcnt lgkmcnt(9)
    v_mfma_f32_16x16x32_bf16 v[208:211], a[60:63], a[28:31], v[208:211]
    v_pk_mul_f32 v[40:41], v[168:169], v[32:33] op_sel_hi:[1,0]
    ds_read_b128 a[32:35], v18 offset:0
    v_pk_mul_f32 v[42:43], v[170:171], v[34:35] op_sel_hi:[1,0]
    v_pk_fma_f32 v[168:169], v[168:169], v[32:33], v[40:41] op_sel:[1,1,0] op_sel_hi:[0,1,1] neg_lo:[1,0,0]
    v_pk_fma_f32 v[170:171], v[170:171], v[34:35], v[42:43] op_sel:[1,1,0] op_sel_hi:[0,1,1] neg_lo:[1,0,0]
    ds_read_b128 a[36:39], v18 offset:64
    v_cvt_pk_bf16_f32 v108, v168, v169
    v_cvt_pk_bf16_f32 v109, v170, v171
    v_pk_mul_f32 v[40:41], v[176:177], v[32:33] op_sel_hi:[1,0]
    ds_read_b128 a[40:43], v18 offset:128
    v_pk_mul_f32 v[42:43], v[178:179], v[34:35] op_sel_hi:[1,0]
    v_pk_fma_f32 v[176:177], v[176:177], v[32:33], v[40:41] op_sel:[1,1,0] op_sel_hi:[0,1,1] neg_lo:[1,0,0]
    v_pk_fma_f32 v[178:179], v[178:179], v[34:35], v[42:43] op_sel:[1,1,0] op_sel_hi:[0,1,1] neg_lo:[1,0,0]
    ds_read_b128 a[44:47], v18 offset:192
    v_cvt_pk_bf16_f32 v110, v176, v177
    v_cvt_pk_bf16_f32 v111, v178, v179
    v_pk_mul_f32 v[40:41], v[184:185], v[32:33] op_sel_hi:[1,0]
    ds_read_b128 a[48:51], v18 offset:256
    v_pk_mul_f32 v[42:43], v[186:187], v[34:35] op_sel_hi:[1,0]
    v_pk_fma_f32 v[184:185], v[184:185], v[32:33], v[40:41] op_sel:[1,1,0] op_sel_hi:[0,1,1] neg_lo:[1,0,0]
    v_pk_fma_f32 v[186:187], v[186:187], v[34:35], v[42:43] op_sel:[1,1,0] op_sel_hi:[0,1,1] neg_lo:[1,0,0]
    ds_read_b128 a[52:55], v18 offset:320
    s_waitcnt lgkmcnt(5)
    v_mfma_f32_16x16x32_bf16 v[212:215], a[32:35], a[0:3], 0
    v_cvt_pk_bf16_f32 v112, v184, v185
    v_cvt_pk_bf16_f32 v113, v186, v187
    ds_read_b128 a[56:59], v18 offset:384
    v_pk_mul_f32 v[40:41], v[192:193], v[32:33] op_sel_hi:[1,0]
    v_pk_mul_f32 v[42:43], v[194:195], v[34:35] op_sel_hi:[1,0]
    v_pk_fma_f32 v[192:193], v[192:193], v[32:33], v[40:41] op_sel:[1,1,0] op_sel_hi:[0,1,1] neg_lo:[1,0,0]
    ds_read_b128 a[60:63], v18 offset:448
    v_pk_fma_f32 v[194:195], v[194:195], v[34:35], v[42:43] op_sel:[1,1,0] op_sel_hi:[0,1,1] neg_lo:[1,0,0]
    s_waitcnt lgkmcnt(6)
    v_mfma_f32_16x16x32_bf16 v[212:215], a[36:39], a[4:7], v[212:215]
    v_cvt_pk_bf16_f32 v114, v192, v193
    ds_write_b64 v16, v[108:109] offset:0
    v_cvt_pk_bf16_f32 v115, v194, v195
    v_pk_mul_f32 v[40:41], v[200:201], v[32:33] op_sel_hi:[1,0]
    v_pk_mul_f32 v[42:43], v[202:203], v[34:35] op_sel_hi:[1,0]
    ds_write_b64 v16, v[110:111] offset:528
    v_pk_fma_f32 v[200:201], v[200:201], v[32:33], v[40:41] op_sel:[1,1,0] op_sel_hi:[0,1,1] neg_lo:[1,0,0]
    v_pk_fma_f32 v[202:203], v[202:203], v[34:35], v[42:43] op_sel:[1,1,0] op_sel_hi:[0,1,1] neg_lo:[1,0,0]
    s_waitcnt lgkmcnt(7)
    v_mfma_f32_16x16x32_bf16 v[212:215], a[40:43], a[8:11], v[212:215]
    ds_write_b64 v16, v[112:113] offset:1056
    v_cvt_pk_bf16_f32 v116, v200, v201
    v_cvt_pk_bf16_f32 v117, v202, v203
    v_pk_mul_f32 v[40:41], v[168:169], v[32:33] op_sel_hi:[1,0]
    ds_write_b64 v16, v[114:115] offset:1584
    v_pk_mul_f32 v[42:43], v[170:171], v[34:35] op_sel_hi:[1,0]
    v_pk_fma_f32 v[168:169], v[168:169], v[32:33], v[40:41] op_sel:[1,1,0] op_sel_hi:[0,1,1] neg_lo:[1,0,0]
    v_pk_fma_f32 v[170:171], v[170:171], v[34:35], v[42:43] op_sel:[1,1,0] op_sel_hi:[0,1,1] neg_lo:[1,0,0]
    ds_write_b64 v16, v[116:117] offset:2112
    s_waitcnt lgkmcnt(9)
    v_mfma_f32_16x16x32_bf16 v[212:215], a[44:47], a[12:15], v[212:215]
    v_cvt_pk_bf16_f32 v118, v168, v169
    v_cvt_pk_bf16_f32 v119, v170, v171
    ds_write_b64 v16, v[118:119] offset:2640
    v_pk_mul_f32 v[40:41], v[176:177], v[32:33] op_sel_hi:[1,0]
    v_pk_mul_f32 v[42:43], v[178:179], v[34:35] op_sel_hi:[1,0]
    v_pk_fma_f32 v[176:177], v[176:177], v[32:33], v[40:41] op_sel:[1,1,0] op_sel_hi:[0,1,1] neg_lo:[1,0,0]
    v_pk_fma_f32 v[178:179], v[178:179], v[34:35], v[42:43] op_sel:[1,1,0] op_sel_hi:[0,1,1] neg_lo:[1,0,0]
    s_waitcnt lgkmcnt(9)
    v_mfma_f32_16x16x32_bf16 v[212:215], a[48:51], a[16:19], v[212:215]
    v_cvt_pk_bf16_f32 v100, v176, v177
    v_cvt_pk_bf16_f32 v101, v178, v179
    ds_write_b64 v16, v[100:101] offset:3168
    v_pk_mul_f32 v[40:41], v[184:185], v[32:33] op_sel_hi:[1,0]
    v_pk_mul_f32 v[42:43], v[186:187], v[34:35] op_sel_hi:[1,0]
    v_pk_fma_f32 v[184:185], v[184:185], v[32:33], v[40:41] op_sel:[1,1,0] op_sel_hi:[0,1,1] neg_lo:[1,0,0]
    v_pk_fma_f32 v[186:187], v[186:187], v[34:35], v[42:43] op_sel:[1,1,0] op_sel_hi:[0,1,1] neg_lo:[1,0,0]
    s_waitcnt lgkmcnt(9)
    v_mfma_f32_16x16x32_bf16 v[212:215], a[52:55], a[20:23], v[212:215]
    v_cvt_pk_bf16_f32 v102, v184, v185
    v_cvt_pk_bf16_f32 v103, v186, v187
    ds_write_b64 v16, v[102:103] offset:3696
    v_pk_mul_f32 v[40:41], v[192:193], v[32:33] op_sel_hi:[1,0]
    v_pk_mul_f32 v[42:43], v[194:195], v[34:35] op_sel_hi:[1,0]
    v_pk_fma_f32 v[192:193], v[192:193], v[32:33], v[40:41] op_sel:[1,1,0] op_sel_hi:[0,1,1] neg_lo:[1,0,0]
    v_pk_fma_f32 v[194:195], v[194:195], v[34:35], v[42:43] op_sel:[1,1,0] op_sel_hi:[0,1,1] neg_lo:[1,0,0]
    s_waitcnt lgkmcnt(9)
    v_mfma_f32_16x16x32_bf16 v[212:215], a[56:59], a[24:27], v[212:215]
    v_cvt_pk_bf16_f32 v104, v192, v193
    v_cvt_pk_bf16_f32 v105, v194, v195
    ds_write_b64 v16, v[104:105] offset:4224
    v_pk_mul_f32 v[40:41], v[200:201], v[32:33] op_sel_hi:[1,0]
    v_pk_mul_f32 v[42:43], v[202:203], v[34:35] op_sel_hi:[1,0]
    v_pk_fma_f32 v[200:201], v[200:201], v[32:33], v[40:41] op_sel:[1,1,0] op_sel_hi:[0,1,1] neg_lo:[1,0,0]
    v_pk_fma_f32 v[202:203], v[202:203], v[34:35], v[42:43] op_sel:[1,1,0] op_sel_hi:[0,1,1] neg_lo:[1,0,0]
    s_waitcnt lgkmcnt(9)
    v_mfma_f32_16x16x32_bf16 v[212:215], a[60:63], a[28:31], v[212:215]
    v_cvt_pk_bf16_f32 v106, v200, v201
    v_cvt_pk_bf16_f32 v107, v202, v203
    ds_write_b64 v16, v[106:107] offset:4752
    v_lshlrev_b32 v4, 16, v163
    ds_read_b128 a[32:35], v19 offset:0
    v_cmp_eq_u32 vcc, 0, v1
    s_nop 1
    v_cndmask_b32 v4, 0, v4, vcc
    v_add_f32 v208, v208, v4
    ds_read_b128 a[36:39], v19 offset:64
    v_cvt_pk_bf16_f32 v122, v208, v210
    v_cvt_pk_bf16_f32 v123, v209, v211
    v_pk_mul_f32 v[40:41], v[168:169], v[32:33] op_sel_hi:[1,0]
    ds_read_b128 a[40:43], v19 offset:128
    v_pk_mul_f32 v[42:43], v[170:171], v[34:35] op_sel_hi:[1,0]
    v_pk_fma_f32 v[168:169], v[168:169], v[32:33], v[40:41] op_sel:[1,1,0] op_sel_hi:[0,1,1] neg_lo:[1,0,0]
    v_pk_fma_f32 v[170:171], v[170:171], v[34:35], v[42:43] op_sel:[1,1,0] op_sel_hi:[0,1,1] neg_lo:[1,0,0]
    ds_read_b128 a[44:47], v19 offset:192
    v_cvt_pk_bf16_f32 v108, v168, v169
    v_cvt_pk_bf16_f32 v109, v170, v171
    v_pk_mul_f32 v[40:41], v[184:185], v[32:33] op_sel_hi:[1,0]
    ds_read_b128 a[48:51], v19 offset:256
    v_pk_mul_f32 v[42:43], v[186:187], v[34:35] op_sel_hi:[1,0]
    v_pk_fma_f32 v[184:185], v[184:185], v[32:33], v[40:41] op_sel:[1,1,0] op_sel_hi:[0,1,1] neg_lo:[1,0,0]
    v_pk_fma_f32 v[186:187], v[186:187], v[34:35], v[42:43] op_sel:[1,1,0] op_sel_hi:[0,1,1] neg_lo:[1,0,0]
    ds_read_b128 a[52:55], v19 offset:320
    v_cvt_pk_bf16_f32 v110, v184, v185
    v_cvt_pk_bf16_f32 v111, v186, v187
    v_pk_mul_f32 v[40:41], v[200:201], v[32:33] op_sel_hi:[1,0]
    ds_read_b128 a[56:59], v19 offset:384
    v_pk_mul_f32 v[42:43], v[202:203], v[34:35] op_sel_hi:[1,0]
    v_pk_fma_f32 v[200:201], v[200:201], v[32:33], v[40:41] op_sel:[1,1,0] op_sel_hi:[0,1,1] neg_lo:[1,0,0]
    v_pk_fma_f32 v[202:203], v[202:203], v[34:35], v[42:43] op_sel:[1,1,0] op_sel_hi:[0,1,1] neg_lo:[1,0,0]
    ds_read_b128 a[60:63], v19 offset:448
    v_cvt_pk_bf16_f32 v112, v200, v201
    v_cvt_pk_bf16_f32 v113, v202, v203
    v_pk_mul_f32 v[40:41], v[168:169], v[32:33] op_sel_hi:[1,0]
    ds_write_b32 v21, v122 offset:17408
    v_pk_mul_f32 v[42:43], v[170:171], v[34:35] op_sel_hi:[1,0]
    v_pk_fma_f32 v[168:169], v[168:169], v[32:33], v[40:41] op_sel:[1,1,0] op_sel_hi:[0,1,1] neg_lo:[1,0,0]
    v_pk_fma_f32 v[170:171], v[170:171], v[34:35], v[42:43] op_sel:[1,1,0] op_sel_hi:[0,1,1] neg_lo:[1,0,0]
    ds_write_b32 v21, v123 offset:19584
    s_waitcnt lgkmcnt(9)
    v_mfma_f32_16x16x32_bf16 v[216:219], a[32:35], a[0:3], 0
    v_cvt_pk_bf16_f32 v114, v168, v169
    v_cvt_pk_bf16_f32 v115, v170, v171
    ds_write_b64 v16, v[108:109] offset:0
    v_pk_mul_f32 v[40:41], v[184:185], v[32:33] op_sel_hi:[1,0]
    v_pk_mul_f32 v[42:43], v[186:187], v[34:35] op_sel_hi:[1,0]
    v_pk_fma_f32 v[184:185], v[184:185], v[32:33], v[40:41] op_sel:[1,1,0] op_sel_hi:[0,1,1] neg_lo:[1,0,0]
    ds_write_b64 v16, v[110:111] offset:528
    v_pk_fma_f32 v[186:187], v[186:187], v[34:35], v[42:43] op_sel:[1,1,0] op_sel_hi:[0,1,1] neg_lo:[1,0,0]
    s_waitcnt lgkmcnt(10)
    v_mfma_f32_16x16x32_bf16 v[216:219], a[36:39], a[4:7], v[216:219]
    v_cvt_pk_bf16_f32 v116, v184, v185
    ds_write_b64 v16, v[112:113] offset:1056
    v_cvt_pk_bf16_f32 v117, v186, v187
    v_pk_mul_f32 v[40:41], v[200:201], v[32:33] op_sel_hi:[1,0]
    v_pk_mul_f32 v[42:43], v[202:203], v[34:35] op_sel_hi:[1,0]
    ds_write_b64 v16, v[114:115] offset:1584
    v_pk_fma_f32 v[200:201], v[200:201], v[32:33], v[40:41] op_sel:[1,1,0] op_sel_hi:[0,1,1] neg_lo:[1,0,0]
    v_pk_fma_f32 v[202:203], v[202:203], v[34:35], v[42:43] op_sel:[1,1,0] op_sel_hi:[0,1,1] neg_lo:[1,0,0]
    s_waitcnt lgkmcnt(11)
    v_mfma_f32_16x16x32_bf16 v[216:219], a[40:43], a[8:11], v[216:219]
    ds_write_b64 v16, v[116:117] offset:2112
    v_cvt_pk_bf16_f32 v118, v200, v201
    v_cvt_pk_bf16_f32 v119, v202, v203
    ds_write_b64 v16, v[118:119] offset:2640
    v_pk_mul_f32 v[40:41], v[168:169], v[32:33] op_sel_hi:[1,0]
    v_pk_mul_f32 v[42:43], v[170:171], v[34:35] op_sel_hi:[1,0]
    v_pk_fma_f32 v[168:169], v[168:169], v[32:33], v[40:41] op_sel:[1,1,0] op_sel_hi:[0,1,1] neg_lo:[1,0,0]
    v_pk_fma_f32 v[170:171], v[170:171], v[34:35], v[42:43] op_sel:[1,1,0] op_sel_hi:[0,1,1] neg_lo:[1,0,0]
    s_waitcnt lgkmcnt(12)
    v_mfma_f32_16x16x32_bf16 v[216:219], a[44:47], a[12:15], v[216:219]
    v_cvt_pk_bf16_f32 v100, v168, v169
    v_cvt_pk_bf16_f32 v101, v170, v171
    ds_write_b64 v16, v[100:101] offset:3168
    v_pk_mul_f32 v[40:41], v[184:185], v[32:33] op_sel_hi:[1,0]
    v_pk_mul_f32 v[42:43], v[186:187], v[34:35] op_sel_hi:[1,0]
    v_pk_fma_f32 v[184:185], v[184:185], v[32:33], v[40:41] op_sel:[1,1,0] op_sel_hi:[0,1,1] neg_lo:[1,0,0]
    v_pk_fma_f32 v[186:187], v[186:187], v[34:35], v[42:43] op_sel:[1,1,0] op_sel_hi:[0,1,1] neg_lo:[1,0,0]
    s_waitcnt lgkmcnt(12)
    v_mfma_f32_16x16x32_bf16 v[216:219], a[48:51], a[16:19], v[216:219]
    v_cvt_pk_bf16_f32 v102, v184, v185
    v_cvt_pk_bf16_f32 v103, v186, v187
    ds_write_b64 v16, v[102:103] offset:3696
    v_pk_mul_f32 v[40:41], v[200:201], v[32:33] op_sel_hi:[1,0]
    v_pk_mul_f32 v[42:43], v[202:203], v[34:35] op_sel_hi:[1,0]
    v_pk_fma_f32 v[200:201], v[200:201], v[32:33], v[40:41] op_sel:[1,1,0] op_sel_hi:[0,1,1] neg_lo:[1,0,0]
    v_pk_fma_f32 v[202:203], v[202:203], v[34:35], v[42:43] op_sel:[1,1,0] op_sel_hi:[0,1,1] neg_lo:[1,0,0]
    s_waitcnt lgkmcnt(12)
    v_mfma_f32_16x16x32_bf16 v[216:219], a[52:55], a[20:23], v[216:219]
    v_cvt_pk_bf16_f32 v104, v200, v201
    v_cvt_pk_bf16_f32 v105, v202, v203
    ds_write_b64 v16, v[104:105] offset:4224
    v_pk_mul_f32 v[40:41], v[168:169], v[32:33] op_sel_hi:[1,0]
    v_pk_mul_f32 v[42:43], v[170:171], v[34:35] op_sel_hi:[1,0]
    v_pk_fma_f32 v[168:169], v[168:169], v[32:33], v[40:41] op_sel:[1,1,0] op_sel_hi:[0,1,1] neg_lo:[1,0,0]
    v_pk_fma_f32 v[170:171], v[170:171], v[34:35], v[42:43] op_sel:[1,1,0] op_sel_hi:[0,1,1] neg_lo:[1,0,0]
    s_waitcnt lgkmcnt(12)
    v_mfma_f32_16x16x32_bf16 v[216:219], a[56:59], a[24:27], v[216:219]
    v_cvt_pk_bf16_f32 v106, v168, v169
    v_cvt_pk_bf16_f32 v107, v170, v171
    ds_write_b64 v16, v[106:107] offset:4752
    v_pk_mul_f32 v[40:41], v[184:185], v[32:33] op_sel_hi:[1,0]
    v_pk_mul_f32 v[42:43], v[186:187], v[34:35] op_sel_hi:[1,0]
    v_pk_fma_f32 v[184:185], v[184:185], v[32:33], v[40:41] op_sel:[1,1,0] op_sel_hi:[0,1,1] neg_lo:[1,0,0]
    v_pk_fma_f32 v[186:187], v[186:187], v[34:35], v[42:43] op_sel:[1,1,0] op_sel_hi:[0,1,1] neg_lo:[1,0,0]
    s_waitcnt lgkmcnt(12)
    v_mfma_f32_16x16x32_bf16 v[216:219], a[60:63], a[28:31], v[216:219]
    v_cvt_pk_bf16_f32 v108, v184, v185
    v_cvt_pk_bf16_f32 v109, v186, v187
    ds_write_b64 v16, v[108:109] offset:5280
    v_pk_mul_f32 v[40:41], v[200:201], v[32:33] op_sel_hi:[1,0]
    v_pk_mul_f32 v[42:43], v[202:203], v[34:35] op_sel_hi:[1,0]
    v_pk_fma_f32 v[200:201], v[200:201], v[32:33], v[40:41] op_sel:[1,1,0] op_sel_hi:[0,1,1] neg_lo:[1,0,0]
    v_pk_fma_f32 v[202:203], v[202:203], v[34:35], v[42:43] op_sel:[1,1,0] op_sel_hi:[0,1,1] neg_lo:[1,0,0]
    v_cvt_pk_bf16_f32 v110, v200, v201
    v_cvt_pk_bf16_f32 v111, v202, v203
    ds_write_b64 v16, v[110:111] offset:5808
    v_cvt_pk_bf16_f32 v126, v212, v213
    ds_read_b128 a[32:35], v20 offset:0
    v_cvt_pk_bf16_f32 v127, v212, v214
    v_cvt_pk_bf16_f32 v128, v216, v216
    v_cvt_pk_bf16_f32 v129, v217, v218
    ds_read_b128 a[36:39], v20 offset:64
    v_cvt_pk_bf16_f32 v130, v216, v217
    v_cvt_pk_bf16_f32 v131, v217, v218
    s_waitcnt lgkmcnt(1)
    v_mfma_f32_16x16x32_bf16 v[220:223], a[32:35], a[0:3], 0
    ds_read_b128 a[40:43], v20 offset:128
    v_lshlrev_b32 v4, 16, v164
    v_mul_f32 v5, 0x3fb8aa3b, v4
    v_exp_f32 v5, v5
    ds_read_b128 a[44:47], v20 offset:192
    v_lshlrev_b32 v6, 16, v156
    v_and_b32 v7, s58, v156
    s_waitcnt lgkmcnt(2)
    v_mfma_f32_16x16x32_bf16 v[220:223], a[36:39], a[4:7], v[220:223]
    ds_read_b128 a[48:51], v20 offset:256
    v_mul_f32 v6, 0x3fb8aa3b, v6
    v_mul_f32 v7, 0x3fb8aa3b, v7
    v_exp_f32 v6, v6
    ds_read_b128 a[52:55], v20 offset:320
    v_exp_f32 v7, v7
    s_waitcnt lgkmcnt(3)
    v_mfma_f32_16x16x32_bf16 v[220:223], a[40:43], a[8:11], v[220:223]
    v_cvt_pk_bf16_f32 v5, v5, v5
    ds_read_b128 a[56:59], v20 offset:384
    v_and_b32 v44, s58, v5
    v_cvt_pk_bf16_f32 v6, v6, v7
    v_and_b32 v7, s58, v6
    ds_read_b128 a[60:63], v20 offset:448
    s_waitcnt lgkmcnt(4)
    v_mfma_f32_16x16x32_bf16 v[220:223], a[44:47], a[12:15], v[220:223]
    v_lshlrev_b32 v6, 16, v6
    v_mul_f32 v6, v6, v44
    ds_write_b32 v21, v126 offset:17664
    v_mul_f32 v7, v7, v44
    v_mul_f32 v6, 0xbfb8aa3b, v6
    s_waitcnt lgkmcnt(4)
    v_mfma_f32_16x16x32_bf16 v[220:223], a[48:51], a[16:19], v[220:223]
    ds_write_b32 v21, v127 offset:19840
    v_mul_f32 v7, 0xbfb8aa3b, v7
    v_lshlrev_b32 v8, 16, v157
    v_and_b32 v9, s58, v157
    ds_write_b64 v22, v[128:129] offset:17920
    v_mul_f32 v8, v8, v44
    s_waitcnt lgkmcnt(5)
    v_mfma_f32_16x16x32_bf16 v[220:223], a[52:55], a[20:23], v[220:223]
    v_mul_f32 v9, v9, v44
    ds_write_b64 v22, v[130:131] offset:20096
    v_mul_f32 v8, 0.15915494, v8
    v_mul_f32 v9, 0.15915494, v9
    v_add_f32 v5, v44, v44
    s_waitcnt lgkmcnt(5)
    v_mfma_f32_16x16x32_bf16 v[220:223], a[56:59], a[24:27], v[220:223]
    v_lshlrev_b32 v168, 16, v158
    v_lshlrev_b32 v169, 16, v159
    v_and_b32 v170, s58, v158
    v_and_b32 v171, s58, v159
    s_waitcnt lgkmcnt(4)
    v_mfma_f32_16x16x32_bf16 v[220:223], a[60:63], a[28:31], v[220:223]
    v_mul_f32 v168, v168, v5
    v_mul_f32 v169, v169, v5
    v_mul_f32 v170, v170, v5
    v_mul_f32 v171, v171, v5
    v_mul_f32 v40, 0x41800000, v6
    v_mul_f32 v41, 0x41800000, v8
    v_exp_f32 v40, v40
    v_fract_f32 v41, v41
    v_mul_f32 v42, 0x41800000, v7
    v_mul_f32 v43, 0x41800000, v9
    v_exp_f32 v42, v42
    v_fract_f32 v43, v43
    v_cos_f32 v28, v41
    v_sin_f32 v29, v41
    v_cos_f32 v30, v43
    v_sin_f32 v31, v43
    v_mul_f32 v28, v28, v40
    v_mul_f32 v29, -v29, v40
    v_mul_f32 v30, v30, v42
    v_mul_f32 v31, -v31, v42
    v_exp_f32 v40, v6
    v_fract_f32 v41, v8
    v_exp_f32 v42, v7
    v_fract_f32 v43, v9
    v_cos_f32 v24, v41
    v_sin_f32 v25, v41
    v_cos_f32 v26, v43
    v_sin_f32 v27, v43
    v_mul_f32 v24, v24, v40
    v_mul_f32 v25, v25, v40
    v_mul_f32 v26, v26, v42
    v_mul_f32 v27, v27, v42
    v_mul_f32 v40, 0x43800000, v6
    v_mul_f32 v41, 0x43800000, v8
    v_exp_f32 v40, v40
    v_fract_f32 v41, v41
    v_mul_f32 v42, 0x43800000, v7
    v_mul_f32 v43, 0x43800000, v9
    v_exp_f32 v42, v42
    v_fract_f32 v43, v43
    v_cos_f32 v32, v41
    v_sin_f32 v33, v41
    v_cos_f32 v34, v43
    v_sin_f32 v35, v43
    v_mul_f32 v32, v32, v40
    v_mul_f32 v33, v33, v40
    v_mul_f32 v34, v34, v42
    v_mul_f32 v35, v35, v42
    v_cvt_pk_bf16_f32 v4, v220, v220
    v_cvt_pk_bf16_f32 v5, v220, v221
    v_cvt_pk_bf16_f32 v6, v221, v221
    v_cvt_pk_bf16_f32 v7, v222, v222
    v_cvt_pk_bf16_f32 v8, v220, v220
    v_cvt_pk_bf16_f32 v9, v221, v221
    v_cvt_pk_bf16_f32 v10, v221, v221
    v_cvt_pk_bf16_f32 v11, v222, v222
    ds_write_b128 v23, v[4:7] offset:18432
    ds_write_b128 v23, v[8:11] offset:20608
    v_mov_b32 v112, 0x3f80
    v_mov_b32 v113, 0x3f80
    ds_write_b64 v16, v[112:113] offset:0
    v_cvt_pk_bf16_f32 v114, v28, v29
    v_cvt_pk_bf16_f32 v115, v30, v31
    ds_write_b64 v16, v[114:115] offset:528
    v_pk_mul_f32 v[40:41], v[28:29], v[28:29] op_sel_hi:[1,0]
    v_pk_mul_f32 v[42:43], v[30:31], v[30:31] op_sel_hi:[1,0]
    v_pk_fma_f32 v[36:37], v[28:29], v[28:29], v[40:41] op_sel:[1,1,0] op_sel_hi:[0,1,1] neg_lo:[1,0,0]
    v_pk_fma_f32 v[38:39], v[30:31], v[30:31], v[42:43] op_sel:[1,1,0] op_sel_hi:[0,1,1] neg_lo:[1,0,0]
    v_cvt_pk_bf16_f32 v116, v36, v37
    v_cvt_pk_bf16_f32 v117, v38, v39
    ds_write_b64 v16, v[116:117] offset:1056
    v_pk_mul_f32 v[40:41], v[36:37], v[28:29] op_sel_hi:[1,0]
    v_pk_mul_f32 v[42:43], v[38:39], v[30:31] op_sel_hi:[1,0]
    v_pk_fma_f32 v[36:37], v[36:37], v[28:29], v[40:41] op_sel:[1,1,0] op_sel_hi:[0,1,1] neg_lo:[1,0,0]
    v_pk_fma_f32 v[38:39], v[38:39], v[30:31], v[42:43] op_sel:[1,1,0] op_sel_hi:[0,1,1] neg_lo:[1,0,0]
    v_cvt_pk_bf16_f32 v118, v36, v37
    v_cvt_pk_bf16_f32 v119, v38, v39
    ds_write_b64 v16, v[118:119] offset:1584
    v_pk_mul_f32 v[40:41], v[36:37], v[28:29] op_sel_hi:[1,0]
    v_pk_mul_f32 v[42:43], v[38:39], v[30:31] op_sel_hi:[1,0]
    v_pk_fma_f32 v[36:37], v[36:37], v[28:29], v[40:41] op_sel:[1,1,0] op_sel_hi:[0,1,1] neg_lo:[1,0,0]
    v_pk_fma_f32 v[38:39], v[38:39], v[30:31], v[42:43] op_sel:[1,1,0] op_sel_hi:[0,1,1] neg_lo:[1,0,0]
    v_cvt_pk_bf16_f32 v100, v36, v37
    v_cvt_pk_bf16_f32 v101, v38, v39
    ds_write_b64 v16, v[100:101] offset:2112
    v_pk_mul_f32 v[40:41], v[36:37], v[28:29] op_sel_hi:[1,0]
    v_pk_mul_f32 v[42:43], v[38:39], v[30:31] op_sel_hi:[1,0]
    v_pk_fma_f32 v[36:37], v[36:37], v[28:29], v[40:41] op_sel:[1,1,0] op_sel_hi:[0,1,1] neg_lo:[1,0,0]
    v_pk_fma_f32 v[38:39], v[38:39], v[30:31], v[42:43] op_sel:[1,1,0] op_sel_hi:[0,1,1] neg_lo:[1,0,0]
    v_cvt_pk_bf16_f32 v102, v36, v37
    v_cvt_pk_bf16_f32 v103, v38, v39
    ds_write_b64 v16, v[102:103] offset:2640
    v_pk_mul_f32 v[40:41], v[36:37], v[28:29] op_sel_hi:[1,0]
    v_pk_mul_f32 v[42:43], v[38:39], v[30:31] op_sel_hi:[1,0]
    v_pk_fma_f32 v[36:37], v[36:37], v[28:29], v[40:41] op_sel:[1,1,0] op_sel_hi:[0,1,1] neg_lo:[1,0,0]
    v_pk_fma_f32 v[38:39], v[38:39], v[30:31], v[42:43] op_sel:[1,1,0] op_sel_hi:[0,1,1] neg_lo:[1,0,0]
    v_cvt_pk_bf16_f32 v104, v36, v37
    v_cvt_pk_bf16_f32 v105, v38, v39
    ds_write_b64 v16, v[104:105] offset:3168
    v_pk_mul_f32 v[40:41], v[36:37], v[28:29] op_sel_hi:[1,0]
    v_pk_mul_f32 v[42:43], v[38:39], v[30:31] op_sel_hi:[1,0]
    v_pk_fma_f32 v[36:37], v[36:37], v[28:29], v[40:41] op_sel:[1,1,0] op_sel_hi:[0,1,1] neg_lo:[1,0,0]
    v_pk_fma_f32 v[38:39], v[38:39], v[30:31], v[42:43] op_sel:[1,1,0] op_sel_hi:[0,1,1] neg_lo:[1,0,0]
    v_cvt_pk_bf16_f32 v106, v36, v37
    v_cvt_pk_bf16_f32 v107, v38, v39
    ds_write_b64 v16, v[106:107] offset:3696
    v_pk_mul_f32 v[40:41], v[36:37], v[28:29] op_sel_hi:[1,0]
    v_pk_mul_f32 v[42:43], v[38:39], v[30:31] op_sel_hi:[1,0]
    v_pk_fma_f32 v[36:37], v[36:37], v[28:29], v[40:41] op_sel:[1,1,0] op_sel_hi:[0,1,1] neg_lo:[1,0,0]
    v_pk_fma_f32 v[38:39], v[38:39], v[30:31], v[42:43] op_sel:[1,1,0] op_sel_hi:[0,1,1] neg_lo:[1,0,0]
    v_cvt_pk_bf16_f32 v108, v36, v37
    v_cvt_pk_bf16_f32 v109, v38, v39
    ds_write_b64 v16, v[108:109] offset:4224
    v_pk_mul_f32 v[40:41], v[36:37], v[28:29] op_sel_hi:[1,0]
    v_pk_mul_f32 v[42:43], v[38:39], v[30:31] op_sel_hi:[1,0]
    v_pk_fma_f32 v[36:37], v[36:37], v[28:29], v[40:41] op_sel:[1,1,0] op_sel_hi:[0,1,1] neg_lo:[1,0,0]
    v_pk_fma_f32 v[38:39], v[38:39], v[30:31], v[42:43] op_sel:[1,1,0] op_sel_hi:[0,1,1] neg_lo:[1,0,0]
    v_cvt_pk_bf16_f32 v110, v36, v37
    v_cvt_pk_bf16_f32 v111, v38, v39
    ds_write_b64 v16, v[110:111] offset:4752
    v_pk_mul_f32 v[40:41], v[36:37], v[28:29] op_sel_hi:[1,0]
    v_pk_mul_f32 v[42:43], v[38:39], v[30:31] op_sel_hi:[1,0]
    v_pk_fma_f32 v[36:37], v[36:37], v[28:29], v[40:41] op_sel:[1,1,0] op_sel_hi:[0,1,1] neg_lo:[1,0,0]
    v_pk_fma_f32 v[38:39], v[38:39], v[30:31], v[42:43] op_sel:[1,1,0] op_sel_hi:[0,1,1] neg_lo:[1,0,0]
    v_cvt_pk_bf16_f32 v112, v36, v37
    v_cvt_pk_bf16_f32 v113, v38, v39
    ds_write_b64 v16, v[112:113] offset:5280
    v_pk_mul_f32 v[40:41], v[36:37], v[28:29] op_sel_hi:[1,0]
    v_pk_mul_f32 v[42:43], v[38:39], v[30:31] op_sel_hi:[1,0]
    v_pk_fma_f32 v[36:37], v[36:37], v[28:29], v[40:41] op_sel:[1,1,0] op_sel_hi:[0,1,1] neg_lo:[1,0,0]
    v_pk_fma_f32 v[38:39], v[38:39], v[30:31], v[42:43] op_sel:[1,1,0] op_sel_hi:[0,1,1] neg_lo:[1,0,0]
    v_cvt_pk_bf16_f32 v114, v36, v37
    v_cvt_pk_bf16_f32 v115, v38, v39
    ds_write_b64 v16, v[114:115] offset:5808
    v_pk_mul_f32 v[40:41], v[36:37], v[28:29] op_sel_hi:[1,0]
    v_pk_mul_f32 v[42:43], v[38:39], v[30:31] op_sel_hi:[1,0]
    v_pk_fma_f32 v[36:37], v[36:37], v[28:29], v[40:41] op_sel:[1,1,0] op_sel_hi:[0,1,1] neg_lo:[1,0,0]
    v_pk_fma_f32 v[38:39], v[38:39], v[30:31], v[42:43] op_sel:[1,1,0] op_sel_hi:[0,1,1] neg_lo:[1,0,0]
    v_cvt_pk_bf16_f32 v116, v36, v37
    v_cvt_pk_bf16_f32 v117, v38, v39
    ds_write_b64 v16, v[116:117] offset:6336
    v_pk_mul_f32 v[40:41], v[36:37], v[28:29] op_sel_hi:[1,0]
    v_pk_mul_f32 v[42:43], v[38:39], v[30:31] op_sel_hi:[1,0]
    v_pk_fma_f32 v[36:37], v[36:37], v[28:29], v[40:41] op_sel:[1,1,0] op_sel_hi:[0,1,1] neg_lo:[1,0,0]
    v_pk_fma_f32 v[38:39], v[38:39], v[30:31], v[42:43] op_sel:[1,1,0] op_sel_hi:[0,1,1] neg_lo:[1,0,0]
    v_cvt_pk_bf16_f32 v118, v36, v37
    v_cvt_pk_bf16_f32 v119, v38, v39
    ds_write_b64 v16, v[118:119] offset:6864
    v_pk_mul_f32 v[40:41], v[36:37], v[28:29] op_sel_hi:[1,0]
    v_pk_mul_f32 v[42:43], v[38:39], v[30:31] op_sel_hi:[1,0]
    v_pk_fma_f32 v[36:37], v[36:37], v[28:29], v[40:41] op_sel:[1,1,0] op_sel_hi:[0,1,1] neg_lo:[1,0,0]
    v_pk_fma_f32 v[38:39], v[38:39], v[30:31], v[42:43] op_sel:[1,1,0] op_sel_hi:[0,1,1] neg_lo:[1,0,0]
    v_cvt_pk_bf16_f32 v100, v36, v37
    v_cvt_pk_bf16_f32 v101, v38, v39
    ds_write_b64 v16, v[100:101] offset:7392
    v_pk_mul_f32 v[40:41], v[36:37], v[28:29] op_sel_hi:[1,0]
    v_pk_mul_f32 v[42:43], v[38:39], v[30:31] op_sel_hi:[1,0]
    v_pk_fma_f32 v[36:37], v[36:37], v[28:29], v[40:41] op_sel:[1,1,0] op_sel_hi:[0,1,1] neg_lo:[1,0,0]
    v_pk_fma_f32 v[38:39], v[38:39], v[30:31], v[42:43] op_sel:[1,1,0] op_sel_hi:[0,1,1] neg_lo:[1,0,0]
    v_cvt_pk_bf16_f32 v102, v36, v37
    v_cvt_pk_bf16_f32 v103, v38, v39
    ds_write_b64 v16, v[102:103] offset:7920
    v_cvt_pk_bf16_f32 v104, v168, v169
    ds_read_b128 a[0:3], v17 offset:0
    v_cvt_pk_bf16_f32 v105, v170, v171
    buffer_load_dword v144, v143, s[24:27], 0 offen sc1
    v_pk_mul_f32 v[40:41], v[168:169], v[24:25] op_sel_hi:[1,0]
    v_pk_mul_f32 v[42:43], v[170:171], v[26:27] op_sel_hi:[1,0]
    ds_read_b128 a[4:7], v17 offset:64
    v_pk_fma_f32 v[204:205], v[168:169], v[24:25], v[40:41] op_sel:[1,1,0] op_sel_hi:[0,1,1] neg_lo:[1,0,0]
    v_pk_fma_f32 v[206:207], v[170:171], v[26:27], v[42:43] op_sel:[1,1,0] op_sel_hi:[0,1,1] neg_lo:[1,0,0]
    v_cvt_pk_bf16_f32 v106, v204, v205
    ds_read_b128 a[8:11], v17 offset:128
    v_cvt_pk_bf16_f32 v107, v206, v207
    v_pk_mul_f32 v[40:41], v[204:205], v[24:25] op_sel_hi:[1,0]
    v_pk_mul_f32 v[42:43], v[206:207], v[26:27] op_sel_hi:[1,0]
    ds_read_b128 a[12:15], v17 offset:192
    v_pk_fma_f32 v[172:173], v[204:205], v[24:25], v[40:41] op_sel:[1,1,0] op_sel_hi:[0,1,1] neg_lo:[1,0,0]
    v_pk_fma_f32 v[174:175], v[206:207], v[26:27], v[42:43] op_sel:[1,1,0] op_sel_hi:[0,1,1] neg_lo:[1,0,0]
    v_cvt_pk_bf16_f32 v108, v172, v173
    ds_read_b128 a[16:19], v17 offset:256
    v_cvt_pk_bf16_f32 v109, v174, v175
    v_pk_mul_f32 v[40:41], v[172:173], v[24:25] op_sel_hi:[1,0]
    v_pk_mul_f32 v[42:43], v[174:175], v[26:27] op_sel_hi:[1,0]
    ds_read_b128 a[20:23], v17 offset:320
    v_pk_fma_f32 v[204:205], v[172:173], v[24:25], v[40:41] op_sel:[1,1,0] op_sel_hi:[0,1,1] neg_lo:[1,0,0]
    v_pk_fma_f32 v[206:207], v[174:175], v[26:27], v[42:43] op_sel:[1,1,0] op_sel_hi:[0,1,1] neg_lo:[1,0,0]
    v_cvt_pk_bf16_f32 v110, v204, v205
    ds_read_b128 a[24:27], v17 offset:384
    v_cvt_pk_bf16_f32 v111, v206, v207
    v_pk_mul_f32 v[40:41], v[204:205], v[24:25] op_sel_hi:[1,0]
    v_pk_mul_f32 v[42:43], v[206:207], v[26:27] op_sel_hi:[1,0]
    ds_read_b128 a[28:31], v17 offset:448
    v_pk_fma_f32 v[176:177], v[204:205], v[24:25], v[40:41] op_sel:[1,1,0] op_sel_hi:[0,1,1] neg_lo:[1,0,0]
    v_pk_fma_f32 v[178:179], v[206:207], v[26:27], v[42:43] op_sel:[1,1,0] op_sel_hi:[0,1,1] neg_lo:[1,0,0]
    v_cvt_pk_bf16_f32 v112, v176, v177
    ds_write_b64 v16, v[104:105] offset:0
    v_cvt_pk_bf16_f32 v113, v178, v179
    v_pk_mul_f32 v[40:41], v[176:177], v[24:25] op_sel_hi:[1,0]
    v_pk_mul_f32 v[42:43], v[178:179], v[26:27] op_sel_hi:[1,0]
    ds_write_b64 v16, v[106:107] offset:528
    v_pk_fma_f32 v[204:205], v[176:177], v[24:25], v[40:41] op_sel:[1,1,0] op_sel_hi:[0,1,1] neg_lo:[1,0,0]
    v_pk_fma_f32 v[206:207], v[178:179], v[26:27], v[42:43] op_sel:[1,1,0] op_sel_hi:[0,1,1] neg_lo:[1,0,0]
    v_cvt_pk_bf16_f32 v114, v204, v205
    ds_write_b64 v16, v[108:109] offset:1056
    v_cvt_pk_bf16_f32 v115, v206, v207
    v_pk_mul_f32 v[40:41], v[204:205], v[24:25] op_sel_hi:[1,0]
    v_pk_mul_f32 v[42:43], v[206:207], v[26:27] op_sel_hi:[1,0]
    ds_write_b64 v16, v[110:111] offset:1584
    v_pk_fma_f32 v[180:181], v[204:205], v[24:25], v[40:41] op_sel:[1,1,0] op_sel_hi:[0,1,1] neg_lo:[1,0,0]
    v_pk_fma_f32 v[182:183], v[206:207], v[26:27], v[42:43] op_sel:[1,1,0] op_sel_hi:[0,1,1] neg_lo:[1,0,0]
    v_cvt_pk_bf16_f32 v116, v180, v181
    ds_write_b64 v16, v[112:113] offset:2112
    v_cvt_pk_bf16_f32 v117, v182, v183
    v_pk_mul_f32 v[40:41], v[180:181], v[24:25] op_sel_hi:[1,0]
    v_pk_mul_f32 v[42:43], v[182:183], v[26:27] op_sel_hi:[1,0]
    ds_write_b64 v16, v[114:115] offset:2640
    v_pk_fma_f32 v[204:205], v[180:181], v[24:25], v[40:41] op_sel:[1,1,0] op_sel_hi:[0,1,1] neg_lo:[1,0,0]
    v_pk_fma_f32 v[206:207], v[182:183], v[26:27], v[42:43] op_sel:[1,1,0] op_sel_hi:[0,1,1] neg_lo:[1,0,0]
    v_cvt_pk_bf16_f32 v118, v204, v205
    ds_write_b64 v16, v[116:117] offset:3168
    v_cvt_pk_bf16_f32 v119, v206, v207
    ds_write_b64 v16, v[118:119] offset:3696
    v_pk_mul_f32 v[40:41], v[204:205], v[24:25] op_sel_hi:[1,0]
    v_pk_mul_f32 v[42:43], v[206:207], v[26:27] op_sel_hi:[1,0]
    v_pk_fma_f32 v[184:185], v[204:205], v[24:25], v[40:41] op_sel:[1,1,0] op_sel_hi:[0,1,1] neg_lo:[1,0,0]
    v_pk_fma_f32 v[186:187], v[206:207], v[26:27], v[42:43] op_sel:[1,1,0] op_sel_hi:[0,1,1] neg_lo:[1,0,0]
    v_cvt_pk_bf16_f32 v100, v184, v185
    v_cvt_pk_bf16_f32 v101, v186, v187
    ds_write_b64 v16, v[100:101] offset:4224
    v_pk_mul_f32 v[40:41], v[184:185], v[24:25] op_sel_hi:[1,0]
    v_pk_mul_f32 v[42:43], v[186:187], v[26:27] op_sel_hi:[1,0]
    v_pk_fma_f32 v[204:205], v[184:185], v[24:25], v[40:41] op_sel:[1,1,0] op_sel_hi:[0,1,1] neg_lo:[1,0,0]
    v_pk_fma_f32 v[206:207], v[186:187], v[26:27], v[42:43] op_sel:[1,1,0] op_sel_hi:[0,1,1] neg_lo:[1,0,0]
    v_cvt_pk_bf16_f32 v102, v204, v205
    v_cvt_pk_bf16_f32 v103, v206, v207
    ds_write_b64 v16, v[102:103] offset:4752
    v_pk_mul_f32 v[40:41], v[204:205], v[24:25] op_sel_hi:[1,0]
    v_pk_mul_f32 v[42:43], v[206:207], v[26:27] op_sel_hi:[1,0]
    v_pk_fma_f32 v[188:189], v[204:205], v[24:25], v[40:41] op_sel:[1,1,0] op_sel_hi:[0,1,1] neg_lo:[1,0,0]
    v_pk_fma_f32 v[190:191], v[206:207], v[26:27], v[42:43] op_sel:[1,1,0] op_sel_hi:[0,1,1] neg_lo:[1,0,0]
    v_cvt_pk_bf16_f32 v104, v188, v189
    v_cvt_pk_bf16_f32 v105, v190, v191
    ds_write_b64 v16, v[104:105] offset:5280
    v_pk_mul_f32 v[40:41], v[188:189], v[24:25] op_sel_hi:[1,0]
    v_pk_mul_f32 v[42:43], v[190:191], v[26:27] op_sel_hi:[1,0]
    v_pk_fma_f32 v[204:205], v[188:189], v[24:25], v[40:41] op_sel:[1,1,0] op_sel_hi:[0,1,1] neg_lo:[1,0,0]
    v_pk_fma_f32 v[206:207], v[190:191], v[26:27], v[42:43] op_sel:[1,1,0] op_sel_hi:[0,1,1] neg_lo:[1,0,0]
    v_cvt_pk_bf16_f32 v106, v204, v205
    v_cvt_pk_bf16_f32 v107, v206, v207
    ds_write_b64 v16, v[106:107] offset:5808
    v_pk_mul_f32 v[40:41], v[204:205], v[24:25] op_sel_hi:[1,0]
    v_pk_mul_f32 v[42:43], v[206:207], v[26:27] op_sel_hi:[1,0]
    v_pk_fma_f32 v[192:193], v[204:205], v[24:25], v[40:41] op_sel:[1,1,0] op_sel_hi:[0,1,1] neg_lo:[1,0,0]
    v_pk_fma_f32 v[194:195], v[206:207], v[26:27], v[42:43] op_sel:[1,1,0] op_sel_hi:[0,1,1] neg_lo:[1,0,0]
    v_cvt_pk_bf16_f32 v108, v192, v193
    v_cvt_pk_bf16_f32 v109, v194, v195
    ds_write_b64 v16, v[108:109] offset:6336
    v_pk_mul_f32 v[40:41], v[192:193], v[24:25] op_sel_hi:[1,0]
    v_pk_mul_f32 v[42:43], v[194:195], v[26:27] op_sel_hi:[1,0]
    v_pk_fma_f32 v[204:205], v[192:193], v[24:25], v[40:41] op_sel:[1,1,0] op_sel_hi:[0,1,1] neg_lo:[1,0,0]
    v_pk_fma_f32 v[206:207], v[194:195], v[26:27], v[42:43] op_sel:[1,1,0] op_sel_hi:[0,1,1] neg_lo:[1,0,0]
    v_cvt_pk_bf16_f32 v110, v204, v205
    v_cvt_pk_bf16_f32 v111, v206, v207
    ds_write_b64 v16, v[110:111] offset:6864
    s_mov_b64 exec, 3
    ds_write_b128 v142, v[52:55]
    ds_write_b128 v142, v[52:55] offset:4224
    ds_write_b128 v142, v[52:55] offset:33792
    ds_write_b128 v142, v[52:55] offset:38016
    s_mov_b64 exec, -1
    s_waitcnt vmcnt(0)
    v_cmp_gt_u32 vcc, 2, v144
    s_nop 0
    s_and_b64 vcc, vcc, s[100:101]
    s_cbranch_vccnz L_pu_slow
L_pu_ok:
    s_barrier
    v_min_u32 v143, 15, v1
    v_lshlrev_b32 v143, 2, v143
    v_lshl_add_u32 v143, s28, 8, v143
    v_pk_mul_f32 v[40:41], v[204:205], v[24:25] op_sel_hi:[1,0]
    v_pk_mul_f32 v[42:43], v[206:207], v[26:27] op_sel_hi:[1,0]
    v_pk_fma_f32 v[196:197], v[204:205], v[24:25], v[40:41] op_sel:[1,1,0] op_sel_hi:[0,1,1] neg_lo:[1,0,0]
    v_pk_fma_f32 v[198:199], v[206:207], v[26:27], v[42:43] op_sel:[1,1,0] op_sel_hi:[0,1,1] neg_lo:[1,0,0]
    v_cvt_pk_bf16_f32 v112, v196, v197
    v_cvt_pk_bf16_f32 v113, v198, v199
    ds_write_b64 v16, v[112:113] offset:7392
    s_add_u32 m0, s51, 32
    v_pk_mul_f32 v[40:41], v[196:197], v[24:25] op_sel_hi:[1,0]
    v_pk_mul_f32 v[42:43], v[198:199], v[26:27] op_sel_hi:[1,0]
    v_pk_fma_f32 v[204:205], v[196:197], v[24:25], v[40:41] op_sel:[1,1,0] op_sel_hi:[0,1,1] neg_lo:[1,0,0]
    v_pk_fma_f32 v[206:207], v[198:199], v[26:27], v[42:43] op_sel:[1,1,0] op_sel_hi:[0,1,1] neg_lo:[1,0,0]
    v_cvt_pk_bf16_f32 v114, v204, v205
    v_cvt_pk_bf16_f32 v115, v206, v207
    ds_write_b64 v16, v[114:115] offset:7920
    s_add_u32 s34, s50, 0
    v_pk_mul_f32 v[40:41], v[204:205], v[24:25] op_sel_hi:[1,0]
    v_pk_mul_f32 v[42:43], v[206:207], v[26:27] op_sel_hi:[1,0]
    v_pk_fma_f32 v[200:201], v[204:205], v[24:25], v[40:41] op_sel:[1,1,0] op_sel_hi:[0,1,1] neg_lo:[1,0,0]
    v_pk_fma_f32 v[202:203], v[206:207], v[26:27], v[42:43] op_sel:[1,1,0] op_sel_hi:[0,1,1] neg_lo:[1,0,0]
    v_pk_mul_f32 v[40:41], v[168:169], v[32:33] op_sel_hi:[1,0]
    ds_read_b128 a[32:35], v17 offset:0
    v_pk_mul_f32 v[42:43], v[170:171], v[34:35] op_sel_hi:[1,0]
    v_pk_fma_f32 v[168:169], v[168:169], v[32:33], v[40:41] op_sel:[1,1,0] op_sel_hi:[0,1,1] neg_lo:[1,0,0]
    v_pk_fma_f32 v[170:171], v[170:171], v[34:35], v[42:43] op_sel:[1,1,0] op_sel_hi:[0,1,1] neg_lo:[1,0,0]
    ds_read_b128 a[36:39], v17 offset:64
    v_cvt_pk_bf16_f32 v116, v168, v169
    v_cvt_pk_bf16_f32 v117, v170, v171
    buffer_load_dwordx4 v136, s[16:19], s34 offen offset:0 sc1 lds
    v_pk_mul_f32 v[40:41], v[172:173], v[32:33] op_sel_hi:[1,0]
    ds_read_b128 a[40:43], v17 offset:128
    v_pk_mul_f32 v[42:43], v[174:175], v[34:35] op_sel_hi:[1,0]
    v_pk_fma_f32 v[172:173], v[172:173], v[32:33], v[40:41] op_sel:[1,1,0] op_sel_hi:[0,1,1] neg_lo:[1,0,0]
    v_pk_fma_f32 v[174:175], v[174:175], v[34:35], v[42:43] op_sel:[1,1,0] op_sel_hi:[0,1,1] neg_lo:[1,0,0]
    ds_read_b128 a[44:47], v17 offset:192
    v_cvt_pk_bf16_f32 v118, v172, v173
    v_cvt_pk_bf16_f32 v119, v174, v175
    buffer_load_dwordx4 v136, s[16:19], s34 offen offset:1024 sc1 lds
    v_pk_mul_f32 v[40:41], v[176:177], v[32:33] op_sel_hi:[1,0]
    ds_read_b128 a[48:51], v17 offset:256
    v_pk_mul_f32 v[42:43], v[178:179], v[34:35] op_sel_hi:[1,0]
    v_pk_fma_f32 v[176:177], v[176:177], v[32:33], v[40:41] op_sel:[1,1,0] op_sel_hi:[0,1,1] neg_lo:[1,0,0]
    v_pk_fma_f32 v[178:179], v[178:179], v[34:35], v[42:43] op_sel:[1,1,0] op_sel_hi:[0,1,1] neg_lo:[1,0,0]
    ds_read_b128 a[52:55], v17 offset:320
    v_cvt_pk_bf16_f32 v100, v176, v177
    v_cvt_pk_bf16_f32 v101, v178, v179
    buffer_load_dwordx4 v136, s[16:19], s34 offen offset:2048 sc1 lds
    v_pk_mul_f32 v[40:41], v[180:181], v[32:33] op_sel_hi:[1,0]
    ds_read_b128 a[56:59], v17 offset:384
    v_pk_mul_f32 v[42:43], v[182:183], v[34:35] op_sel_hi:[1,0]
    v_pk_fma_f32 v[180:181], v[180:181], v[32:33], v[40:41] op_sel:[1,1,0] op_sel_hi:[0,1,1] neg_lo:[1,0,0]
    v_pk_fma_f32 v[182:183], v[182:183], v[34:35], v[42:43] op_sel:[1,1,0] op_sel_hi:[0,1,1] neg_lo:[1,0,0]
    ds_read_b128 a[60:63], v17 offset:448
    s_waitcnt lgkmcnt(7)
    v_mfma_f32_16x16x32_bf16 v[208:211], a[32:35], a[0:3], 0
    v_cvt_pk_bf16_f32 v102, v180, v181
    v_cvt_pk_bf16_f32 v103, v182, v183
    ds_write_b64 v16, v[116:117] offset:0
    buffer_load_dwordx4 v136, s[16:19], s34 offen offset:3072 sc1 lds
    v_pk_mul_f32 v[40:41], v[184:185], v[32:33] op_sel_hi:[1,0]
    v_pk_mul_f32 v[42:43], v[186:187], v[34:35] op_sel_hi:[1,0]
    v_pk_fma_f32 v[184:185], v[184:185], v[32:33], v[40:41] op_sel:[1,1,0] op_sel_hi:[0,1,1] neg_lo:[1,0,0]
    ds_write_b64 v16, v[118:119] offset:528
    v_pk_fma_f32 v[186:187], v[186:187], v[34:35], v[42:43] op_sel:[1,1,0] op_sel_hi:[0,1,1] neg_lo:[1,0,0]
    s_waitcnt lgkmcnt(8)
    v_mfma_f32_16x16x32_bf16 v[208:211], a[36:39], a[4:7], v[208:211]
    v_cvt_pk_bf16_f32 v104, v184, v185
    ds_write_b64 v16, v[100:101] offset:1056
    v_cvt_pk_bf16_f32 v105, v186, v187
    s_add_u32 m0, s51, 4256
    v_pk_mul_f32 v[40:41], v[188:189], v[32:33] op_sel_hi:[1,0]
    v_pk_mul_f32 v[42:43], v[190:191], v[34:35] op_sel_hi:[1,0]
    ds_write_b64 v16, v[102:103] offset:1584
    v_pk_fma_f32 v[188:189], v[188:189], v[32:33], v[40:41] op_sel:[1,1,0] op_sel_hi:[0,1,1] neg_lo:[1,0,0]
    v_pk_fma_f32 v[190:191], v[190:191], v[34:35], v[42:43] op_sel:[1,1,0] op_sel_hi:[0,1,1] neg_lo:[1,0,0]
    s_waitcnt lgkmcnt(9)
    v_mfma_f32_16x16x32_bf16 v[208:211], a[40:43], a[8:11], v[208:211]
    ds_write_b64 v16, v[104:105] offset:2112
    v_cvt_pk_bf16_f32 v106, v188, v189
    v_cvt_pk_bf16_f32 v107, v190, v191
    ds_write_b64 v16, v[106:107] offset:2640
    s_sub_u32 s34, s34, 4
    v_pk_mul_f32 v[40:41], v[192:193], v[32:33] op_sel_hi:[1,0]
    v_pk_mul_f32 v[42:43], v[194:195], v[34:35] op_sel_hi:[1,0]
    v_pk_fma_f32 v[192:193], v[192:193], v[32:33], v[40:41] op_sel:[1,1,0] op_sel_hi:[0,1,1] neg_lo:[1,0,0]
    v_pk_fma_f32 v[194:195], v[194:195], v[34:35], v[42:43] op_sel:[1,1,0] op_sel_hi:[0,1,1] neg_lo:[1,0,0]
    s_waitcnt lgkmcnt(10)
    v_mfma_f32_16x16x32_bf16 v[208:211], a[44:47], a[12:15], v[208:211]
    v_cvt_pk_bf16_f32 v108, v192, v193
    v_cvt_pk_bf16_f32 v109, v194, v195
    ds_write_b64 v16, v[108:109] offset:3168
    buffer_load_dwordx4 v136, s[16:19], s34 offen offset:0 sc1 lds
    v_pk_mul_f32 v[40:41], v[196:197], v[32:33] op_sel_hi:[1,0]
    v_pk_mul_f32 v[42:43], v[198:199], v[34:35] op_sel_hi:[1,0]
    v_pk_fma_f32 v[196:197], v[196:197], v[32:33], v[40:41] op_sel:[1,1,0] op_sel_hi:[0,1,1] neg_lo:[1,0,0]
    v_pk_fma_f32 v[198:199], v[198:199], v[34:35], v[42:43] op_sel:[1,1,0] op_sel_hi:[0,1,1] neg_lo:[1,0,0]
    s_waitcnt lgkmcnt(10)
    v_mfma_f32_16x16x32_bf16 v[208:211], a[48:51], a[16:19], v[208:211]
    v_cvt_pk_bf16_f32 v110, v196, v197
    v_cvt_pk_bf16_f32 v111, v198, v199
    ds_write_b64 v16, v[110:111] offset:3696
    buffer_load_dwordx4 v136, s[16:19], s34 offen offset:1024 sc1 lds
    v_pk_mul_f32 v[40:41], v[200:201], v[32:33] op_sel_hi:[1,0]
    v_pk_mul_f32 v[42:43], v[202:203], v[34:35] op_sel_hi:[1,0]
    v_pk_fma_f32 v[200:201], v[200:201], v[32:33], v[40:41] op_sel:[1,1,0] op_sel_hi:[0,1,1] neg_lo:[1,0,0]
    v_pk_fma_f32 v[202:203], v[202:203], v[34:35], v[42:43] op_sel:[1,1,0] op_sel_hi:[0,1,1] neg_lo:[1,0,0]
    s_waitcnt lgkmcnt(10)
    v_mfma_f32_16x16x32_bf16 v[208:211], a[52:55], a[20:23], v[208:211]
    v_cvt_pk_bf16_f32 v112, v200, v201
    v_cvt_pk_bf16_f32 v113, v202, v203
    ds_write_b64 v16, v[112:113] offset:4224
    buffer_load_dwordx4 v136, s[16:19], s34 offen offset:2048 sc1 lds
    s_waitcnt lgkmcnt(10)
    v_mfma_f32_16x16x32_bf16 v[208:211], a[56:59], a[24:27], v[208:211]
    s_waitcnt lgkmcnt(9)
    v_mfma_f32_16x16x32_bf16 v[208:211], a[60:63], a[28:31], v[208:211]
    v_pk_mul_f32 v[40:41], v[168:169], v[32:33] op_sel_hi:[1,0]
    ds_read_b128 a[32:35], v18 offset:0
    v_pk_mul_f32 v[42:43], v[170:171], v[34:35] op_sel_hi:[1,0]
    v_pk_fma_f32 v[168:169], v[168:169], v[32:33], v[40:41] op_sel:[1,1,0] op_sel_hi:[0,1,1] neg_lo:[1,0,0]
    v_pk_fma_f32 v[170:171], v[170:171], v[34:35], v[42:43] op_sel:[1,1,0] op_sel_hi:[0,1,1] neg_lo:[1,0,0]
    ds_read_b128 a[36:39], v18 offset:64
    v_cvt_pk_bf16_f32 v114, v168, v169
    v_cvt_pk_bf16_f32 v115, v170, v171
    buffer_load_dwordx4 v136, s[16:19], s34 offen offset:3072 sc1 lds
    v_pk_mul_f32 v[40:41], v[176:177], v[32:33] op_sel_hi:[1,0]
    ds_read_b128 a[40:43], v18 offset:128
    v_pk_mul_f32 v[42:43], v[178:179], v[34:35] op_sel_hi:[1,0]
    v_pk_fma_f32 v[176:177], v[176:177], v[32:33], v[40:41] op_sel:[1,1,0] op_sel_hi:[0,1,1] neg_lo:[1,0,0]
    v_pk_fma_f32 v[178:179], v[178:179], v[34:35], v[42:43] op_sel:[1,1,0] op_sel_hi:[0,1,1] neg_lo:[1,0,0]
    ds_read_b128 a[44:47], v18 offset:192
    v_cvt_pk_bf16_f32 v116, v176, v177
    v_cvt_pk_bf16_f32 v117, v178, v179
    v_pk_mul_f32 v[40:41], v[184:185], v[32:33] op_sel_hi:[1,0]
    ds_read_b128 a[48:51], v18 offset:256
    v_pk_mul_f32 v[42:43], v[186:187], v[34:35] op_sel_hi:[1,0]
    v_pk_fma_f32 v[184:185], v[184:185], v[32:33], v[40:41] op_sel:[1,1,0] op_sel_hi:[0,1,1] neg_lo:[1,0,0]
    v_pk_fma_f32 v[186:187], v[186:187], v[34:35], v[42:43] op_sel:[1,1,0] op_sel_hi:[0,1,1] neg_lo:[1,0,0]
    ds_read_b128 a[52:55], v18 offset:320
    s_waitcnt lgkmcnt(5)
    v_mfma_f32_16x16x32_bf16 v[212:215], a[32:35], a[0:3], 0
    v_cvt_pk_bf16_f32 v118, v184, v185
    v_cvt_pk_bf16_f32 v119, v186, v187
    ds_read_b128 a[56:59], v18 offset:384
    s_mul_i32 s34, s28, 16
    v_min_u32 v146, 15, v1
    v_add_lshl_u32 v146, v146, s34, 7
    v_add_u32 v146, L_conv0-L_pc, v146
    v_min_u32 v146, L_end-L_pc, v146
    global_load_dword v147, v146, s[56:57]
    v_pk_mul_f32 v[40:41], v[192:193], v[32:33] op_sel_hi:[1,0]
    v_pk_mul_f32 v[42:43], v[194:195], v[34:35] op_sel_hi:[1,0]
    v_pk_fma_f32 v[192:193], v[192:193], v[32:33], v[40:41] op_sel:[1,1,0] op_sel_hi:[0,1,1] neg_lo:[1,0,0]
    ds_read_b128 a[60:63], v18 offset:448
    v_pk_fma_f32 v[194:195], v[194:195], v[34:35], v[42:43] op_sel:[1,1,0] op_sel_hi:[0,1,1] neg_lo:[1,0,0]
    s_waitcnt lgkmcnt(6)
    v_mfma_f32_16x16x32_bf16 v[212:215], a[36:39], a[4:7], v[212:215]
    v_cvt_pk_bf16_f32 v100, v192, v193
    ds_write_b64 v16, v[114:115] offset:0
    v_cvt_pk_bf16_f32 v101, v194, v195
    v_pk_mul_f32 v[40:41], v[200:201], v[32:33] op_sel_hi:[1,0]
    v_pk_mul_f32 v[42:43], v[202:203], v[34:35] op_sel_hi:[1,0]
    ds_write_b64 v16, v[116:117] offset:528
    v_pk_fma_f32 v[200:201], v[200:201], v[32:33], v[40:41] op_sel:[1,1,0] op_sel_hi:[0,1,1] neg_lo:[1,0,0]
    v_pk_fma_f32 v[202:203], v[202:203], v[34:35], v[42:43] op_sel:[1,1,0] op_sel_hi:[0,1,1] neg_lo:[1,0,0]
    s_waitcnt lgkmcnt(7)
    v_mfma_f32_16x16x32_bf16 v[212:215], a[40:43], a[8:11], v[212:215]
    ds_write_b64 v16, v[118:119] offset:1056
    v_cvt_pk_bf16_f32 v102, v200, v201
    v_cvt_pk_bf16_f32 v103, v202, v203
    v_pk_mul_f32 v[40:41], v[168:169], v[32:33] op_sel_hi:[1,0]
    ds_write_b64 v16, v[100:101] offset:1584
    v_pk_mul_f32 v[42:43], v[170:171], v[34:35] op_sel_hi:[1,0]
    v_pk_fma_f32 v[168:169], v[168:169], v[32:33], v[40:41] op_sel:[1,1,0] op_sel_hi:[0,1,1] neg_lo:[1,0,0]
    v_pk_fma_f32 v[170:171], v[170:171], v[34:35], v[42:43] op_sel:[1,1,0] op_sel_hi:[0,1,1] neg_lo:[1,0,0]
    ds_write_b64 v16, v[102:103] offset:2112
    s_waitcnt lgkmcnt(9)
    v_mfma_f32_16x16x32_bf16 v[212:215], a[44:47], a[12:15], v[212:215]
    v_cvt_pk_bf16_f32 v104, v168, v169
    v_cvt_pk_bf16_f32 v105, v170, v171
    ds_write_b64 v16, v[104:105] offset:2640
    v_pk_mul_f32 v[40:41], v[176:177], v[32:33] op_sel_hi:[1,0]
    v_pk_mul_f32 v[42:43], v[178:179], v[34:35] op_sel_hi:[1,0]
    v_pk_fma_f32 v[176:177], v[176:177], v[32:33], v[40:41] op_sel:[1,1,0] op_sel_hi:[0,1,1] neg_lo:[1,0,0]
    v_pk_fma_f32 v[178:179], v[178:179], v[34:35], v[42:43] op_sel:[1,1,0] op_sel_hi:[0,1,1] neg_lo:[1,0,0]
    s_waitcnt lgkmcnt(9)
    v_mfma_f32_16x16x32_bf16 v[212:215], a[48:51], a[16:19], v[212:215]
    v_cvt_pk_bf16_f32 v106, v176, v177
    v_cvt_pk_bf16_f32 v107, v178, v179
    ds_write_b64 v16, v[106:107] offset:3168
    v_pk_mul_f32 v[40:41], v[184:185], v[32:33] op_sel_hi:[1,0]
    v_pk_mul_f32 v[42:43], v[186:187], v[34:35] op_sel_hi:[1,0]
    v_pk_fma_f32 v[184:185], v[184:185], v[32:33], v[40:41] op_sel:[1,1,0] op_sel_hi:[0,1,1] neg_lo:[1,0,0]
    v_pk_fma_f32 v[186:187], v[186:187], v[34:35], v[42:43] op_sel:[1,1,0] op_sel_hi:[0,1,1] neg_lo:[1,0,0]
    s_waitcnt lgkmcnt(9)
    v_mfma_f32_16x16x32_bf16 v[212:215], a[52:55], a[20:23], v[212:215]
    v_cvt_pk_bf16_f32 v108, v184, v185
    v_cvt_pk_bf16_f32 v109, v186, v187
    ds_write_b64 v16, v[108:109] offset:3696
    v_pk_mul_f32 v[40:41], v[192:193], v[32:33] op_sel_hi:[1,0]
    v_pk_mul_f32 v[42:43], v[194:195], v[34:35] op_sel_hi:[1,0]
    v_pk_fma_f32 v[192:193], v[192:193], v[32:33], v[40:41] op_sel:[1,1,0] op_sel_hi:[0,1,1] neg_lo:[1,0,0]
    v_pk_fma_f32 v[194:195], v[194:195], v[34:35], v[42:43] op_sel:[1,1,0] op_sel_hi:[0,1,1] neg_lo:[1,0,0]
    s_waitcnt lgkmcnt(9)
    v_mfma_f32_16x16x32_bf16 v[212:215], a[56:59], a[24:27], v[212:215]
    v_cvt_pk_bf16_f32 v110, v192, v193
    v_cvt_pk_bf16_f32 v111, v194, v195
    ds_write_b64 v16, v[110:111] offset:4224
    v_pk_mul_f32 v[40:41], v[200:201], v[32:33] op_sel_hi:[1,0]
    v_pk_mul_f32 v[42:43], v[202:203], v[34:35] op_sel_hi:[1,0]
    v_pk_fma_f32 v[200:201], v[200:201], v[32:33], v[40:41] op_sel:[1,1,0] op_sel_hi:[0,1,1] neg_lo:[1,0,0]
    v_pk_fma_f32 v[202:203], v[202:203], v[34:35], v[42:43] op_sel:[1,1,0] op_sel_hi:[0,1,1] neg_lo:[1,0,0]
    s_waitcnt lgkmcnt(9)
    v_mfma_f32_16x16x32_bf16 v[212:215], a[60:63], a[28:31], v[212:215]
    v_cvt_pk_bf16_f32 v112, v200, v201
    v_cvt_pk_bf16_f32 v113, v202, v203
    ds_write_b64 v16, v[112:113] offset:4752
    v_lshlrev_b32 v4, 16, v165
    ds_read_b128 a[32:35], v19 offset:0
    v_cmp_eq_u32 vcc, 0, v1
    s_nop 1
    v_cndmask_b32 v4, 0, v4, vcc
    v_add_f32 v208, v208, v4
    ds_read_b128 a[36:39], v19 offset:64
    v_cvt_pk_bf16_f32 v122, v208, v210
    v_cvt_pk_bf16_f32 v123, v209, v211
    v_pk_mul_f32 v[40:41], v[168:169], v[32:33] op_sel_hi:[1,0]
    ds_read_b128 a[40:43], v19 offset:128
    v_pk_mul_f32 v[42:43], v[170:171], v[34:35] op_sel_hi:[1,0]
    v_pk_fma_f32 v[168:169], v[168:169], v[32:33], v[40:41] op_sel:[1,1,0] op_sel_hi:[0,1,1] neg_lo:[1,0,0]
    v_pk_fma_f32 v[170:171], v[170:171], v[34:35], v[42:43] op_sel:[1,1,0] op_sel_hi:[0,1,1] neg_lo:[1,0,0]
    ds_read_b128 a[44:47], v19 offset:192
    v_cvt_pk_bf16_f32 v114, v168, v169
    v_cvt_pk_bf16_f32 v115, v170, v171
    v_pk_mul_f32 v[40:41], v[184:185], v[32:33] op_sel_hi:[1,0]
    ds_read_b128 a[48:51], v19 offset:256
    v_pk_mul_f32 v[42:43], v[186:187], v[34:35] op_sel_hi:[1,0]
    v_pk_fma_f32 v[184:185], v[184:185], v[32:33], v[40:41] op_sel:[1,1,0] op_sel_hi:[0,1,1] neg_lo:[1,0,0]
    v_pk_fma_f32 v[186:187], v[186:187], v[34:35], v[42:43] op_sel:[1,1,0] op_sel_hi:[0,1,1] neg_lo:[1,0,0]
    ds_read_b128 a[52:55], v19 offset:320
    v_cvt_pk_bf16_f32 v116, v184, v185
    v_cvt_pk_bf16_f32 v117, v186, v187
    v_pk_mul_f32 v[40:41], v[200:201], v[32:33] op_sel_hi:[1,0]
    ds_read_b128 a[56:59], v19 offset:384
    v_pk_mul_f32 v[42:43], v[202:203], v[34:35] op_sel_hi:[1,0]
    v_pk_fma_f32 v[200:201], v[200:201], v[32:33], v[40:41] op_sel:[1,1,0] op_sel_hi:[0,1,1] neg_lo:[1,0,0]
    v_pk_fma_f32 v[202:203], v[202:203], v[34:35], v[42:43] op_sel:[1,1,0] op_sel_hi:[0,1,1] neg_lo:[1,0,0]
    ds_read_b128 a[60:63], v19 offset:448
    v_cvt_pk_bf16_f32 v118, v200, v201
    v_cvt_pk_bf16_f32 v119, v202, v203
    v_pk_mul_f32 v[40:41], v[168:169], v[32:33] op_sel_hi:[1,0]
    ds_write_b32 v21, v122 offset:34816
    v_pk_mul_f32 v[42:43], v[170:171], v[34:35] op_sel_hi:[1,0]
    v_pk_fma_f32 v[168:169], v[168:169], v[32:33], v[40:41] op_sel:[1,1,0] op_sel_hi:[0,1,1] neg_lo:[1,0,0]
    v_pk_fma_f32 v[170:171], v[170:171], v[34:35], v[42:43] op_sel:[1,1,0] op_sel_hi:[0,1,1] neg_lo:[1,0,0]
    ds_write_b32 v21, v123 offset:36992
    s_waitcnt lgkmcnt(9)
    v_mfma_f32_16x16x32_bf16 v[216:219], a[32:35], a[0:3], 0
    v_cvt_pk_bf16_f32 v100, v168, v169
    v_cvt_pk_bf16_f32 v101, v170, v171
    ds_write_b64 v16, v[114:115] offset:0
    v_pk_mul_f32 v[40:41], v[184:185], v[32:33] op_sel_hi:[1,0]
    v_pk_mul_f32 v[42:43], v[186:187], v[34:35] op_sel_hi:[1,0]
    v_pk_fma_f32 v[184:185], v[184:185], v[32:33], v[40:41] op_sel:[1,1,0] op_sel_hi:[0,1,1] neg_lo:[1,0,0]
    ds_write_b64 v16, v[116:117] offset:528
    v_pk_fma_f32 v[186:187], v[186:187], v[34:35], v[42:43] op_sel:[1,1,0] op_sel_hi:[0,1,1] neg_lo:[1,0,0]
    s_waitcnt lgkmcnt(10)
    v_mfma_f32_16x16x32_bf16 v[216:219], a[36:39], a[4:7], v[216:219]
    v_cvt_pk_bf16_f32 v102, v184, v185
    ds_write_b64 v16, v[118:119] offset:1056
    v_cvt_pk_bf16_f32 v103, v186, v187
    v_pk_mul_f32 v[40:41], v[200:201], v[32:33] op_sel_hi:[1,0]
    v_pk_mul_f32 v[42:43], v[202:203], v[34:35] op_sel_hi:[1,0]
    ds_write_b64 v16, v[100:101] offset:1584
    v_pk_fma_f32 v[200:201], v[200:201], v[32:33], v[40:41] op_sel:[1,1,0] op_sel_hi:[0,1,1] neg_lo:[1,0,0]
    v_pk_fma_f32 v[202:203], v[202:203], v[34:35], v[42:43] op_sel:[1,1,0] op_sel_hi:[0,1,1] neg_lo:[1,0,0]
    s_waitcnt lgkmcnt(11)
    v_mfma_f32_16x16x32_bf16 v[216:219], a[40:43], a[8:11], v[216:219]
    ds_write_b64 v16, v[102:103] offset:2112
    v_cvt_pk_bf16_f32 v104, v200, v201
    v_cvt_pk_bf16_f32 v105, v202, v203
    ds_write_b64 v16, v[104:105] offset:2640
    v_pk_mul_f32 v[40:41], v[168:169], v[32:33] op_sel_hi:[1,0]
    v_pk_mul_f32 v[42:43], v[170:171], v[34:35] op_sel_hi:[1,0]
    v_pk_fma_f32 v[168:169], v[168:169], v[32:33], v[40:41] op_sel:[1,1,0] op_sel_hi:[0,1,1] neg_lo:[1,0,0]
    v_pk_fma_f32 v[170:171], v[170:171], v[34:35], v[42:43] op_sel:[1,1,0] op_sel_hi:[0,1,1] neg_lo:[1,0,0]
    s_waitcnt lgkmcnt(12)
    v_mfma_f32_16x16x32_bf16 v[216:219], a[44:47], a[12:15], v[216:219]
    v_cvt_pk_bf16_f32 v106, v168, v169
    v_cvt_pk_bf16_f32 v107, v170, v171
    ds_write_b64 v16, v[106:107] offset:3168
    v_pk_mul_f32 v[40:41], v[184:185], v[32:33] op_sel_hi:[1,0]
    v_pk_mul_f32 v[42:43], v[186:187], v[34:35] op_sel_hi:[1,0]
    v_pk_fma_f32 v[184:185], v[184:185], v[32:33], v[40:41] op_sel:[1,1,0] op_sel_hi:[0,1,1] neg_lo:[1,0,0]
    v_pk_fma_f32 v[186:187], v[186:187], v[34:35], v[42:43] op_sel:[1,1,0] op_sel_hi:[0,1,1] neg_lo:[1,0,0]
    s_waitcnt lgkmcnt(12)
    v_mfma_f32_16x16x32_bf16 v[216:219], a[48:51], a[16:19], v[216:219]
    v_cvt_pk_bf16_f32 v108, v184, v185
    v_cvt_pk_bf16_f32 v109, v186, v187
    ds_write_b64 v16, v[108:109] offset:3696
    v_pk_mul_f32 v[40:41], v[200:201], v[32:33] op_sel_hi:[1,0]
    v_pk_mul_f32 v[42:43], v[202:203], v[34:35] op_sel_hi:[1,0]
    v_pk_fma_f32 v[200:201], v[200:201], v[32:33], v[40:41] op_sel:[1,1,0] op_sel_hi:[0,1,1] neg_lo:[1,0,0]
    v_pk_fma_f32 v[202:203], v[202:203], v[34:35], v[42:43] op_sel:[1,1,0] op_sel_hi:[0,1,1] neg_lo:[1,0,0]
    s_waitcnt lgkmcnt(12)
    v_mfma_f32_16x16x32_bf16 v[216:219], a[52:55], a[20:23], v[216:219]
    v_cvt_pk_bf16_f32 v110, v200, v201
    v_cvt_pk_bf16_f32 v111, v202, v203
    ds_write_b64 v16, v[110:111] offset:4224
    v_pk_mul_f32 v[40:41], v[168:169], v[32:33] op_sel_hi:[1,0]
    v_pk_mul_f32 v[42:43], v[170:171], v[34:35] op_sel_hi:[1,0]
    v_pk_fma_f32 v[168:169], v[168:169], v[32:33], v[40:41] op_sel:[1,1,0] op_sel_hi:[0,1,1] neg_lo:[1,0,0]
    v_pk_fma_f32 v[170:171], v[170:171], v[34:35], v[42:43] op_sel:[1,1,0] op_sel_hi:[0,1,1] neg_lo:[1,0,0]
    s_waitcnt lgkmcnt(12)
    v_mfma_f32_16x16x32_bf16 v[216:219], a[56:59], a[24:27], v[216:219]
    v_cvt_pk_bf16_f32 v112, v168, v169
    v_cvt_pk_bf16_f32 v113, v170, v171
    ds_write_b64 v16, v[112:113] offset:4752
    v_pk_mul_f32 v[40:41], v[184:185], v[32:33] op_sel_hi:[1,0]
    v_pk_mul_f32 v[42:43], v[186:187], v[34:35] op_sel_hi:[1,0]
    v_pk_fma_f32 v[184:185], v[184:185], v[32:33], v[40:41] op_sel:[1,1,0] op_sel_hi:[0,1,1] neg_lo:[1,0,0]
    v_pk_fma_f32 v[186:187], v[186:187], v[34:35], v[42:43] op_sel:[1,1,0] op_sel_hi:[0,1,1] neg_lo:[1,0,0]
    s_waitcnt lgkmcnt(12)
    v_mfma_f32_16x16x32_bf16 v[216:219], a[60:63], a[28:31], v[216:219]
    v_cvt_pk_bf16_f32 v114, v184, v185
    v_cvt_pk_bf16_f32 v115, v186, v187
    ds_write_b64 v16, v[114:115] offset:5280
    v_pk_mul_f32 v[40:41], v[200:201], v[32:33] op_sel_hi:[1,0]
    v_pk_mul_f32 v[42:43], v[202:203], v[34:35] op_sel_hi:[1,0]
    v_pk_fma_f32 v[200:201], v[200:201], v[32:33], v[40:41] op_sel:[1,1,0] op_sel_hi:[0,1,1] neg_lo:[1,0,0]
    v_pk_fma_f32 v[202:203], v[202:203], v[34:35], v[42:43] op_sel:[1,1,0] op_sel_hi:[0,1,1] neg_lo:[1,0,0]
    v_cvt_pk_bf16_f32 v116, v200, v201
    v_cvt_pk_bf16_f32 v117, v202, v203
    ds_write_b64 v16, v[116:117] offset:5808
    v_cvt_pk_bf16_f32 v126, v212, v213
    ds_read_b128 a[32:35], v20 offset:0
    v_cvt_pk_bf16_f32 v127, v212, v214
    v_cvt_pk_bf16_f32 v128, v216, v216
    v_cvt_pk_bf16_f32 v129, v217, v218
    ds_read_b128 a[36:39], v20 offset:64
    v_cvt_pk_bf16_f32 v130, v216, v217
    v_cvt_pk_bf16_f32 v131, v217, v218
    s_waitcnt lgkmcnt(1)
    v_mfma_f32_16x16x32_bf16 v[220:223], a[32:35], a[0:3], 0
    ds_read_b128 a[40:43], v20 offset:128
    s_waitcnt lgkmcnt(1)
    v_mfma_f32_16x16x32_bf16 v[220:223], a[36:39], a[4:7], v[220:223]
    s_waitcnt lgkmcnt(0)
    v_mfma_f32_16x16x32_bf16 v[220:223], a[40:43], a[8:11], v[220:223]
    ds_read_b128 a[44:47], v20 offset:192
    s_waitcnt lgkmcnt(0)
    v_mfma_f32_16x16x32_bf16 v[220:223], a[44:47], a[12:15], v[220:223]
    ds_read_b128 a[48:51], v20 offset:256
    s_waitcnt lgkmcnt(0)
    v_mfma_f32_16x16x32_bf16 v[220:223], a[48:51], a[16:19], v[220:223]
    ds_read_b128 a[52:55], v20 offset:320
    s_waitcnt lgkmcnt(0)
    v_mfma_f32_16x16x32_bf16 v[220:223], a[52:55], a[20:23], v[220:223]
    ds_read_b128 a[56:59], v20 offset:384
    s_waitcnt lgkmcnt(0)
    v_mfma_f32_16x16x32_bf16 v[220:223], a[56:59], a[24:27], v[220:223]
    ds_read_b128 a[60:63], v20 offset:448
    s_waitcnt lgkmcnt(0)
    v_mfma_f32_16x16x32_bf16 v[220:223], a[60:63], a[28:31], v[220:223]
    ds_write_b32 v21, v126 offset:35072
    ds_write_b32 v21, v127 offset:37248
    ds_write_b64 v22, v[128:129] offset:35328
    ds_write_b64 v22, v[130:131] offset:37504
    s_nop 3
    v_cvt_pk_bf16_f32 v4, v220, v220
    v_cvt_pk_bf16_f32 v5, v220, v221
    v_cvt_pk_bf16_f32 v6, v221, v221
    v_cvt_pk_bf16_f32 v7, v222, v222
    v_cvt_pk_bf16_f32 v8, v220, v220
    v_cvt_pk_bf16_f32 v9, v221, v221
    v_cvt_pk_bf16_f32 v10, v221, v221
    v_cvt_pk_bf16_f32 v11, v222, v222
    ds_write_b128 v23, v[4:7] offset:35840
    ds_write_b128 v23, v[8:11] offset:38016
    s_waitcnt lgkmcnt(0)
    s_barrier
    s_waitcnt vmcnt(0)
    ds_write_b32 v141, v52 offset:0
    ds_read_b64_tr_b16 a[128:129], v137 offset:16
    ds_read_b64_tr_b16 a[130:131], v137 offset:0
    ds_read_b128 a[0:3], v138 offset:0
    ds_read_b64_tr_b16 a[132:133], v137 offset:144
    ds_read_b64_tr_b16 a[134:135], v137 offset:128
    ds_read_b128 a[4:7], v138 offset:64
    ds_read_b64_tr_b16 a[136:137], v137 offset:272
    ds_read_b64_tr_b16 a[138:139], v137 offset:256
    ds_read_b128 a[8:11], v138 offset:128
    ds_read_b64_tr_b16 a[140:141], v137 offset:400
    ds_read_b64_tr_b16 a[142:143], v137 offset:384
    ds_read_b128 a[12:15], v138 offset:192
    ds_read_b64_tr_b16 a[144:145], v137 offset:528
    ds_read_b64_tr_b16 a[146:147], v137 offset:512
    ds_read_b128 a[16:19], v138 offset:256
    ds_read_b64_tr_b16 a[148:149], v137 offset:656
    ds_read_b64_tr_b16 a[150:151], v137 offset:640
    ds_read_b128 a[20:23], v138 offset:320
    ds_read_b64_tr_b16 a[152:153], v137 offset:784
    ds_read_b64_tr_b16 a[154:155], v137 offset:768
    ds_read_b128 a[24:27], v138 offset:384
    ds_read_b64_tr_b16 a[156:157], v137 offset:912
    ds_read_b64_tr_b16 a[158:159], v137 offset:896
    ds_read_b128 a[28:31], v138 offset:448
L_conv0:
    s_waitcnt lgkmcnt(14)
    v_mfma_f32_16x16x32_bf16 v[100:103], a[0:3], a[132:135], 0
    v_mfma_f32_16x16x32_bf16 v[100:103], a[4:7], a[128:131], v[100:103]
    s_waitcnt lgkmcnt(12)
    v_mfma_f32_16x16x32_bf16 v[104:107], a[0:3], a[140:143], 0
    v_mfma_f32_16x16x32_bf16 v[104:107], a[4:7], a[136:139], v[104:107]
    v_mfma_f32_16x16x32_bf16 v[104:107], a[8:11], a[132:135], v[104:107]
    v_mfma_f32_16x16x32_bf16 v[104:107], a[12:15], a[128:131], v[104:107]
    s_nop 2
    v_cndmask_b32 v112, v101, v52, s[30:31]
    v_cndmask_b32 v113, v103, v101, s[30:31]
    s_nop 0
    v_add_f32_dpp v114, v112, v100 wave_ror:1 row_mask:0xf bank_mask:0xf
    v_add_f32_dpp v115, v113, v102 wave_ror:1 row_mask:0xf bank_mask:0xf
    v_cvt_pk_bf16_f32 v116, v114, v115
    ds_write_b16 v139, v116 offset:0
    ds_write_b16_d16_hi v139, v116 offset:512
    s_waitcnt lgkmcnt(8)
    v_mfma_f32_16x16x32_bf16 v[108:111], a[0:3], a[148:151], 0
    ds_read_b64_tr_b16 a[160:161], v137 offset:1040
    ds_read_b64_tr_b16 a[162:163], v137 offset:1024
    v_mfma_f32_16x16x32_bf16 v[108:111], a[4:7], a[144:147], v[108:111]
    ds_read_b128 a[32:35], v138 offset:512
    ds_read_b64_tr_b16 a[164:165], v137 offset:1168
    v_mfma_f32_16x16x32_bf16 v[108:111], a[8:11], a[140:143], v[108:111]
    ds_read_b64_tr_b16 a[166:167], v137 offset:1152
    ds_read_b128 a[36:39], v138 offset:576
    v_mfma_f32_16x16x32_bf16 v[108:111], a[12:15], a[136:139], v[108:111]
    v_cndmask_b32 v112, v105, v103, s[30:31]
    v_cndmask_b32 v113, v107, v105, s[30:31]
    v_mfma_f32_16x16x32_bf16 v[108:111], a[16:19], a[132:135], v[108:111]
    v_add_f32_dpp v114, v112, v104 wave_ror:1 row_mask:0xf bank_mask:0xf
    v_add_f32_dpp v115, v113, v106 wave_ror:1 row_mask:0xf bank_mask:0xf
    v_mfma_f32_16x16x32_bf16 v[108:111], a[20:23], a[128:131], v[108:111]
    v_cvt_pk_bf16_f32 v116, v114, v115
    ds_write_b16 v139, v116 offset:1024
    ds_write_b16_d16_hi v139, v116 offset:1536
    s_waitcnt lgkmcnt(10)
    v_mfma_f32_16x16x32_bf16 v[100:103], a[0:3], a[156:159], 0
    ds_read_b64_tr_b16 a[168:169], v137 offset:1296
    ds_read_b64_tr_b16 a[170:171], v137 offset:1280
    v_mfma_f32_16x16x32_bf16 v[100:103], a[4:7], a[152:155], v[100:103]
    ds_read_b128 a[40:43], v138 offset:640
    ds_read_b64_tr_b16 a[172:173], v137 offset:1424
    v_mfma_f32_16x16x32_bf16 v[100:103], a[8:11], a[148:151], v[100:103]
    ds_read_b64_tr_b16 a[174:175], v137 offset:1408
    ds_read_b128 a[44:47], v138 offset:704
    v_mfma_f32_16x16x32_bf16 v[100:103], a[12:15], a[144:147], v[100:103]
    v_cndmask_b32 v112, v109, v107, s[30:31]
    v_cndmask_b32 v113, v111, v109, s[30:31]
    v_mfma_f32_16x16x32_bf16 v[100:103], a[16:19], a[140:143], v[100:103]
    v_add_f32_dpp v114, v112, v108 wave_ror:1 row_mask:0xf bank_mask:0xf
    v_add_f32_dpp v115, v113, v110 wave_ror:1 row_mask:0xf bank_mask:0xf
    v_mfma_f32_16x16x32_bf16 v[100:103], a[20:23], a[136:139], v[100:103]
    v_cvt_pk_bf16_f32 v116, v114, v115
    ds_write_b16 v139, v116 offset:2048
    v_mfma_f32_16x16x32_bf16 v[100:103], a[24:27], a[132:135], v[100:103]
    ds_write_b16_d16_hi v139, v116 offset:2560
    v_mfma_f32_16x16x32_bf16 v[100:103], a[28:31], a[128:131], v[100:103]
    s_waitcnt lgkmcnt(10)
    v_mfma_f32_16x16x32_bf16 v[104:107], a[0:3], a[164:167], 0
    ds_read_b64_tr_b16 a[176:177], v137 offset:1552
    ds_read_b64_tr_b16 a[178:179], v137 offset:1536
    v_mfma_f32_16x16x32_bf16 v[104:107], a[4:7], a[160:163], v[104:107]
    ds_read_b128 a[48:51], v138 offset:768
    ds_read_b64_tr_b16 a[180:181], v137 offset:1680
    v_mfma_f32_16x16x32_bf16 v[104:107], a[8:11], a[156:159], v[104:107]
    ds_read_b64_tr_b16 a[182:183], v137 offset:1664
    ds_read_b128 a[52:55], v138 offset:832
    v_mfma_f32_16x16x32_bf16 v[104:107], a[12:15], a[152:155], v[104:107]
    v_cndmask_b32 v112, v101, v111, s[30:31]
    v_cndmask_b32 v113, v103, v101, s[30:31]
    v_mfma_f32_16x16x32_bf16 v[104:107], a[16:19], a[148:151], v[104:107]
    v_add_f32_dpp v114, v112, v100 wave_ror:1 row_mask:0xf bank_mask:0xf
    v_add_f32_dpp v115, v113, v102 wave_ror:1 row_mask:0xf bank_mask:0xf
    v_mfma_f32_16x16x32_bf16 v[104:107], a[20:23], a[144:147], v[104:107]
    v_cvt_pk_bf16_f32 v116, v114, v115
    ds_write_b16 v139, v116 offset:3072
    v_mfma_f32_16x16x32_bf16 v[104:107], a[24:27], a[140:143], v[104:107]
    ds_write_b16_d16_hi v139, v116 offset:3584
    v_mfma_f32_16x16x32_bf16 v[104:107], a[28:31], a[136:139], v[104:107]
    v_mfma_f32_16x16x32_bf16 v[104:107], a[32:35], a[132:135], v[104:107]
    v_mfma_f32_16x16x32_bf16 v[104:107], a[36:39], a[128:131], v[104:107]
    s_waitcnt lgkmcnt(10)
    v_mfma_f32_16x16x32_bf16 v[108:111], a[0:3], a[172:175], 0
    ds_read_b64_tr_b16 a[184:185], v137 offset:1808
    v_mfma_f32_16x16x32_bf16 v[108:111], a[4:7], a[168:171], v[108:111]
    ds_read_b64_tr_b16 a[186:187], v137 offset:1792
    v_mfma_f32_16x16x32_bf16 v[108:111], a[8:11], a[164:167], v[108:111]
    ds_read_b128 a[56:59], v138 offset:896
    v_mfma_f32_16x16x32_bf16 v[108:111], a[12:15], a[160:163], v[108:111]
    ds_read_b64_tr_b16 a[188:189], v137 offset:1936
    v_cndmask_b32 v112, v105, v103, s[30:31]
    v_mfma_f32_16x16x32_bf16 v[108:111], a[16:19], a[156:159], v[108:111]
    ds_read_b64_tr_b16 a[190:191], v137 offset:1920
    v_cndmask_b32 v113, v107, v105, s[30:31]
    v_mfma_f32_16x16x32_bf16 v[108:111], a[20:23], a[152:155], v[108:111]
    ds_read_b128 a[60:63], v138 offset:960
    v_add_f32_dpp v114, v112, v104 wave_ror:1 row_mask:0xf bank_mask:0xf
    v_mfma_f32_16x16x32_bf16 v[108:111], a[24:27], a[148:151], v[108:111]
    v_add_f32_dpp v115, v113, v106 wave_ror:1 row_mask:0xf bank_mask:0xf
    v_cvt_pk_bf16_f32 v116, v114, v115
    v_mfma_f32_16x16x32_bf16 v[108:111], a[28:31], a[144:147], v[108:111]
    ds_write_b16 v139, v116 offset:4096
    v_mfma_f32_16x16x32_bf16 v[108:111], a[32:35], a[140:143], v[108:111]
    ds_write_b16_d16_hi v139, v116 offset:4608
    v_mfma_f32_16x16x32_bf16 v[108:111], a[36:39], a[136:139], v[108:111]
    v_mfma_f32_16x16x32_bf16 v[108:111], a[40:43], a[132:135], v[108:111]
    v_mfma_f32_16x16x32_bf16 v[108:111], a[44:47], a[128:131], v[108:111]
    s_waitcnt lgkmcnt(10)
    v_mfma_f32_16x16x32_bf16 v[100:103], a[0:3], a[180:183], 0
    ds_read_b64_tr_b16 a[192:193], v137 offset:2064
    v_mfma_f32_16x16x32_bf16 v[100:103], a[4:7], a[176:179], v[100:103]
    ds_read_b64_tr_b16 a[194:195], v137 offset:2048
    v_mfma_f32_16x16x32_bf16 v[100:103], a[8:11], a[172:175], v[100:103]
    ds_read_b128 a[64:67], v138 offset:1024
    v_mfma_f32_16x16x32_bf16 v[100:103], a[12:15], a[168:171], v[100:103]
    ds_read_b64_tr_b16 a[196:197], v137 offset:2192
    v_cndmask_b32 v112, v109, v107, s[30:31]
    v_mfma_f32_16x16x32_bf16 v[100:103], a[16:19], a[164:167], v[100:103]
    ds_read_b64_tr_b16 a[198:199], v137 offset:2176
    v_cndmask_b32 v113, v111, v109, s[30:31]
    v_mfma_f32_16x16x32_bf16 v[100:103], a[20:23], a[160:163], v[100:103]
    ds_read_b128 a[68:71], v138 offset:1088
    v_add_f32_dpp v114, v112, v108 wave_ror:1 row_mask:0xf bank_mask:0xf
    v_mfma_f32_16x16x32_bf16 v[100:103], a[24:27], a[156:159], v[100:103]
    v_add_f32_dpp v115, v113, v110 wave_ror:1 row_mask:0xf bank_mask:0xf
    v_cvt_pk_bf16_f32 v116, v114, v115
    v_mfma_f32_16x16x32_bf16 v[100:103], a[28:31], a[152:155], v[100:103]
    ds_write_b16 v139, v116 offset:5120
    v_mfma_f32_16x16x32_bf16 v[100:103], a[32:35], a[148:151], v[100:103]
    ds_write_b16_d16_hi v139, v116 offset:5632
    v_mfma_f32_16x16x32_bf16 v[100:103], a[36:39], a[144:147], v[100:103]
    v_mfma_f32_16x16x32_bf16 v[100:103], a[40:43], a[140:143], v[100:103]
    v_mfma_f32_16x16x32_bf16 v[100:103], a[44:47], a[136:139], v[100:103]
    v_mfma_f32_16x16x32_bf16 v[100:103], a[48:51], a[132:135], v[100:103]
    v_mfma_f32_16x16x32_bf16 v[100:103], a[52:55], a[128:131], v[100:103]
    s_waitcnt lgkmcnt(10)
    v_mfma_f32_16x16x32_bf16 v[104:107], a[0:3], a[188:191], 0
    ds_read_b64_tr_b16 a[200:201], v137 offset:2320
    v_mfma_f32_16x16x32_bf16 v[104:107], a[4:7], a[184:187], v[104:107]
    ds_read_b64_tr_b16 a[202:203], v137 offset:2304
    v_mfma_f32_16x16x32_bf16 v[104:107], a[8:11], a[180:183], v[104:107]
    ds_read_b128 a[72:75], v138 offset:1152
    v_mfma_f32_16x16x32_bf16 v[104:107], a[12:15], a[176:179], v[104:107]
    ds_read_b64_tr_b16 a[204:205], v137 offset:2448
    v_cndmask_b32 v112, v101, v111, s[30:31]
    v_mfma_f32_16x16x32_bf16 v[104:107], a[16:19], a[172:175], v[104:107]
    ds_read_b64_tr_b16 a[206:207], v137 offset:2432
    v_cndmask_b32 v113, v103, v101, s[30:31]
    v_mfma_f32_16x16x32_bf16 v[104:107], a[20:23], a[168:171], v[104:107]
    ds_read_b128 a[76:79], v138 offset:1216
    v_add_f32_dpp v114, v112, v100 wave_ror:1 row_mask:0xf bank_mask:0xf
    v_mfma_f32_16x16x32_bf16 v[104:107], a[24:27], a[164:167], v[104:107]
    v_add_f32_dpp v115, v113, v102 wave_ror:1 row_mask:0xf bank_mask:0xf
    v_cvt_pk_bf16_f32 v116, v114, v115
    v_mfma_f32_16x16x32_bf16 v[104:107], a[28:31], a[160:163], v[104:107]
    ds_write_b16 v139, v116 offset:6144
    v_mfma_f32_16x16x32_bf16 v[104:107], a[32:35], a[156:159], v[104:107]
    ds_write_b16_d16_hi v139, v116 offset:6656
    v_mfma_f32_16x16x32_bf16 v[104:107], a[36:39], a[152:155], v[104:107]
    v_mfma_f32_16x16x32_bf16 v[104:107], a[40:43], a[148:151], v[104:107]
    v_mfma_f32_16x16x32_bf16 v[104:107], a[44:47], a[144:147], v[104:107]
    v_mfma_f32_16x16x32_bf16 v[104:107], a[48:51], a[140:143], v[104:107]
    v_mfma_f32_16x16x32_bf16 v[104:107], a[52:55], a[136:139], v[104:107]
    v_mfma_f32_16x16x32_bf16 v[104:107], a[56:59], a[132:135], v[104:107]
    v_mfma_f32_16x16x32_bf16 v[104:107], a[60:63], a[128:131], v[104:107]
    s_mul_i32 s34, s28, 16
    v_min_u32 v146, 15, v1
    v_add_lshl_u32 v146, v146, s34, 7
    v_add_u32 v146, L_conv1-L_pc, v146
    v_min_u32 v146, L_end-L_pc, v146
    global_load_dword v147, v146, s[56:57]
    s_waitcnt lgkmcnt(10)
    v_mfma_f32_16x16x32_bf16 v[108:111], a[0:3], a[196:199], 0
    ds_read_b64_tr_b16 a[208:209], v137 offset:2576
    v_mfma_f32_16x16x32_bf16 v[108:111], a[4:7], a[192:195], v[108:111]
    ds_read_b64_tr_b16 a[210:211], v137 offset:2560
    v_mfma_f32_16x16x32_bf16 v[108:111], a[8:11], a[188:191], v[108:111]
    ds_read_b128 a[80:83], v138 offset:1280
    v_mfma_f32_16x16x32_bf16 v[108:111], a[12:15], a[184:187], v[108:111]
    ds_read_b64_tr_b16 a[212:213], v137 offset:2704
    v_cndmask_b32 v112, v105, v103, s[30:31]
    v_mfma_f32_16x16x32_bf16 v[108:111], a[16:19], a[180:183], v[108:111]
    ds_read_b64_tr_b16 a[214:215], v137 offset:2688
    v_cndmask_b32 v113, v107, v105, s[30:31]
    v_mfma_f32_16x16x32_bf16 v[108:111], a[20:23], a[176:179], v[108:111]
    ds_read_b128 a[84:87], v138 offset:1344
    v_add_f32_dpp v114, v112, v104 wave_ror:1 row_mask:0xf bank_mask:0xf
    v_mfma_f32_16x16x32_bf16 v[108:111], a[24:27], a[172:175], v[108:111]
    v_add_f32_dpp v115, v113, v106 wave_ror:1 row_mask:0xf bank_mask:0xf
    v_cvt_pk_bf16_f32 v116, v114, v115
    v_mfma_f32_16x16x32_bf16 v[108:111], a[28:31], a[168:171], v[108:111]
    ds_write_b16 v139, v116 offset:7168
    v_mfma_f32_16x16x32_bf16 v[108:111], a[32:35], a[164:167], v[108:111]
    ds_write_b16_d16_hi v139, v116 offset:7680
    v_mfma_f32_16x16x32_bf16 v[108:111], a[36:39], a[160:163], v[108:111]
    v_mfma_f32_16x16x32_bf16 v[108:111], a[40:43], a[156:159], v[108:111]
    v_mfma_f32_16x16x32_bf16 v[108:111], a[44:47], a[152:155], v[108:111]
    v_mfma_f32_16x16x32_bf16 v[108:111], a[48:51], a[148:151], v[108:111]
    v_mfma_f32_16x16x32_bf16 v[108:111], a[52:55], a[144:147], v[108:111]
    v_mfma_f32_16x16x32_bf16 v[108:111], a[56:59], a[140:143], v[108:111]
    v_mfma_f32_16x16x32_bf16 v[108:111], a[60:63], a[136:139], v[108:111]
    v_mfma_f32_16x16x32_bf16 v[108:111], a[64:67], a[132:135], v[108:111]
    v_mfma_f32_16x16x32_bf16 v[108:111], a[68:71], a[128:131], v[108:111]
    s_waitcnt lgkmcnt(10)
    v_mfma_f32_16x16x32_bf16 v[100:103], a[0:3], a[204:207], 0
    ds_read_b64_tr_b16 a[216:217], v137 offset:2832
    v_mfma_f32_16x16x32_bf16 v[100:103], a[4:7], a[200:203], v[100:103]
    ds_read_b64_tr_b16 a[218:219], v137 offset:2816
    v_mfma_f32_16x16x32_bf16 v[100:103], a[8:11], a[196:199], v[100:103]
    ds_read_b128 a[88:91], v138 offset:1408
    v_mfma_f32_16x16x32_bf16 v[100:103], a[12:15], a[192:195], v[100:103]
    ds_read_b64_tr_b16 a[220:221], v137 offset:2960
    v_cndmask_b32 v112, v109, v107, s[30:31]
    v_mfma_f32_16x16x32_bf16 v[100:103], a[16:19], a[188:191], v[100:103]
    ds_read_b64_tr_b16 a[222:223], v137 offset:2944
    v_cndmask_b32 v113, v111, v109, s[30:31]
    v_mfma_f32_16x16x32_bf16 v[100:103], a[20:23], a[184:187], v[100:103]
    ds_read_b128 a[92:95], v138 offset:1472
    v_add_f32_dpp v114, v112, v108 wave_ror:1 row_mask:0xf bank_mask:0xf
    v_mfma_f32_16x16x32_bf16 v[100:103], a[24:27], a[180:183], v[100:103]
    v_add_f32_dpp v115, v113, v110 wave_ror:1 row_mask:0xf bank_mask:0xf
    v_cvt_pk_bf16_f32 v116, v114, v115
    v_mfma_f32_16x16x32_bf16 v[100:103], a[28:31], a[176:179], v[100:103]
    ds_write_b16 v139, v116 offset:8192
    v_mfma_f32_16x16x32_bf16 v[100:103], a[32:35], a[172:175], v[100:103]
    ds_write_b16_d16_hi v139, v116 offset:8704
    v_mfma_f32_16x16x32_bf16 v[100:103], a[36:39], a[168:171], v[100:103]
    s_add_u32 m0, s51, 33824
    v_mfma_f32_16x16x32_bf16 v[100:103], a[40:43], a[164:167], v[100:103]
    s_add_u32 s34, s50, 65536
    v_mfma_f32_16x16x32_bf16 v[100:103], a[44:47], a[160:163], v[100:103]
    v_mfma_f32_16x16x32_bf16 v[100:103], a[48:51], a[156:159], v[100:103]
    buffer_load_dwordx4 v136, s[16:19], s34 offen offset:0 sc1 lds
    v_mfma_f32_16x16x32_bf16 v[100:103], a[52:55], a[152:155], v[100:103]
    v_mfma_f32_16x16x32_bf16 v[100:103], a[56:59], a[148:151], v[100:103]
    buffer_load_dwordx4 v136, s[16:19], s34 offen offset:1024 sc1 lds
    v_mfma_f32_16x16x32_bf16 v[100:103], a[60:63], a[144:147], v[100:103]
    v_mfma_f32_16x16x32_bf16 v[100:103], a[64:67], a[140:143], v[100:103]
    buffer_load_dwordx4 v136, s[16:19], s34 offen offset:2048 sc1 lds
    v_mfma_f32_16x16x32_bf16 v[100:103], a[68:71], a[136:139], v[100:103]
    v_mfma_f32_16x16x32_bf16 v[100:103], a[72:75], a[132:135], v[100:103]
    buffer_load_dwordx4 v136, s[16:19], s34 offen offset:3072 sc1 lds
    v_mfma_f32_16x16x32_bf16 v[100:103], a[76:79], a[128:131], v[100:103]
    s_waitcnt lgkmcnt(10)
    v_mfma_f32_16x16x32_bf16 v[104:107], a[0:3], a[212:215], 0
    ds_read_b64_tr_b16 a[224:225], v137 offset:3088
    v_mfma_f32_16x16x32_bf16 v[104:107], a[4:7], a[208:211], v[104:107]
    ds_read_b64_tr_b16 a[226:227], v137 offset:3072
    v_mfma_f32_16x16x32_bf16 v[104:107], a[8:11], a[204:207], v[104:107]
    ds_read_b128 a[96:99], v138 offset:1536
    v_mfma_f32_16x16x32_bf16 v[104:107], a[12:15], a[200:203], v[104:107]
    ds_read_b64_tr_b16 a[228:229], v137 offset:3216
    v_cndmask_b32 v112, v101, v111, s[30:31]
    v_mfma_f32_16x16x32_bf16 v[104:107], a[16:19], a[196:199], v[104:107]
    ds_read_b64_tr_b16 a[230:231], v137 offset:3200
    v_cndmask_b32 v113, v103, v101, s[30:31]
    v_mfma_f32_16x16x32_bf16 v[104:107], a[20:23], a[192:195], v[104:107]
    ds_read_b128 a[100:103], v138 offset:1600
    v_add_f32_dpp v114, v112, v100 wave_ror:1 row_mask:0xf bank_mask:0xf
    v_mfma_f32_16x16x32_bf16 v[104:107], a[24:27], a[188:191], v[104:107]
    v_add_f32_dpp v115, v113, v102 wave_ror:1 row_mask:0xf bank_mask:0xf
    v_cvt_pk_bf16_f32 v116, v114, v115
    v_mfma_f32_16x16x32_bf16 v[104:107], a[28:31], a[184:187], v[104:107]
    ds_write_b16 v139, v116 offset:9216
    v_mfma_f32_16x16x32_bf16 v[104:107], a[32:35], a[180:183], v[104:107]
    ds_write_b16_d16_hi v139, v116 offset:9728
    v_mfma_f32_16x16x32_bf16 v[104:107], a[36:39], a[176:179], v[104:107]
    s_add_u32 m0, s51, 38048
    v_mfma_f32_16x16x32_bf16 v[104:107], a[40:43], a[172:175], v[104:107]
    s_sub_u32 s34, s34, 4
    v_mfma_f32_16x16x32_bf16 v[104:107], a[44:47], a[168:171], v[104:107]
    v_mfma_f32_16x16x32_bf16 v[104:107], a[48:51], a[164:167], v[104:107]
    buffer_load_dwordx4 v136, s[16:19], s34 offen offset:0 sc1 lds
    v_mfma_f32_16x16x32_bf16 v[104:107], a[52:55], a[160:163], v[104:107]
    v_mfma_f32_16x16x32_bf16 v[104:107], a[56:59], a[156:159], v[104:107]
    buffer_load_dwordx4 v136, s[16:19], s34 offen offset:1024 sc1 lds
    v_mfma_f32_16x16x32_bf16 v[104:107], a[60:63], a[152:155], v[104:107]
    v_mfma_f32_16x16x32_bf16 v[104:107], a[64:67], a[148:151], v[104:107]
    buffer_load_dwordx4 v136, s[16:19], s34 offen offset:2048 sc1 lds
    v_mfma_f32_16x16x32_bf16 v[104:107], a[68:71], a[144:147], v[104:107]
    v_mfma_f32_16x16x32_bf16 v[104:107], a[72:75], a[140:143], v[104:107]
    buffer_load_dwordx4 v136, s[16:19], s34 offen offset:3072 sc1 lds
    v_mfma_f32_16x16x32_bf16 v[104:107], a[76:79], a[136:139], v[104:107]
    v_mfma_f32_16x16x32_bf16 v[104:107], a[80:83], a[132:135], v[104:107]
    v_mfma_f32_16x16x32_bf16 v[104:107], a[84:87], a[128:131], v[104:107]
    s_waitcnt lgkmcnt(10)
    v_mfma_f32_16x16x32_bf16 v[108:111], a[0:3], a[220:223], 0
    ds_read_b64_tr_b16 a[232:233], v137 offset:3344
    v_mfma_f32_16x16x32_bf16 v[108:111], a[4:7], a[216:219], v[108:111]
    ds_read_b64_tr_b16 a[234:235], v137 offset:3328
    v_mfma_f32_16x16x32_bf16 v[108:111], a[8:11], a[212:215], v[108:111]
    ds_read_b128 a[104:107], v138 offset:1664
    v_mfma_f32_16x16x32_bf16 v[108:111], a[12:15], a[208:211], v[108:111]
    ds_read_b64_tr_b16 a[236:237], v137 offset:3472
    v_cndmask_b32 v112, v105, v103, s[30:31]
    v_mfma_f32_16x16x32_bf16 v[108:111], a[16:19], a[204:207], v[108:111]
    ds_read_b64_tr_b16 a[238:239], v137 offset:3456
    v_cndmask_b32 v113, v107, v105, s[30:31]
    v_mfma_f32_16x16x32_bf16 v[108:111], a[20:23], a[200:203], v[108:111]
    ds_read_b128 a[108:111], v138 offset:1728
    v_add_f32_dpp v114, v112, v104 wave_ror:1 row_mask:0xf bank_mask:0xf
    v_mfma_f32_16x16x32_bf16 v[108:111], a[24:27], a[196:199], v[108:111]
    v_add_f32_dpp v115, v113, v106 wave_ror:1 row_mask:0xf bank_mask:0xf
    v_cvt_pk_bf16_f32 v116, v114, v115
    v_mfma_f32_16x16x32_bf16 v[108:111], a[28:31], a[192:195], v[108:111]
    ds_write_b16 v139, v116 offset:10240
    v_mfma_f32_16x16x32_bf16 v[108:111], a[32:35], a[188:191], v[108:111]
    ds_write_b16_d16_hi v139, v116 offset:10752
    v_mfma_f32_16x16x32_bf16 v[108:111], a[36:39], a[184:187], v[108:111]
    v_mfma_f32_16x16x32_bf16 v[108:111], a[40:43], a[180:183], v[108:111]
    v_mfma_f32_16x16x32_bf16 v[108:111], a[44:47], a[176:179], v[108:111]
    v_mfma_f32_16x16x32_bf16 v[108:111], a[48:51], a[172:175], v[108:111]
    v_mfma_f32_16x16x32_bf16 v[108:111], a[52:55], a[168:171], v[108:111]
    v_mfma_f32_16x16x32_bf16 v[108:111], a[56:59], a[164:167], v[108:111]
    v_mfma_f32_16x16x32_bf16 v[108:111], a[60:63], a[160:163], v[108:111]
    v_mfma_f32_16x16x32_bf16 v[108:111], a[64:67], a[156:159], v[108:111]
    v_mfma_f32_16x16x32_bf16 v[108:111], a[68:71], a[152:155], v[108:111]
    v_mfma_f32_16x16x32_bf16 v[108:111], a[72:75], a[148:151], v[108:111]
    v_mfma_f32_16x16x32_bf16 v[108:111], a[76:79], a[144:147], v[108:111]
    v_mfma_f32_16x16x32_bf16 v[108:111], a[80:83], a[140:143], v[108:111]
    v_mfma_f32_16x16x32_bf16 v[108:111], a[84:87], a[136:139], v[108:111]
    v_mfma_f32_16x16x32_bf16 v[108:111], a[88:91], a[132:135], v[108:111]
    v_mfma_f32_16x16x32_bf16 v[108:111], a[92:95], a[128:131], v[108:111]
    s_waitcnt lgkmcnt(10)
    v_mfma_f32_16x16x32_bf16 v[100:103], a[0:3], a[228:231], 0
    ds_read_b64_tr_b16 a[240:241], v137 offset:3600
    v_mfma_f32_16x16x32_bf16 v[100:103], a[4:7], a[224:227], v[100:103]
    ds_read_b64_tr_b16 a[242:243], v137 offset:3584
    v_mfma_f32_16x16x32_bf16 v[100:103], a[8:11], a[220:223], v[100:103]
    ds_read_b128 a[112:115], v138 offset:1792
    v_mfma_f32_16x16x32_bf16 v[100:103], a[12:15], a[216:219], v[100:103]
    ds_read_b64_tr_b16 a[244:245], v137 offset:3728
    v_cndmask_b32 v112, v109, v107, s[30:31]
    v_mfma_f32_16x16x32_bf16 v[100:103], a[16:19], a[212:215], v[100:103]
    ds_read_b64_tr_b16 a[246:247], v137 offset:3712
    v_cndmask_b32 v113, v111, v109, s[30:31]
    v_mfma_f32_16x16x32_bf16 v[100:103], a[20:23], a[208:211], v[100:103]
    ds_read_b128 a[116:119], v138 offset:1856
    v_add_f32_dpp v114, v112, v108 wave_ror:1 row_mask:0xf bank_mask:0xf
    v_mfma_f32_16x16x32_bf16 v[100:103], a[24:27], a[204:207], v[100:103]
    v_add_f32_dpp v115, v113, v110 wave_ror:1 row_mask:0xf bank_mask:0xf
    v_cvt_pk_bf16_f32 v116, v114, v115
    v_mfma_f32_16x16x32_bf16 v[100:103], a[28:31], a[200:203], v[100:103]
    ds_write_b16 v139, v116 offset:11264
    v_mfma_f32_16x16x32_bf16 v[100:103], a[32:35], a[196:199], v[100:103]
    ds_write_b16_d16_hi v139, v116 offset:11776
    v_mfma_f32_16x16x32_bf16 v[100:103], a[36:39], a[192:195], v[100:103]
    v_mfma_f32_16x16x32_bf16 v[100:103], a[40:43], a[188:191], v[100:103]
    v_mfma_f32_16x16x32_bf16 v[100:103], a[44:47], a[184:187], v[100:103]
    v_mfma_f32_16x16x32_bf16 v[100:103], a[48:51], a[180:183], v[100:103]
    v_mfma_f32_16x16x32_bf16 v[100:103], a[52:55], a[176:179], v[100:103]
    v_mfma_f32_16x16x32_bf16 v[100:103], a[56:59], a[172:175], v[100:103]
    v_mfma_f32_16x16x32_bf16 v[100:103], a[60:63], a[168:171], v[100:103]
    v_mfma_f32_16x16x32_bf16 v[100:103], a[64:67], a[164:167], v[100:103]
    v_mfma_f32_16x16x32_bf16 v[100:103], a[68:71], a[160:163], v[100:103]
    v_mfma_f32_16x16x32_bf16 v[100:103], a[72:75], a[156:159], v[100:103]
    v_mfma_f32_16x16x32_bf16 v[100:103], a[76:79], a[152:155], v[100:103]
    v_mfma_f32_16x16x32_bf16 v[100:103], a[80:83], a[148:151], v[100:103]
    v_mfma_f32_16x16x32_bf16 v[100:103], a[84:87], a[144:147], v[100:103]
    v_mfma_f32_16x16x32_bf16 v[100:103], a[88:91], a[140:143], v[100:103]
    v_mfma_f32_16x16x32_bf16 v[100:103], a[92:95], a[136:139], v[100:103]
    v_mfma_f32_16x16x32_bf16 v[100:103], a[96:99], a[132:135], v[100:103]
    v_mfma_f32_16x16x32_bf16 v[100:103], a[100:103], a[128:131], v[100:103]
    s_waitcnt lgkmcnt(10)
    v_mfma_f32_16x16x32_bf16 v[104:107], a[0:3], a[236:239], 0
    ds_read_b64_tr_b16 a[248:249], v137 offset:3856
    v_mfma_f32_16x16x32_bf16 v[104:107], a[4:7], a[232:235], v[104:107]
    ds_read_b64_tr_b16 a[250:251], v137 offset:3840
    v_mfma_f32_16x16x32_bf16 v[104:107], a[8:11], a[228:231], v[104:107]
    ds_read_b128 a[120:123], v138 offset:1920
    v_mfma_f32_16x16x32_bf16 v[104:107], a[12:15], a[224:227], v[104:107]
    ds_read_b64_tr_b16 a[252:253], v137 offset:3984
    v_cndmask_b32 v112, v101, v111, s[30:31]
    v_mfma_f32_16x16x32_bf16 v[104:107], a[16:19], a[220:223], v[104:107]
    ds_read_b64_tr_b16 a[254:255], v137 offset:3968
    v_cndmask_b32 v113, v103, v101, s[30:31]
    v_mfma_f32_16x16x32_bf16 v[104:107], a[20:23], a[216:219], v[104:107]
    ds_read_b128 a[124:127], v138 offset:1984
    v_add_f32_dpp v114, v112, v100 wave_ror:1 row_mask:0xf bank_mask:0xf
    v_mfma_f32_16x16x32_bf16 v[104:107], a[24:27], a[212:215], v[104:107]
    v_add_f32_dpp v115, v113, v102 wave_ror:1 row_mask:0xf bank_mask:0xf
    v_cvt_pk_bf16_f32 v116, v114, v115
    v_mfma_f32_16x16x32_bf16 v[104:107], a[28:31], a[208:211], v[104:107]
    ds_write_b16 v139, v116 offset:12288
    v_mfma_f32_16x16x32_bf16 v[104:107], a[32:35], a[204:207], v[104:107]
    ds_write_b16_d16_hi v139, v116 offset:12800
    v_mfma_f32_16x16x32_bf16 v[104:107], a[36:39], a[200:203], v[104:107]
    s_movk_i32 s53, 192
    v_mfma_f32_16x16x32_bf16 v[104:107], a[40:43], a[196:199], v[104:107]
    buffer_load_dword v144, v143, s[24:27], s53 offen sc1
    v_mfma_f32_16x16x32_bf16 v[104:107], a[44:47], a[192:195], v[104:107]
    v_mfma_f32_16x16x32_bf16 v[104:107], a[48:51], a[188:191], v[104:107]
    v_mfma_f32_16x16x32_bf16 v[104:107], a[52:55], a[184:187], v[104:107]
    v_mfma_f32_16x16x32_bf16 v[104:107], a[56:59], a[180:183], v[104:107]
    v_mfma_f32_16x16x32_bf16 v[104:107], a[60:63], a[176:179], v[104:107]
    v_mfma_f32_16x16x32_bf16 v[104:107], a[64:67], a[172:175], v[104:107]
    v_mfma_f32_16x16x32_bf16 v[104:107], a[68:71], a[168:171], v[104:107]
    v_mfma_f32_16x16x32_bf16 v[104:107], a[72:75], a[164:167], v[104:107]
    v_mfma_f32_16x16x32_bf16 v[104:107], a[76:79], a[160:163], v[104:107]
    v_mfma_f32_16x16x32_bf16 v[104:107], a[80:83], a[156:159], v[104:107]
    v_mfma_f32_16x16x32_bf16 v[104:107], a[84:87], a[152:155], v[104:107]
    v_mfma_f32_16x16x32_bf16 v[104:107], a[88:91], a[148:151], v[104:107]
    v_mfma_f32_16x16x32_bf16 v[104:107], a[92:95], a[144:147], v[104:107]
    v_mfma_f32_16x16x32_bf16 v[104:107], a[96:99], a[140:143], v[104:107]
    v_mfma_f32_16x16x32_bf16 v[104:107], a[100:103], a[136:139], v[104:107]
    v_mfma_f32_16x16x32_bf16 v[104:107], a[104:107], a[132:135], v[104:107]
    v_mfma_f32_16x16x32_bf16 v[104:107], a[108:111], a[128:131], v[104:107]
    s_waitcnt lgkmcnt(10)
    v_mfma_f32_16x16x32_bf16 v[108:111], a[0:3], a[244:247], 0
    v_mfma_f32_16x16x32_bf16 v[108:111], a[4:7], a[240:243], v[108:111]
    v_mfma_f32_16x16x32_bf16 v[108:111], a[8:11], a[236:239], v[108:111]
    v_mfma_f32_16x16x32_bf16 v[108:111], a[12:15], a[232:235], v[108:111]
    s_nop 2
    v_cndmask_b32 v112, v105, v103, s[30:31]
    v_cndmask_b32 v113, v107, v105, s[30:31]
    v_mfma_f32_16x16x32_bf16 v[108:111], a[16:19], a[228:231], v[108:111]
    v_add_f32_dpp v114, v112, v104 wave_ror:1 row_mask:0xf bank_mask:0xf
    v_add_f32_dpp v115, v113, v106 wave_ror:1 row_mask:0xf bank_mask:0xf
    v_mfma_f32_16x16x32_bf16 v[108:111], a[20:23], a[224:227], v[108:111]
    v_cvt_pk_bf16_f32 v116, v114, v115
    v_mfma_f32_16x16x32_bf16 v[108:111], a[24:27], a[220:223], v[108:111]
    ds_write_b16 v139, v116 offset:13312
    v_mfma_f32_16x16x32_bf16 v[108:111], a[28:31], a[216:219], v[108:111]
    ds_write_b16_d16_hi v139, v116 offset:13824
    v_mfma_f32_16x16x32_bf16 v[108:111], a[32:35], a[212:215], v[108:111]
    v_mfma_f32_16x16x32_bf16 v[108:111], a[36:39], a[208:211], v[108:111]
    v_mfma_f32_16x16x32_bf16 v[108:111], a[40:43], a[204:207], v[108:111]
    v_mfma_f32_16x16x32_bf16 v[108:111], a[44:47], a[200:203], v[108:111]
    v_mfma_f32_16x16x32_bf16 v[108:111], a[48:51], a[196:199], v[108:111]
    v_mfma_f32_16x16x32_bf16 v[108:111], a[52:55], a[192:195], v[108:111]
    v_mfma_f32_16x16x32_bf16 v[108:111], a[56:59], a[188:191], v[108:111]
    v_mfma_f32_16x16x32_bf16 v[108:111], a[60:63], a[184:187], v[108:111]
    v_mfma_f32_16x16x32_bf16 v[108:111], a[64:67], a[180:183], v[108:111]
    v_mfma_f32_16x16x32_bf16 v[108:111], a[68:71], a[176:179], v[108:111]
    v_mfma_f32_16x16x32_bf16 v[108:111], a[72:75], a[172:175], v[108:111]
    v_mfma_f32_16x16x32_bf16 v[108:111], a[76:79], a[168:171], v[108:111]
    v_mfma_f32_16x16x32_bf16 v[108:111], a[80:83], a[164:167], v[108:111]
    v_mfma_f32_16x16x32_bf16 v[108:111], a[84:87], a[160:163], v[108:111]
    v_mfma_f32_16x16x32_bf16 v[108:111], a[88:91], a[156:159], v[108:111]
    v_mfma_f32_16x16x32_bf16 v[108:111], a[92:95], a[152:155], v[108:111]
    v_mfma_f32_16x16x32_bf16 v[108:111], a[96:99], a[148:151], v[108:111]
    v_mfma_f32_16x16x32_bf16 v[108:111], a[100:103], a[144:147], v[108:111]
    v_mfma_f32_16x16x32_bf16 v[108:111], a[104:107], a[140:143], v[108:111]
    v_mfma_f32_16x16x32_bf16 v[108:111], a[108:111], a[136:139], v[108:111]
    v_mfma_f32_16x16x32_bf16 v[108:111], a[112:115], a[132:135], v[108:111]
    v_mfma_f32_16x16x32_bf16 v[108:111], a[116:119], a[128:131], v[108:111]
    s_waitcnt lgkmcnt(4)
    v_mfma_f32_16x16x32_bf16 v[100:103], a[0:3], a[252:255], 0
    v_mfma_f32_16x16x32_bf16 v[100:103], a[4:7], a[248:251], v[100:103]
    v_mfma_f32_16x16x32_bf16 v[100:103], a[8:11], a[244:247], v[100:103]
    v_mfma_f32_16x16x32_bf16 v[100:103], a[12:15], a[240:243], v[100:103]
    s_nop 2
    v_cndmask_b32 v112, v109, v107, s[30:31]
    v_cndmask_b32 v113, v111, v109, s[30:31]
    v_mfma_f32_16x16x32_bf16 v[100:103], a[16:19], a[236:239], v[100:103]
    v_add_f32_dpp v114, v112, v108 wave_ror:1 row_mask:0xf bank_mask:0xf
    v_add_f32_dpp v115, v113, v110 wave_ror:1 row_mask:0xf bank_mask:0xf
    v_mfma_f32_16x16x32_bf16 v[100:103], a[20:23], a[232:235], v[100:103]
    v_cvt_pk_bf16_f32 v116, v114, v115
    v_mfma_f32_16x16x32_bf16 v[100:103], a[24:27], a[228:231], v[100:103]
    ds_write_b16 v139, v116 offset:14336
    v_mfma_f32_16x16x32_bf16 v[100:103], a[28:31], a[224:227], v[100:103]
    ds_write_b16_d16_hi v139, v116 offset:14848
    v_mfma_f32_16x16x32_bf16 v[100:103], a[96:99], a[156:159], v[100:103]
    v_mfma_f32_16x16x32_bf16 v[100:103], a[100:103], a[152:155], v[100:103]
    v_mfma_f32_16x16x32_bf16 v[100:103], a[104:107], a[148:151], v[100:103]
    v_mfma_f32_16x16x32_bf16 v[100:103], a[108:111], a[144:147], v[100:103]
    v_mfma_f32_16x16x32_bf16 v[100:103], a[112:115], a[140:143], v[100:103]
    v_mfma_f32_16x16x32_bf16 v[100:103], a[116:119], a[136:139], v[100:103]
    v_mfma_f32_16x16x32_bf16 v[100:103], a[120:123], a[132:135], v[100:103]
    v_mfma_f32_16x16x32_bf16 v[100:103], a[124:127], a[128:131], v[100:103]
    v_mfma_f32_16x16x32_bf16 v[100:103], a[32:35], a[220:223], v[100:103]
    s_waitcnt vmcnt(1)
    ds_write_b32 v141, v52 offset:33792
    v_mfma_f32_16x16x32_bf16 v[100:103], a[36:39], a[216:219], v[100:103]
    ds_read_b64_tr_b16 a[128:129], v137 offset:33808
    ds_read_b64_tr_b16 a[130:131], v137 offset:33792
    v_mfma_f32_16x16x32_bf16 v[100:103], a[40:43], a[212:215], v[100:103]
    ds_read_b128 a[0:3], v138 offset:17408
    ds_read_b64_tr_b16 a[132:133], v137 offset:33936
    v_mfma_f32_16x16x32_bf16 v[100:103], a[44:47], a[208:211], v[100:103]
    ds_read_b64_tr_b16 a[134:135], v137 offset:33920
    ds_read_b128 a[4:7], v138 offset:17472
    v_mfma_f32_16x16x32_bf16 v[100:103], a[48:51], a[204:207], v[100:103]
    ds_read_b64_tr_b16 a[136:137], v137 offset:34064
    ds_read_b64_tr_b16 a[138:139], v137 offset:34048
    v_mfma_f32_16x16x32_bf16 v[100:103], a[52:55], a[200:203], v[100:103]
    ds_read_b128 a[8:11], v138 offset:17536
    ds_read_b64_tr_b16 a[140:141], v137 offset:34192
    v_mfma_f32_16x16x32_bf16 v[100:103], a[56:59], a[196:199], v[100:103]
    ds_read_b64_tr_b16 a[142:143], v137 offset:34176
    ds_read_b128 a[12:15], v138 offset:17600
    v_mfma_f32_16x16x32_bf16 v[100:103], a[60:63], a[192:195], v[100:103]
    ds_read_b64_tr_b16 a[144:145], v137 offset:34320
    ds_read_b64_tr_b16 a[146:147], v137 offset:34304
    v_mfma_f32_16x16x32_bf16 v[100:103], a[64:67], a[188:191], v[100:103]
    ds_read_b128 a[16:19], v138 offset:17664
    ds_read_b64_tr_b16 a[148:149], v137 offset:34448
    v_mfma_f32_16x16x32_bf16 v[100:103], a[68:71], a[184:187], v[100:103]
    ds_read_b64_tr_b16 a[150:151], v137 offset:34432
    ds_read_b128 a[20:23], v138 offset:17728
    v_mfma_f32_16x16x32_bf16 v[100:103], a[72:75], a[180:183], v[100:103]
    ds_read_b64_tr_b16 a[152:153], v137 offset:34576
    ds_read_b64_tr_b16 a[154:155], v137 offset:34560
    v_mfma_f32_16x16x32_bf16 v[100:103], a[76:79], a[176:179], v[100:103]
    ds_read_b128 a[24:27], v138 offset:17792
    ds_read_b64_tr_b16 a[156:157], v137 offset:34704
    v_mfma_f32_16x16x32_bf16 v[100:103], a[80:83], a[172:175], v[100:103]
    ds_read_b64_tr_b16 a[158:159], v137 offset:34688
    ds_read_b128 a[28:31], v138 offset:17856
    v_mfma_f32_16x16x32_bf16 v[100:103], a[84:87], a[168:171], v[100:103]
    v_mfma_f32_16x16x32_bf16 v[100:103], a[88:91], a[164:167], v[100:103]
    v_mfma_f32_16x16x32_bf16 v[100:103], a[92:95], a[160:163], v[100:103]
L_conv1:
    s_waitcnt lgkmcnt(14)
    v_mfma_f32_16x16x32_bf16 v[104:107], a[0:3], a[132:135], 0
    v_mfma_f32_16x16x32_bf16 v[104:107], a[4:7], a[128:131], v[104:107]
    s_nop 4
    v_cndmask_b32 v112, v101, v111, s[30:31]
    v_cndmask_b32 v113, v103, v101, s[30:31]
    s_nop 0
    v_add_f32_dpp v114, v112, v100 wave_ror:1 row_mask:0xf bank_mask:0xf
    v_add_f32_dpp v115, v113, v102 wave_ror:1 row_mask:0xf bank_mask:0xf
    v_cvt_pk_bf16_f32 v116, v114, v115
    ds_write_b16 v139, v116 offset:15360
    ds_write_b16_d16_hi v139, v116 offset:15872
    s_waitcnt lgkmcnt(14)
    v_mfma_f32_16x16x32_bf16 v[108:111], a[0:3], a[140:143], 0
    v_mfma_f32_16x16x32_bf16 v[108:111], a[4:7], a[136:139], v[108:111]
    v_mfma_f32_16x16x32_bf16 v[108:111], a[8:11], a[132:135], v[108:111]
    v_mfma_f32_16x16x32_bf16 v[108:111], a[12:15], a[128:131], v[108:111]
    v_cndmask_b32 v112, v105, v52, s[30:31]
    v_cndmask_b32 v113, v107, v105, s[30:31]
    s_nop 0
    v_add_f32_dpp v114, v112, v104 wave_ror:1 row_mask:0xf bank_mask:0xf
    v_add_f32_dpp v115, v113, v106 wave_ror:1 row_mask:0xf bank_mask:0xf
    v_cvt_pk_bf16_f32 v116, v114, v115
    ds_write_b16 v139, v116 offset:16384
    ds_write_b16_d16_hi v139, v116 offset:16896
    s_waitcnt lgkmcnt(10)
    v_mfma_f32_16x16x32_bf16 v[100:103], a[0:3], a[148:151], 0
    ds_read_b64_tr_b16 a[160:161], v137 offset:34832
    ds_read_b64_tr_b16 a[162:163], v137 offset:34816
    v_mfma_f32_16x16x32_bf16 v[100:103], a[4:7], a[144:147], v[100:103]
    ds_read_b128 a[32:35], v138 offset:17920
    ds_read_b64_tr_b16 a[164:165], v137 offset:34960
    v_mfma_f32_16x16x32_bf16 v[100:103], a[8:11], a[140:143], v[100:103]
    ds_read_b64_tr_b16 a[166:167], v137 offset:34944
    ds_read_b128 a[36:39], v138 offset:17984
    v_mfma_f32_16x16x32_bf16 v[100:103], a[12:15], a[136:139], v[100:103]
    v_cndmask_b32 v112, v109, v107, s[30:31]
    v_cndmask_b32 v113, v111, v109, s[30:31]
    v_mfma_f32_16x16x32_bf16 v[100:103], a[16:19], a[132:135], v[100:103]
    v_add_f32_dpp v114, v112, v108 wave_ror:1 row_mask:0xf bank_mask:0xf
    v_add_f32_dpp v115, v113, v110 wave_ror:1 row_mask:0xf bank_mask:0xf
    v_mfma_f32_16x16x32_bf16 v[100:103], a[20:23], a[128:131], v[100:103]
    v_cvt_pk_bf16_f32 v116, v114, v115
    ds_write_b16 v139, v116 offset:17408
    ds_write_b16_d16_hi v139, v116 offset:17920
    s_waitcnt lgkmcnt(12)
    v_mfma_f32_16x16x32_bf16 v[104:107], a[0:3], a[156:159], 0
    ds_read_b64_tr_b16 a[168:169], v137 offset:35088
    ds_read_b64_tr_b16 a[170:171], v137 offset:35072
    v_mfma_f32_16x16x32_bf16 v[104:107], a[4:7], a[152:155], v[104:107]
    ds_read_b128 a[40:43], v138 offset:18048
    ds_read_b64_tr_b16 a[172:173], v137 offset:35216
    v_mfma_f32_16x16x32_bf16 v[104:107], a[8:11], a[148:151], v[104:107]
    ds_read_b64_tr_b16 a[174:175], v137 offset:35200
    ds_read_b128 a[44:47], v138 offset:18112
    v_mfma_f32_16x16x32_bf16 v[104:107], a[12:15], a[144:147], v[104:107]
    v_cndmask_b32 v112, v101, v111, s[30:31]
    v_cndmask_b32 v113, v103, v101, s[30:31]
    v_mfma_f32_16x16x32_bf16 v[104:107], a[16:19], a[140:143], v[104:107]
    v_add_f32_dpp v114, v112, v100 wave_ror:1 row_mask:0xf bank_mask:0xf
    v_add_f32_dpp v115, v113, v102 wave_ror:1 row_mask:0xf bank_mask:0xf
    v_mfma_f32_16x16x32_bf16 v[104:107], a[20:23], a[136:139], v[104:107]
    v_cvt_pk_bf16_f32 v116, v114, v115
    ds_write_b16 v139, v116 offset:18432
    v_mfma_f32_16x16x32_bf16 v[104:107], a[24:27], a[132:135], v[104:107]
    ds_write_b16_d16_hi v139, v116 offset:18944
    v_mfma_f32_16x16x32_bf16 v[104:107], a[28:31], a[128:131], v[104:107]
    s_waitcnt lgkmcnt(10)
    v_mfma_f32_16x16x32_bf16 v[108:111], a[0:3], a[164:167], 0
    ds_read_b64_tr_b16 a[176:177], v137 offset:35344
    ds_read_b64_tr_b16 a[178:179], v137 offset:35328
    v_mfma_f32_16x16x32_bf16 v[108:111], a[4:7], a[160:163], v[108:111]
    ds_read_b128 a[48:51], v138 offset:18176
    ds_read_b64_tr_b16 a[180:181], v137 offset:35472
    v_mfma_f32_16x16x32_bf16 v[108:111], a[8:11], a[156:159], v[108:111]
    ds_read_b64_tr_b16 a[182:183], v137 offset:35456
    ds_read_b128 a[52:55], v138 offset:18240
    v_mfma_f32_16x16x32_bf16 v[108:111], a[12:15], a[152:155], v[108:111]
    v_cndmask_b32 v112, v105, v103, s[30:31]
    v_cndmask_b32 v113, v107, v105, s[30:31]
    v_mfma_f32_16x16x32_bf16 v[108:111], a[16:19], a[148:151], v[108:111]
    v_add_f32_dpp v114, v112, v104 wave_ror:1 row_mask:0xf bank_mask:0xf
    v_add_f32_dpp v115, v113, v106 wave_ror:1 row_mask:0xf bank_mask:0xf
    v_mfma_f32_16x16x32_bf16 v[108:111], a[20:23], a[144:147], v[108:111]
    v_cvt_pk_bf16_f32 v116, v114, v115
    ds_write_b16 v139, v116 offset:19456
    v_mfma_f32_16x16x32_bf16 v[108:111], a[24:27], a[140:143], v[108:111]
    ds_write_b16_d16_hi v139, v116 offset:19968
    v_mfma_f32_16x16x32_bf16 v[108:111], a[28:31], a[136:139], v[108:111]
    v_mfma_f32_16x16x32_bf16 v[108:111], a[32:35], a[132:135], v[108:111]
    v_mfma_f32_16x16x32_bf16 v[108:111], a[36:39], a[128:131], v[108:111]
    s_waitcnt lgkmcnt(10)
    v_mfma_f32_16x16x32_bf16 v[100:103], a[0:3], a[172:175], 0
    ds_read_b64_tr_b16 a[184:185], v137 offset:35600
    v_mfma_f32_16x16x32_bf16 v[100:103], a[4:7], a[168:171], v[100:103]
    ds_read_b64_tr_b16 a[186:187], v137 offset:35584
    v_mfma_f32_16x16x32_bf16 v[100:103], a[8:11], a[164:167], v[100:103]
    ds_read_b128 a[56:59], v138 offset:18304
    v_mfma_f32_16x16x32_bf16 v[100:103], a[12:15], a[160:163], v[100:103]
    ds_read_b64_tr_b16 a[188:189], v137 offset:35728
    v_cndmask_b32 v112, v109, v107, s[30:31]
    v_mfma_f32_16x16x32_bf16 v[100:103], a[16:19], a[156:159], v[100:103]
    ds_read_b64_tr_b16 a[190:191], v137 offset:35712
    v_cndmask_b32 v113, v111, v109, s[30:31]
    v_mfma_f32_16x16x32_bf16 v[100:103], a[20:23], a[152:155], v[100:103]
    ds_read_b128 a[60:63], v138 offset:18368
    v_add_f32_dpp v114, v112, v108 wave_ror:1 row_mask:0xf bank_mask:0xf
    v_mfma_f32_16x16x32_bf16 v[100:103], a[24:27], a[148:151], v[100:103]
    v_add_f32_dpp v115, v113, v110 wave_ror:1 row_mask:0xf bank_mask:0xf
    v_cvt_pk_bf16_f32 v116, v114, v115
    v_mfma_f32_16x16x32_bf16 v[100:103], a[28:31], a[144:147], v[100:103]
    ds_write_b16 v139, v116 offset:20480
    v_mfma_f32_16x16x32_bf16 v[100:103], a[32:35], a[140:143], v[100:103]
    ds_write_b16_d16_hi v139, v116 offset:20992
    v_mfma_f32_16x16x32_bf16 v[100:103], a[36:39], a[136:139], v[100:103]
    v_mfma_f32_16x16x32_bf16 v[100:103], a[40:43], a[132:135], v[100:103]
    v_mfma_f32_16x16x32_bf16 v[100:103], a[44:47], a[128:131], v[100:103]
    s_waitcnt lgkmcnt(10)
    v_mfma_f32_16x16x32_bf16 v[104:107], a[0:3], a[180:183], 0
    ds_read_b64_tr_b16 a[192:193], v137 offset:35856
    v_mfma_f32_16x16x32_bf16 v[104:107], a[4:7], a[176:179], v[104:107]
    ds_read_b64_tr_b16 a[194:195], v137 offset:35840
    v_mfma_f32_16x16x32_bf16 v[104:107], a[8:11], a[172:175], v[104:107]
    ds_read_b128 a[64:67], v138 offset:18432
    v_mfma_f32_16x16x32_bf16 v[104:107], a[12:15], a[168:171], v[104:107]
    ds_read_b64_tr_b16 a[196:197], v137 offset:35984
    v_cndmask_b32 v112, v101, v111, s[30:31]
    v_mfma_f32_16x16x32_bf16 v[104:107], a[16:19], a[164:167], v[104:107]
    ds_read_b64_tr_b16 a[198:199], v137 offset:35968
    v_cndmask_b32 v113, v103, v101, s[30:31]
    v_mfma_f32_16x16x32_bf16 v[104:107], a[20:23], a[160:163], v[104:107]
    ds_read_b128 a[68:71], v138 offset:18496
    v_add_f32_dpp v114, v112, v100 wave_ror:1 row_mask:0xf bank_mask:0xf
    v_mfma_f32_16x16x32_bf16 v[104:107], a[24:27], a[156:159], v[104:107]
    v_add_f32_dpp v115, v113, v102 wave_ror:1 row_mask:0xf bank_mask:0xf
    v_cvt_pk_bf16_f32 v116, v114, v115
    v_mfma_f32_16x16x32_bf16 v[104:107], a[28:31], a[152:155], v[104:107]
    ds_write_b16 v139, v116 offset:21504
    v_mfma_f32_16x16x32_bf16 v[104:107], a[32:35], a[148:151], v[104:107]
    ds_write_b16_d16_hi v139, v116 offset:22016
    v_mfma_f32_16x16x32_bf16 v[104:107], a[36:39], a[144:147], v[104:107]
    s_waitcnt vmcnt(0)
    v_cmp_gt_u32 vcc, 4, v144
    s_nop 0
    s_and_b64 vcc, vcc, s[100:101]
    s_cbranch_vccnz L_pk_slow
L_pk_ok:
    v_mfma_f32_16x16x32_bf16 v[104:107], a[40:43], a[140:143], v[104:107]
    v_mfma_f32_16x16x32_bf16 v[104:107], a[44:47], a[136:139], v[104:107]
    s_barrier
    v_mfma_f32_16x16x32_bf16 v[104:107], a[48:51], a[132:135], v[104:107]
    ds_read_b128 v[64:67], v140 offset:0
    v_mfma_f32_16x16x32_bf16 v[104:107], a[52:55], a[128:131], v[104:107]
    ds_read_b128 v[68:71], v140 offset:1024
    ds_read_b128 v[72:75], v140 offset:2048
    ds_read_b128 v[76:79], v140 offset:3072
    s_add_u32 s35, s52, 0
    s_waitcnt lgkmcnt(14)
    v_mfma_f32_16x16x32_bf16 v[108:111], a[0:3], a[188:191], 0
    ds_read_b64_tr_b16 a[200:201], v137 offset:36112
    v_mfma_f32_16x16x32_bf16 v[108:111], a[4:7], a[184:187], v[108:111]
    ds_read_b64_tr_b16 a[202:203], v137 offset:36096
    v_mfma_f32_16x16x32_bf16 v[108:111], a[8:11], a[180:183], v[108:111]
    ds_read_b128 a[72:75], v138 offset:18560
    v_mfma_f32_16x16x32_bf16 v[108:111], a[12:15], a[176:179], v[108:111]
    ds_read_b64_tr_b16 a[204:205], v137 offset:36240
    v_cndmask_b32 v112, v105, v103, s[30:31]
    v_mfma_f32_16x16x32_bf16 v[108:111], a[16:19], a[172:175], v[108:111]
    ds_read_b64_tr_b16 a[206:207], v137 offset:36224
    v_cndmask_b32 v113, v107, v105, s[30:31]
    v_mfma_f32_16x16x32_bf16 v[108:111], a[20:23], a[168:171], v[108:111]
    ds_read_b128 a[76:79], v138 offset:18624
    v_add_f32_dpp v114, v112, v104 wave_ror:1 row_mask:0xf bank_mask:0xf
    v_mfma_f32_16x16x32_bf16 v[108:111], a[24:27], a[164:167], v[108:111]
    v_add_f32_dpp v115, v113, v106 wave_ror:1 row_mask:0xf bank_mask:0xf
    v_cvt_pk_bf16_f32 v116, v114, v115
    v_mfma_f32_16x16x32_bf16 v[108:111], a[28:31], a[160:163], v[108:111]
    ds_write_b16 v139, v116 offset:22528
    v_mfma_f32_16x16x32_bf16 v[108:111], a[32:35], a[156:159], v[108:111]
    ds_write_b16_d16_hi v139, v116 offset:23040
    v_mfma_f32_16x16x32_bf16 v[108:111], a[36:39], a[152:155], v[108:111]
    s_waitcnt lgkmcnt(11)
    v_mfma_f32_16x16x32_bf16 v[108:111], a[40:43], a[148:151], v[108:111]
    buffer_store_dwordx4 v[64:67], v136, s[16:19], s35 offen offset:0 sc1
    v_mfma_f32_16x16x32_bf16 v[108:111], a[44:47], a[144:147], v[108:111]
    s_waitcnt lgkmcnt(10)
    v_mfma_f32_16x16x32_bf16 v[108:111], a[48:51], a[140:143], v[108:111]
    buffer_store_dwordx4 v[68:71], v136, s[16:19], s35 offen offset:1024 sc1
    v_mfma_f32_16x16x32_bf16 v[108:111], a[52:55], a[136:139], v[108:111]
    s_waitcnt lgkmcnt(9)
    v_mfma_f32_16x16x32_bf16 v[108:111], a[56:59], a[132:135], v[108:111]
    buffer_store_dwordx4 v[72:75], v136, s[16:19], s35 offen offset:2048 sc1
    v_mfma_f32_16x16x32_bf16 v[108:111], a[60:63], a[128:131], v[108:111]
    s_waitcnt lgkmcnt(8)
    buffer_store_dwordx4 v[76:79], v136, s[16:19], s35 offen offset:3072 sc1
    s_mul_i32 s34, s28, 16
    v_min_u32 v146, 15, v1
    v_add_lshl_u32 v146, v146, s34, 7
    v_add_u32 v146, L_conv2-L_pc, v146
    v_min_u32 v146, L_end-L_pc, v146
    global_load_dword v147, v146, s[56:57]
    v_mfma_f32_16x16x32_bf16 v[100:103], a[0:3], a[196:199], 0
    ds_read_b64_tr_b16 a[208:209], v137 offset:36368
    v_mfma_f32_16x16x32_bf16 v[100:103], a[4:7], a[192:195], v[100:103]
    ds_read_b64_tr_b16 a[210:211], v137 offset:36352
    v_mfma_f32_16x16x32_bf16 v[100:103], a[8:11], a[188:191], v[100:103]
    ds_read_b128 a[80:83], v138 offset:18688
    v_mfma_f32_16x16x32_bf16 v[100:103], a[12:15], a[184:187], v[100:103]
    ds_read_b64_tr_b16 a[212:213], v137 offset:36496
    v_cndmask_b32 v112, v109, v107, s[30:31]
    v_mfma_f32_16x16x32_bf16 v[100:103], a[16:19], a[180:183], v[100:103]
    ds_read_b64_tr_b16 a[214:215], v137 offset:36480
    v_cndmask_b32 v113, v111, v109, s[30:31]
    v_mfma_f32_16x16x32_bf16 v[100:103], a[20:23], a[176:179], v[100:103]
    ds_read_b128 a[84:87], v138 offset:18752
    v_add_f32_dpp v114, v112, v108 wave_ror:1 row_mask:0xf bank_mask:0xf
    v_mfma_f32_16x16x32_bf16 v[100:103], a[24:27], a[172:175], v[100:103]
    v_add_f32_dpp v115, v113, v110 wave_ror:1 row_mask:0xf bank_mask:0xf
    v_cvt_pk_bf16_f32 v116, v114, v115
    v_mfma_f32_16x16x32_bf16 v[100:103], a[28:31], a[168:171], v[100:103]
    ds_write_b16 v139, v116 offset:23552
    v_mfma_f32_16x16x32_bf16 v[100:103], a[32:35], a[164:167], v[100:103]
    ds_write_b16_d16_hi v139, v116 offset:24064
    v_mfma_f32_16x16x32_bf16 v[100:103], a[36:39], a[160:163], v[100:103]
    v_mfma_f32_16x16x32_bf16 v[100:103], a[40:43], a[156:159], v[100:103]
    v_mfma_f32_16x16x32_bf16 v[100:103], a[44:47], a[152:155], v[100:103]
    v_mfma_f32_16x16x32_bf16 v[100:103], a[48:51], a[148:151], v[100:103]
    v_mfma_f32_16x16x32_bf16 v[100:103], a[52:55], a[144:147], v[100:103]
    v_mfma_f32_16x16x32_bf16 v[100:103], a[56:59], a[140:143], v[100:103]
    v_mfma_f32_16x16x32_bf16 v[100:103], a[60:63], a[136:139], v[100:103]
    v_mfma_f32_16x16x32_bf16 v[100:103], a[64:67], a[132:135], v[100:103]
    v_mfma_f32_16x16x32_bf16 v[100:103], a[68:71], a[128:131], v[100:103]
    s_waitcnt lgkmcnt(10)
    v_mfma_f32_16x16x32_bf16 v[104:107], a[0:3], a[204:207], 0
    ds_read_b64_tr_b16 a[216:217], v137 offset:36624
    v_mfma_f32_16x16x32_bf16 v[104:107], a[4:7], a[200:203], v[104:107]
    ds_read_b64_tr_b16 a[218:219], v137 offset:36608
    v_mfma_f32_16x16x32_bf16 v[104:107], a[8:11], a[196:199], v[104:107]
    ds_read_b128 a[88:91], v138 offset:18816
    v_mfma_f32_16x16x32_bf16 v[104:107], a[12:15], a[192:195], v[104:107]
    ds_read_b64_tr_b16 a[220:221], v137 offset:36752
    v_cndmask_b32 v112, v101, v111, s[30:31]
    v_mfma_f32_16x16x32_bf16 v[104:107], a[16:19], a[188:191], v[104:107]
    ds_read_b64_tr_b16 a[222:223], v137 offset:36736
    v_cndmask_b32 v113, v103, v101, s[30:31]
    v_mfma_f32_16x16x32_bf16 v[104:107], a[20:23], a[184:187], v[104:107]
    ds_read_b128 a[92:95], v138 offset:18880
    v_add_f32_dpp v114, v112, v100 wave_ror:1 row_mask:0xf bank_mask:0xf
    v_mfma_f32_16x16x32_bf16 v[104:107], a[24:27], a[180:183], v[104:107]
    v_add_f32_dpp v115, v113, v102 wave_ror:1 row_mask:0xf bank_mask:0xf
    v_cvt_pk_bf16_f32 v116, v114, v115
    v_mfma_f32_16x16x32_bf16 v[104:107], a[28:31], a[176:179], v[104:107]
    ds_write_b16 v139, v116 offset:24576
    v_mfma_f32_16x16x32_bf16 v[104:107], a[32:35], a[172:175], v[104:107]
    ds_write_b16_d16_hi v139, v116 offset:25088
    v_mfma_f32_16x16x32_bf16 v[104:107], a[36:39], a[168:171], v[104:107]
    s_add_u32 m0, s51, 32
    v_mfma_f32_16x16x32_bf16 v[104:107], a[40:43], a[164:167], v[104:107]
    s_add_u32 s34, s50, 131072
    v_mfma_f32_16x16x32_bf16 v[104:107], a[44:47], a[160:163], v[104:107]
    v_mfma_f32_16x16x32_bf16 v[104:107], a[48:51], a[156:159], v[104:107]
    buffer_load_dwordx4 v136, s[16:19], s34 offen offset:0 sc1 lds
    v_mfma_f32_16x16x32_bf16 v[104:107], a[52:55], a[152:155], v[104:107]
    v_mfma_f32_16x16x32_bf16 v[104:107], a[56:59], a[148:151], v[104:107]
    buffer_load_dwordx4 v136, s[16:19], s34 offen offset:1024 sc1 lds
    v_mfma_f32_16x16x32_bf16 v[104:107], a[60:63], a[144:147], v[104:107]
    v_mfma_f32_16x16x32_bf16 v[104:107], a[64:67], a[140:143], v[104:107]
    buffer_load_dwordx4 v136, s[16:19], s34 offen offset:2048 sc1 lds
    v_mfma_f32_16x16x32_bf16 v[104:107], a[68:71], a[136:139], v[104:107]
    v_mfma_f32_16x16x32_bf16 v[104:107], a[72:75], a[132:135], v[104:107]
    buffer_load_dwordx4 v136, s[16:19], s34 offen offset:3072 sc1 lds
    v_mfma_f32_16x16x32_bf16 v[104:107], a[76:79], a[128:131], v[104:107]
    s_waitcnt lgkmcnt(10)
    v_mfma_f32_16x16x32_bf16 v[108:111], a[0:3], a[212:215], 0
    ds_read_b64_tr_b16 a[224:225], v137 offset:36880
    v_mfma_f32_16x16x32_bf16 v[108:111], a[4:7], a[208:211], v[108:111]
    ds_read_b64_tr_b16 a[226:227], v137 offset:36864
    v_mfma_f32_16x16x32_bf16 v[108:111], a[8:11], a[204:207], v[108:111]
    ds_read_b128 a[96:99], v138 offset:18944
    v_mfma_f32_16x16x32_bf16 v[108:111], a[12:15], a[200:203], v[108:111]
    ds_read_b64_tr_b16 a[228:229], v137 offset:37008
    v_cndmask_b32 v112, v105, v103, s[30:31]
    v_mfma_f32_16x16x32_bf16 v[108:111], a[16:19], a[196:199], v[108:111]
    ds_read_b64_tr_b16 a[230:231], v137 offset:36992
    v_cndmask_b32 v113, v107, v105, s[30:31]
    v_mfma_f32_16x16x32_bf16 v[108:111], a[20:23], a[192:195], v[108:111]
    ds_read_b128 a[100:103], v138 offset:19008
    v_add_f32_dpp v114, v112, v104 wave_ror:1 row_mask:0xf bank_mask:0xf
    v_mfma_f32_16x16x32_bf16 v[108:111], a[24:27], a[188:191], v[108:111]
    v_add_f32_dpp v115, v113, v106 wave_ror:1 row_mask:0xf bank_mask:0xf
    v_cvt_pk_bf16_f32 v116, v114, v115
    v_mfma_f32_16x16x32_bf16 v[108:111], a[28:31], a[184:187], v[108:111]
    ds_write_b16 v139, v116 offset:25600
    v_mfma_f32_16x16x32_bf16 v[108:111], a[32:35], a[180:183], v[108:111]
    ds_write_b16_d16_hi v139, v116 offset:26112
    v_mfma_f32_16x16x32_bf16 v[108:111], a[36:39], a[176:179], v[108:111]
    s_add_u32 m0, s51, 4256
    v_mfma_f32_16x16x32_bf16 v[108:111], a[40:43], a[172:175], v[108:111]
    s_sub_u32 s34, s34, 4
    v_mfma_f32_16x16x32_bf16 v[108:111], a[44:47], a[168:171], v[108:111]
    v_mfma_f32_16x16x32_bf16 v[108:111], a[48:51], a[164:167], v[108:111]
    buffer_load_dwordx4 v136, s[16:19], s34 offen offset:0 sc1 lds
    v_mfma_f32_16x16x32_bf16 v[108:111], a[52:55], a[160:163], v[108:111]
    v_mfma_f32_16x16x32_bf16 v[108:111], a[56:59], a[156:159], v[108:111]
    buffer_load_dwordx4 v136, s[16:19], s34 offen offset:1024 sc1 lds
    v_mfma_f32_16x16x32_bf16 v[108:111], a[60:63], a[152:155], v[108:111]
    v_mfma_f32_16x16x32_bf16 v[108:111], a[64:67], a[148:151], v[108:111]
    buffer_load_dwordx4 v136, s[16:19], s34 offen offset:2048 sc1 lds
    v_mfma_f32_16x16x32_bf16 v[108:111], a[68:71], a[144:147], v[108:111]
    v_mfma_f32_16x16x32_bf16 v[108:111], a[72:75], a[140:143], v[108:111]
    buffer_load_dwordx4 v136, s[16:19], s34 offen offset:3072 sc1 lds
    v_mfma_f32_16x16x32_bf16 v[108:111], a[76:79], a[136:139], v[108:111]
    v_mfma_f32_16x16x32_bf16 v[108:111], a[80:83], a[132:135], v[108:111]
    v_mfma_f32_16x16x32_bf16 v[108:111], a[84:87], a[128:131], v[108:111]
    s_waitcnt lgkmcnt(10)
    v_mfma_f32_16x16x32_bf16 v[100:103], a[0:3], a[220:223], 0
    ds_read_b64_tr_b16 a[232:233], v137 offset:37136
    v_mfma_f32_16x16x32_bf16 v[100:103], a[4:7], a[216:219], v[100:103]
    ds_read_b64_tr_b16 a[234:235], v137 offset:37120
    v_mfma_f32_16x16x32_bf16 v[100:103], a[8:11], a[212:215], v[100:103]
    ds_read_b128 a[104:107], v138 offset:19072
    v_mfma_f32_16x16x32_bf16 v[100:103], a[12:15], a[208:211], v[100:103]
    ds_read_b64_tr_b16 a[236:237], v137 offset:37264
    v_cndmask_b32 v112, v109, v107, s[30:31]
    v_mfma_f32_16x16x32_bf16 v[100:103], a[16:19], a[204:207], v[100:103]
    ds_read_b64_tr_b16 a[238:239], v137 offset:37248
    v_cndmask_b32 v113, v111, v109, s[30:31]
    v_mfma_f32_16x16x32_bf16 v[100:103], a[20:23], a[200:203], v[100:103]
    ds_read_b128 a[108:111], v138 offset:19136
    v_add_f32_dpp v114, v112, v108 wave_ror:1 row_mask:0xf bank_mask:0xf
    v_mfma_f32_16x16x32_bf16 v[100:103], a[24:27], a[196:199], v[100:103]
    v_add_f32_dpp v115, v113, v110 wave_ror:1 row_mask:0xf bank_mask:0xf
    v_cvt_pk_bf16_f32 v116, v114, v115
    v_mfma_f32_16x16x32_bf16 v[100:103], a[28:31], a[192:195], v[100:103]
    ds_write_b16 v139, v116 offset:26624
    v_mfma_f32_16x16x32_bf16 v[100:103], a[32:35], a[188:191], v[100:103]
    ds_write_b16_d16_hi v139, v116 offset:27136
    v_mfma_f32_16x16x32_bf16 v[100:103], a[36:39], a[184:187], v[100:103]
    v_mfma_f32_16x16x32_bf16 v[100:103], a[40:43], a[180:183], v[100:103]
    v_mfma_f32_16x16x32_bf16 v[100:103], a[44:47], a[176:179], v[100:103]
    v_mfma_f32_16x16x32_bf16 v[100:103], a[48:51], a[172:175], v[100:103]
    v_mfma_f32_16x16x32_bf16 v[100:103], a[52:55], a[168:171], v[100:103]
    v_mfma_f32_16x16x32_bf16 v[100:103], a[56:59], a[164:167], v[100:103]
    v_mfma_f32_16x16x32_bf16 v[100:103], a[60:63], a[160:163], v[100:103]
    v_mfma_f32_16x16x32_bf16 v[100:103], a[64:67], a[156:159], v[100:103]
    v_mfma_f32_16x16x32_bf16 v[100:103], a[68:71], a[152:155], v[100:103]
    v_mfma_f32_16x16x32_bf16 v[100:103], a[72:75], a[148:151], v[100:103]
    v_mfma_f32_16x16x32_bf16 v[100:103], a[76:79], a[144:147], v[100:103]
    v_mfma_f32_16x16x32_bf16 v[100:103], a[80:83], a[140:143], v[100:103]
    v_mfma_f32_16x16x32_bf16 v[100:103], a[84:87], a[136:139], v[100:103]
    v_mfma_f32_16x16x32_bf16 v[100:103], a[88:91], a[132:135], v[100:103]
    v_mfma_f32_16x16x32_bf16 v[100:103], a[92:95], a[128:131], v[100:103]
    s_waitcnt lgkmcnt(10)
    v_mfma_f32_16x16x32_bf16 v[104:107], a[0:3], a[228:231], 0
    ds_read_b64_tr_b16 a[240:241], v137 offset:37392
    v_mfma_f32_16x16x32_bf16 v[104:107], a[4:7], a[224:227], v[104:107]
    ds_read_b64_tr_b16 a[242:243], v137 offset:37376
    v_mfma_f32_16x16x32_bf16 v[104:107], a[8:11], a[220:223], v[104:107]
    ds_read_b128 a[112:115], v138 offset:19200
    v_mfma_f32_16x16x32_bf16 v[104:107], a[12:15], a[216:219], v[104:107]
    ds_read_b64_tr_b16 a[244:245], v137 offset:37520
    v_cndmask_b32 v112, v101, v111, s[30:31]
    v_mfma_f32_16x16x32_bf16 v[104:107], a[16:19], a[212:215], v[104:107]
    ds_read_b64_tr_b16 a[246:247], v137 offset:37504
    v_cndmask_b32 v113, v103, v101, s[30:31]
    v_mfma_f32_16x16x32_bf16 v[104:107], a[20:23], a[208:211], v[104:107]
    ds_read_b128 a[116:119], v138 offset:19264
    v_add_f32_dpp v114, v112, v100 wave_ror:1 row_mask:0xf bank_mask:0xf
    v_mfma_f32_16x16x32_bf16 v[104:107], a[24:27], a[204:207], v[104:107]
    v_add_f32_dpp v115, v113, v102 wave_ror:1 row_mask:0xf bank_mask:0xf
    v_cvt_pk_bf16_f32 v116, v114, v115
    v_mfma_f32_16x16x32_bf16 v[104:107], a[28:31], a[200:203], v[104:107]
    ds_write_b16 v139, v116 offset:27648
    v_mfma_f32_16x16x32_bf16 v[104:107], a[32:35], a[196:199], v[104:107]
    ds_write_b16_d16_hi v139, v116 offset:28160
    v_mfma_f32_16x16x32_bf16 v[104:107], a[36:39], a[192:195], v[104:107]
    v_mfma_f32_16x16x32_bf16 v[104:107], a[40:43], a[188:191], v[104:107]
    v_mfma_f32_16x16x32_bf16 v[104:107], a[44:47], a[184:187], v[104:107]
    v_mfma_f32_16x16x32_bf16 v[104:107], a[48:51], a[180:183], v[104:107]
    v_mfma_f32_16x16x32_bf16 v[104:107], a[52:55], a[176:179], v[104:107]
    v_mfma_f32_16x16x32_bf16 v[104:107], a[56:59], a[172:175], v[104:107]
    v_mfma_f32_16x16x32_bf16 v[104:107], a[60:63], a[168:171], v[104:107]
    v_mfma_f32_16x16x32_bf16 v[104:107], a[64:67], a[164:167], v[104:107]
    v_mfma_f32_16x16x32_bf16 v[104:107], a[68:71], a[160:163], v[104:107]
    v_mfma_f32_16x16x32_bf16 v[104:107], a[72:75], a[156:159], v[104:107]
    v_mfma_f32_16x16x32_bf16 v[104:107], a[76:79], a[152:155], v[104:107]
    v_mfma_f32_16x16x32_bf16 v[104:107], a[80:83], a[148:151], v[104:107]
    v_mfma_f32_16x16x32_bf16 v[104:107], a[84:87], a[144:147], v[104:107]
    v_mfma_f32_16x16x32_bf16 v[104:107], a[88:91], a[140:143], v[104:107]
    v_mfma_f32_16x16x32_bf16 v[104:107], a[92:95], a[136:139], v[104:107]
    v_mfma_f32_16x16x32_bf16 v[104:107], a[96:99], a[132:135], v[104:107]
    v_mfma_f32_16x16x32_bf16 v[104:107], a[100:103], a[128:131], v[104:107]
    s_waitcnt lgkmcnt(10)
    v_mfma_f32_16x16x32_bf16 v[108:111], a[0:3], a[236:239], 0
    ds_read_b64_tr_b16 a[248:249], v137 offset:37648
    v_mfma_f32_16x16x32_bf16 v[108:111], a[4:7], a[232:235], v[108:111]
    ds_read_b64_tr_b16 a[250:251], v137 offset:37632
    v_mfma_f32_16x16x32_bf16 v[108:111], a[8:11], a[228:231], v[108:111]
    ds_read_b128 a[120:123], v138 offset:19328
    v_mfma_f32_16x16x32_bf16 v[108:111], a[12:15], a[224:227], v[108:111]
    ds_read_b64_tr_b16 a[252:253], v137 offset:37776
    v_cndmask_b32 v112, v105, v103, s[30:31]
    v_mfma_f32_16x16x32_bf16 v[108:111], a[16:19], a[220:223], v[108:111]
    ds_read_b64_tr_b16 a[254:255], v137 offset:37760
    v_cndmask_b32 v113, v107, v105, s[30:31]
    v_mfma_f32_16x16x32_bf16 v[108:111], a[20:23], a[216:219], v[108:111]
    ds_read_b128 a[124:127], v138 offset:19392
    v_add_f32_dpp v114, v112, v104 wave_ror:1 row_mask:0xf bank_mask:0xf
    v_mfma_f32_16x16x32_bf16 v[108:111], a[24:27], a[212:215], v[108:111]
    v_add_f32_dpp v115, v113, v106 wave_ror:1 row_mask:0xf bank_mask:0xf
    v_cvt_pk_bf16_f32 v116, v114, v115
    v_mfma_f32_16x16x32_bf16 v[108:111], a[28:31], a[208:211], v[108:111]
    ds_write_b16 v139, v116 offset:28672
    v_mfma_f32_16x16x32_bf16 v[108:111], a[32:35], a[204:207], v[108:111]
    ds_write_b16_d16_hi v139, v116 offset:29184
    v_mfma_f32_16x16x32_bf16 v[108:111], a[36:39], a[200:203], v[108:111]
    v_mfma_f32_16x16x32_bf16 v[108:111], a[40:43], a[196:199], v[108:111]
    v_mfma_f32_16x16x32_bf16 v[108:111], a[44:47], a[192:195], v[108:111]
    v_mfma_f32_16x16x32_bf16 v[108:111], a[48:51], a[188:191], v[108:111]
    v_mfma_f32_16x16x32_bf16 v[108:111], a[52:55], a[184:187], v[108:111]
    v_mfma_f32_16x16x32_bf16 v[108:111], a[56:59], a[180:183], v[108:111]
    v_mfma_f32_16x16x32_bf16 v[108:111], a[60:63], a[176:179], v[108:111]
    v_mfma_f32_16x16x32_bf16 v[108:111], a[64:67], a[172:175], v[108:111]
    v_mfma_f32_16x16x32_bf16 v[108:111], a[68:71], a[168:171], v[108:111]
    v_mfma_f32_16x16x32_bf16 v[108:111], a[72:75], a[164:167], v[108:111]
    v_mfma_f32_16x16x32_bf16 v[108:111], a[76:79], a[160:163], v[108:111]
    v_mfma_f32_16x16x32_bf16 v[108:111], a[80:83], a[156:159], v[108:111]
    v_mfma_f32_16x16x32_bf16 v[108:111], a[84:87], a[152:155], v[108:111]
    v_mfma_f32_16x16x32_bf16 v[108:111], a[88:91], a[148:151], v[108:111]
    v_mfma_f32_16x16x32_bf16 v[108:111], a[92:95], a[144:147], v[108:111]
    v_mfma_f32_16x16x32_bf16 v[108:111], a[96:99], a[140:143], v[108:111]
    v_mfma_f32_16x16x32_bf16 v[108:111], a[100:103], a[136:139], v[108:111]
    v_mfma_f32_16x16x32_bf16 v[108:111], a[104:107], a[132:135], v[108:111]
    v_mfma_f32_16x16x32_bf16 v[108:111], a[108:111], a[128:131], v[108:111]
    s_waitcnt lgkmcnt(10)
    v_mfma_f32_16x16x32_bf16 v[100:103], a[0:3], a[244:247], 0
    s_waitcnt lgkmcnt(2)
    v_mfma_f32_16x16x32_bf16 v[100:103], a[4:7], a[240:243], v[100:103]
    s_barrier
    v_mfma_f32_16x16x32_bf16 v[100:103], a[8:11], a[236:239], v[100:103]
    v_mfma_f32_16x16x32_bf16 v[100:103], a[12:15], a[232:235], v[100:103]
    s_nop 0
    v_cndmask_b32 v112, v109, v107, s[30:31]
    v_cndmask_b32 v113, v111, v109, s[30:31]
    v_mfma_f32_16x16x32_bf16 v[100:103], a[16:19], a[228:231], v[100:103]
    v_add_f32_dpp v114, v112, v108 wave_ror:1 row_mask:0xf bank_mask:0xf
    v_add_f32_dpp v115, v113, v110 wave_ror:1 row_mask:0xf bank_mask:0xf
    v_mfma_f32_16x16x32_bf16 v[100:103], a[20:23], a[224:227], v[100:103]
    v_cvt_pk_bf16_f32 v116, v114, v115
    v_mfma_f32_16x16x32_bf16 v[100:103], a[24:27], a[220:223], v[100:103]
    ds_write_b16 v139, v116 offset:29696
    v_mfma_f32_16x16x32_bf16 v[100:103], a[28:31], a[216:219], v[100:103]
    ds_write_b16_d16_hi v139, v116 offset:30208
    v_mfma_f32_16x16x32_bf16 v[100:103], a[32:35], a[212:215], v[100:103]
    v_mfma_f32_16x16x32_bf16 v[100:103], a[36:39], a[208:211], v[100:103]
    v_mfma_f32_16x16x32_bf16 v[100:103], a[40:43], a[204:207], v[100:103]
    v_mfma_f32_16x16x32_bf16 v[100:103], a[44:47], a[200:203], v[100:103]
    v_mfma_f32_16x16x32_bf16 v[100:103], a[48:51], a[196:199], v[100:103]
    v_mfma_f32_16x16x32_bf16 v[100:103], a[52:55], a[192:195], v[100:103]
    v_mfma_f32_16x16x32_bf16 v[100:103], a[56:59], a[188:191], v[100:103]
    v_mfma_f32_16x16x32_bf16 v[100:103], a[60:63], a[184:187], v[100:103]
    v_mfma_f32_16x16x32_bf16 v[100:103], a[64:67], a[180:183], v[100:103]
    v_mfma_f32_16x16x32_bf16 v[100:103], a[68:71], a[176:179], v[100:103]
    v_mfma_f32_16x16x32_bf16 v[100:103], a[72:75], a[172:175], v[100:103]
    v_mfma_f32_16x16x32_bf16 v[100:103], a[76:79], a[168:171], v[100:103]
    v_mfma_f32_16x16x32_bf16 v[100:103], a[80:83], a[164:167], v[100:103]
    v_mfma_f32_16x16x32_bf16 v[100:103], a[84:87], a[160:163], v[100:103]
    v_mfma_f32_16x16x32_bf16 v[100:103], a[88:91], a[156:159], v[100:103]
    v_mfma_f32_16x16x32_bf16 v[100:103], a[92:95], a[152:155], v[100:103]
    v_mfma_f32_16x16x32_bf16 v[100:103], a[96:99], a[148:151], v[100:103]
    v_mfma_f32_16x16x32_bf16 v[100:103], a[100:103], a[144:147], v[100:103]
    v_mfma_f32_16x16x32_bf16 v[100:103], a[104:107], a[140:143], v[100:103]
    v_mfma_f32_16x16x32_bf16 v[100:103], a[108:111], a[136:139], v[100:103]
    v_mfma_f32_16x16x32_bf16 v[100:103], a[112:115], a[132:135], v[100:103]
    v_mfma_f32_16x16x32_bf16 v[100:103], a[116:119], a[128:131], v[100:103]
    v_mfma_f32_16x16x32_bf16 v[104:107], a[0:3], a[252:255], 0
    v_mfma_f32_16x16x32_bf16 v[104:107], a[4:7], a[248:251], v[104:107]
    v_mfma_f32_16x16x32_bf16 v[104:107], a[8:11], a[244:247], v[104:107]
    v_mfma_f32_16x16x32_bf16 v[104:107], a[12:15], a[240:243], v[104:107]
    s_nop 3
    v_cndmask_b32 v112, v101, v111, s[30:31]
    v_cndmask_b32 v113, v103, v101, s[30:31]
    v_mfma_f32_16x16x32_bf16 v[104:107], a[16:19], a[236:239], v[104:107]
    v_add_f32_dpp v114, v112, v100 wave_ror:1 row_mask:0xf bank_mask:0xf
    v_add_f32_dpp v115, v113, v102 wave_ror:1 row_mask:0xf bank_mask:0xf
    v_mfma_f32_16x16x32_bf16 v[104:107], a[20:23], a[232:235], v[104:107]
    v_cvt_pk_bf16_f32 v116, v114, v115
    v_mfma_f32_16x16x32_bf16 v[104:107], a[24:27], a[228:231], v[104:107]
    ds_write_b16 v139, v116 offset:30720
    v_mfma_f32_16x16x32_bf16 v[104:107], a[28:31], a[224:227], v[104:107]
    ds_write_b16_d16_hi v139, v116 offset:31232
    v_mfma_f32_16x16x32_bf16 v[104:107], a[96:99], a[156:159], v[104:107]
    v_mfma_f32_16x16x32_bf16 v[104:107], a[100:103], a[152:155], v[104:107]
    v_mfma_f32_16x16x32_bf16 v[104:107], a[104:107], a[148:151], v[104:107]
    v_mfma_f32_16x16x32_bf16 v[104:107], a[108:111], a[144:147], v[104:107]
    v_mfma_f32_16x16x32_bf16 v[104:107], a[112:115], a[140:143], v[104:107]
    v_mfma_f32_16x16x32_bf16 v[104:107], a[116:119], a[136:139], v[104:107]
    v_mfma_f32_16x16x32_bf16 v[104:107], a[120:123], a[132:135], v[104:107]
    v_mfma_f32_16x16x32_bf16 v[104:107], a[124:127], a[128:131], v[104:107]
    v_mfma_f32_16x16x32_bf16 v[104:107], a[32:35], a[220:223], v[104:107]
    s_waitcnt vmcnt(0)
    ds_write_b32 v141, v52 offset:0
    v_mfma_f32_16x16x32_bf16 v[104:107], a[36:39], a[216:219], v[104:107]
    ds_read_b64_tr_b16 a[128:129], v137 offset:16
    ds_read_b64_tr_b16 a[130:131], v137 offset:0
    v_mfma_f32_16x16x32_bf16 v[104:107], a[40:43], a[212:215], v[104:107]
    ds_read_b128 a[0:3], v138 offset:34816
    ds_read_b64_tr_b16 a[132:133], v137 offset:144
    v_mfma_f32_16x16x32_bf16 v[104:107], a[44:47], a[208:211], v[104:107]
    ds_read_b64_tr_b16 a[134:135], v137 offset:128
    ds_read_b128 a[4:7], v138 offset:34880
    v_mfma_f32_16x16x32_bf16 v[104:107], a[48:51], a[204:207], v[104:107]
    ds_read_b64_tr_b16 a[136:137], v137 offset:272
    ds_read_b64_tr_b16 a[138:139], v137 offset:256
    v_mfma_f32_16x16x32_bf16 v[104:107], a[52:55], a[200:203], v[104:107]
    ds_read_b128 a[8:11], v138 offset:34944
    ds_read_b64_tr_b16 a[140:141], v137 offset:400
    v_mfma_f32_16x16x32_bf16 v[104:107], a[56:59], a[196:199], v[104:107]
    ds_read_b64_tr_b16 a[142:143], v137 offset:384
    ds_read_b128 a[12:15], v138 offset:35008
    v_mfma_f32_16x16x32_bf16 v[104:107], a[60:63], a[192:195], v[104:107]
    ds_read_b64_tr_b16 a[144:145], v137 offset:528
    ds_read_b64_tr_b16 a[146:147], v137 offset:512
    v_mfma_f32_16x16x32_bf16 v[104:107], a[64:67], a[188:191], v[104:107]
    ds_read_b128 a[16:19], v138 offset:35072
    ds_read_b64_tr_b16 a[148:149], v137 offset:656
    v_mfma_f32_16x16x32_bf16 v[104:107], a[68:71], a[184:187], v[104:107]
    ds_read_b64_tr_b16 a[150:151], v137 offset:640
    ds_read_b128 a[20:23], v138 offset:35136
    v_mfma_f32_16x16x32_bf16 v[104:107], a[72:75], a[180:183], v[104:107]
    ds_read_b64_tr_b16 a[152:153], v137 offset:784
    ds_read_b64_tr_b16 a[154:155], v137 offset:768
    v_mfma_f32_16x16x32_bf16 v[104:107], a[76:79], a[176:179], v[104:107]
    ds_read_b128 a[24:27], v138 offset:35200
    ds_read_b64_tr_b16 a[156:157], v137 offset:912
    v_mfma_f32_16x16x32_bf16 v[104:107], a[80:83], a[172:175], v[104:107]
    ds_read_b64_tr_b16 a[158:159], v137 offset:896
    ds_read_b128 a[28:31], v138 offset:35264
    v_mfma_f32_16x16x32_bf16 v[104:107], a[84:87], a[168:171], v[104:107]
    v_mfma_f32_16x16x32_bf16 v[104:107], a[88:91], a[164:167], v[104:107]
    v_mfma_f32_16x16x32_bf16 v[104:107], a[92:95], a[160:163], v[104:107]
L_conv2:
    s_waitcnt lgkmcnt(14)
    v_mfma_f32_16x16x32_bf16 v[108:111], a[0:3], a[132:135], 0
    v_mfma_f32_16x16x32_bf16 v[108:111], a[4:7], a[128:131], v[108:111]
    s_nop 4
    v_cndmask_b32 v112, v105, v103, s[30:31]
    v_cndmask_b32 v113, v107, v105, s[30:31]
    s_nop 0
    v_add_f32_dpp v114, v112, v104 wave_ror:1 row_mask:0xf bank_mask:0xf
    v_add_f32_dpp v115, v113, v106 wave_ror:1 row_mask:0xf bank_mask:0xf
    v_cvt_pk_bf16_f32 v116, v114, v115
    ds_write_b16 v139, v116 offset:31744
    ds_write_b16_d16_hi v139, v116 offset:32256
    s_waitcnt lgkmcnt(14)
    v_mfma_f32_16x16x32_bf16 v[100:103], a[0:3], a[140:143], 0
    v_mfma_f32_16x16x32_bf16 v[100:103], a[4:7], a[136:139], v[100:103]
    v_mfma_f32_16x16x32_bf16 v[100:103], a[8:11], a[132:135], v[100:103]
    v_mfma_f32_16x16x32_bf16 v[100:103], a[12:15], a[128:131], v[100:103]
    v_cndmask_b32 v112, v109, v52, s[30:31]
    v_cndmask_b32 v113, v111, v109, s[30:31]
    s_nop 0
    v_add_f32_dpp v114, v112, v108 wave_ror:1 row_mask:0xf bank_mask:0xf
    v_add_f32_dpp v115, v113, v110 wave_ror:1 row_mask:0xf bank_mask:0xf
    v_cvt_pk_bf16_f32 v116, v114, v115
    ds_write_b16 v139, v116 offset:0
    ds_write_b16_d16_hi v139, v116 offset:512
    s_waitcnt lgkmcnt(10)
    v_mfma_f32_16x16x32_bf16 v[104:107], a[0:3], a[148:151], 0
    ds_read_b64_tr_b16 a[160:161], v137 offset:1040
    ds_read_b64_tr_b16 a[162:163], v137 offset:1024
    v_mfma_f32_16x16x32_bf16 v[104:107], a[4:7], a[144:147], v[104:107]
    ds_read_b128 a[32:35], v138 offset:35328
    ds_read_b64_tr_b16 a[164:165], v137 offset:1168
    v_mfma_f32_16x16x32_bf16 v[104:107], a[8:11], a[140:143], v[104:107]
    ds_read_b64_tr_b16 a[166:167], v137 offset:1152
    ds_read_b128 a[36:39], v138 offset:35392
    v_mfma_f32_16x16x32_bf16 v[104:107], a[12:15], a[136:139], v[104:107]
    v_cndmask_b32 v112, v101, v111, s[30:31]
    v_cndmask_b32 v113, v103, v101, s[30:31]
    v_mfma_f32_16x16x32_bf16 v[104:107], a[16:19], a[132:135], v[104:107]
    v_add_f32_dpp v114, v112, v100 wave_ror:1 row_mask:0xf bank_mask:0xf
    v_add_f32_dpp v115, v113, v102 wave_ror:1 row_mask:0xf bank_mask:0xf
    v_mfma_f32_16x16x32_bf16 v[104:107], a[20:23], a[128:131], v[104:107]
    v_cvt_pk_bf16_f32 v116, v114, v115
    ds_write_b16 v139, v116 offset:1024
    ds_write_b16_d16_hi v139, v116 offset:1536
    s_waitcnt lgkmcnt(12)
    v_mfma_f32_16x16x32_bf16 v[108:111], a[0:3], a[156:159], 0
    ds_read_b64_tr_b16 a[168:169], v137 offset:1296
    ds_read_b64_tr_b16 a[170:171], v137 offset:1280
    v_mfma_f32_16x16x32_bf16 v[108:111], a[4:7], a[152:155], v[108:111]
    ds_read_b128 a[40:43], v138 offset:35456
    ds_read_b64_tr_b16 a[172:173], v137 offset:1424
    v_mfma_f32_16x16x32_bf16 v[108:111], a[8:11], a[148:151], v[108:111]
    ds_read_b64_tr_b16 a[174:175], v137 offset:1408
    ds_read_b128 a[44:47], v138 offset:35520
    v_mfma_f32_16x16x32_bf16 v[108:111], a[12:15], a[144:147], v[108:111]
    v_cndmask_b32 v112, v105, v103, s[30:31]
    v_cndmask_b32 v113, v107, v105, s[30:31]
    v_mfma_f32_16x16x32_bf16 v[108:111], a[16:19], a[140:143], v[108:111]
    v_add_f32_dpp v114, v112, v104 wave_ror:1 row_mask:0xf bank_mask:0xf
    v_add_f32_dpp v115, v113, v106 wave_ror:1 row_mask:0xf bank_mask:0xf
    v_mfma_f32_16x16x32_bf16 v[108:111], a[20:23], a[136:139], v[108:111]
    v_cvt_pk_bf16_f32 v116, v114, v115
    ds_write_b16 v139, v116 offset:2048
    v_mfma_f32_16x16x32_bf16 v[108:111], a[24:27], a[132:135], v[108:111]
    ds_write_b16_d16_hi v139, v116 offset:2560
    v_mfma_f32_16x16x32_bf16 v[108:111], a[28:31], a[128:131], v[108:111]
    s_waitcnt lgkmcnt(10)
    v_mfma_f32_16x16x32_bf16 v[100:103], a[0:3], a[164:167], 0
    ds_read_b64_tr_b16 a[176:177], v137 offset:1552
    ds_read_b64_tr_b16 a[178:179], v137 offset:1536
    v_mfma_f32_16x16x32_bf16 v[100:103], a[4:7], a[160:163], v[100:103]
    ds_read_b128 a[48:51], v138 offset:35584
    ds_read_b64_tr_b16 a[180:181], v137 offset:1680
    v_mfma_f32_16x16x32_bf16 v[100:103], a[8:11], a[156:159], v[100:103]
    ds_read_b64_tr_b16 a[182:183], v137 offset:1664
    ds_read_b128 a[52:55], v138 offset:35648
    v_mfma_f32_16x16x32_bf16 v[100:103], a[12:15], a[152:155], v[100:103]
    v_cndmask_b32 v112, v109, v107, s[30:31]
    v_cndmask_b32 v113, v111, v109, s[30:31]
    v_mfma_f32_16x16x32_bf16 v[100:103], a[16:19], a[148:151], v[100:103]
    v_add_f32_dpp v114, v112, v108 wave_ror:1 row_mask:0xf bank_mask:0xf
    v_add_f32_dpp v115, v113, v110 wave_ror:1 row_mask:0xf bank_mask:0xf
    v_mfma_f32_16x16x32_bf16 v[100:103], a[20:23], a[144:147], v[100:103]
    v_cvt_pk_bf16_f32 v116, v114, v115
    ds_write_b16 v139, v116 offset:3072
    v_mfma_f32_16x16x32_bf16 v[100:103], a[24:27], a[140:143], v[100:103]
    ds_write_b16_d16_hi v139, v116 offset:3584
    v_mfma_f32_16x16x32_bf16 v[100:103], a[28:31], a[136:139], v[100:103]
    v_mfma_f32_16x16x32_bf16 v[100:103], a[32:35], a[132:135], v[100:103]
    v_mfma_f32_16x16x32_bf16 v[100:103], a[36:39], a[128:131], v[100:103]
    s_waitcnt lgkmcnt(10)
    v_mfma_f32_16x16x32_bf16 v[104:107], a[0:3], a[172:175], 0
    ds_read_b64_tr_b16 a[184:185], v137 offset:1808
    v_mfma_f32_16x16x32_bf16 v[104:107], a[4:7], a[168:171], v[104:107]
    ds_read_b64_tr_b16 a[186:187], v137 offset:1792
    v_mfma_f32_16x16x32_bf16 v[104:107], a[8:11], a[164:167], v[104:107]
    ds_read_b128 a[56:59], v138 offset:35712
    v_mfma_f32_16x16x32_bf16 v[104:107], a[12:15], a[160:163], v[104:107]
    ds_read_b64_tr_b16 a[188:189], v137 offset:1936
    v_cndmask_b32 v112, v101, v111, s[30:31]
    v_mfma_f32_16x16x32_bf16 v[104:107], a[16:19], a[156:159], v[104:107]
    ds_read_b64_tr_b16 a[190:191], v137 offset:1920
    v_cndmask_b32 v113, v103, v101, s[30:31]
    v_mfma_f32_16x16x32_bf16 v[104:107], a[20:23], a[152:155], v[104:107]
    ds_read_b128 a[60:63], v138 offset:35776
    v_add_f32_dpp v114, v112, v100 wave_ror:1 row_mask:0xf bank_mask:0xf
    v_mfma_f32_16x16x32_bf16 v[104:107], a[24:27], a[148:151], v[104:107]
    v_add_f32_dpp v115, v113, v102 wave_ror:1 row_mask:0xf bank_mask:0xf
    v_cvt_pk_bf16_f32 v116, v114, v115
    v_mfma_f32_16x16x32_bf16 v[104:107], a[28:31], a[144:147], v[104:107]
    ds_write_b16 v139, v116 offset:4096
    v_mfma_f32_16x16x32_bf16 v[104:107], a[32:35], a[140:143], v[104:107]
    ds_write_b16_d16_hi v139, v116 offset:4608
    v_mfma_f32_16x16x32_bf16 v[104:107], a[36:39], a[136:139], v[104:107]
    v_mfma_f32_16x16x32_bf16 v[104:107], a[40:43], a[132:135], v[104:107]
    v_mfma_f32_16x16x32_bf16 v[104:107], a[44:47], a[128:131], v[104:107]
    s_waitcnt lgkmcnt(10)
    v_mfma_f32_16x16x32_bf16 v[108:111], a[0:3], a[180:183], 0
    ds_read_b64_tr_b16 a[192:193], v137 offset:2064
    v_mfma_f32_16x16x32_bf16 v[108:111], a[4:7], a[176:179], v[108:111]
    ds_read_b64_tr_b16 a[194:195], v137 offset:2048
    v_mfma_f32_16x16x32_bf16 v[108:111], a[8:11], a[172:175], v[108:111]
    ds_read_b128 a[64:67], v138 offset:35840
    v_mfma_f32_16x16x32_bf16 v[108:111], a[12:15], a[168:171], v[108:111]
    ds_read_b64_tr_b16 a[196:197], v137 offset:2192
    v_cndmask_b32 v112, v105, v103, s[30:31]
    v_mfma_f32_16x16x32_bf16 v[108:111], a[16:19], a[164:167], v[108:111]
    ds_read_b64_tr_b16 a[198:199], v137 offset:2176
    v_cndmask_b32 v113, v107, v105, s[30:31]
    v_mfma_f32_16x16x32_bf16 v[108:111], a[20:23], a[160:163], v[108:111]
    ds_read_b128 a[68:71], v138 offset:35904
    v_add_f32_dpp v114, v112, v104 wave_ror:1 row_mask:0xf bank_mask:0xf
    v_mfma_f32_16x16x32_bf16 v[108:111], a[24:27], a[156:159], v[108:111]
    v_add_f32_dpp v115, v113, v106 wave_ror:1 row_mask:0xf bank_mask:0xf
    v_cvt_pk_bf16_f32 v116, v114, v115
    v_mfma_f32_16x16x32_bf16 v[108:111], a[28:31], a[152:155], v[108:111]
    ds_write_b16 v139, v116 offset:5120
    v_mfma_f32_16x16x32_bf16 v[108:111], a[32:35], a[148:151], v[108:111]
    ds_write_b16_d16_hi v139, v116 offset:5632
    v_mfma_f32_16x16x32_bf16 v[108:111], a[36:39], a[144:147], v[108:111]
    v_mfma_f32_16x16x32_bf16 v[108:111], a[40:43], a[140:143], v[108:111]
    s_barrier
    v_mfma_f32_16x16x32_bf16 v[108:111], a[44:47], a[136:139], v[108:111]
    ds_read_b128 v[64:67], v140 offset:16384
    v_mfma_f32_16x16x32_bf16 v[108:111], a[48:51], a[132:135], v[108:111]
    ds_read_b128 v[68:71], v140 offset:17408
    v_mfma_f32_16x16x32_bf16 v[108:111], a[52:55], a[128:131], v[108:111]
    ds_read_b128 v[72:75], v140 offset:18432
    ds_read_b128 v[76:79], v140 offset:19456
    s_add_u32 s35, s52, 65536
    s_waitcnt lgkmcnt(14)
    v_mfma_f32_16x16x32_bf16 v[100:103], a[0:3], a[188:191], 0
    ds_read_b64_tr_b16 a[200:201], v137 offset:2320
    v_mfma_f32_16x16x32_bf16 v[100:103], a[4:7], a[184:187], v[100:103]
    ds_read_b64_tr_b16 a[202:203], v137 offset:2304
    v_mfma_f32_16x16x32_bf16 v[100:103], a[8:11], a[180:183], v[100:103]
    ds_read_b128 a[72:75], v138 offset:35968
    v_mfma_f32_16x16x32_bf16 v[100:103], a[12:15], a[176:179], v[100:103]
    ds_read_b64_tr_b16 a[204:205], v137 offset:2448
    v_cndmask_b32 v112, v109, v107, s[30:31]
    v_mfma_f32_16x16x32_bf16 v[100:103], a[16:19], a[172:175], v[100:103]
    ds_read_b64_tr_b16 a[206:207], v137 offset:2432
    v_cndmask_b32 v113, v111, v109, s[30:31]
    v_mfma_f32_16x16x32_bf16 v[100:103], a[20:23], a[168:171], v[100:103]
    ds_read_b128 a[76:79], v138 offset:36032
    v_add_f32_dpp v114, v112, v108 wave_ror:1 row_mask:0xf bank_mask:0xf
    v_mfma_f32_16x16x32_bf16 v[100:103], a[24:27], a[164:167], v[100:103]
    v_add_f32_dpp v115, v113, v110 wave_ror:1 row_mask:0xf bank_mask:0xf
    v_cvt_pk_bf16_f32 v116, v114, v115
    v_mfma_f32_16x16x32_bf16 v[100:103], a[28:31], a[160:163], v[100:103]
    ds_write_b16 v139, v116 offset:6144
    v_mfma_f32_16x16x32_bf16 v[100:103], a[32:35], a[156:159], v[100:103]
    ds_write_b16_d16_hi v139, v116 offset:6656
    v_mfma_f32_16x16x32_bf16 v[100:103], a[36:39], a[152:155], v[100:103]
    s_waitcnt lgkmcnt(11)
    v_mfma_f32_16x16x32_bf16 v[100:103], a[40:43], a[148:151], v[100:103]
    buffer_store_dwordx4 v[64:67], v136, s[16:19], s35 offen offset:0 sc1
    v_mfma_f32_16x16x32_bf16 v[100:103], a[44:47], a[144:147], v[100:103]
    s_waitcnt lgkmcnt(10)
    v_mfma_f32_16x16x32_bf16 v[100:103], a[48:51], a[140:143], v[100:103]
    buffer_store_dwordx4 v[68:71], v136, s[16:19], s35 offen offset:1024 sc1
    v_mfma_f32_16x16x32_bf16 v[100:103], a[52:55], a[136:139], v[100:103]
    s_waitcnt lgkmcnt(9)
    v_mfma_f32_16x16x32_bf16 v[100:103], a[56:59], a[132:135], v[100:103]
    buffer_store_dwordx4 v[72:75], v136, s[16:19], s35 offen offset:2048 sc1
    v_mfma_f32_16x16x32_bf16 v[100:103], a[60:63], a[128:131], v[100:103]
    s_waitcnt lgkmcnt(8)
    buffer_store_dwordx4 v[76:79], v136, s[16:19], s35 offen offset:3072 sc1
    v_mfma_f32_16x16x32_bf16 v[104:107], a[0:3], a[196:199], 0
    ds_read_b64_tr_b16 a[208:209], v137 offset:2576
    v_mfma_f32_16x16x32_bf16 v[104:107], a[4:7], a[192:195], v[104:107]
    ds_read_b64_tr_b16 a[210:211], v137 offset:2560
    v_mfma_f32_16x16x32_bf16 v[104:107], a[8:11], a[188:191], v[104:107]
    ds_read_b128 a[80:83], v138 offset:36096
    v_mfma_f32_16x16x32_bf16 v[104:107], a[12:15], a[184:187], v[104:107]
    ds_read_b64_tr_b16 a[212:213], v137 offset:2704
    v_cndmask_b32 v112, v101, v111, s[30:31]
    v_mfma_f32_16x16x32_bf16 v[104:107], a[16:19], a[180:183], v[104:107]
    ds_read_b64_tr_b16 a[214:215], v137 offset:2688
    v_cndmask_b32 v113, v103, v101, s[30:31]
    v_mfma_f32_16x16x32_bf16 v[104:107], a[20:23], a[176:179], v[104:107]
    ds_read_b128 a[84:87], v138 offset:36160
    v_add_f32_dpp v114, v112, v100 wave_ror:1 row_mask:0xf bank_mask:0xf
    v_mfma_f32_16x16x32_bf16 v[104:107], a[24:27], a[172:175], v[104:107]
    v_add_f32_dpp v115, v113, v102 wave_ror:1 row_mask:0xf bank_mask:0xf
    v_cvt_pk_bf16_f32 v116, v114, v115
    v_mfma_f32_16x16x32_bf16 v[104:107], a[28:31], a[168:171], v[104:107]
    ds_write_b16 v139, v116 offset:7168
    v_mfma_f32_16x16x32_bf16 v[104:107], a[32:35], a[164:167], v[104:107]
    ds_write_b16_d16_hi v139, v116 offset:7680
    v_mfma_f32_16x16x32_bf16 v[104:107], a[36:39], a[160:163], v[104:107]
    v_mfma_f32_16x16x32_bf16 v[104:107], a[40:43], a[156:159], v[104:107]
    v_mfma_f32_16x16x32_bf16 v[104:107], a[44:47], a[152:155], v[104:107]
    v_mfma_f32_16x16x32_bf16 v[104:107], a[48:51], a[148:151], v[104:107]
    v_mfma_f32_16x16x32_bf16 v[104:107], a[52:55], a[144:147], v[104:107]
    v_mfma_f32_16x16x32_bf16 v[104:107], a[56:59], a[140:143], v[104:107]
    v_mfma_f32_16x16x32_bf16 v[104:107], a[60:63], a[136:139], v[104:107]
    v_mfma_f32_16x16x32_bf16 v[104:107], a[64:67], a[132:135], v[104:107]
    v_mfma_f32_16x16x32_bf16 v[104:107], a[68:71], a[128:131], v[104:107]
    s_waitcnt lgkmcnt(10)
    v_mfma_f32_16x16x32_bf16 v[108:111], a[0:3], a[204:207], 0
    ds_read_b64_tr_b16 a[216:217], v137 offset:2832
    v_mfma_f32_16x16x32_bf16 v[108:111], a[4:7], a[200:203], v[108:111]
    ds_read_b64_tr_b16 a[218:219], v137 offset:2816
    v_mfma_f32_16x16x32_bf16 v[108:111], a[8:11], a[196:199], v[108:111]
    ds_read_b128 a[88:91], v138 offset:36224
    v_mfma_f32_16x16x32_bf16 v[108:111], a[12:15], a[192:195], v[108:111]
    ds_read_b64_tr_b16 a[220:221], v137 offset:2960
    v_cndmask_b32 v112, v105, v103, s[30:31]
    v_mfma_f32_16x16x32_bf16 v[108:111], a[16:19], a[188:191], v[108:111]
    ds_read_b64_tr_b16 a[222:223], v137 offset:2944
    v_cndmask_b32 v113, v107, v105, s[30:31]
    v_mfma_f32_16x16x32_bf16 v[108:111], a[20:23], a[184:187], v[108:111]
    ds_read_b128 a[92:95], v138 offset:36288
    v_add_f32_dpp v114, v112, v104 wave_ror:1 row_mask:0xf bank_mask:0xf
    v_mfma_f32_16x16x32_bf16 v[108:111], a[24:27], a[180:183], v[108:111]
    v_add_f32_dpp v115, v113, v106 wave_ror:1 row_mask:0xf bank_mask:0xf
    v_cvt_pk_bf16_f32 v116, v114, v115
    v_mfma_f32_16x16x32_bf16 v[108:111], a[28:31], a[176:179], v[108:111]
    ds_write_b16 v139, v116 offset:8192
    v_mfma_f32_16x16x32_bf16 v[108:111], a[32:35], a[172:175], v[108:111]
    ds_write_b16_d16_hi v139, v116 offset:8704
    v_mfma_f32_16x16x32_bf16 v[108:111], a[36:39], a[168:171], v[108:111]
    v_mfma_f32_16x16x32_bf16 v[108:111], a[40:43], a[164:167], v[108:111]
    v_mfma_f32_16x16x32_bf16 v[108:111], a[44:47], a[160:163], v[108:111]
    v_mfma_f32_16x16x32_bf16 v[108:111], a[48:51], a[156:159], v[108:111]
    v_mfma_f32_16x16x32_bf16 v[108:111], a[52:55], a[152:155], v[108:111]
    v_mfma_f32_16x16x32_bf16 v[108:111], a[56:59], a[148:151], v[108:111]
    v_mfma_f32_16x16x32_bf16 v[108:111], a[60:63], a[144:147], v[108:111]
    v_mfma_f32_16x16x32_bf16 v[108:111], a[64:67], a[140:143], v[108:111]
    v_mfma_f32_16x16x32_bf16 v[108:111], a[68:71], a[136:139], v[108:111]
    v_mfma_f32_16x16x32_bf16 v[108:111], a[72:75], a[132:135], v[108:111]
    v_mfma_f32_16x16x32_bf16 v[108:111], a[76:79], a[128:131], v[108:111]
    s_waitcnt lgkmcnt(10)
    v_mfma_f32_16x16x32_bf16 v[100:103], a[0:3], a[212:215], 0
    ds_read_b64_tr_b16 a[224:225], v137 offset:3088
    v_mfma_f32_16x16x32_bf16 v[100:103], a[4:7], a[208:211], v[100:103]
    ds_read_b64_tr_b16 a[226:227], v137 offset:3072
    v_mfma_f32_16x16x32_bf16 v[100:103], a[8:11], a[204:207], v[100:103]
    ds_read_b128 a[96:99], v138 offset:36352
    v_mfma_f32_16x16x32_bf16 v[100:103], a[12:15], a[200:203], v[100:103]
    ds_read_b64_tr_b16 a[228:229], v137 offset:3216
    v_cndmask_b32 v112, v109, v107, s[30:31]
    v_mfma_f32_16x16x32_bf16 v[100:103], a[16:19], a[196:199], v[100:103]
    ds_read_b64_tr_b16 a[230:231], v137 offset:3200
    v_cndmask_b32 v113, v111, v109, s[30:31]
    v_mfma_f32_16x16x32_bf16 v[100:103], a[20:23], a[192:195], v[100:103]
    ds_read_b128 a[100:103], v138 offset:36416
    v_add_f32_dpp v114, v112, v108 wave_ror:1 row_mask:0xf bank_mask:0xf
    v_mfma_f32_16x16x32_bf16 v[100:103], a[24:27], a[188:191], v[100:103]
    v_add_f32_dpp v115, v113, v110 wave_ror:1 row_mask:0xf bank_mask:0xf
    v_cvt_pk_bf16_f32 v116, v114, v115
    v_mfma_f32_16x16x32_bf16 v[100:103], a[28:31], a[184:187], v[100:103]
    ds_write_b16 v139, v116 offset:9216
    v_mfma_f32_16x16x32_bf16 v[100:103], a[32:35], a[180:183], v[100:103]
    ds_write_b16_d16_hi v139, v116 offset:9728
    v_mfma_f32_16x16x32_bf16 v[100:103], a[36:39], a[176:179], v[100:103]
    v_mfma_f32_16x16x32_bf16 v[100:103], a[40:43], a[172:175], v[100:103]
    v_mfma_f32_16x16x32_bf16 v[100:103], a[44:47], a[168:171], v[100:103]
    v_mfma_f32_16x16x32_bf16 v[100:103], a[48:51], a[164:167], v[100:103]
    v_mfma_f32_16x16x32_bf16 v[100:103], a[52:55], a[160:163], v[100:103]
    v_mfma_f32_16x16x32_bf16 v[100:103], a[56:59], a[156:159], v[100:103]
    v_mfma_f32_16x16x32_bf16 v[100:103], a[60:63], a[152:155], v[100:103]
    v_mfma_f32_16x16x32_bf16 v[100:103], a[64:67], a[148:151], v[100:103]
    v_mfma_f32_16x16x32_bf16 v[100:103], a[68:71], a[144:147], v[100:103]
    v_mfma_f32_16x16x32_bf16 v[100:103], a[72:75], a[140:143], v[100:103]
    v_mfma_f32_16x16x32_bf16 v[100:103], a[76:79], a[136:139], v[100:103]
    v_mfma_f32_16x16x32_bf16 v[100:103], a[80:83], a[132:135], v[100:103]
    v_mfma_f32_16x16x32_bf16 v[100:103], a[84:87], a[128:131], v[100:103]
    s_waitcnt lgkmcnt(10)
    v_mfma_f32_16x16x32_bf16 v[104:107], a[0:3], a[220:223], 0
    ds_read_b64_tr_b16 a[232:233], v137 offset:3344
    v_mfma_f32_16x16x32_bf16 v[104:107], a[4:7], a[216:219], v[104:107]
    ds_read_b64_tr_b16 a[234:235], v137 offset:3328
    v_mfma_f32_16x16x32_bf16 v[104:107], a[8:11], a[212:215], v[104:107]
    ds_read_b128 a[104:107], v138 offset:36480
    v_mfma_f32_16x16x32_bf16 v[104:107], a[12:15], a[208:211], v[104:107]
    ds_read_b64_tr_b16 a[236:237], v137 offset:3472
    v_cndmask_b32 v112, v101, v111, s[30:31]
    v_mfma_f32_16x16x32_bf16 v[104:107], a[16:19], a[204:207], v[104:107]
    ds_read_b64_tr_b16 a[238:239], v137 offset:3456
    v_cndmask_b32 v113, v103, v101, s[30:31]
    v_mfma_f32_16x16x32_bf16 v[104:107], a[20:23], a[200:203], v[104:107]
    ds_read_b128 a[108:111], v138 offset:36544
    v_add_f32_dpp v114, v112, v100 wave_ror:1 row_mask:0xf bank_mask:0xf
    v_mfma_f32_16x16x32_bf16 v[104:107], a[24:27], a[196:199], v[104:107]
    v_add_f32_dpp v115, v113, v102 wave_ror:1 row_mask:0xf bank_mask:0xf
    v_cvt_pk_bf16_f32 v116, v114, v115
    v_mfma_f32_16x16x32_bf16 v[104:107], a[28:31], a[192:195], v[104:107]
    ds_write_b16 v139, v116 offset:10240
    v_mfma_f32_16x16x32_bf16 v[104:107], a[32:35], a[188:191], v[104:107]
    ds_write_b16_d16_hi v139, v116 offset:10752
    v_mfma_f32_16x16x32_bf16 v[104:107], a[36:39], a[184:187], v[104:107]
    v_mfma_f32_16x16x32_bf16 v[104:107], a[40:43], a[180:183], v[104:107]
    v_mfma_f32_16x16x32_bf16 v[104:107], a[44:47], a[176:179], v[104:107]
    v_mfma_f32_16x16x32_bf16 v[104:107], a[48:51], a[172:175], v[104:107]
    v_mfma_f32_16x16x32_bf16 v[104:107], a[52:55], a[168:171], v[104:107]
    v_mfma_f32_16x16x32_bf16 v[104:107], a[56:59], a[164:167], v[104:107]
    v_mfma_f32_16x16x32_bf16 v[104:107], a[60:63], a[160:163], v[104:107]
    v_mfma_f32_16x16x32_bf16 v[104:107], a[64:67], a[156:159], v[104:107]
    v_mfma_f32_16x16x32_bf16 v[104:107], a[68:71], a[152:155], v[104:107]
    v_mfma_f32_16x16x32_bf16 v[104:107], a[72:75], a[148:151], v[104:107]
    v_mfma_f32_16x16x32_bf16 v[104:107], a[76:79], a[144:147], v[104:107]
    v_mfma_f32_16x16x32_bf16 v[104:107], a[80:83], a[140:143], v[104:107]
    v_mfma_f32_16x16x32_bf16 v[104:107], a[84:87], a[136:139], v[104:107]
    v_mfma_f32_16x16x32_bf16 v[104:107], a[88:91], a[132:135], v[104:107]
    v_mfma_f32_16x16x32_bf16 v[104:107], a[92:95], a[128:131], v[104:107]
    s_waitcnt lgkmcnt(10)
    v_mfma_f32_16x16x32_bf16 v[108:111], a[0:3], a[228:231], 0
    ds_read_b64_tr_b16 a[240:241], v137 offset:3600
    v_mfma_f32_16x16x32_bf16 v[108:111], a[4:7], a[224:227], v[108:111]
    ds_read_b64_tr_b16 a[242:243], v137 offset:3584
    v_mfma_f32_16x16x32_bf16 v[108:111], a[8:11], a[220:223], v[108:111]
    ds_read_b128 a[112:115], v138 offset:36608
    v_mfma_f32_16x16x32_bf16 v[108:111], a[12:15], a[216:219], v[108:111]
    ds_read_b64_tr_b16 a[244:245], v137 offset:3728
    v_cndmask_b32 v112, v105, v103, s[30:31]
    v_mfma_f32_16x16x32_bf16 v[108:111], a[16:19], a[212:215], v[108:111]
    ds_read_b64_tr_b16 a[246:247], v137 offset:3712
    v_cndmask_b32 v113, v107, v105, s[30:31]
    v_mfma_f32_16x16x32_bf16 v[108:111], a[20:23], a[208:211], v[108:111]
    ds_read_b128 a[116:119], v138 offset:36672
    v_add_f32_dpp v114, v112, v104 wave_ror:1 row_mask:0xf bank_mask:0xf
    v_mfma_f32_16x16x32_bf16 v[108:111], a[24:27], a[204:207], v[108:111]
    v_add_f32_dpp v115, v113, v106 wave_ror:1 row_mask:0xf bank_mask:0xf
    v_cvt_pk_bf16_f32 v116, v114, v115
    v_mfma_f32_16x16x32_bf16 v[108:111], a[28:31], a[200:203], v[108:111]
    ds_write_b16 v139, v116 offset:11264
    v_mfma_f32_16x16x32_bf16 v[108:111], a[32:35], a[196:199], v[108:111]
    ds_write_b16_d16_hi v139, v116 offset:11776
    v_mfma_f32_16x16x32_bf16 v[108:111], a[36:39], a[192:195], v[108:111]
    v_mfma_f32_16x16x32_bf16 v[108:111], a[40:43], a[188:191], v[108:111]
    v_mfma_f32_16x16x32_bf16 v[108:111], a[44:47], a[184:187], v[108:111]
    v_mfma_f32_16x16x32_bf16 v[108:111], a[48:51], a[180:183], v[108:111]
    v_mfma_f32_16x16x32_bf16 v[108:111], a[52:55], a[176:179], v[108:111]
    v_mfma_f32_16x16x32_bf16 v[108:111], a[56:59], a[172:175], v[108:111]
    v_mfma_f32_16x16x32_bf16 v[108:111], a[60:63], a[168:171], v[108:111]
    v_mfma_f32_16x16x32_bf16 v[108:111], a[64:67], a[164:167], v[108:111]
    v_mfma_f32_16x16x32_bf16 v[108:111], a[68:71], a[160:163], v[108:111]
    v_mfma_f32_16x16x32_bf16 v[108:111], a[72:75], a[156:159], v[108:111]
    v_mfma_f32_16x16x32_bf16 v[108:111], a[76:79], a[152:155], v[108:111]
    v_mfma_f32_16x16x32_bf16 v[108:111], a[80:83], a[148:151], v[108:111]
    v_mfma_f32_16x16x32_bf16 v[108:111], a[84:87], a[144:147], v[108:111]
    v_mfma_f32_16x16x32_bf16 v[108:111], a[88:91], a[140:143], v[108:111]
    v_mfma_f32_16x16x32_bf16 v[108:111], a[92:95], a[136:139], v[108:111]
    v_mfma_f32_16x16x32_bf16 v[108:111], a[96:99], a[132:135], v[108:111]
    v_mfma_f32_16x16x32_bf16 v[108:111], a[100:103], a[128:131], v[108:111]
    s_waitcnt lgkmcnt(10)
    v_mfma_f32_16x16x32_bf16 v[100:103], a[0:3], a[236:239], 0
    ds_read_b64_tr_b16 a[248:249], v137 offset:3856
    v_mfma_f32_16x16x32_bf16 v[100:103], a[4:7], a[232:235], v[100:103]
    ds_read_b64_tr_b16 a[250:251], v137 offset:3840
    v_mfma_f32_16x16x32_bf16 v[100:103], a[8:11], a[228:231], v[100:103]
    ds_read_b128 a[120:123], v138 offset:36736
    v_mfma_f32_16x16x32_bf16 v[100:103], a[12:15], a[224:227], v[100:103]
    ds_read_b64_tr_b16 a[252:253], v137 offset:3984
    v_cndmask_b32 v112, v109, v107, s[30:31]
    v_mfma_f32_16x16x32_bf16 v[100:103], a[16:19], a[220:223], v[100:103]
    ds_read_b64_tr_b16 a[254:255], v137 offset:3968
    v_cndmask_b32 v113, v111, v109, s[30:31]
    v_mfma_f32_16x16x32_bf16 v[100:103], a[20:23], a[216:219], v[100:103]
    ds_read_b128 a[124:127], v138 offset:36800
    v_add_f32_dpp v114, v112, v108 wave_ror:1 row_mask:0xf bank_mask:0xf
    v_mfma_f32_16x16x32_bf16 v[100:103], a[24:27], a[212:215], v[100:103]
    v_add_f32_dpp v115, v113, v110 wave_ror:1 row_mask:0xf bank_mask:0xf
    v_cvt_pk_bf16_f32 v116, v114, v115
    v_mfma_f32_16x16x32_bf16 v[100:103], a[28:31], a[208:211], v[100:103]
    ds_write_b16 v139, v116 offset:12288
    v_mfma_f32_16x16x32_bf16 v[100:103], a[32:35], a[204:207], v[100:103]
    ds_write_b16_d16_hi v139, v116 offset:12800
    v_mfma_f32_16x16x32_bf16 v[100:103], a[36:39], a[200:203], v[100:103]
    s_lshl_b32 s34, s28, 10
    v_subrev_u32 v145, s34, v140
    v_mfma_f32_16x16x32_bf16 v[100:103], a[40:43], a[196:199], v[100:103]
    s_add_u32 s35, s52, 131072
    s_sub_u32 s35, s35, s34
    v_mfma_f32_16x16x32_bf16 v[100:103], a[44:47], a[192:195], v[100:103]
    s_waitcnt lgkmcnt(0)
    v_mfma_f32_16x16x32_bf16 v[100:103], a[48:51], a[188:191], v[100:103]
    s_barrier
    v_mfma_f32_16x16x32_bf16 v[100:103], a[52:55], a[184:187], v[100:103]
    ds_read_b128 v[64:67], v145 offset:0
    v_mfma_f32_16x16x32_bf16 v[100:103], a[56:59], a[180:183], v[100:103]
    ds_read_b128 v[68:71], v145 offset:1024
    v_mfma_f32_16x16x32_bf16 v[100:103], a[60:63], a[176:179], v[100:103]
    ds_read_b128 v[72:75], v145 offset:2048
    v_mfma_f32_16x16x32_bf16 v[100:103], a[64:67], a[172:175], v[100:103]
    v_mfma_f32_16x16x32_bf16 v[100:103], a[68:71], a[168:171], v[100:103]
    v_mfma_f32_16x16x32_bf16 v[100:103], a[72:75], a[164:167], v[100:103]
    v_mfma_f32_16x16x32_bf16 v[100:103], a[76:79], a[160:163], v[100:103]
    v_mfma_f32_16x16x32_bf16 v[100:103], a[80:83], a[156:159], v[100:103]
    v_mfma_f32_16x16x32_bf16 v[100:103], a[84:87], a[152:155], v[100:103]
    v_mfma_f32_16x16x32_bf16 v[100:103], a[88:91], a[148:151], v[100:103]
    v_mfma_f32_16x16x32_bf16 v[100:103], a[92:95], a[144:147], v[100:103]
    v_mfma_f32_16x16x32_bf16 v[100:103], a[96:99], a[140:143], v[100:103]
    v_mfma_f32_16x16x32_bf16 v[100:103], a[100:103], a[136:139], v[100:103]
    v_mfma_f32_16x16x32_bf16 v[100:103], a[104:107], a[132:135], v[100:103]
    v_mfma_f32_16x16x32_bf16 v[100:103], a[108:111], a[128:131], v[100:103]
    v_mfma_f32_16x16x32_bf16 v[104:107], a[0:3], a[244:247], 0
    s_waitcnt lgkmcnt(2)
    v_mfma_f32_16x16x32_bf16 v[104:107], a[4:7], a[240:243], v[104:107]
    v_mfma_f32_16x16x32_bf16 v[104:107], a[8:11], a[236:239], v[104:107]
    buffer_store_dwordx4 v[64:67], v136, s[16:19], s35 offen offset:0 sc1
    v_mfma_f32_16x16x32_bf16 v[104:107], a[12:15], a[232:235], v[104:107]
    s_nop 1
    v_cndmask_b32 v112, v101, v111, s[30:31]
    v_cndmask_b32 v113, v103, v101, s[30:31]
    v_mfma_f32_16x16x32_bf16 v[104:107], a[16:19], a[228:231], v[104:107]
    v_add_f32_dpp v114, v112, v100 wave_ror:1 row_mask:0xf bank_mask:0xf
    v_add_f32_dpp v115, v113, v102 wave_ror:1 row_mask:0xf bank_mask:0xf
    v_mfma_f32_16x16x32_bf16 v[104:107], a[20:23], a[224:227], v[104:107]
    v_cvt_pk_bf16_f32 v116, v114, v115
    v_mfma_f32_16x16x32_bf16 v[104:107], a[24:27], a[220:223], v[104:107]
    ds_write_b16 v139, v116 offset:13312
    v_mfma_f32_16x16x32_bf16 v[104:107], a[28:31], a[216:219], v[104:107]
    ds_write_b16_d16_hi v139, v116 offset:13824
    v_mfma_f32_16x16x32_bf16 v[104:107], a[32:35], a[212:215], v[104:107]
    s_waitcnt lgkmcnt(3)
    v_mfma_f32_16x16x32_bf16 v[104:107], a[36:39], a[208:211], v[104:107]
    v_mfma_f32_16x16x32_bf16 v[104:107], a[40:43], a[204:207], v[104:107]
    buffer_store_dwordx4 v[68:71], v136, s[16:19], s35 offen offset:1024 sc1
    v_mfma_f32_16x16x32_bf16 v[104:107], a[44:47], a[200:203], v[104:107]
    s_waitcnt lgkmcnt(2)
    v_mfma_f32_16x16x32_bf16 v[104:107], a[48:51], a[196:199], v[104:107]
    buffer_store_dwordx4 v[72:75], v136, s[16:19], s35 offen offset:2048 sc1
    v_mfma_f32_16x16x32_bf16 v[104:107], a[52:55], a[192:195], v[104:107]
    v_add_u32 v145, s34, v136
    v_mfma_f32_16x16x32_bf16 v[104:107], a[56:59], a[188:191], v[104:107]
    s_lshl_b32 s34, s34, 1
    s_sub_u32 s35, s35, s34
    s_add_u32 s35, s35, 12288
    v_mfma_f32_16x16x32_bf16 v[104:107], a[60:63], a[184:187], v[104:107]
    v_mfma_f32_16x16x32_bf16 v[104:107], a[64:67], a[180:183], v[104:107]
    v_mfma_f32_16x16x32_bf16 v[104:107], a[68:71], a[176:179], v[104:107]
    v_mfma_f32_16x16x32_bf16 v[104:107], a[72:75], a[172:175], v[104:107]
    v_mfma_f32_16x16x32_bf16 v[104:107], a[76:79], a[168:171], v[104:107]
    v_mfma_f32_16x16x32_bf16 v[104:107], a[80:83], a[164:167], v[104:107]
    v_mfma_f32_16x16x32_bf16 v[104:107], a[84:87], a[160:163], v[104:107]
    v_mfma_f32_16x16x32_bf16 v[104:107], a[88:91], a[156:159], v[104:107]
    v_mfma_f32_16x16x32_bf16 v[104:107], a[92:95], a[152:155], v[104:107]
    v_mfma_f32_16x16x32_bf16 v[104:107], a[96:99], a[148:151], v[104:107]
    v_mfma_f32_16x16x32_bf16 v[104:107], a[100:103], a[144:147], v[104:107]
    v_mfma_f32_16x16x32_bf16 v[104:107], a[104:107], a[140:143], v[104:107]
    v_mfma_f32_16x16x32_bf16 v[104:107], a[108:111], a[136:139], v[104:107]
    v_mfma_f32_16x16x32_bf16 v[104:107], a[112:115], a[132:135], v[104:107]
    v_mfma_f32_16x16x32_bf16 v[104:107], a[116:119], a[128:131], v[104:107]
    v_mfma_f32_16x16x32_bf16 v[108:111], a[0:3], a[252:255], 0
    v_mfma_f32_16x16x32_bf16 v[108:111], a[4:7], a[248:251], v[108:111]
    v_mfma_f32_16x16x32_bf16 v[108:111], a[8:11], a[244:247], v[108:111]
    v_mfma_f32_16x16x32_bf16 v[108:111], a[12:15], a[240:243], v[108:111]
    s_nop 3
    v_cndmask_b32 v112, v105, v103, s[30:31]
    v_cndmask_b32 v113, v107, v105, s[30:31]
    v_mfma_f32_16x16x32_bf16 v[108:111], a[16:19], a[236:239], v[108:111]
    v_add_f32_dpp v114, v112, v104 wave_ror:1 row_mask:0xf bank_mask:0xf
    v_add_f32_dpp v115, v113, v106 wave_ror:1 row_mask:0xf bank_mask:0xf
    v_mfma_f32_16x16x32_bf16 v[108:111], a[20:23], a[232:235], v[108:111]
    v_cvt_pk_bf16_f32 v116, v114, v115
    v_mfma_f32_16x16x32_bf16 v[108:111], a[24:27], a[228:231], v[108:111]
    ds_write_b16 v139, v116 offset:14336
    v_mfma_f32_16x16x32_bf16 v[108:111], a[28:31], a[224:227], v[108:111]
    ds_write_b16_d16_hi v139, v116 offset:14848
    v_mfma_f32_16x16x32_bf16 v[108:111], a[32:35], a[220:223], v[108:111]
    v_mfma_f32_16x16x32_bf16 v[108:111], a[36:39], a[216:219], v[108:111]
    v_mfma_f32_16x16x32_bf16 v[108:111], a[40:43], a[212:215], v[108:111]
    v_mfma_f32_16x16x32_bf16 v[108:111], a[44:47], a[208:211], v[108:111]
    v_mfma_f32_16x16x32_bf16 v[108:111], a[48:51], a[204:207], v[108:111]
    v_mfma_f32_16x16x32_bf16 v[108:111], a[52:55], a[200:203], v[108:111]
    v_mfma_f32_16x16x32_bf16 v[108:111], a[56:59], a[196:199], v[108:111]
    v_mfma_f32_16x16x32_bf16 v[108:111], a[60:63], a[192:195], v[108:111]
    v_mfma_f32_16x16x32_bf16 v[108:111], a[64:67], a[188:191], v[108:111]
    v_mfma_f32_16x16x32_bf16 v[108:111], a[68:71], a[184:187], v[108:111]
    v_mfma_f32_16x16x32_bf16 v[108:111], a[72:75], a[180:183], v[108:111]
    v_mfma_f32_16x16x32_bf16 v[108:111], a[76:79], a[176:179], v[108:111]
    v_mfma_f32_16x16x32_bf16 v[108:111], a[80:83], a[172:175], v[108:111]
    v_mfma_f32_16x16x32_bf16 v[108:111], a[84:87], a[168:171], v[108:111]
    v_mfma_f32_16x16x32_bf16 v[108:111], a[88:91], a[164:167], v[108:111]
    v_mfma_f32_16x16x32_bf16 v[108:111], a[92:95], a[160:163], v[108:111]
    v_mfma_f32_16x16x32_bf16 v[108:111], a[96:99], a[156:159], v[108:111]
    v_mfma_f32_16x16x32_bf16 v[108:111], a[100:103], a[152:155], v[108:111]
    v_mfma_f32_16x16x32_bf16 v[108:111], a[104:107], a[148:151], v[108:111]
    v_mfma_f32_16x16x32_bf16 v[108:111], a[108:111], a[144:147], v[108:111]
    v_mfma_f32_16x16x32_bf16 v[108:111], a[112:115], a[140:143], v[108:111]
    v_mfma_f32_16x16x32_bf16 v[108:111], a[116:119], a[136:139], v[108:111]
    v_mfma_f32_16x16x32_bf16 v[108:111], a[120:123], a[132:135], v[108:111]
    v_mfma_f32_16x16x32_bf16 v[108:111], a[124:127], a[128:131], v[108:111]
    s_nop 7
    v_cndmask_b32 v112, v109, v107, s[30:31]
    v_cndmask_b32 v113, v111, v109, s[30:31]
    s_nop 0
    v_add_f32_dpp v114, v112, v108 wave_ror:1 row_mask:0xf bank_mask:0xf
    v_add_f32_dpp v115, v113, v110 wave_ror:1 row_mask:0xf bank_mask:0xf
    v_cvt_pk_bf16_f32 v116, v114, v115
    ds_write_b16 v139, v116 offset:15360
    ds_write_b16_d16_hi v139, v116 offset:15872
    s_waitcnt lgkmcnt(0)
    s_barrier
    ds_read_b128 v[76:79], v145 offset:12288
    s_waitcnt lgkmcnt(0)
    buffer_store_dwordx4 v[76:79], v136, s[16:19], s35 offen sc1
L_aux_done:
    s_endpgm
L_hs_slow:
    s_mov_b32 s59, 0
L_hs_spin:
    s_sleep 8
    buffer_load_dword v5, v4, s[24:27], 0 offen sc1
    s_waitcnt vmcnt(0)
    v_cmp_gt_u32 vcc, v6, v5
    s_nop 0
    s_cbranch_vccz L_hs_ok
    s_add_u32 s59, s59, 1
    s_cmp_lt_u32 s59, 131072
    s_cbranch_scc1 L_hs_spin
    s_branch L_hs_ok
L_rare_helper:
    ds_read_b64_tr_b16 v[168:169], v5 offset:0
    ds_read_b64_tr_b16 v[170:171], v5 offset:4736
    ds_read_b64_tr_b16 v[172:173], v5 offset:32
    ds_read_b64_tr_b16 v[174:175], v5 offset:4768
    ds_read_b64_tr_b16 v[176:177], v5 offset:64
    ds_read_b64_tr_b16 v[178:179], v5 offset:4800
    ds_read_b64_tr_b16 v[180:181], v5 offset:96
    ds_read_b64_tr_b16 v[182:183], v5 offset:4832
    ds_read_b64_tr_b16 v[184:185], v5 offset:128
    ds_read_b64_tr_b16 v[186:187], v5 offset:4864
    ds_read_b64_tr_b16 v[188:189], v5 offset:160
    ds_read_b64_tr_b16 v[190:191], v5 offset:4896
    ds_read_b64_tr_b16 v[192:193], v5 offset:192
    ds_read_b64_tr_b16 v[194:195], v5 offset:4928
    ds_read_b64_tr_b16 v[196:197], v5 offset:224
    ds_read_b64_tr_b16 v[198:199], v5 offset:4960
    ds_read_b64_tr_b16 v[200:201], v5 offset:256
    ds_read_b64_tr_b16 v[202:203], v5 offset:4992
    s_waitcnt lgkmcnt(0)
    buffer_store_dwordx4 v[168:171], v252, s[16:19], s55 offen sc1
    s_add_u32 s55, s55, 65536
    buffer_store_dwordx4 v[172:175], v252, s[16:19], s55 offen sc1
    s_add_u32 s55, s55, 65536
    buffer_store_dwordx4 v[176:179], v252, s[16:19], s55 offen sc1
    s_add_u32 s55, s55, 65536
    buffer_store_dwordx4 v[180:183], v252, s[16:19], s55 offen sc1
    s_add_u32 s55, s55, 65536
    buffer_store_dwordx4 v[184:187], v252, s[16:19], s55 offen sc1
    s_add_u32 s55, s55, 65536
    buffer_store_dwordx4 v[188:191], v252, s[16:19], s55 offen sc1
    s_add_u32 s55, s55, 65536
    buffer_store_dwordx4 v[192:195], v252, s[16:19], s55 offen sc1
    s_add_u32 s55, s55, 65536
    buffer_store_dwordx4 v[196:199], v252, s[16:19], s55 offen sc1
    s_add_u32 s55, s55, 65536
    buffer_store_dwordx4 v[200:203], v252, s[16:19], s55 offen sc1
    s_waitcnt vmcnt(0)
    s_barrier
    v_lshlrev_b32 v12, 2, v0
    v_and_b32 v12, 0x300, v12
    v_mov_b32 v13, 2
    buffer_store_dword v13, v12, s[24:27], s49 offen sc1
    s_cmp_eq_u32 s3, 30
    s_cbranch_scc0 L_hlp_x
    v_accvgpr_read_b32 v64, a96
    v_accvgpr_read_b32 v65, a97
    v_accvgpr_read_b32 v66, a98
    v_accvgpr_read_b32 v67, a99
    v_accvgpr_read_b32 v68, a100
    v_accvgpr_read_b32 v69, a101
    v_accvgpr_read_b32 v70, a102
    v_accvgpr_read_b32 v71, a103
    v_accvgpr_read_b32 v72, a104
    v_accvgpr_read_b32 v73, a105
    v_accvgpr_read_b32 v74, a106
    v_accvgpr_read_b32 v75, a107
    v_accvgpr_read_b32 v76, a108
    v_accvgpr_read_b32 v77, a109
    v_accvgpr_read_b32 v78, a110
    v_accvgpr_read_b32 v79, a111
    v_accvgpr_read_b32 v80, a112
    v_accvgpr_read_b32 v81, a113
    v_accvgpr_read_b32 v82, a114
    v_accvgpr_read_b32 v83, a115
    v_accvgpr_read_b32 v84, a116
    v_accvgpr_read_b32 v85, a117
    v_accvgpr_read_b32 v86, a118
    v_accvgpr_read_b32 v87, a119
    v_accvgpr_read_b32 v88, a120
    v_accvgpr_read_b32 v89, a121
    v_accvgpr_read_b32 v90, a122
    v_accvgpr_read_b32 v91, a123
    v_accvgpr_read_b32 v92, a124
    v_accvgpr_read_b32 v93, a125
    v_accvgpr_read_b32 v94, a126
    v_accvgpr_read_b32 v95, a127
    v_accvgpr_read_b32 v96, a128
    v_accvgpr_read_b32 v97, a129
    v_accvgpr_read_b32 v98, a130
    v_accvgpr_read_b32 v99, a131
    v_accvgpr_read_b32 v100, a132
    v_accvgpr_read_b32 v101, a133
    v_accvgpr_read_b32 v102, a134
    v_accvgpr_read_b32 v103, a135
    v_accvgpr_read_b32 v104, a136
    v_accvgpr_read_b32 v105, a137
    v_accvgpr_read_b32 v106, a138
    v_accvgpr_read_b32 v107, a139
    v_accvgpr_read_b32 v108, a140
    v_accvgpr_read_b32 v109, a141
    v_accvgpr_read_b32 v110, a142
    v_accvgpr_read_b32 v111, a143
    v_accvgpr_read_b32 v112, a144
    v_accvgpr_read_b32 v113, a145
    v_accvgpr_read_b32 v114, a146
    v_accvgpr_read_b32 v115, a147
    v_accvgpr_read_b32 v116, a148
    v_accvgpr_read_b32 v117, a149
    v_accvgpr_read_b32 v118, a150
    v_accvgpr_read_b32 v119, a151
    v_accvgpr_read_b32 v120, a152
    v_accvgpr_read_b32 v121, a153
    v_accvgpr_read_b32 v122, a154
    v_accvgpr_read_b32 v123, a155
    v_accvgpr_read_b32 v124, a156
    v_accvgpr_read_b32 v125, a157
    v_accvgpr_read_b32 v126, a158
    v_accvgpr_read_b32 v127, a159
    v_accvgpr_read_b32 v128, a160
    v_accvgpr_read_b32 v129, a161
    v_accvgpr_read_b32 v130, a162
    v_accvgpr_read_b32 v131, a163
    v_accvgpr_read_b32 v132, a164
    v_accvgpr_read_b32 v133, a165
    v_accvgpr_read_b32 v134, a166
    v_accvgpr_read_b32 v135, a167
    s_mov_b32 s34, 0x00003f80
    s_mov_b32 s35, 0x3f800000
    v_dot2_f32_bf16 v56, v64, s34, 0
    v_dot2_f32_bf16 v57, v64, s35, 0
    v_dot2_f32_bf16 v58, v65, s34, 0
    v_dot2_f32_bf16 v59, v65, s35, 0
    v_dot2_f32_bf16 v60, v66, s34, 0
    v_dot2_f32_bf16 v61, v66, s35, 0
    v_dot2_f32_bf16 v62, v67, s34, 0
    v_dot2_f32_bf16 v63, v67, s35, 0
    v_dot2_f32_bf16 v56, v68, s34, v56
    v_dot2_f32_bf16 v57, v68, s35, v57
    v_dot2_f32_bf16 v58, v69, s34, v58
    v_dot2_f32_bf16 v59, v69, s35, v59
    v_dot2_f32_bf16 v60, v70, s34, v60
    v_dot2_f32_bf16 v61, v70, s35, v61
    v_dot2_f32_bf16 v62, v71, s34, v62
    v_dot2_f32_bf16 v63, v71, s35, v63
    v_dot2_f32_bf16 v56, v72, s34, v56
    v_dot2_f32_bf16 v57, v72, s35, v57
    v_dot2_f32_bf16 v58, v73, s34, v58
    v_dot2_f32_bf16 v59, v73, s35, v59
    v_dot2_f32_bf16 v60, v74, s34, v60
    v_dot2_f32_bf16 v61, v74, s35, v61
    v_dot2_f32_bf16 v62, v75, s34, v62
    v_dot2_f32_bf16 v63, v75, s35, v63
    v_dot2_f32_bf16 v56, v76, s34, v56
    v_dot2_f32_bf16 v57, v76, s35, v57
    v_dot2_f32_bf16 v58, v77, s34, v58
    v_dot2_f32_bf16 v59, v77, s35, v59
    v_dot2_f32_bf16 v60, v78, s34, v60
    v_dot2_f32_bf16 v61, v78, s35, v61
    v_dot2_f32_bf16 v62, v79, s34, v62
    v_dot2_f32_bf16 v63, v79, s35, v63
    v_dot2_f32_bf16 v56, v80, s34, v56
    v_dot2_f32_bf16 v57, v80, s35, v57
    v_dot2_f32_bf16 v58, v81, s34, v58
    v_dot2_f32_bf16 v59, v81, s35, v59
    v_dot2_f32_bf16 v60, v82, s34, v60
    v_dot2_f32_bf16 v61, v82, s35, v61
    v_dot2_f32_bf16 v62, v83, s34, v62
    v_dot2_f32_bf16 v63, v83, s35, v63
    v_dot2_f32_bf16 v56, v84, s34, v56
    v_dot2_f32_bf16 v57, v84, s35, v57
    v_dot2_f32_bf16 v58, v85, s34, v58
    v_dot2_f32_bf16 v59, v85, s35, v59
    v_dot2_f32_bf16 v60, v86, s34, v60
    v_dot2_f32_bf16 v61, v86, s35, v61
    v_dot2_f32_bf16 v62, v87, s34, v62
    v_dot2_f32_bf16 v63, v87, s35, v63
    v_dot2_f32_bf16 v56, v88, s34, v56
    v_dot2_f32_bf16 v57, v88, s35, v57
    v_dot2_f32_bf16 v58, v89, s34, v58
    v_dot2_f32_bf16 v59, v89, s35, v59
    v_dot2_f32_bf16 v60, v90, s34, v60
    v_dot2_f32_bf16 v61, v90, s35, v61
    v_dot2_f32_bf16 v62, v91, s34, v62
    v_dot2_f32_bf16 v63, v91, s35, v63
    v_dot2_f32_bf16 v56, v92, s34, v56
    v_dot2_f32_bf16 v57, v92, s35, v57
    v_dot2_f32_bf16 v58, v93, s34, v58
    v_dot2_f32_bf16 v59, v93, s35, v59
    v_dot2_f32_bf16 v60, v94, s34, v60
    v_dot2_f32_bf16 v61, v94, s35, v61
    v_dot2_f32_bf16 v62, v95, s34, v62
    v_dot2_f32_bf16 v63, v95, s35, v63
    v_dot2_f32_bf16 v56, v96, s34, v56
    v_dot2_f32_bf16 v57, v96, s35, v57
    v_dot2_f32_bf16 v58, v97, s34, v58
    v_dot2_f32_bf16 v59, v97, s35, v59
    v_dot2_f32_bf16 v60, v98, s34, v60
    v_dot2_f32_bf16 v61, v98, s35, v61
    v_dot2_f32_bf16 v62, v99, s34, v62
    v_dot2_f32_bf16 v63, v99, s35, v63
    v_dot2_f32_bf16 v56, v100, s34, v56
    v_dot2_f32_bf16 v57, v100, s35, v57
    v_dot2_f32_bf16 v58, v101, s34, v58
    v_dot2_f32_bf16 v59, v101, s35, v59
    v_dot2_f32_bf16 v60, v102, s34, v60
    v_dot2_f32_bf16 v61, v102, s35, v61
    v_dot2_f32_bf16 v62, v103, s34, v62
    v_dot2_f32_bf16 v63, v103, s35, v63
    v_dot2_f32_bf16 v56, v104, s34, v56
    v_dot2_f32_bf16 v57, v104, s35, v57
    v_dot2_f32_bf16 v58, v105, s34, v58
    v_dot2_f32_bf16 v59, v105, s35, v59
    v_dot2_f32_bf16 v60, v106, s34, v60
    v_dot2_f32_bf16 v61, v106, s35, v61
    v_dot2_f32_bf16 v62, v107, s34, v62
    v_dot2_f32_bf16 v63, v107, s35, v63
    v_dot2_f32_bf16 v56, v108, s34, v56
    v_dot2_f32_bf16 v57, v108, s35, v57
    v_dot2_f32_bf16 v58, v109, s34, v58
    v_dot2_f32_bf16 v59, v109, s35, v59
    v_dot2_f32_bf16 v60, v110, s34, v60
    v_dot2_f32_bf16 v61, v110, s35, v61
    v_dot2_f32_bf16 v62, v111, s34, v62
    v_dot2_f32_bf16 v63, v111, s35, v63
    v_dot2_f32_bf16 v56, v112, s34, v56
    v_dot2_f32_bf16 v57, v112, s35, v57
    v_dot2_f32_bf16 v58, v113, s34, v58
    v_dot2_f32_bf16 v59, v113, s35, v59
    v_dot2_f32_bf16 v60, v114, s34, v60
    v_dot2_f32_bf16 v61, v114, s35, v61
    v_dot2_f32_bf16 v62, v115, s34, v62
    v_dot2_f32_bf16 v63, v115, s35, v63
    v_dot2_f32_bf16 v56, v116, s34, v56
    v_dot2_f32_bf16 v57, v116, s35, v57
    v_dot2_f32_bf16 v58, v117, s34, v58
    v_dot2_f32_bf16 v59, v117, s35, v59
    v_dot2_f32_bf16 v60, v118, s34, v60
    v_dot2_f32_bf16 v61, v118, s35, v61
    v_dot2_f32_bf16 v62, v119, s34, v62
    v_dot2_f32_bf16 v63, v119, s35, v63
    v_dot2_f32_bf16 v56, v120, s34, v56
    v_dot2_f32_bf16 v57, v120, s35, v57
    v_dot2_f32_bf16 v58, v121, s34, v58
    v_dot2_f32_bf16 v59, v121, s35, v59
    v_dot2_f32_bf16 v60, v122, s34, v60
    v_dot2_f32_bf16 v61, v122, s35, v61
    v_dot2_f32_bf16 v62, v123, s34, v62
    v_dot2_f32_bf16 v63, v123, s35, v63
    v_dot2_f32_bf16 v56, v124, s34, v56
    v_dot2_f32_bf16 v57, v124, s35, v57
    v_dot2_f32_bf16 v58, v125, s34, v58
    v_dot2_f32_bf16 v59, v125, s35, v59
    v_dot2_f32_bf16 v60, v126, s34, v60
    v_dot2_f32_bf16 v61, v126, s35, v61
    v_dot2_f32_bf16 v62, v127, s34, v62
    v_dot2_f32_bf16 v63, v127, s35, v63
    v_dot2_f32_bf16 v56, v128, s34, v56
    v_dot2_f32_bf16 v57, v128, s35, v57
    v_dot2_f32_bf16 v58, v129, s34, v58
    v_dot2_f32_bf16 v59, v129, s35, v59
    v_dot2_f32_bf16 v60, v130, s34, v60
    v_dot2_f32_bf16 v61, v130, s35, v61
    v_dot2_f32_bf16 v62, v131, s34, v62
    v_dot2_f32_bf16 v63, v131, s35, v63
    v_dot2_f32_bf16 v56, v132, s34, v56
    v_dot2_f32_bf16 v57, v132, s35, v57
    v_dot2_f32_bf16 v58, v133, s34, v58
    v_dot2_f32_bf16 v59, v133, s35, v59
    v_dot2_f32_bf16 v60, v134, s34, v60
    v_dot2_f32_bf16 v61, v134, s35, v61
    v_dot2_f32_bf16 v62, v135, s34, v62
    v_dot2_f32_bf16 v63, v135, s35, v63
    s_lshl_b32 s34, s28, 11
    s_add_u32 s34, s34, 124416
    v_add_u32 v5, s34, v15
    ds_write_b128 v5, v[56:59]
    ds_write_b128 v5, v[60:63] offset:16
    s_mov_b64 exec, 0xffff
    v_lshl_add_u32 v14, v1, 4, s34
    ds_read_b128 v[64:67], v14 offset:0
    ds_read_b128 v[68:71], v14 offset:256
    ds_read_b128 v[72:75], v14 offset:512
    ds_read_b128 v[76:79], v14 offset:768
    ds_read_b128 v[80:83], v14 offset:1024
    ds_read_b128 v[84:87], v14 offset:1280
    ds_read_b128 v[88:91], v14 offset:1536
    ds_read_b128 v[92:95], v14 offset:1792
    s_waitcnt lgkmcnt(6)
    v_pk_add_f32 v[64:65], v[64:65], v[68:69]
    v_pk_add_f32 v[66:67], v[66:67], v[70:71]
    s_waitcnt lgkmcnt(5)
    v_pk_add_f32 v[64:65], v[64:65], v[72:73]
    v_pk_add_f32 v[66:67], v[66:67], v[74:75]
    s_waitcnt lgkmcnt(4)
    v_pk_add_f32 v[64:65], v[64:65], v[76:77]
    v_pk_add_f32 v[66:67], v[66:67], v[78:79]
    s_waitcnt lgkmcnt(3)
    v_pk_add_f32 v[64:65], v[64:65], v[80:81]
    v_pk_add_f32 v[66:67], v[66:67], v[82:83]
    s_waitcnt lgkmcnt(2)
    v_pk_add_f32 v[64:65], v[64:65], v[84:85]
    v_pk_add_f32 v[66:67], v[66:67], v[86:87]
    s_waitcnt lgkmcnt(1)
    v_pk_add_f32 v[64:65], v[64:65], v[88:89]
    v_pk_add_f32 v[66:67], v[66:67], v[90:91]
    s_waitcnt lgkmcnt(0)
    v_pk_add_f32 v[64:65], v[64:65], v[92:93]
    v_pk_add_f32 v[66:67], v[66:67], v[94:95]
    ds_write_b128 v14, v[64:67]
    s_mov_b64 exec, -1
    s_waitcnt lgkmcnt(0)
    s_barrier
    s_mov_b64 exec, 0xffff
    v_lshlrev_b32 v14, 4, v1
    v_add_u32 v14, 124416, v14
    ds_read_b128 v[16:19], v14 offset:0
    ds_read_b128 v[20:23], v14 offset:2048
    ds_read_b128 v[24:27], v14 offset:4096
    ds_read_b128 v[28:31], v14 offset:6144
    s_lshl_b32 s34, s63, 8
    s_add_u32 s34, s34, 32768
    v_lshlrev_b32 v12, 4, v1
    v_lshl_add_u32 v12, s28, 30, v12
    s_waitcnt lgkmcnt(0)
    v_pk_add_f32 v[16:17], v[16:17], v[20:21]
    v_pk_add_f32 v[18:19], v[18:19], v[22:23]
    v_pk_add_f32 v[24:25], v[24:25], v[28:29]
    v_pk_add_f32 v[26:27], v[26:27], v[30:31]
    v_pk_add_f32 v[16:17], v[16:17], v[24:25]
    v_pk_add_f32 v[18:19], v[18:19], v[26:27]
    buffer_store_dwordx4 v[16:19], v12, s[16:19], s34 offen sc1
    s_mov_b64 exec, 4
    v_lshlrev_b32 v12, 2, v0
    v_and_b32 v12, 0x300, v12
    v_mov_b32 v13, 3
    s_waitcnt vmcnt(0)
    buffer_store_dword v167, v166, s[16:19], 0 offen sc1
    buffer_store_dword v13, v12, s[24:27], s49 offen sc1
    s_mov_b64 exec, -1
L_hlp_x:
    v_mov_b32 v8, -1
    v_mov_b32 v9, -1
    v_mov_b32 v10, -1
    v_mov_b32 v11, -1
    v_lshlrev_b32 v7, 4, v1
    s_sub_u32 s35, s29, 48
    s_lshl_b32 s34, s35, 10
    s_mul_i32 s50, s28, 589824
    s_add_u32 s34, s34, s50
    s_add_u32 s34, s34, 2424832
    s_cmp_eq_u32 s3, 30
    s_cselect_b32 s50, 8, 0
    s_cselect_b32 s52, 0, 8
    s_lshl_b32 s51, s50, 14
    s_add_u32 s34, s34, s51
L_sentq:
    buffer_store_dwordx4 v[8:11], v7, s[16:19], s34 offen sc1
    s_cmp_lt_u32 s50, s52
    s_cbranch_scc0 L_sentq1
    s_sub_u32 s51, s34, 8192
    buffer_store_dwordx4 v[8:11], v7, s[16:19], s51 offen sc1
L_sentq1:
    s_add_u32 s34, s34, 16384
    s_add_u32 s50, s50, 1
    s_cmp_lt_u32 s50, 36
    s_cbranch_scc1 L_sentq
    s_waitcnt vmcnt(0)
    s_barrier
    v_lshlrev_b32 v12, 2, v0
    v_and_b32 v12, 0x300, v12
    v_mov_b32 v13, 4
    buffer_store_dword v13, v12, s[24:27], s49 offen sc1
    s_mul_i32 s34, s35, 589824
    s_mul_i32 s50, s28, 3072
    s_add_u32 s34, s34, s50
    s_add_u32 s34, s34, 23658496
    s_mov_b32 s50, 0
L_sent:
    s_and_b32 s51, s50, 3
    s_bfe_u32 s52, s50, 0x20002
    s_cmp_eq_u32 s51, s52
    s_cbranch_scc1 L_sent_skip
    buffer_store_dwordx4 v[8:11], v7, s[16:19], s34 offen sc1
    buffer_store_dwordx4 v[8:11], v7, s[16:19], s34 offen offset:1024 sc1
    buffer_store_dwordx4 v[8:11], v7, s[16:19], s34 offen offset:2048 sc1
L_sent_skip:
    s_add_u32 s34, s34, 12288
    s_add_u32 s50, s50, 1
    s_cmp_lt_u32 s50, 48
    s_cbranch_scc1 L_sent
L_sent_done:
    v_lshlrev_b32 v4, 2, v0
    v_cmp_gt_u32 vcc, 48, v1
    s_nop 1
    v_cndmask_b32 v6, 4, 1, vcc
    buffer_load_dword v5, v4, s[24:27], 0 offen sc1
    s_waitcnt vmcnt(0)
    v_cmp_gt_u32 vcc, v6, v5
    s_nop 0
    s_and_b64 vcc, vcc, s[100:101]
    s_cbranch_vccnz L_hs_slow
L_hs_ok:
    s_waitcnt vmcnt(0)
    s_barrier
    s_cmp_eq_u32 s28, 0
    s_cbranch_scc0 L_aux_done
    v_lshrrev_b32 v4, 4, v1
    v_and_b32 v5, 15, v1
    v_lshlrev_b32 v4, 7, v4
    v_lshl_add_u32 v4, v5, 2, v4
    v_mov_b32 v5, 1
    s_mul_i32 s34, s35, 384
    s_add_u32 s34, s34, 8192
    s_lshr_b64 exec, -1, 16
    buffer_store_dword v5, v4, s[16:19], s34 offen sc1
    s_mov_b64 exec, -1
    s_branch L_aux_done
L_pu_slow:
    s_mov_b32 s59, 0
L_pu_spin:
    s_sleep 8
    buffer_load_dword v144, v143, s[24:27], 0 offen sc1
    s_waitcnt vmcnt(0)
    v_cmp_gt_u32 vcc, 2, v144
    s_nop 0
    s_cbranch_vccz L_pu_ok
    s_add_u32 s59, s59, 1
    s_cmp_lt_u32 s59, 131072
    s_cbranch_scc1 L_pu_spin
    s_branch L_pu_ok
L_pk_slow:
    s_mov_b32 s59, 0
L_pk_spin:
    s_sleep 8
    buffer_load_dword v144, v143, s[24:27], s53 offen sc1
    s_waitcnt vmcnt(0)
    v_cmp_gt_u32 vcc, 4, v144
    s_nop 0
    s_cbranch_vccz L_pk_ok
    s_add_u32 s59, s59, 1
    s_cmp_lt_u32 s59, 131072
    s_cbranch_scc1 L_pk_spin
    s_branch L_pk_ok
L_end:
    s_endpgm
.section .rodata,"a"
.p2align 6
.amdhsa_kernel parallel_sum__ssm_conv_s4d__dense_activation_relu__prompt_kernel
  .amdhsa_next_free_vgpr 512
  .amdhsa_next_free_sgpr 102
  .amdhsa_accum_offset 256
  .amdhsa_group_segment_fixed_size 0
  .amdhsa_kernarg_size 104
  .amdhsa_user_sgpr_count 2
  .amdhsa_user_sgpr_kernarg_segment_ptr 1
  .amdhsa_system_sgpr_workgroup_id_x 1
  .amdhsa_float_denorm_mode_32 3
.end_amdhsa_kernel
```
